```python
import torch

def _softmax(x, axis=-1):
    return torch.softmax(x, dim=axis)
def _gelu(x):
    return torch.nn.functional.gelu(x, approximate="tanh")
def _silu(x):
    return torch.nn.functional.silu(x)
def _sigmoid(x):
    return torch.sigmoid(x)
def _layernorm(x, axis=-1, eps=1e-5):
    m = x.mean(dim=axis, keepdim=True)
    v = x.var(dim=axis, keepdim=True, unbiased=False)
    return (x - m) / torch.sqrt(v + eps)
def _scatter_add(tgt, idx, src, axis=0):
    return tgt.clone().index_add_(axis, idx, src)
def _segment_sum(src, seg, n):
    out = torch.zeros((n,) + src.shape[1:], dtype=src.dtype)
    return out.index_add_(0, seg, src)
def _pad(x, pw):
    flat = tuple(v for pair in reversed(pw) for v in pair)
    return torch.nn.functional.pad(x, flat)

kernel_name = 'concat_heads__ssm_conv_h3__compressed_kv_cla__prompt'

def setup_inputs():

    _w = (lambda a: (lambda t: t.to(torch.bfloat16) if t.is_floating_point() else t)(torch.as_tensor(a)))
    def _A_setup():
        B, S, D = 1, 2048, 512
        ks = 4
        return {
            "q": _w((lambda *s: torch.randn(*s, dtype=torch.bfloat16) * 0.05)(B, S, D)),
            "k": _w((lambda *s: torch.randn(*s, dtype=torch.bfloat16) * 0.1)(B, S, D)),
            "v": _w((lambda *s: torch.randn(*s, dtype=torch.bfloat16) * 0.1)(B, S, D)),
            "shift_k": _w((lambda *s: torch.randn(*s, dtype=torch.bfloat16) * 0.1)(D, ks) * 0.5),
            "ssm_k": _w((lambda *s: torch.randn(*s, dtype=torch.bfloat16) * 0.1)(D, S) * (1.0 / S ** 0.5)),
            "ssm_D": _w((lambda *s: torch.randn(*s, dtype=torch.bfloat16) * 0.1)(D)),
        }
    _A_in = _A_setup()

    def _B_setup():
        B, H, Sq, Sk, D, M = 1, 32, 2048, 2048, 128, 512
        Dc = 4 * D
        return {
            "x": _w((lambda *s: torch.randn(*s, dtype=torch.bfloat16) * 3.2)(B, Sq, M)),
            "c_kv": _w((lambda *s: torch.randn(*s, dtype=torch.bfloat16) * 0.05)(B, Sk, Dc)),
            "w_q": _w((lambda *s: torch.randn(*s, dtype=torch.bfloat16) * 3.2)(M, H, D) * (M ** -0.5)),
            "w_uk": _w((lambda *s: torch.randn(*s, dtype=torch.bfloat16) * 3.2)(Dc, H, D) * (Dc ** -0.5)),
            "w_uv": _w((lambda *s: torch.randn(*s, dtype=torch.bfloat16) * 0.05)(Dc, H, D) * (Dc ** -0.5)),
            "w_o": _w((lambda *s: torch.randn(*s, dtype=torch.bfloat16) * 0.05)(H, D, M) * ((H * D) ** -0.5)),
        }
    _B_in = _B_setup()

    return {
        "A_q": _A_in["q"],
        "A_k": _A_in["k"],
        "A_v": _A_in["v"],
        "A_shift_k": _A_in["shift_k"],
        "A_ssm_k": _A_in["ssm_k"],
        "A_ssm_D": _A_in["ssm_D"],
        "B_x": _B_in["x"],
        "B_c_kv": _B_in["c_kv"],
        "B_w_q": _B_in["w_q"],
        "B_w_uk": _B_in["w_uk"],
        "B_w_uv": _B_in["w_uv"],
        "B_w_o": _B_in["w_o"],
    }

def reference(A_q, A_k, A_v, A_shift_k, A_ssm_k, A_ssm_D, B_x, B_c_kv, B_w_q, B_w_uk, B_w_uv, B_w_o):
    def _A_ref(q, k, v, shift_k, ssm_k, ssm_D):
        B, S, D = q.shape
        ks = shift_k.shape[-1]
        k_pad = _pad(k, ((0, 0), (ks - 1, 0), (0, 0)))
        k_shift = torch.zeros_like(k)
        for t in range(ks):
            k_shift = k_shift + k_pad[:, t:t + S, :] * shift_k[:, ks - 1 - t][None, None, :]
        kv = k_shift * v
        L = 2 * S
        kv_pad = _pad(kv, ((0, 0), (0, S), (0, 0)))
        kf_pad = _pad(ssm_k, ((0, 0), (0, S)))
        kv_f = (lambda x, axes=(-2,-1): torch.fft.rfft2(x.float(), dim=axes))(kv_pad[:, None, :, :], axes=(1, 2))
        kf_f = (lambda x, axes=(-2,-1): torch.fft.rfft2(x.float(), dim=axes))(kf_pad[:, None, :], axes=(1, 2))
        kf_f = (lambda x, *d: x.permute(*d))(kf_f, 1, 2, 0)
        y_f = kv_f * kf_f[None, :, :, :]
        y = (lambda x, s, axes=(-2,-1): torch.fft.irfft2(x, s=s, dim=axes).to(torch.bfloat16))(y_f, (1, L), axes=(1, 2))[:, 0, :S, :]
        y = y + kv * ssm_D[None, None, :]
        return q * y

    def _B_ref(x, c_kv, w_q, w_uk, w_uv, w_o):
        B, Sq, M = x.shape[0], x.shape[1], x.shape[2]
        Sk = c_kv.shape[1]
        H, D = w_q.shape[1], w_q.shape[2]
        q = torch.einsum("bqm,mhd->bhqd", x, w_q)
        k = torch.einsum("bkc,chd->bhkd", c_kv, w_uk)
        v = torch.einsum("bkc,chd->bhkd", c_kv, w_uv)
        scores = torch.einsum("bhqd,bhkd->bhqk", q, k) * (D ** -0.5)
        off = Sk - Sq
        qi = torch.arange(Sq)[:, None]
        kj = torch.arange(Sk)[None, :]
        cmask = kj <= (qi + off)
        scores = torch.where(cmask[None, None], scores, -1e9)
        p = _softmax(scores, axis=-1)
        ctx = torch.einsum("bhqk,bhkd->bhqd", p, v)
        return torch.einsum("bhqd,hdm->bqm", ctx, w_o)

    a = _A_ref(A_q, A_k, A_v, A_shift_k, A_ssm_k, A_ssm_D)
    b = _B_ref(B_x, B_c_kv, B_w_q, B_w_uk, B_w_uv, B_w_o)
    return torch.concatenate([a, b], axis=-1)
```

```asm
; @launch grid=(256,1,1) block=(256,1,1) lds=163840
.amdgcn_target "amdgcn-amd-amdhsa--gfx950"
.text
.globl concat_heads__ssm_conv_h3__compressed_kv_cla__prompt_kernel
.p2align 8
.type concat_heads__ssm_conv_h3__compressed_kv_cla__prompt_kernel,@function
concat_heads__ssm_conv_h3__compressed_kv_cla__prompt_kernel:
  s_cmp_ge_u32 s2, 256
  s_cbranch_scc1 L_exit
  s_load_dwordx8 s[44:51], s[0:1], 48
  s_load_dwordx8 s[52:59], s[0:1], 80
  s_load_dwordx2 s[60:61], s[0:1], 112
  s_load_dwordx8 s[32:39], s[0:1], 0
  s_load_dwordx4 s[40:43], s[0:1], 32
  s_memrealtime s[92:93]
  v_lshrrev_b32 v1, 6, v0
  v_and_b32 v0, 63, v0
  s_and_b32 s7, s2, 7
  v_readfirstlane_b32 s4, v1
  s_lshr_b32 s3, s2, 3
  s_and_b32 s5, s3, 3
  s_lshl_b32 s24, s7, 2
  s_add_u32 s5, s5, s24
  s_lshr_b32 s6, s3, 2
  s_getpc_b64 s[26:27]
L_pc0:
  s_lshl_b32 s24, s3, 2
  s_add_u32 s24, s24, s4
  s_lshl_b32 s24, s24, 10
  s_add_u32 s24, s24, L_pc0-L_pc0
  v_and_b32 v1, 7, v0
  v_lshlrev_b32 v1, 7, v1
  v_add_u32 v1, s24, v1
  v_min_u32 v1, slow-L_pc0-4, v1
  global_load_dword v60, v1, s[26:27]
  s_lshr_b32 s26, s4, 1
  s_add_u32 s27, s26, 2
  s_mul_i32 s28, s26, 3
  s_sub_u32 s29, 2, s26
  s_sub_u32 s24, 15, s6
  s_and_b32 s25, s4, 1
  s_cmp_eq_u32 s25, 0
  s_cselect_b32 s24, s6, s24
  s_cselect_b32 s26, s26, s28
  s_cselect_b32 s27, s27, s29
  s_lshl_b32 s24, s24, 17
  s_lshl_b32 s26, s26, 15
  s_lshl_b32 s27, s27, 15
  v_and_b32 v11, 7, v0
  v_lshrrev_b32 v12, 4, v0
  v_xor_b32 v11, v11, v12
  v_lshlrev_b32 v11, 4, v11
  v_lshrrev_b32 v13, 3, v0
  v_lshl_add_u32 v11, v13, 10, v11
  v_add_u32 v8, s24, v11
  v_xor_b32 v9, 64, v8
  s_lshl_b32 s24, s25, 2
  v_or_b32 v13, s24, v12
  v_bfe_u32 v11, v0, 1, 3
  v_xor_b32 v11, v11, v13
  v_lshlrev_b32 v11, 5, v11
  v_and_b32 v13, 1, v0
  v_lshl_add_u32 v11, v13, 4, v11
  v_lshl_add_u32 v11, v12, 13, v11
  s_lshl_b32 s24, s25, 16
  s_lshl_b32 s25, s5, 8
  s_add_u32 s24, s24, s25
  v_add_u32 v10, s24, v11
  s_lshl_b32 s80, s4, 13
  s_sub_u32 s27, s27, s26
  v_add_u32 v8, s26, v8
  v_add_u32 v9, s26, v9
  s_mov_b32 s64, 0
  s_mov_b32 s65, 7168
  s_mov_b32 s66, 14336
  s_mov_b32 s67, 21504
  v_add_u32 v11, s27, v8
  v_add_u32 v12, s27, v9
  s_mov_b32 s72, 0
  s_mov_b32 s73, 31744
  s_mov_b32 s74, 129024
  s_mov_b32 s75, 160768
  s_mov_b32 s76, 262144
  s_mov_b32 s77, 293888
  s_mov_b32 s78, 391168
  s_mov_b32 s79, 422912
  s_lshl_b32 s24, s2, 2
  s_add_u32 s24, s24, s4
  s_lshl_b32 s24, s24, 11
  v_and_b32 v50, 15, v0
  v_lshlrev_b32 v50, 7, v50
  v_add_u32 v50, s24, v50
  s_waitcnt lgkmcnt(0)
  s_mov_b32 s8, s46
  s_mov_b32 s9, s47
  s_mov_b32 s10, 2097152
  s_mov_b32 s11, 0x20000
  s_cmp_lt_u32 s4, 2
  s_cselect_b32 s12, s50, s52
  s_cselect_b32 s13, s51, s53
  s_mov_b32 s14, 4194304
  s_mov_b32 s15, 0x20000
  s_mov_b32 s20, s60
  s_mov_b32 s21, s61
  s_mov_b32 s22, 71303168
  s_mov_b32 s23, 0x20000
  s_and_b32 s24, s4, 1
  s_lshl_b32 s25, s6, 1
  s_add_u32 m0, s80, 32768
  s_nop 0
  buffer_load_dwordx4 v10, s[12:15], s72 offen offset:0 lds
  s_add_u32 s24, s24, s25
  s_lshl_b32 s24, s24, 16
  buffer_load_dwordx4 v10, s[12:15], s73 offen offset:1024 lds
  s_lshl_b32 s25, s5, 8
  s_add_u32 s24, s24, s25
  buffer_load_dwordx4 v10, s[12:15], s74 offen offset:2048 lds
  v_bfe_u32 v51, v0, 1, 3
  v_lshlrev_b32 v51, 13, v51
  buffer_load_dwordx4 v10, s[12:15], s75 offen offset:3072 lds
  v_and_b32 v1, 1, v0
  v_lshl_add_u32 v51, v1, 7, v51
  s_add_u32 m0, s80, 36864
  s_nop 0
  buffer_load_dwordx4 v10, s[12:15], s76 offen offset:0 lds
  v_add_u32 v51, s24, v51
  buffer_load_dwordx4 v10, s[12:15], s77 offen offset:1024 lds
  buffer_load_dwordx4 v10, s[12:15], s78 offen offset:2048 lds
  buffer_load_dwordx4 v10, s[12:15], s79 offen offset:3072 lds
  v_add_u32 v10, 0x80000, v10
  s_add_u32 m0, s80, 0
  s_nop 0
  buffer_load_dwordx4 v8, s[8:11], s64 offen offset:0 lds
  buffer_load_dwordx4 v9, s[8:11], s65 offen offset:1024 lds
  buffer_load_dwordx4 v8, s[8:11], s66 offen offset:2048 lds
  buffer_load_dwordx4 v9, s[8:11], s67 offen offset:3072 lds
  s_add_u32 m0, s80, 4096
  s_nop 0
  buffer_load_dwordx4 v11, s[8:11], s64 offen offset:0 lds
  buffer_load_dwordx4 v12, s[8:11], s65 offen offset:1024 lds
  buffer_load_dwordx4 v11, s[8:11], s66 offen offset:2048 lds
  buffer_load_dwordx4 v12, s[8:11], s67 offen offset:3072 lds
  s_mov_b32 m0, 0x27000
  s_nop 0
  buffer_load_dword v50, s[8:11], 0 offen offset:0 lds
  v_add_u32 v51, 0x100000, v51
  s_mov_b32 m0, 0x27000
  s_nop 0
  buffer_load_dword v51, s[12:15], 0 offen offset:0 lds
  v_add_u32 v51, 0x100000, v51
  s_mov_b32 m0, 0x27000
  s_nop 0
  buffer_load_dword v51, s[12:15], 0 offen offset:0 lds
  v_add_u32 v8, 128, v8
  v_add_u32 v9, 128, v9
  v_add_u32 v11, 128, v11
  v_add_u32 v12, 128, v12
  s_xor_b32 s80, s80, 0x10000
  v_and_b32 v13, 15, v0
  v_lshrrev_b32 v14, 4, v0
  v_bfe_u32 v15, v0, 1, 3
  s_add_u32 m0, s80, 32768
  s_nop 0
  buffer_load_dwordx4 v10, s[12:15], s72 offen offset:0 lds
  v_xor_b32 v15, v15, v14
  v_lshlrev_b32 v15, 4, v15
  v_lshl_add_u32 v15, v13, 7, v15
  buffer_load_dwordx4 v10, s[12:15], s73 offen offset:1024 lds
  s_lshr_b32 s24, s4, 1
  s_lshl_b32 s24, s24, 14
  v_add_u32 v2, s24, v15
  buffer_load_dwordx4 v10, s[12:15], s74 offen offset:2048 lds
  v_xor_b32 v3, 64, v2
  v_bfe_u32 v13, v0, 2, 3
  s_and_b32 s24, s4, 1
  buffer_load_dwordx4 v10, s[12:15], s75 offen offset:3072 lds
  s_lshl_b32 s24, s24, 2
  v_xor_b32 v13, s24, v13
  v_lshlrev_b32 v13, 5, v13
  s_add_u32 m0, s80, 36864
  v_and_b32 v14, 3, v0
  v_lshl_add_u32 v13, v14, 3, v13
  v_bfe_u32 v14, v0, 2, 2
  v_lshl_add_u32 v13, v14, 8, v13
  v_bfe_u32 v14, v0, 4, 1
  v_lshl_add_u32 v13, v14, 13, v13
  v_bfe_u32 v14, v0, 5, 1
  v_lshl_add_u32 v13, v14, 11, v13
  v_add_u32 v4, 32768, v13
  v_xor_b32 v5, 32, v4
  v_xor_b32 v6, 64, v4
  v_xor_b32 v7, 96, v4
  v_and_b32 v29, 31, v0
  v_lshlrev_b32 v29, 2, v29
  s_add_u32 s24, s2, s4
  s_cmp_lg_u32 s24, 0
  s_cbranch_scc1 L_nononce
  s_mov_b32 s16, s58
  s_mov_b32 s17, s59
  s_mov_b32 s18, 256
  s_mov_b32 s19, 0x20000
  s_lshl_b32 s92, s92, 4
  s_or_b32 s92, s92, 0x80000000
  v_mov_b32 v1, s92
  buffer_store_dword v1, v29, s[16:19], 0 offen sc1
L_nononce:
  s_waitcnt vmcnt(7)
  s_barrier
  ds_read_b128 a[64:67], v2 offset:0
  ds_read_b128 a[68:71], v3 offset:0
  ds_read_b64_tr_b16 a[128:129], v4 offset:0
  ds_read_b64_tr_b16 a[130:131], v4 offset:1024
  ds_read_b64_tr_b16 a[132:133], v4 offset:4096
  ds_read_b64_tr_b16 a[134:135], v4 offset:5120
  ds_read_b64_tr_b16 a[136:137], v5 offset:0
  ds_read_b64_tr_b16 a[138:139], v5 offset:1024
  ds_read_b64_tr_b16 a[140:141], v5 offset:4096
  ds_read_b64_tr_b16 a[142:143], v5 offset:5120
  ds_read_b64_tr_b16 a[144:145], v6 offset:0
  ds_read_b64_tr_b16 a[146:147], v6 offset:1024
  ds_read_b64_tr_b16 a[148:149], v6 offset:4096
  ds_read_b64_tr_b16 a[150:151], v6 offset:5120
  ds_read_b64_tr_b16 a[152:153], v7 offset:0
  ds_read_b64_tr_b16 a[154:155], v7 offset:1024
  ds_read_b64_tr_b16 a[156:157], v7 offset:4096
  ds_read_b64_tr_b16 a[158:159], v7 offset:5120
  ds_read_b64_tr_b16 a[160:161], v4 offset:16384
  ds_read_b64_tr_b16 a[162:163], v4 offset:17408
  ds_read_b64_tr_b16 a[164:165], v4 offset:20480
  ds_read_b64_tr_b16 a[166:167], v4 offset:21504
  ds_read_b64_tr_b16 a[168:169], v5 offset:16384
  ds_read_b64_tr_b16 a[170:171], v5 offset:17408
  ds_read_b64_tr_b16 a[172:173], v5 offset:20480
  ds_read_b64_tr_b16 a[174:175], v5 offset:21504
  ds_read_b64_tr_b16 a[176:177], v6 offset:16384
  ds_read_b64_tr_b16 a[178:179], v6 offset:17408
  ds_read_b64_tr_b16 a[180:181], v6 offset:20480
  ds_read_b64_tr_b16 a[182:183], v6 offset:21504
  ds_read_b64_tr_b16 a[184:185], v7 offset:16384
  ds_read_b64_tr_b16 a[186:187], v7 offset:17408
  ds_read_b64_tr_b16 a[188:189], v7 offset:20480
  ds_read_b64_tr_b16 a[190:191], v7 offset:21504
  ds_read_b128 a[72:75], v2 offset:2048
  ds_read_b128 a[76:79], v3 offset:2048
  ds_read_b128 a[80:83], v2 offset:4096
  ds_read_b128 a[84:87], v3 offset:4096
  ds_read_b128 a[88:91], v2 offset:6144
  ds_read_b128 a[92:95], v3 offset:6144
  ds_read_b128 a[96:99], v2 offset:8192
  ds_read_b128 a[100:103], v3 offset:8192
  ds_read_b128 a[104:107], v2 offset:10240
  ds_read_b128 a[108:111], v3 offset:10240
  ds_read_b128 a[112:115], v2 offset:12288
  ds_read_b128 a[116:119], v3 offset:12288
  s_waitcnt lgkmcnt(15)
  v_mfma_f32_16x16x32_bf16 v[64:67], a[128:131], a[64:67], 0
  ds_read_b128 a[120:123], v2 offset:14336
  ds_read_b128 a[124:127], v3 offset:14336
  v_mfma_f32_16x16x32_bf16 v[64:67], a[132:135], a[68:71], v[64:67]
  buffer_load_dwordx4 v10, s[12:15], s76 offen offset:0 lds
  v_mfma_f32_16x16x32_bf16 v[68:71], a[136:139], a[64:67], 0
  v_xor_b32 v2, 0x10000, v2
  v_xor_b32 v3, 0x10000, v3
  v_mfma_f32_16x16x32_bf16 v[68:71], a[140:143], a[68:71], v[68:71]
  v_xor_b32 v4, 0x10000, v4
  v_xor_b32 v5, 0x10000, v5
  v_mfma_f32_16x16x32_bf16 v[72:75], a[144:147], a[64:67], 0
  v_xor_b32 v6, 0x10000, v6
  v_xor_b32 v7, 0x10000, v7
  v_mfma_f32_16x16x32_bf16 v[72:75], a[148:151], a[68:71], v[72:75]
  buffer_load_dwordx4 v10, s[12:15], s77 offen offset:1024 lds
  v_mfma_f32_16x16x32_bf16 v[76:79], a[152:155], a[64:67], 0
  s_mov_b32 s84, s44
  s_mov_b32 s85, s45
  s_mov_b32 s86, 2097152
  v_mfma_f32_16x16x32_bf16 v[76:79], a[156:159], a[68:71], v[76:79]
  s_mov_b32 s87, 0x20000
  s_mov_b32 s88, s48
  s_mov_b32 s89, s49
  v_mfma_f32_16x16x32_bf16 v[80:83], a[64:67], a[160:163], 0
  s_mov_b32 s90, 4194304
  s_mov_b32 s91, 0x20000
  s_lshl_b32 s24, s6, 2
  v_mfma_f32_16x16x32_bf16 v[80:83], a[68:71], a[164:167], v[80:83]
  buffer_load_dwordx4 v10, s[12:15], s78 offen offset:2048 lds
  v_mfma_f32_16x16x32_bf16 v[84:87], a[64:67], a[168:171], 0
  s_add_u32 s24, s24, s4
  s_lshl_b32 s24, s24, 15
  s_lshl_b32 s25, s24, 1
  v_mfma_f32_16x16x32_bf16 v[84:87], a[68:71], a[172:175], v[84:87]
  s_sub_u32 s25, 2064384, s25
  v_and_b32 v24, 7, v0
  v_lshrrev_b32 v25, 4, v0
  v_mfma_f32_16x16x32_bf16 v[88:91], a[64:67], a[176:179], 0
  v_xor_b32 v24, v24, v25
  v_lshlrev_b32 v24, 4, v24
  v_mfma_f32_16x16x32_bf16 v[88:91], a[68:71], a[180:183], v[88:91]
  buffer_load_dwordx4 v10, s[12:15], s79 offen offset:3072 lds
  s_waitcnt lgkmcnt(15)
  v_mfma_f32_16x16x32_bf16 v[92:95], a[64:67], a[184:187], 0
  v_add_u32 v10, 0x80000, v10
  v_lshrrev_b32 v26, 3, v0
  s_waitcnt lgkmcnt(14)
  v_mfma_f32_16x16x32_bf16 v[92:95], a[68:71], a[188:191], v[92:95]
  s_add_u32 m0, s80, 0
  v_lshl_add_u32 v24, v26, 10, v24
  v_add_u32 v13, s24, v24
  s_waitcnt lgkmcnt(13)
  v_mfma_f32_16x16x32_bf16 v[96:99], a[128:131], a[72:75], 0
  v_xor_b32 v14, 64, v13
  s_waitcnt lgkmcnt(12)
  v_mfma_f32_16x16x32_bf16 v[96:99], a[132:135], a[76:79], v[96:99]
  buffer_load_dwordx4 v8, s[8:11], s64 offen offset:0 lds
  v_mfma_f32_16x16x32_bf16 v[100:103], a[136:139], a[72:75], 0
  s_add_u32 s68, s25, 0
  s_add_u32 s69, s25, 7168
  s_add_u32 s70, s25, 14336
  v_mfma_f32_16x16x32_bf16 v[100:103], a[140:143], a[76:79], v[100:103]
  s_add_u32 s71, s25, 21504
  s_lshr_b32 s25, s4, 1
  s_lshl_b32 s24, s25, 2
  v_mfma_f32_16x16x32_bf16 v[104:107], a[144:147], a[72:75], 0
  v_or_b32 v26, s24, v25
  v_bfe_u32 v24, v0, 1, 3
  v_mfma_f32_16x16x32_bf16 v[104:107], a[148:151], a[76:79], v[104:107]
  buffer_load_dwordx4 v9, s[8:11], s65 offen offset:1024 lds
  v_mfma_f32_16x16x32_bf16 v[108:111], a[152:155], a[72:75], 0
  v_xor_b32 v24, v24, v26
  v_lshlrev_b32 v24, 5, v24
  v_mfma_f32_16x16x32_bf16 v[108:111], a[156:159], a[76:79], v[108:111]
  v_and_b32 v26, 1, v0
  v_lshl_add_u32 v24, v26, 4, v24
  v_mfma_f32_16x16x32_bf16 v[112:115], a[72:75], a[160:163], 0
  v_lshl_add_u32 v24, v25, 13, v24
  v_mfma_f32_16x16x32_bf16 v[112:115], a[76:79], a[164:167], v[112:115]
  buffer_load_dwordx4 v8, s[8:11], s66 offen offset:2048 lds
  v_mfma_f32_16x16x32_bf16 v[116:119], a[72:75], a[168:171], 0
  s_lshl_b32 s24, s25, 16
  s_and_b32 s25, s4, 1
  s_lshl_b32 s25, s25, 18
  v_mfma_f32_16x16x32_bf16 v[116:119], a[76:79], a[172:175], v[116:119]
  s_add_u32 s24, s24, s25
  s_lshl_b32 s25, s5, 8
  s_add_u32 s24, s24, s25
  v_mfma_f32_16x16x32_bf16 v[120:123], a[72:75], a[176:179], 0
  v_add_u32 v15, s24, v24
  v_mfma_f32_16x16x32_bf16 v[120:123], a[76:79], a[180:183], v[120:123]
  buffer_load_dwordx4 v9, s[8:11], s67 offen offset:3072 lds
  v_mfma_f32_16x16x32_bf16 v[124:127], a[72:75], a[184:187], 0
  s_add_u32 m0, s80, 4096
  s_lshl_b32 s25, s6, 2
  s_add_u32 s24, s4, s25
  v_mfma_f32_16x16x32_bf16 v[124:127], a[76:79], a[188:191], v[124:127]
  s_lshl_b32 s24, s24, 17
  s_lshl_b32 s25, s5, 8
  s_add_u32 s24, s24, s25
  s_waitcnt lgkmcnt(11)
  v_mfma_f32_16x16x32_bf16 v[128:131], a[128:131], a[80:83], 0
  v_and_b32 v55, 1, v0
  v_lshlrev_b32 v55, 7, v55
  s_waitcnt lgkmcnt(10)
  v_mfma_f32_16x16x32_bf16 v[128:131], a[132:135], a[84:87], v[128:131]
  buffer_load_dwordx4 v11, s[8:11], s64 offen offset:0 lds
  v_mfma_f32_16x16x32_bf16 v[132:135], a[136:139], a[80:83], 0
  v_bfe_u32 v27, v0, 1, 4
  v_lshl_add_u32 v55, v27, 13, v55
  v_mfma_f32_16x16x32_bf16 v[132:135], a[140:143], a[84:87], v[132:135]
  v_add_u32 v55, s24, v55
  v_lshrrev_b32 v17, 3, v0
  v_mfma_f32_16x16x32_bf16 v[136:139], a[144:147], a[80:83], 0
  v_and_b32 v16, 7, v0
  v_lshlrev_b32 v62, 10, v17
  v_mfma_f32_16x16x32_bf16 v[136:139], a[148:151], a[84:87], v[136:139]
  buffer_load_dwordx4 v12, s[8:11], s65 offen offset:1024 lds
  v_mfma_f32_16x16x32_bf16 v[140:143], a[152:155], a[80:83], 0
  v_lshl_add_u32 v62, v16, 4, v62
  v_mfma_f32_16x16x32_bf16 v[140:143], a[156:159], a[84:87], v[140:143]
  s_lshl_b32 s24, s3, 16
  s_lshl_b32 s25, s7, 7
  s_add_u32 s24, s24, s25
  v_mfma_f32_16x16x32_bf16 v[144:147], a[80:83], a[160:163], 0
  v_add_u32 v62, s24, v62
  v_subrev_u32 v61, 8192, v62
  v_mfma_f32_16x16x32_bf16 v[144:147], a[84:87], a[164:167], v[144:147]
  buffer_load_dwordx4 v11, s[8:11], s66 offen offset:2048 lds
  v_mfma_f32_16x16x32_bf16 v[148:151], a[80:83], a[168:171], 0
  s_lshl_b32 s24, s4, 14
  v_add_u32 v62, s24, v62
  v_mul_u32_u24 v63, 1056, v16
  v_mfma_f32_16x16x32_bf16 v[148:151], a[84:87], a[172:175], v[148:151]
  v_lshl_add_u32 v63, v17, 2, v63
  v_mfma_f32_16x16x32_bf16 v[152:155], a[80:83], a[176:179], 0
  s_lshl_b32 s24, s4, 5
  s_add_u32 s24, s24, 131072
  v_add_u32 v63, s24, v63
  v_mfma_f32_16x16x32_bf16 v[152:155], a[84:87], a[180:183], v[152:155]
  buffer_load_dwordx4 v12, s[8:11], s67 offen offset:3072 lds
  v_mfma_f32_16x16x32_bf16 v[156:159], a[80:83], a[184:187], 0
  s_lshl_b32 s24, s7, 2
  v_add_u32 v8, 128, v8
  v_add_u32 v9, 128, v9
  v_mfma_f32_16x16x32_bf16 v[156:159], a[84:87], a[188:191], v[156:159]
  s_add_u32 s24, s24, s4
  v_add_u32 v11, 128, v11
  v_add_u32 v12, 128, v12
  s_waitcnt lgkmcnt(9)
  v_mfma_f32_16x16x32_bf16 v[160:163], a[128:131], a[88:91], 0
  s_xor_b32 s80, s80, 0x10000
  s_lshl_b32 s24, s24, 3
  v_add_u32 v17, s24, v17
  s_waitcnt lgkmcnt(8)
  v_mfma_f32_16x16x32_bf16 v[160:163], a[132:135], a[92:95], v[160:163]
  v_lshlrev_b32 v53, 14, v17
  v_lshlrev_b32 v17, 4, v17
  v_mfma_f32_16x16x32_bf16 v[164:167], a[136:139], a[88:91], 0
  s_lshl_b32 s24, s3, 3
  v_add_u32 v16, s24, v16
  v_lshlrev_b32 v16, 4, v16
  v_mfma_f32_16x16x32_bf16 v[164:167], a[140:143], a[92:95], v[164:167]
  v_sub_u32 v53, v53, v16
  v_add_u32 v53, 50335728, v53
  v_mfma_f32_16x16x32_bf16 v[168:171], a[144:147], a[88:91], 0
  s_mul_i32 s26, s4, 2112
  s_mov_b32 s27, 7136
  v_mfma_f32_16x16x32_bf16 v[168:171], a[148:151], a[92:95], v[168:171]
  v_mfma_f32_16x16x32_bf16 v[172:175], a[152:155], a[88:91], 0
  v_mfma_f32_16x16x32_bf16 v[172:175], a[156:159], a[92:95], v[172:175]
  v_mfma_f32_16x16x32_bf16 v[176:179], a[88:91], a[160:163], 0
  v_mfma_f32_16x16x32_bf16 v[176:179], a[92:95], a[164:167], v[176:179]
  v_mfma_f32_16x16x32_bf16 v[180:183], a[88:91], a[168:171], 0
  v_mfma_f32_16x16x32_bf16 v[180:183], a[92:95], a[172:175], v[180:183]
  v_mfma_f32_16x16x32_bf16 v[184:187], a[88:91], a[176:179], 0
  v_mfma_f32_16x16x32_bf16 v[184:187], a[92:95], a[180:183], v[184:187]
  v_mfma_f32_16x16x32_bf16 v[188:191], a[88:91], a[184:187], 0
  v_mfma_f32_16x16x32_bf16 v[188:191], a[92:95], a[188:191], v[188:191]
  s_waitcnt lgkmcnt(7)
  v_mfma_f32_16x16x32_bf16 v[192:195], a[128:131], a[96:99], 0
  s_waitcnt lgkmcnt(6)
  v_mfma_f32_16x16x32_bf16 v[192:195], a[132:135], a[100:103], v[192:195]
  v_mfma_f32_16x16x32_bf16 v[196:199], a[136:139], a[96:99], 0
  v_mfma_f32_16x16x32_bf16 v[196:199], a[140:143], a[100:103], v[196:199]
  v_mfma_f32_16x16x32_bf16 v[200:203], a[144:147], a[96:99], 0
  v_mfma_f32_16x16x32_bf16 v[200:203], a[148:151], a[100:103], v[200:203]
  v_mfma_f32_16x16x32_bf16 v[204:207], a[152:155], a[96:99], 0
  v_mfma_f32_16x16x32_bf16 v[204:207], a[156:159], a[100:103], v[204:207]
  v_mfma_f32_16x16x32_bf16 v[208:211], a[96:99], a[160:163], 0
  s_waitcnt vmcnt(0) lgkmcnt(0)
  s_barrier
  v_mfma_f32_16x16x32_bf16 v[208:211], a[100:103], a[164:167], v[208:211]
  s_add_u32 m0, s80, 32768
  v_mfma_f32_16x16x32_bf16 v[212:215], a[96:99], a[168:171], 0
  buffer_load_dwordx4 v10, s[12:15], s72 offen offset:0 lds
  v_mfma_f32_16x16x32_bf16 v[212:215], a[100:103], a[172:175], v[212:215]
  ds_read_b128 a[64:67], v2 offset:0
  ds_read_b128 a[68:71], v3 offset:0
  v_mfma_f32_16x16x32_bf16 v[216:219], a[96:99], a[176:179], 0
  ds_read_b64_tr_b16 a[192:193], v4 offset:0
  ds_read_b64_tr_b16 a[194:195], v4 offset:1024
  v_mfma_f32_16x16x32_bf16 v[216:219], a[100:103], a[180:183], v[216:219]
  ds_read_b64_tr_b16 a[196:197], v4 offset:4096
  ds_read_b64_tr_b16 a[198:199], v4 offset:5120
  v_mfma_f32_16x16x32_bf16 v[220:223], a[96:99], a[184:187], 0
  v_mfma_f32_16x16x32_bf16 v[220:223], a[100:103], a[188:191], v[220:223]
  buffer_load_dwordx4 v10, s[12:15], s73 offen offset:1024 lds
  v_mfma_f32_16x16x32_bf16 v[224:227], a[128:131], a[104:107], 0
  ds_read_b128 a[72:75], v2 offset:2048
  ds_read_b128 a[76:79], v3 offset:2048
  v_mfma_f32_16x16x32_bf16 v[224:227], a[132:135], a[108:111], v[224:227]
  ds_read_b64_tr_b16 a[200:201], v5 offset:0
  ds_read_b64_tr_b16 a[202:203], v5 offset:1024
  v_mfma_f32_16x16x32_bf16 v[228:231], a[136:139], a[104:107], 0
  ds_read_b64_tr_b16 a[204:205], v5 offset:4096
  v_mfma_f32_16x16x32_bf16 v[228:231], a[140:143], a[108:111], v[228:231]
  ds_read_b64_tr_b16 a[206:207], v5 offset:5120
  v_mfma_f32_16x16x32_bf16 v[232:235], a[144:147], a[104:107], 0
  buffer_load_dwordx4 v10, s[12:15], s74 offen offset:2048 lds
  v_mfma_f32_16x16x32_bf16 v[232:235], a[148:151], a[108:111], v[232:235]
  ds_read_b128 a[80:83], v2 offset:4096
  ds_read_b128 a[84:87], v3 offset:4096
  v_mfma_f32_16x16x32_bf16 v[236:239], a[152:155], a[104:107], 0
  ds_read_b64_tr_b16 a[208:209], v6 offset:0
  ds_read_b64_tr_b16 a[210:211], v6 offset:1024
  v_mfma_f32_16x16x32_bf16 v[236:239], a[156:159], a[108:111], v[236:239]
  ds_read_b64_tr_b16 a[212:213], v6 offset:4096
  v_mfma_f32_16x16x32_bf16 v[240:243], a[104:107], a[160:163], 0
  ds_read_b64_tr_b16 a[214:215], v6 offset:5120
  v_mfma_f32_16x16x32_bf16 v[240:243], a[108:111], a[164:167], v[240:243]
  buffer_load_dwordx4 v10, s[12:15], s75 offen offset:3072 lds
  v_mfma_f32_16x16x32_bf16 v[244:247], a[104:107], a[168:171], 0
  s_add_u32 m0, s80, 36864
  ds_read_b128 a[88:91], v2 offset:6144
  ds_read_b128 a[92:95], v3 offset:6144
  v_mfma_f32_16x16x32_bf16 v[244:247], a[108:111], a[172:175], v[244:247]
  ds_read_b64_tr_b16 a[216:217], v7 offset:0
  ds_read_b64_tr_b16 a[218:219], v7 offset:1024
  v_mfma_f32_16x16x32_bf16 v[248:251], a[104:107], a[176:179], 0
  ds_read_b64_tr_b16 a[220:221], v7 offset:4096
  v_mfma_f32_16x16x32_bf16 v[248:251], a[108:111], a[180:183], v[248:251]
  ds_read_b64_tr_b16 a[222:223], v7 offset:5120
  v_mfma_f32_16x16x32_bf16 v[252:255], a[104:107], a[184:187], 0
  buffer_load_dwordx4 v10, s[12:15], s76 offen offset:0 lds
  v_mfma_f32_16x16x32_bf16 v[252:255], a[108:111], a[188:191], v[252:255]
  ds_read_b128 a[96:99], v2 offset:8192
  ds_read_b128 a[100:103], v3 offset:8192
  v_mfma_f32_16x16x32_bf16 a[0:3], a[128:131], a[112:115], 0
  ds_read_b64_tr_b16 a[224:225], v4 offset:16384
  ds_read_b64_tr_b16 a[226:227], v4 offset:17408
  v_mfma_f32_16x16x32_bf16 a[0:3], a[132:135], a[116:119], a[0:3]
  ds_read_b64_tr_b16 a[228:229], v4 offset:20480
  v_mfma_f32_16x16x32_bf16 a[4:7], a[136:139], a[112:115], 0
  ds_read_b64_tr_b16 a[230:231], v4 offset:21504
  v_mfma_f32_16x16x32_bf16 a[4:7], a[140:143], a[116:119], a[4:7]
  buffer_load_dwordx4 v10, s[12:15], s77 offen offset:1024 lds
  v_mfma_f32_16x16x32_bf16 a[8:11], a[144:147], a[112:115], 0
  ds_read_b128 a[104:107], v2 offset:10240
  ds_read_b128 a[108:111], v3 offset:10240
  v_mfma_f32_16x16x32_bf16 a[8:11], a[148:151], a[116:119], a[8:11]
  ds_read_b64_tr_b16 a[232:233], v5 offset:16384
  ds_read_b64_tr_b16 a[234:235], v5 offset:17408
  v_mfma_f32_16x16x32_bf16 a[12:15], a[152:155], a[112:115], 0
  ds_read_b64_tr_b16 a[236:237], v5 offset:20480
  v_mfma_f32_16x16x32_bf16 a[12:15], a[156:159], a[116:119], a[12:15]
  v_mfma_f32_16x16x32_bf16 a[16:19], a[112:115], a[160:163], 0
  buffer_load_dwordx4 v10, s[12:15], s78 offen offset:2048 lds
  v_mfma_f32_16x16x32_bf16 a[16:19], a[116:119], a[164:167], a[16:19]
  ds_read_b64_tr_b16 a[238:239], v5 offset:21504
  ds_read_b64_tr_b16 a[240:241], v6 offset:16384
  v_mfma_f32_16x16x32_bf16 a[20:23], a[112:115], a[168:171], 0
  ds_read_b64_tr_b16 a[242:243], v6 offset:17408
  v_mfma_f32_16x16x32_bf16 a[20:23], a[116:119], a[172:175], a[20:23]
  v_mfma_f32_16x16x32_bf16 a[24:27], a[112:115], a[176:179], 0
  ds_read_b64_tr_b16 a[244:245], v6 offset:20480
  v_mfma_f32_16x16x32_bf16 a[24:27], a[116:119], a[180:183], a[24:27]
  buffer_load_dwordx4 v10, s[12:15], s79 offen offset:3072 lds
  v_mfma_f32_16x16x32_bf16 a[28:31], a[112:115], a[184:187], 0
  ds_read_b64_tr_b16 a[246:247], v6 offset:21504
  v_add_u32 v10, 0x80000, v10
  v_mfma_f32_16x16x32_bf16 a[28:31], a[116:119], a[188:191], a[28:31]
  s_add_u32 m0, s80, 0
  ds_read_b64_tr_b16 a[248:249], v7 offset:16384
  v_mfma_f32_16x16x32_bf16 a[32:35], a[128:131], a[120:123], 0
  ds_read_b128 a[112:115], v2 offset:12288
  ds_read_b128 a[116:119], v3 offset:12288
  v_mfma_f32_16x16x32_bf16 a[32:35], a[132:135], a[124:127], a[32:35]
  ds_read_b64_tr_b16 a[250:251], v7 offset:17408
  ds_read_b64_tr_b16 a[252:253], v7 offset:20480
  v_mfma_f32_16x16x32_bf16 a[36:39], a[136:139], a[120:123], 0
  buffer_load_dwordx4 v8, s[8:11], s64 offen offset:0 lds
  v_mfma_f32_16x16x32_bf16 a[36:39], a[140:143], a[124:127], a[36:39]
  ds_read_b64_tr_b16 a[254:255], v7 offset:21504
  v_mfma_f32_16x16x32_bf16 a[40:43], a[144:147], a[120:123], 0
  v_mfma_f32_16x16x32_bf16 a[40:43], a[148:151], a[124:127], a[40:43]
  v_mfma_f32_16x16x32_bf16 a[44:47], a[152:155], a[120:123], 0
  v_mfma_f32_16x16x32_bf16 a[44:47], a[156:159], a[124:127], a[44:47]
  buffer_load_dwordx4 v9, s[8:11], s65 offen offset:1024 lds
  v_mfma_f32_16x16x32_bf16 a[48:51], a[120:123], a[160:163], 0
  v_mfma_f32_16x16x32_bf16 a[48:51], a[124:127], a[164:167], a[48:51]
  v_mfma_f32_16x16x32_bf16 a[52:55], a[120:123], a[168:171], 0
  v_mfma_f32_16x16x32_bf16 a[52:55], a[124:127], a[172:175], a[52:55]
  v_mfma_f32_16x16x32_bf16 a[56:59], a[120:123], a[176:179], 0
  buffer_load_dwordx4 v8, s[8:11], s66 offen offset:2048 lds
  v_mfma_f32_16x16x32_bf16 a[56:59], a[124:127], a[180:183], a[56:59]
  v_mfma_f32_16x16x32_bf16 a[60:63], a[120:123], a[184:187], 0
  v_mfma_f32_16x16x32_bf16 a[60:63], a[124:127], a[188:191], a[60:63]
  s_waitcnt lgkmcnt(0)
  v_mfma_f32_16x16x32_bf16 v[64:67], a[192:195], a[64:67], v[64:67]
  ds_read_b128 a[120:123], v2 offset:14336
  ds_read_b128 a[124:127], v3 offset:14336
  v_mfma_f32_16x16x32_bf16 v[64:67], a[196:199], a[68:71], v[64:67]
  buffer_load_dwordx4 v9, s[8:11], s67 offen offset:3072 lds
  v_mfma_f32_16x16x32_bf16 v[68:71], a[200:203], a[64:67], v[68:71]
  s_add_u32 m0, s80, 4096
  v_xor_b32 v2, 0x10000, v2
  v_xor_b32 v3, 0x10000, v3
  v_mfma_f32_16x16x32_bf16 v[68:71], a[204:207], a[68:71], v[68:71]
  v_xor_b32 v4, 0x10000, v4
  v_xor_b32 v5, 0x10000, v5
  v_mfma_f32_16x16x32_bf16 v[72:75], a[208:211], a[64:67], v[72:75]
  v_xor_b32 v6, 0x10000, v6
  v_xor_b32 v7, 0x10000, v7
  v_mfma_f32_16x16x32_bf16 v[72:75], a[212:215], a[68:71], v[72:75]
  v_mfma_f32_16x16x32_bf16 v[76:79], a[216:219], a[64:67], v[76:79]
  buffer_load_dwordx4 v11, s[8:11], s64 offen offset:0 lds
  v_mfma_f32_16x16x32_bf16 v[76:79], a[220:223], a[68:71], v[76:79]
  v_mfma_f32_16x16x32_bf16 v[80:83], a[64:67], a[224:227], v[80:83]
  v_mfma_f32_16x16x32_bf16 v[80:83], a[68:71], a[228:231], v[80:83]
  v_mfma_f32_16x16x32_bf16 v[84:87], a[64:67], a[232:235], v[84:87]
  v_mfma_f32_16x16x32_bf16 v[84:87], a[68:71], a[236:239], v[84:87]
  buffer_load_dwordx4 v12, s[8:11], s65 offen offset:1024 lds
  v_mfma_f32_16x16x32_bf16 v[88:91], a[64:67], a[240:243], v[88:91]
  v_mfma_f32_16x16x32_bf16 v[88:91], a[68:71], a[244:247], v[88:91]
  v_mfma_f32_16x16x32_bf16 v[92:95], a[64:67], a[248:251], v[92:95]
  v_mfma_f32_16x16x32_bf16 v[92:95], a[68:71], a[252:255], v[92:95]
  v_mfma_f32_16x16x32_bf16 v[96:99], a[192:195], a[72:75], v[96:99]
  buffer_load_dwordx4 v11, s[8:11], s66 offen offset:2048 lds
  v_mfma_f32_16x16x32_bf16 v[96:99], a[196:199], a[76:79], v[96:99]
  v_mfma_f32_16x16x32_bf16 v[100:103], a[200:203], a[72:75], v[100:103]
  v_mfma_f32_16x16x32_bf16 v[100:103], a[204:207], a[76:79], v[100:103]
  v_mfma_f32_16x16x32_bf16 v[104:107], a[208:211], a[72:75], v[104:107]
  v_mfma_f32_16x16x32_bf16 v[104:107], a[212:215], a[76:79], v[104:107]
  buffer_load_dwordx4 v12, s[8:11], s67 offen offset:3072 lds
  v_mfma_f32_16x16x32_bf16 v[108:111], a[216:219], a[72:75], v[108:111]
  s_mov_b32 s16, s38
  v_add_u32 v8, 128, v8
  v_add_u32 v9, 128, v9
  v_mfma_f32_16x16x32_bf16 v[108:111], a[220:223], a[76:79], v[108:111]
  s_mov_b32 s17, s39
  v_add_u32 v11, 128, v11
  v_add_u32 v12, 128, v12
  v_mfma_f32_16x16x32_bf16 v[112:115], a[72:75], a[224:227], v[112:115]
  s_xor_b32 s80, s80, 0x10000
  s_mov_b32 s18, 4096
  s_mov_b32 s19, 0x20000
  v_mfma_f32_16x16x32_bf16 v[112:115], a[76:79], a[228:231], v[112:115]
  buffer_load_dwordx4 v[56:59], v17, s[16:19], 0 offen
  v_mfma_f32_16x16x32_bf16 v[116:119], a[72:75], a[232:235], v[116:119]
  s_mov_b32 s16, s34
  s_mov_b32 s17, s35
  s_mov_b32 s18, 2097152
  v_mfma_f32_16x16x32_bf16 v[116:119], a[76:79], a[236:239], v[116:119]
  s_mov_b32 m0, 131072
  v_mfma_f32_16x16x32_bf16 v[120:123], a[72:75], a[240:243], v[120:123]
  buffer_load_dwordx4 v61, s[16:19], 0 offen lds
  v_mfma_f32_16x16x32_bf16 v[120:123], a[76:79], a[244:247], v[120:123]
  s_add_u32 m0, s26, 132128
  v_mfma_f32_16x16x32_bf16 v[124:127], a[72:75], a[248:251], v[124:127]
  buffer_load_dwordx4 v62, s[16:19], 0 offen lds
  v_mfma_f32_16x16x32_bf16 v[124:127], a[76:79], a[252:255], v[124:127]
  v_mfma_f32_16x16x32_bf16 v[128:131], a[192:195], a[80:83], v[128:131]
  buffer_load_dwordx4 v62, s[16:19], s27 offen offset:1056 lds
  v_mfma_f32_16x16x32_bf16 v[128:131], a[196:199], a[84:87], v[128:131]
  s_mov_b32 s16, s36
  s_mov_b32 s17, s37
  s_mov_b32 m0, 140576
  v_mfma_f32_16x16x32_bf16 v[132:135], a[200:203], a[80:83], v[132:135]
  buffer_load_dwordx4 v61, s[16:19], 0 offen lds
  v_mfma_f32_16x16x32_bf16 v[132:135], a[204:207], a[84:87], v[132:135]
  s_add_u32 m0, s26, 141632
  v_mfma_f32_16x16x32_bf16 v[136:139], a[208:211], a[80:83], v[136:139]
  buffer_load_dwordx4 v62, s[16:19], 0 offen lds
  v_mfma_f32_16x16x32_bf16 v[136:139], a[212:215], a[84:87], v[136:139]
  v_mfma_f32_16x16x32_bf16 v[140:143], a[216:219], a[80:83], v[140:143]
  buffer_load_dwordx4 v62, s[16:19], s27 offen offset:1056 lds
  v_mfma_f32_16x16x32_bf16 v[140:143], a[220:223], a[84:87], v[140:143]
  s_lshl_b32 s24, s7, 5
  s_add_u32 s24, s24, s3
  s_lshr_b32 s25, s24, 1
  v_mfma_f32_16x16x32_bf16 v[144:147], a[80:83], a[224:227], v[144:147]
  s_and_b32 s28, s24, 1
  s_lshl_b32 s28, s28, 2
  s_add_u32 s28, s28, s4
  v_mfma_f32_16x16x32_bf16 v[144:147], a[84:87], a[228:231], v[144:147]
  s_lshl_b32 s29, s25, 15
  s_lshl_b32 s24, s28, 7
  s_add_u32 s36, s29, s24
  v_mfma_f32_16x16x32_bf16 v[148:151], a[80:83], a[232:235], v[148:151]
  s_and_b32 s24, s25, 15
  s_lshl_b32 s24, s24, 14
  s_lshl_b32 s28, s28, 19
  v_mfma_f32_16x16x32_bf16 v[148:151], a[84:87], a[236:239], v[148:151]
  s_add_u32 s28, s28, s24
  s_lshr_b32 s24, s25, 6
  s_lshl_b32 s24, s24, 18
  v_mfma_f32_16x16x32_bf16 v[152:155], a[80:83], a[240:243], v[152:155]
  s_add_u32 s28, s28, s24
  s_bfe_u32 s25, s25, 0x20004
  s_lshl_b32 s25, s25, 12
  v_mfma_f32_16x16x32_bf16 v[152:155], a[84:87], a[244:247], v[152:155]
  s_add_u32 s25, s25, s28
  s_add_u32 s37, s25, 60817408
  s_lshl_b32 s24, s7, 5
  v_mfma_f32_16x16x32_bf16 v[156:159], a[80:83], a[248:251], v[156:159]
  s_add_u32 s24, s24, s3
  s_lshl_b32 s24, s24, 7
  s_add_u32 s93, s24, 59768832
  v_mfma_f32_16x16x32_bf16 v[156:159], a[84:87], a[252:255], v[156:159]
  s_getreg_b32 s38, hwreg(HW_REG_XCC_ID, 0, 4)
  v_mfma_f32_16x16x32_bf16 v[160:163], a[192:195], a[88:91], v[160:163]
  v_mfma_f32_16x16x32_bf16 v[160:163], a[196:199], a[92:95], v[160:163]
  v_mfma_f32_16x16x32_bf16 v[164:167], a[200:203], a[88:91], v[164:167]
  v_mfma_f32_16x16x32_bf16 v[164:167], a[204:207], a[92:95], v[164:167]
  v_mfma_f32_16x16x32_bf16 v[168:171], a[208:211], a[88:91], v[168:171]
  v_mfma_f32_16x16x32_bf16 v[168:171], a[212:215], a[92:95], v[168:171]
  v_mfma_f32_16x16x32_bf16 v[172:175], a[216:219], a[88:91], v[172:175]
  v_mfma_f32_16x16x32_bf16 v[172:175], a[220:223], a[92:95], v[172:175]
  v_mfma_f32_16x16x32_bf16 v[176:179], a[88:91], a[224:227], v[176:179]
  v_mfma_f32_16x16x32_bf16 v[176:179], a[92:95], a[228:231], v[176:179]
  v_mfma_f32_16x16x32_bf16 v[180:183], a[88:91], a[232:235], v[180:183]
  v_mfma_f32_16x16x32_bf16 v[180:183], a[92:95], a[236:239], v[180:183]
  v_mfma_f32_16x16x32_bf16 v[184:187], a[88:91], a[240:243], v[184:187]
  v_mfma_f32_16x16x32_bf16 v[184:187], a[92:95], a[244:247], v[184:187]
  v_mfma_f32_16x16x32_bf16 v[188:191], a[88:91], a[248:251], v[188:191]
  v_mfma_f32_16x16x32_bf16 v[188:191], a[92:95], a[252:255], v[188:191]
  v_mfma_f32_16x16x32_bf16 v[192:195], a[192:195], a[96:99], v[192:195]
  s_waitcnt vmcnt(7) lgkmcnt(0)
  s_barrier
  v_mfma_f32_16x16x32_bf16 v[192:195], a[196:199], a[100:103], v[192:195]
  s_add_u32 m0, s80, 32768
  v_mfma_f32_16x16x32_bf16 v[196:199], a[200:203], a[96:99], v[196:199]
  buffer_load_dwordx4 v10, s[12:15], s72 offen offset:0 lds
  v_mfma_f32_16x16x32_bf16 v[196:199], a[204:207], a[100:103], v[196:199]
  ds_read_b128 a[64:67], v2 offset:0
  ds_read_b128 a[68:71], v3 offset:0
  v_mfma_f32_16x16x32_bf16 v[200:203], a[208:211], a[96:99], v[200:203]
  ds_read_b64_tr_b16 a[128:129], v4 offset:0
  ds_read_b64_tr_b16 a[130:131], v4 offset:1024
  v_mfma_f32_16x16x32_bf16 v[200:203], a[212:215], a[100:103], v[200:203]
  ds_read_b64_tr_b16 a[132:133], v4 offset:4096
  v_mfma_f32_16x16x32_bf16 v[204:207], a[216:219], a[96:99], v[204:207]
  ds_read_b64_tr_b16 a[134:135], v4 offset:5120
  v_mfma_f32_16x16x32_bf16 v[204:207], a[220:223], a[100:103], v[204:207]
  buffer_load_dwordx4 v10, s[12:15], s73 offen offset:1024 lds
  v_mfma_f32_16x16x32_bf16 v[208:211], a[96:99], a[224:227], v[208:211]
  ds_read_b128 a[72:75], v2 offset:2048
  ds_read_b128 a[76:79], v3 offset:2048
  v_mfma_f32_16x16x32_bf16 v[208:211], a[100:103], a[228:231], v[208:211]
  ds_read_b64_tr_b16 a[136:137], v5 offset:0
  ds_read_b64_tr_b16 a[138:139], v5 offset:1024
  v_mfma_f32_16x16x32_bf16 v[212:215], a[96:99], a[232:235], v[212:215]
  v_mfma_f32_16x16x32_bf16 v[212:215], a[100:103], a[236:239], v[212:215]
  ds_read_b64_tr_b16 a[140:141], v5 offset:4096
  v_mfma_f32_16x16x32_bf16 v[216:219], a[96:99], a[240:243], v[216:219]
  buffer_load_dwordx4 v10, s[12:15], s74 offen offset:2048 lds
  v_mfma_f32_16x16x32_bf16 v[216:219], a[100:103], a[244:247], v[216:219]
  ds_read_b128 a[80:83], v2 offset:4096
  ds_read_b128 a[84:87], v3 offset:4096
  v_mfma_f32_16x16x32_bf16 v[220:223], a[96:99], a[248:251], v[220:223]
  ds_read_b64_tr_b16 a[142:143], v5 offset:5120
  ds_read_b64_tr_b16 a[144:145], v6 offset:0
  v_mfma_f32_16x16x32_bf16 v[220:223], a[100:103], a[252:255], v[220:223]
  v_mfma_f32_16x16x32_bf16 v[224:227], a[192:195], a[104:107], v[224:227]
  ds_read_b64_tr_b16 a[146:147], v6 offset:1024
  v_mfma_f32_16x16x32_bf16 v[224:227], a[196:199], a[108:111], v[224:227]
  buffer_load_dwordx4 v10, s[12:15], s75 offen offset:3072 lds
  v_mfma_f32_16x16x32_bf16 v[228:231], a[200:203], a[104:107], v[228:231]
  s_add_u32 m0, s80, 36864
  ds_read_b128 a[88:91], v2 offset:6144
  ds_read_b128 a[92:95], v3 offset:6144
  v_mfma_f32_16x16x32_bf16 v[228:231], a[204:207], a[108:111], v[228:231]
  ds_read_b64_tr_b16 a[148:149], v6 offset:4096
  ds_read_b64_tr_b16 a[150:151], v6 offset:5120
  v_mfma_f32_16x16x32_bf16 v[232:235], a[208:211], a[104:107], v[232:235]
  ds_read_b64_tr_b16 a[152:153], v7 offset:0
  v_mfma_f32_16x16x32_bf16 v[232:235], a[212:215], a[108:111], v[232:235]
  v_mfma_f32_16x16x32_bf16 v[236:239], a[216:219], a[104:107], v[236:239]
  buffer_load_dwordx4 v10, s[12:15], s76 offen offset:0 lds
  v_mfma_f32_16x16x32_bf16 v[236:239], a[220:223], a[108:111], v[236:239]
  ds_read_b128 a[96:99], v2 offset:8192
  ds_read_b128 a[100:103], v3 offset:8192
  v_mfma_f32_16x16x32_bf16 v[240:243], a[104:107], a[224:227], v[240:243]
  ds_read_b64_tr_b16 a[154:155], v7 offset:1024
  ds_read_b64_tr_b16 a[156:157], v7 offset:4096
  v_mfma_f32_16x16x32_bf16 v[240:243], a[108:111], a[228:231], v[240:243]
  ds_read_b64_tr_b16 a[158:159], v7 offset:5120
  v_mfma_f32_16x16x32_bf16 v[244:247], a[104:107], a[232:235], v[244:247]
  v_mfma_f32_16x16x32_bf16 v[244:247], a[108:111], a[236:239], v[244:247]
  buffer_load_dwordx4 v10, s[12:15], s77 offen offset:1024 lds
  v_mfma_f32_16x16x32_bf16 v[248:251], a[104:107], a[240:243], v[248:251]
  ds_read_b64_tr_b16 a[160:161], v4 offset:16384
  ds_read_b64_tr_b16 a[162:163], v4 offset:17408
  v_mfma_f32_16x16x32_bf16 v[248:251], a[108:111], a[244:247], v[248:251]
  v_mfma_f32_16x16x32_bf16 v[252:255], a[104:107], a[248:251], v[252:255]
  ds_read_b64_tr_b16 a[164:165], v4 offset:20480
  v_mfma_f32_16x16x32_bf16 v[252:255], a[108:111], a[252:255], v[252:255]
  ds_read_b64_tr_b16 a[166:167], v4 offset:21504
  v_mfma_f32_16x16x32_bf16 a[0:3], a[192:195], a[112:115], a[0:3]
  ds_read_b128 a[104:107], v2 offset:10240
  ds_read_b128 a[108:111], v3 offset:10240
  v_mfma_f32_16x16x32_bf16 a[0:3], a[196:199], a[116:119], a[0:3]
  buffer_load_dwordx4 v10, s[12:15], s78 offen offset:2048 lds
  v_mfma_f32_16x16x32_bf16 a[4:7], a[200:203], a[112:115], a[4:7]
  ds_read_b64_tr_b16 a[168:169], v5 offset:16384
  ds_read_b64_tr_b16 a[170:171], v5 offset:17408
  v_mfma_f32_16x16x32_bf16 a[4:7], a[204:207], a[116:119], a[4:7]
  v_mfma_f32_16x16x32_bf16 a[8:11], a[208:211], a[112:115], a[8:11]
  ds_read_b64_tr_b16 a[172:173], v5 offset:20480
  v_mfma_f32_16x16x32_bf16 a[8:11], a[212:215], a[116:119], a[8:11]
  ds_read_b64_tr_b16 a[174:175], v5 offset:21504
  v_mfma_f32_16x16x32_bf16 a[12:15], a[216:219], a[112:115], a[12:15]
  buffer_load_dwordx4 v10, s[12:15], s79 offen offset:3072 lds
  v_mfma_f32_16x16x32_bf16 a[12:15], a[220:223], a[116:119], a[12:15]
  ds_read_b64_tr_b16 a[176:177], v6 offset:16384
  v_add_u32 v10, 0x80000, v10
  v_mfma_f32_16x16x32_bf16 a[16:19], a[112:115], a[224:227], a[16:19]
  s_add_u32 m0, s80, 0
  v_mfma_f32_16x16x32_bf16 a[16:19], a[116:119], a[228:231], a[16:19]
  ds_read_b64_tr_b16 a[178:179], v6 offset:17408
  v_mfma_f32_16x16x32_bf16 a[20:23], a[112:115], a[232:235], a[20:23]
  ds_read_b64_tr_b16 a[180:181], v6 offset:20480
  v_mfma_f32_16x16x32_bf16 a[20:23], a[116:119], a[236:239], a[20:23]
  buffer_load_dwordx4 v8, s[8:11], s64 offen offset:0 lds
  v_mfma_f32_16x16x32_bf16 a[24:27], a[112:115], a[240:243], a[24:27]
  ds_read_b64_tr_b16 a[182:183], v6 offset:21504
  v_mfma_f32_16x16x32_bf16 a[24:27], a[116:119], a[244:247], a[24:27]
  ds_read_b64_tr_b16 a[184:185], v7 offset:16384
  v_mfma_f32_16x16x32_bf16 a[28:31], a[112:115], a[248:251], a[28:31]
  v_mfma_f32_16x16x32_bf16 a[28:31], a[116:119], a[252:255], a[28:31]
  ds_read_b64_tr_b16 a[186:187], v7 offset:17408
  v_mfma_f32_16x16x32_bf16 a[32:35], a[192:195], a[120:123], a[32:35]
  ds_read_b128 a[112:115], v2 offset:12288
  ds_read_b128 a[116:119], v3 offset:12288
  v_mfma_f32_16x16x32_bf16 a[32:35], a[196:199], a[124:127], a[32:35]
  buffer_load_dwordx4 v9, s[8:11], s65 offen offset:1024 lds
  v_mfma_f32_16x16x32_bf16 a[36:39], a[200:203], a[120:123], a[36:39]
  ds_read_b64_tr_b16 a[188:189], v7 offset:20480
  ds_read_b64_tr_b16 a[190:191], v7 offset:21504
  v_mfma_f32_16x16x32_bf16 a[36:39], a[204:207], a[124:127], a[36:39]
  v_mfma_f32_16x16x32_bf16 a[40:43], a[208:211], a[120:123], a[40:43]
  v_mfma_f32_16x16x32_bf16 a[40:43], a[212:215], a[124:127], a[40:43]
  v_mfma_f32_16x16x32_bf16 a[44:47], a[216:219], a[120:123], a[44:47]
  buffer_load_dwordx4 v8, s[8:11], s66 offen offset:2048 lds
  v_mfma_f32_16x16x32_bf16 a[44:47], a[220:223], a[124:127], a[44:47]
  v_mfma_f32_16x16x32_bf16 a[48:51], a[120:123], a[224:227], a[48:51]
  v_mfma_f32_16x16x32_bf16 a[48:51], a[124:127], a[228:231], a[48:51]
  v_mfma_f32_16x16x32_bf16 a[52:55], a[120:123], a[232:235], a[52:55]
  v_mfma_f32_16x16x32_bf16 a[52:55], a[124:127], a[236:239], a[52:55]
  buffer_load_dwordx4 v9, s[8:11], s67 offen offset:3072 lds
  v_mfma_f32_16x16x32_bf16 a[56:59], a[120:123], a[240:243], a[56:59]
  s_add_u32 m0, s80, 4096
  v_mfma_f32_16x16x32_bf16 a[56:59], a[124:127], a[244:247], a[56:59]
  v_mfma_f32_16x16x32_bf16 a[60:63], a[120:123], a[248:251], a[60:63]
  v_mfma_f32_16x16x32_bf16 a[60:63], a[124:127], a[252:255], a[60:63]
  s_waitcnt lgkmcnt(0)
  v_mfma_f32_16x16x32_bf16 v[64:67], a[128:131], a[64:67], v[64:67]
  ds_read_b128 a[120:123], v2 offset:14336
  ds_read_b128 a[124:127], v3 offset:14336
  v_mfma_f32_16x16x32_bf16 v[64:67], a[132:135], a[68:71], v[64:67]
  buffer_load_dwordx4 v11, s[8:11], s64 offen offset:0 lds
  v_mfma_f32_16x16x32_bf16 v[68:71], a[136:139], a[64:67], v[68:71]
  v_xor_b32 v2, 0x10000, v2
  v_xor_b32 v3, 0x10000, v3
  v_mfma_f32_16x16x32_bf16 v[68:71], a[140:143], a[68:71], v[68:71]
  v_xor_b32 v4, 0x10000, v4
  v_xor_b32 v5, 0x10000, v5
  v_mfma_f32_16x16x32_bf16 v[72:75], a[144:147], a[64:67], v[72:75]
  v_xor_b32 v6, 0x10000, v6
  v_xor_b32 v7, 0x10000, v7
  v_mfma_f32_16x16x32_bf16 v[72:75], a[148:151], a[68:71], v[72:75]
  v_mfma_f32_16x16x32_bf16 v[76:79], a[152:155], a[64:67], v[76:79]
  buffer_load_dwordx4 v12, s[8:11], s65 offen offset:1024 lds
  v_mfma_f32_16x16x32_bf16 v[76:79], a[156:159], a[68:71], v[76:79]
  v_mfma_f32_16x16x32_bf16 v[80:83], a[64:67], a[160:163], v[80:83]
  v_mfma_f32_16x16x32_bf16 v[80:83], a[68:71], a[164:167], v[80:83]
  v_mfma_f32_16x16x32_bf16 v[84:87], a[64:67], a[168:171], v[84:87]
  v_mfma_f32_16x16x32_bf16 v[84:87], a[68:71], a[172:175], v[84:87]
  buffer_load_dwordx4 v11, s[8:11], s66 offen offset:2048 lds
  v_mfma_f32_16x16x32_bf16 v[88:91], a[64:67], a[176:179], v[88:91]
  v_mfma_f32_16x16x32_bf16 v[88:91], a[68:71], a[180:183], v[88:91]
  v_mfma_f32_16x16x32_bf16 v[92:95], a[64:67], a[184:187], v[92:95]
  v_mfma_f32_16x16x32_bf16 v[92:95], a[68:71], a[188:191], v[92:95]
  v_mfma_f32_16x16x32_bf16 v[96:99], a[128:131], a[72:75], v[96:99]
  buffer_load_dwordx4 v12, s[8:11], s67 offen offset:3072 lds
  v_mfma_f32_16x16x32_bf16 v[96:99], a[132:135], a[76:79], v[96:99]
  s_mov_b32 m0, 0x27000
  v_add_u32 v8, 128, v8
  v_add_u32 v9, 128, v9
  v_mfma_f32_16x16x32_bf16 v[100:103], a[136:139], a[72:75], v[100:103]
  v_add_u32 v11, 128, v11
  v_add_u32 v12, 128, v12
  v_mfma_f32_16x16x32_bf16 v[100:103], a[140:143], a[76:79], v[100:103]
  s_xor_b32 s80, s80, 0x10000
  v_mfma_f32_16x16x32_bf16 v[104:107], a[144:147], a[72:75], v[104:107]
  buffer_load_dword v50, s[84:87], 0 offen offset:0 lds
  v_mfma_f32_16x16x32_bf16 v[104:107], a[148:151], a[76:79], v[104:107]
  s_mov_b32 s16, s58
  s_mov_b32 s17, s59
  s_mov_b32 s18, 256
  v_mfma_f32_16x16x32_bf16 v[108:111], a[152:155], a[72:75], v[108:111]
  buffer_load_dword v30, off, s[16:19], 0 sc1
  v_mfma_f32_16x16x32_bf16 v[108:111], a[156:159], a[76:79], v[108:111]
  v_add_u32 v51, 0x100000, v51
  v_mfma_f32_16x16x32_bf16 v[112:115], a[72:75], a[160:163], v[112:115]
  s_mov_b32 m0, 0x27000
  v_mfma_f32_16x16x32_bf16 v[112:115], a[76:79], a[164:167], v[112:115]
  buffer_load_dword v51, s[12:15], 0 offen offset:0 lds
  v_mfma_f32_16x16x32_bf16 v[116:119], a[72:75], a[168:171], v[116:119]
  v_mfma_f32_16x16x32_bf16 v[116:119], a[76:79], a[172:175], v[116:119]
  v_mfma_f32_16x16x32_bf16 v[120:123], a[72:75], a[176:179], v[120:123]
  v_mfma_f32_16x16x32_bf16 v[120:123], a[76:79], a[180:183], v[120:123]
  v_mfma_f32_16x16x32_bf16 v[124:127], a[72:75], a[184:187], v[124:127]
  v_mfma_f32_16x16x32_bf16 v[124:127], a[76:79], a[188:191], v[124:127]
  v_mfma_f32_16x16x32_bf16 v[128:131], a[128:131], a[80:83], v[128:131]
  v_mfma_f32_16x16x32_bf16 v[128:131], a[132:135], a[84:87], v[128:131]
  v_mfma_f32_16x16x32_bf16 v[132:135], a[136:139], a[80:83], v[132:135]
  v_mfma_f32_16x16x32_bf16 v[132:135], a[140:143], a[84:87], v[132:135]
  v_mfma_f32_16x16x32_bf16 v[136:139], a[144:147], a[80:83], v[136:139]
  v_mfma_f32_16x16x32_bf16 v[136:139], a[148:151], a[84:87], v[136:139]
  v_mfma_f32_16x16x32_bf16 v[140:143], a[152:155], a[80:83], v[140:143]
  v_mfma_f32_16x16x32_bf16 v[140:143], a[156:159], a[84:87], v[140:143]
  v_mfma_f32_16x16x32_bf16 v[144:147], a[80:83], a[160:163], v[144:147]
  v_mfma_f32_16x16x32_bf16 v[144:147], a[84:87], a[164:167], v[144:147]
  v_mfma_f32_16x16x32_bf16 v[148:151], a[80:83], a[168:171], v[148:151]
  v_mfma_f32_16x16x32_bf16 v[148:151], a[84:87], a[172:175], v[148:151]
  v_mfma_f32_16x16x32_bf16 v[152:155], a[80:83], a[176:179], v[152:155]
  v_mfma_f32_16x16x32_bf16 v[152:155], a[84:87], a[180:183], v[152:155]
  v_mfma_f32_16x16x32_bf16 v[156:159], a[80:83], a[184:187], v[156:159]
  v_mfma_f32_16x16x32_bf16 v[156:159], a[84:87], a[188:191], v[156:159]
  v_mfma_f32_16x16x32_bf16 v[160:163], a[128:131], a[88:91], v[160:163]
  v_mfma_f32_16x16x32_bf16 v[160:163], a[132:135], a[92:95], v[160:163]
  v_mfma_f32_16x16x32_bf16 v[164:167], a[136:139], a[88:91], v[164:167]
  v_mfma_f32_16x16x32_bf16 v[164:167], a[140:143], a[92:95], v[164:167]
  v_mfma_f32_16x16x32_bf16 v[168:171], a[144:147], a[88:91], v[168:171]
  v_mfma_f32_16x16x32_bf16 v[168:171], a[148:151], a[92:95], v[168:171]
  v_mfma_f32_16x16x32_bf16 v[172:175], a[152:155], a[88:91], v[172:175]
  v_mfma_f32_16x16x32_bf16 v[172:175], a[156:159], a[92:95], v[172:175]
  v_mfma_f32_16x16x32_bf16 v[176:179], a[88:91], a[160:163], v[176:179]
  v_mfma_f32_16x16x32_bf16 v[176:179], a[92:95], a[164:167], v[176:179]
  v_mfma_f32_16x16x32_bf16 v[180:183], a[88:91], a[168:171], v[180:183]
  s_waitcnt vmcnt(3) lgkmcnt(0)
  s_barrier
  v_mfma_f32_16x16x32_bf16 v[180:183], a[92:95], a[172:175], v[180:183]
  s_add_u32 m0, s80, 32768
  ds_read_b32 v32, v63 offset:512
  ds_read_b32 v33, v63 offset:640
  v_mfma_f32_16x16x32_bf16 v[184:187], a[88:91], a[176:179], v[184:187]
  buffer_load_dwordx4 v10, s[12:15], s72 offen offset:0 lds
  v_mfma_f32_16x16x32_bf16 v[184:187], a[92:95], a[180:183], v[184:187]
  ds_read_b128 a[64:67], v2 offset:0
  ds_read_b128 a[68:71], v3 offset:0
  v_mfma_f32_16x16x32_bf16 v[188:191], a[88:91], a[184:187], v[188:191]
  ds_read_b64_tr_b16 a[192:193], v4 offset:0
  ds_read_b64_tr_b16 a[194:195], v4 offset:1024
  v_mfma_f32_16x16x32_bf16 v[188:191], a[92:95], a[188:191], v[188:191]
  ds_read_b64_tr_b16 a[196:197], v4 offset:4096
  ds_read_b32 v34, v63 offset:768
  v_mfma_f32_16x16x32_bf16 v[192:195], a[128:131], a[96:99], v[192:195]
  ds_read_b32 v35, v63 offset:896
  ds_read_b32 v36, v63 offset:1056
  v_mfma_f32_16x16x32_bf16 v[192:195], a[132:135], a[100:103], v[192:195]
  buffer_load_dwordx4 v10, s[12:15], s73 offen offset:1024 lds
  v_mfma_f32_16x16x32_bf16 v[196:199], a[136:139], a[96:99], v[196:199]
  ds_read_b128 a[72:75], v2 offset:2048
  ds_read_b128 a[76:79], v3 offset:2048
  v_mfma_f32_16x16x32_bf16 v[196:199], a[140:143], a[100:103], v[196:199]
  ds_read_b64_tr_b16 a[198:199], v4 offset:5120
  ds_read_b64_tr_b16 a[200:201], v5 offset:0
  v_mfma_f32_16x16x32_bf16 v[200:203], a[144:147], a[96:99], v[200:203]
  ds_read_b64_tr_b16 a[202:203], v5 offset:1024
  ds_read_b32 v37, v63 offset:1184
  v_mfma_f32_16x16x32_bf16 v[200:203], a[148:151], a[100:103], v[200:203]
  ds_read_b32 v38, v63 offset:1312
  ds_read_b32 v39, v63 offset:1440
  v_mfma_f32_16x16x32_bf16 v[204:207], a[152:155], a[96:99], v[204:207]
  buffer_load_dwordx4 v10, s[12:15], s74 offen offset:2048 lds
  v_mfma_f32_16x16x32_bf16 v[204:207], a[156:159], a[100:103], v[204:207]
  ds_read_b128 a[80:83], v2 offset:4096
  ds_read_b128 a[84:87], v3 offset:4096
  v_mfma_f32_16x16x32_bf16 v[208:211], a[96:99], a[160:163], v[208:211]
  ds_read_b64_tr_b16 a[204:205], v5 offset:4096
  ds_read_b64_tr_b16 a[206:207], v5 offset:5120
  v_mfma_f32_16x16x32_bf16 v[208:211], a[100:103], a[164:167], v[208:211]
  ds_read_b32 v40, v63 offset:1568
  ds_read_b32 v41, v63 offset:1696
  v_mfma_f32_16x16x32_bf16 v[212:215], a[96:99], a[168:171], v[212:215]
  ds_read_b64_tr_b16 a[208:209], v6 offset:0
  ds_read_b32 v42, v63 offset:1824
  v_mfma_f32_16x16x32_bf16 v[212:215], a[100:103], a[172:175], v[212:215]
  buffer_load_dwordx4 v10, s[12:15], s75 offen offset:3072 lds
  v_mfma_f32_16x16x32_bf16 v[216:219], a[96:99], a[176:179], v[216:219]
  s_add_u32 m0, s80, 36864
  ds_read_b128 a[88:91], v2 offset:6144
  ds_read_b128 a[92:95], v3 offset:6144
  v_mfma_f32_16x16x32_bf16 v[216:219], a[100:103], a[180:183], v[216:219]
  ds_read_b64_tr_b16 a[210:211], v6 offset:1024
  ds_read_b64_tr_b16 a[212:213], v6 offset:4096
  v_mfma_f32_16x16x32_bf16 v[220:223], a[96:99], a[184:187], v[220:223]
  ds_read_b32 v43, v63 offset:1952
  ds_read_b32 v44, v63 offset:10400
  v_mfma_f32_16x16x32_bf16 v[220:223], a[100:103], a[188:191], v[220:223]
  ds_read_b64_tr_b16 a[214:215], v6 offset:5120
  ds_read_b32 v45, v63 offset:10560
  v_mfma_f32_16x16x32_bf16 v[224:227], a[128:131], a[104:107], v[224:227]
  buffer_load_dwordx4 v10, s[12:15], s76 offen offset:0 lds
  v_mfma_f32_16x16x32_bf16 v[224:227], a[132:135], a[108:111], v[224:227]
  ds_read_b128 a[96:99], v2 offset:8192
  ds_read_b128 a[100:103], v3 offset:8192
  v_mfma_f32_16x16x32_bf16 v[228:231], a[136:139], a[104:107], v[228:231]
  ds_read_b64_tr_b16 a[216:217], v7 offset:0
  ds_read_b64_tr_b16 a[218:219], v7 offset:1024
  v_mfma_f32_16x16x32_bf16 v[228:231], a[140:143], a[108:111], v[228:231]
  ds_read_b32 v46, v63 offset:10688
  ds_read_b32 v47, v63 offset:10816
  v_mfma_f32_16x16x32_bf16 v[232:235], a[144:147], a[104:107], v[232:235]
  ds_read_b64_tr_b16 a[220:221], v7 offset:4096
  ds_read_b32 v48, v63 offset:10944
  v_mfma_f32_16x16x32_bf16 v[232:235], a[148:151], a[108:111], v[232:235]
  buffer_load_dwordx4 v10, s[12:15], s77 offen offset:1024 lds
  v_mfma_f32_16x16x32_bf16 v[236:239], a[152:155], a[104:107], v[236:239]
  ds_read_b64_tr_b16 a[222:223], v7 offset:5120
  ds_read_b32 v49, v63 offset:11072
  v_mfma_f32_16x16x32_bf16 v[236:239], a[156:159], a[108:111], v[236:239]
  ds_read_b32 v50, v63 offset:11200
  ds_read_b32 v51, v63 offset:11328
  v_mfma_f32_16x16x32_bf16 v[240:243], a[104:107], a[160:163], v[240:243]
  ds_read_b64_tr_b16 a[224:225], v4 offset:16384
  ds_read_b32 v52, v63 offset:11456
  v_mfma_f32_16x16x32_bf16 v[240:243], a[108:111], a[164:167], v[240:243]
  ds_read_b64_tr_b16 a[226:227], v4 offset:17408
  v_mfma_f32_16x16x32_bf16 v[244:247], a[104:107], a[168:171], v[244:247]
  buffer_load_dwordx4 v10, s[12:15], s78 offen offset:2048 lds
  v_mfma_f32_16x16x32_bf16 v[244:247], a[108:111], a[172:175], v[244:247]
  ds_read_b64_tr_b16 a[228:229], v4 offset:20480
  v_mfma_f32_16x16x32_bf16 v[248:251], a[104:107], a[176:179], v[248:251]
  s_waitcnt lgkmcnt(2)
  v_lshlrev_b32 v24, 16, v56
  v_and_b32 v25, 0xffff0000, v56
  v_mfma_f32_16x16x32_bf16 v[248:251], a[108:111], a[180:183], v[248:251]
  ds_read_b64_tr_b16 a[230:231], v4 offset:21504
  v_lshlrev_b32 v26, 16, v57
  v_mfma_f32_16x16x32_bf16 v[252:255], a[104:107], a[184:187], v[252:255]
  v_and_b32 v27, 0xffff0000, v57
  v_lshlrev_b32 v61, 16, v32
  v_mfma_f32_16x16x32_bf16 v[252:255], a[108:111], a[188:191], v[252:255]
  buffer_load_dwordx4 v10, s[12:15], s79 offen offset:3072 lds
  v_mfma_f32_16x16x32_bf16 a[0:3], a[128:131], a[112:115], a[0:3]
  ds_read_b128 a[104:107], v2 offset:10240
  ds_read_b128 a[108:111], v3 offset:10240
  v_mfma_f32_16x16x32_bf16 a[0:3], a[132:135], a[116:119], a[0:3]
  ds_read_b64_tr_b16 a[232:233], v5 offset:16384
  v_add_u32 v10, 0x80000, v10
  v_mfma_f32_16x16x32_bf16 a[4:7], a[136:139], a[112:115], a[4:7]
  s_add_u32 m0, s80, 0
  ds_read_b64_tr_b16 a[234:235], v5 offset:17408
  ds_read_b64_tr_b16 a[236:237], v5 offset:20480
  v_mfma_f32_16x16x32_bf16 a[4:7], a[140:143], a[116:119], a[4:7]
  v_lshlrev_b32 v62, 16, v33
  v_lshlrev_b32 v63, 16, v34
  v_mfma_f32_16x16x32_bf16 a[8:11], a[144:147], a[112:115], a[8:11]
  buffer_load_dwordx4 v8, s[8:11], s64 offen offset:0 lds
  v_mfma_f32_16x16x32_bf16 a[8:11], a[148:151], a[116:119], a[8:11]
  ds_read_b64_tr_b16 a[238:239], v5 offset:21504
  v_lshlrev_b32 v28, 16, v35
  v_mfma_f32_16x16x32_bf16 a[12:15], a[152:155], a[112:115], a[12:15]
  ds_read_b64_tr_b16 a[240:241], v6 offset:16384
  v_mul_f32 v54, v61, v27
  v_mfma_f32_16x16x32_bf16 a[12:15], a[156:159], a[116:119], a[12:15]
  ds_read_b64_tr_b16 a[242:243], v6 offset:17408
  v_fmac_f32 v54, v62, v26
  v_mfma_f32_16x16x32_bf16 a[16:19], a[112:115], a[160:163], a[16:19]
  v_lshlrev_b32 v31, 16, v44
  v_fmac_f32 v54, v63, v25
  v_mfma_f32_16x16x32_bf16 a[16:19], a[116:119], a[164:167], a[16:19]
  buffer_load_dwordx4 v9, s[8:11], s65 offen offset:1024 lds
  v_mfma_f32_16x16x32_bf16 a[20:23], a[112:115], a[168:171], a[20:23]
  ds_read_b64_tr_b16 a[244:245], v6 offset:20480
  v_fmac_f32 v54, v28, v24
  v_mfma_f32_16x16x32_bf16 a[20:23], a[116:119], a[172:175], a[20:23]
  ds_read_b64_tr_b16 a[246:247], v6 offset:21504
  v_mul_f32 v54, v54, v31
  v_mfma_f32_16x16x32_bf16 a[24:27], a[112:115], a[176:179], a[24:27]
  v_lshlrev_b32 v61, 16, v36
  v_mul_f32 v60, v62, v27
  v_mfma_f32_16x16x32_bf16 a[24:27], a[116:119], a[180:183], a[24:27]
  ds_read_b64_tr_b16 a[248:249], v7 offset:16384
  v_fmac_f32 v60, v63, v26
  v_mfma_f32_16x16x32_bf16 a[28:31], a[112:115], a[184:187], a[28:31]
  buffer_load_dwordx4 v8, s[8:11], s66 offen offset:2048 lds
  v_mfma_f32_16x16x32_bf16 a[28:31], a[116:119], a[188:191], a[28:31]
  ds_read_b64_tr_b16 a[250:251], v7 offset:17408
  v_lshlrev_b32 v31, 16, v45
  v_mfma_f32_16x16x32_bf16 a[32:35], a[128:131], a[120:123], a[32:35]
  ds_read_b128 a[112:115], v2 offset:12288
  ds_read_b128 a[116:119], v3 offset:12288
  v_mfma_f32_16x16x32_bf16 a[32:35], a[132:135], a[124:127], a[32:35]
  ds_read_b64_tr_b16 a[252:253], v7 offset:20480
  v_fmac_f32 v60, v28, v25
  v_mfma_f32_16x16x32_bf16 a[36:39], a[136:139], a[120:123], a[36:39]
  ds_read_b64_tr_b16 a[254:255], v7 offset:21504
  v_fmac_f32 v60, v61, v24
  v_mfma_f32_16x16x32_bf16 a[36:39], a[140:143], a[124:127], a[36:39]
  buffer_load_dwordx4 v9, s[8:11], s67 offen offset:3072 lds
  v_mfma_f32_16x16x32_bf16 a[40:43], a[144:147], a[120:123], a[40:43]
  s_add_u32 m0, s80, 4096
  v_mul_f32 v60, v60, v31
  v_cvt_pk_bf16_f32 v19, v60, v54
  v_mfma_f32_16x16x32_bf16 a[40:43], a[148:151], a[124:127], a[40:43]
  v_lshlrev_b32 v62, 16, v37
  v_mul_f32 v54, v63, v27
  v_mfma_f32_16x16x32_bf16 a[44:47], a[152:155], a[120:123], a[44:47]
  v_fmac_f32 v54, v28, v26
  v_lshlrev_b32 v31, 16, v46
  v_mfma_f32_16x16x32_bf16 a[44:47], a[156:159], a[124:127], a[44:47]
  v_fmac_f32 v54, v61, v25
  v_fmac_f32 v54, v62, v24
  v_mfma_f32_16x16x32_bf16 a[48:51], a[120:123], a[160:163], a[48:51]
  buffer_load_dwordx4 v11, s[8:11], s64 offen offset:0 lds
  v_mfma_f32_16x16x32_bf16 a[48:51], a[124:127], a[164:167], a[48:51]
  v_mul_f32 v54, v54, v31
  v_cvt_pk_bf16_f32 v23, v54, v60
  v_mfma_f32_16x16x32_bf16 a[52:55], a[120:123], a[168:171], a[52:55]
  v_lshlrev_b32 v63, 16, v38
  v_mul_f32 v60, v28, v27
  v_mfma_f32_16x16x32_bf16 a[52:55], a[124:127], a[172:175], a[52:55]
  v_fmac_f32 v60, v61, v26
  v_lshlrev_b32 v31, 16, v47
  v_mfma_f32_16x16x32_bf16 a[56:59], a[120:123], a[176:179], a[56:59]
  v_fmac_f32 v60, v62, v25
  v_fmac_f32 v60, v63, v24
  v_mfma_f32_16x16x32_bf16 a[56:59], a[124:127], a[180:183], a[56:59]
  buffer_load_dwordx4 v12, s[8:11], s65 offen offset:1024 lds
  v_mfma_f32_16x16x32_bf16 a[60:63], a[120:123], a[184:187], a[60:63]
  v_mul_f32 v60, v60, v31
  v_cvt_pk_bf16_f32 v18, v60, v54
  v_mfma_f32_16x16x32_bf16 a[60:63], a[124:127], a[188:191], a[60:63]
  s_waitcnt lgkmcnt(0)
  v_lshlrev_b32 v28, 16, v39
  v_mul_f32 v54, v61, v27
  v_mfma_f32_16x16x32_bf16 v[64:67], a[192:195], a[64:67], v[64:67]
  ds_read_b128 a[120:123], v2 offset:14336
  ds_read_b128 a[124:127], v3 offset:14336
  v_mfma_f32_16x16x32_bf16 v[64:67], a[196:199], a[68:71], v[64:67]
  v_fmac_f32 v54, v62, v26
  v_lshlrev_b32 v31, 16, v48
  v_mfma_f32_16x16x32_bf16 v[68:71], a[200:203], a[64:67], v[68:71]
  v_xor_b32 v2, 0x10000, v2
  v_xor_b32 v3, 0x10000, v3
  v_mfma_f32_16x16x32_bf16 v[68:71], a[204:207], a[68:71], v[68:71]
  v_xor_b32 v4, 0x10000, v4
  v_xor_b32 v5, 0x10000, v5
  v_mfma_f32_16x16x32_bf16 v[72:75], a[208:211], a[64:67], v[72:75]
  v_xor_b32 v6, 0x10000, v6
  v_xor_b32 v7, 0x10000, v7
  v_mfma_f32_16x16x32_bf16 v[72:75], a[212:215], a[68:71], v[72:75]
  buffer_load_dwordx4 v11, s[8:11], s66 offen offset:2048 lds
  v_mfma_f32_16x16x32_bf16 v[76:79], a[216:219], a[64:67], v[76:79]
  v_fmac_f32 v54, v63, v25
  v_fmac_f32 v54, v28, v24
  v_mfma_f32_16x16x32_bf16 v[76:79], a[220:223], a[68:71], v[76:79]
  v_mul_f32 v54, v54, v31
  v_cvt_pk_bf16_f32 v22, v54, v60
  v_mfma_f32_16x16x32_bf16 v[80:83], a[64:67], a[224:227], v[80:83]
  v_lshlrev_b32 v61, 16, v40
  v_mul_f32 v60, v62, v27
  v_mfma_f32_16x16x32_bf16 v[80:83], a[68:71], a[228:231], v[80:83]
  v_fmac_f32 v60, v63, v26
  v_lshlrev_b32 v31, 16, v49
  v_mfma_f32_16x16x32_bf16 v[84:87], a[64:67], a[232:235], v[84:87]
  buffer_load_dwordx4 v12, s[8:11], s67 offen offset:3072 lds
  v_mfma_f32_16x16x32_bf16 v[84:87], a[68:71], a[236:239], v[84:87]
  s_mov_b32 m0, 0x27000
  v_add_u32 v8, 128, v8
  v_add_u32 v9, 128, v9
  v_mfma_f32_16x16x32_bf16 v[88:91], a[64:67], a[240:243], v[88:91]
  v_add_u32 v11, 128, v11
  v_add_u32 v12, 128, v12
  v_mfma_f32_16x16x32_bf16 v[88:91], a[68:71], a[244:247], v[88:91]
  s_xor_b32 s80, s80, 0x10000
  v_fmac_f32 v60, v28, v25
  v_fmac_f32 v60, v61, v24
  v_mfma_f32_16x16x32_bf16 v[92:95], a[64:67], a[248:251], v[92:95]
  buffer_load_dword v55, s[88:91], 0 offen offset:0 lds
  v_mfma_f32_16x16x32_bf16 v[92:95], a[68:71], a[252:255], v[92:95]
  v_mul_f32 v60, v60, v31
  v_cvt_pk_bf16_f32 v17, v60, v54
  v_mfma_f32_16x16x32_bf16 v[96:99], a[192:195], a[72:75], v[96:99]
  v_lshlrev_b32 v62, 16, v41
  v_mul_f32 v54, v63, v27
  v_mfma_f32_16x16x32_bf16 v[96:99], a[196:199], a[76:79], v[96:99]
  v_fmac_f32 v54, v28, v26
  v_lshlrev_b32 v31, 16, v50
  v_mfma_f32_16x16x32_bf16 v[100:103], a[200:203], a[72:75], v[100:103]
  v_fmac_f32 v54, v61, v25
  v_fmac_f32 v54, v62, v24
  v_mfma_f32_16x16x32_bf16 v[100:103], a[204:207], a[76:79], v[100:103]
  v_mul_f32 v54, v54, v31
  v_cvt_pk_bf16_f32 v21, v54, v60
  v_mfma_f32_16x16x32_bf16 v[104:107], a[208:211], a[72:75], v[104:107]
  v_lshlrev_b32 v63, 16, v42
  v_mul_f32 v60, v28, v27
  v_mfma_f32_16x16x32_bf16 v[104:107], a[212:215], a[76:79], v[104:107]
  v_fmac_f32 v60, v61, v26
  v_lshlrev_b32 v31, 16, v51
  v_mfma_f32_16x16x32_bf16 v[108:111], a[216:219], a[72:75], v[108:111]
  v_fmac_f32 v60, v62, v25
  v_fmac_f32 v60, v63, v24
  v_mfma_f32_16x16x32_bf16 v[108:111], a[220:223], a[76:79], v[108:111]
  v_mul_f32 v60, v60, v31
  v_cvt_pk_bf16_f32 v16, v60, v54
  v_mfma_f32_16x16x32_bf16 v[112:115], a[72:75], a[224:227], v[112:115]
  v_lshlrev_b32 v28, 16, v43
  v_mul_f32 v54, v61, v27
  v_mfma_f32_16x16x32_bf16 v[112:115], a[76:79], a[228:231], v[112:115]
  v_fmac_f32 v54, v62, v26
  v_lshlrev_b32 v31, 16, v52
  v_mfma_f32_16x16x32_bf16 v[116:119], a[72:75], a[232:235], v[116:119]
  v_fmac_f32 v54, v63, v25
  v_fmac_f32 v54, v28, v24
  v_mfma_f32_16x16x32_bf16 v[116:119], a[76:79], a[236:239], v[116:119]
  v_mul_f32 v54, v54, v31
  v_cvt_pk_bf16_f32 v20, v54, v60
  v_mfma_f32_16x16x32_bf16 v[120:123], a[72:75], a[240:243], v[120:123]
  s_mov_b32 s24, 0
  v_mfma_f32_16x16x32_bf16 v[120:123], a[76:79], a[244:247], v[120:123]
  buffer_store_dwordx4 v[16:19], v53, s[20:23], s24 offen
  v_mfma_f32_16x16x32_bf16 v[124:127], a[72:75], a[248:251], v[124:127]
  s_mov_b32 s24, 4096
  v_mfma_f32_16x16x32_bf16 v[124:127], a[76:79], a[252:255], v[124:127]
  buffer_store_dwordx4 v[20:23], v53, s[20:23], s24 offen
  v_mfma_f32_16x16x32_bf16 v[128:131], a[192:195], a[80:83], v[128:131]
  v_lshlrev_b32 v24, 16, v58
  v_and_b32 v25, 0xffff0000, v58
  v_mfma_f32_16x16x32_bf16 v[128:131], a[196:199], a[84:87], v[128:131]
  v_lshlrev_b32 v26, 16, v59
  v_and_b32 v27, 0xffff0000, v59
  v_mfma_f32_16x16x32_bf16 v[132:135], a[200:203], a[80:83], v[132:135]
  v_and_b32 v61, 0xffff0000, v32
  v_and_b32 v62, 0xffff0000, v33
  v_mfma_f32_16x16x32_bf16 v[132:135], a[204:207], a[84:87], v[132:135]
  v_and_b32 v63, 0xffff0000, v34
  v_and_b32 v28, 0xffff0000, v35
  v_mfma_f32_16x16x32_bf16 v[136:139], a[208:211], a[80:83], v[136:139]
  v_mul_f32 v54, v61, v27
  v_fmac_f32 v54, v62, v26
  v_mfma_f32_16x16x32_bf16 v[136:139], a[212:215], a[84:87], v[136:139]
  v_and_b32 v31, 0xffff0000, v44
  v_fmac_f32 v54, v63, v25
  v_mfma_f32_16x16x32_bf16 v[140:143], a[216:219], a[80:83], v[140:143]
  v_fmac_f32 v54, v28, v24
  v_mul_f32 v54, v54, v31
  v_mfma_f32_16x16x32_bf16 v[140:143], a[220:223], a[84:87], v[140:143]
  v_and_b32 v61, 0xffff0000, v36
  v_mul_f32 v60, v62, v27
  v_mfma_f32_16x16x32_bf16 v[144:147], a[80:83], a[224:227], v[144:147]
  v_fmac_f32 v60, v63, v26
  v_and_b32 v31, 0xffff0000, v45
  v_mfma_f32_16x16x32_bf16 v[144:147], a[84:87], a[228:231], v[144:147]
  v_fmac_f32 v60, v28, v25
  v_fmac_f32 v60, v61, v24
  v_mfma_f32_16x16x32_bf16 v[148:151], a[80:83], a[232:235], v[148:151]
  v_mul_f32 v60, v60, v31
  v_cvt_pk_bf16_f32 v19, v60, v54
  v_mfma_f32_16x16x32_bf16 v[148:151], a[84:87], a[236:239], v[148:151]
  v_and_b32 v62, 0xffff0000, v37
  v_mul_f32 v54, v63, v27
  v_mfma_f32_16x16x32_bf16 v[152:155], a[80:83], a[240:243], v[152:155]
  v_fmac_f32 v54, v28, v26
  v_and_b32 v31, 0xffff0000, v46
  v_mfma_f32_16x16x32_bf16 v[152:155], a[84:87], a[244:247], v[152:155]
  v_fmac_f32 v54, v61, v25
  v_fmac_f32 v54, v62, v24
  v_mfma_f32_16x16x32_bf16 v[156:159], a[80:83], a[248:251], v[156:159]
  v_mul_f32 v54, v54, v31
  v_cvt_pk_bf16_f32 v23, v54, v60
  v_mfma_f32_16x16x32_bf16 v[156:159], a[84:87], a[252:255], v[156:159]
  v_and_b32 v63, 0xffff0000, v38
  v_mul_f32 v60, v28, v27
  v_mfma_f32_16x16x32_bf16 v[160:163], a[192:195], a[88:91], v[160:163]
  v_fmac_f32 v60, v61, v26
  v_and_b32 v31, 0xffff0000, v47
  v_mfma_f32_16x16x32_bf16 v[160:163], a[196:199], a[92:95], v[160:163]
  v_fmac_f32 v60, v62, v25
  v_fmac_f32 v60, v63, v24
  v_mfma_f32_16x16x32_bf16 v[164:167], a[200:203], a[88:91], v[164:167]
  v_mul_f32 v60, v60, v31
  v_cvt_pk_bf16_f32 v18, v60, v54
  v_mfma_f32_16x16x32_bf16 v[164:167], a[204:207], a[92:95], v[164:167]
  v_and_b32 v28, 0xffff0000, v39
  v_mul_f32 v54, v61, v27
  v_mfma_f32_16x16x32_bf16 v[168:171], a[208:211], a[88:91], v[168:171]
  s_waitcnt vmcnt(3) lgkmcnt(0)
  s_barrier
  v_fmac_f32 v54, v62, v26
  v_mfma_f32_16x16x32_bf16 v[168:171], a[212:215], a[92:95], v[168:171]
  s_add_u32 m0, s80, 32768
  v_readfirstlane_b32 s92, v30
  v_and_b32 v31, 0xffff0000, v48
  v_mfma_f32_16x16x32_bf16 v[172:175], a[216:219], a[88:91], v[172:175]
  buffer_load_dwordx4 v10, s[12:15], s72 offen offset:0 lds
  v_mfma_f32_16x16x32_bf16 v[172:175], a[220:223], a[92:95], v[172:175]
  ds_read_b128 a[64:67], v2 offset:0
  ds_read_b128 a[68:71], v3 offset:0
  v_mfma_f32_16x16x32_bf16 v[176:179], a[88:91], a[224:227], v[176:179]
  ds_read_b64_tr_b16 a[128:129], v4 offset:0
  ds_read_b64_tr_b16 a[130:131], v4 offset:1024
  v_mfma_f32_16x16x32_bf16 v[176:179], a[92:95], a[228:231], v[176:179]
  ds_read_b64_tr_b16 a[132:133], v4 offset:4096
  v_fmac_f32 v54, v63, v25
  v_mfma_f32_16x16x32_bf16 v[180:183], a[88:91], a[232:235], v[180:183]
  s_cmp_eq_u32 s92, 0
  s_cbranch_scc1 nspin
nspun:
  v_fmac_f32 v54, v28, v24
  v_mfma_f32_16x16x32_bf16 v[180:183], a[92:95], a[236:239], v[180:183]
  buffer_load_dwordx4 v10, s[12:15], s73 offen offset:1024 lds
  v_mfma_f32_16x16x32_bf16 v[184:187], a[88:91], a[240:243], v[184:187]
  s_or_b32 s92, s92, s38
  ds_read_b128 a[72:75], v2 offset:2048
  ds_read_b128 a[76:79], v3 offset:2048
  v_mfma_f32_16x16x32_bf16 v[184:187], a[92:95], a[244:247], v[184:187]
  ds_read_b64_tr_b16 a[134:135], v4 offset:5120
  ds_read_b64_tr_b16 a[136:137], v5 offset:0
  v_mfma_f32_16x16x32_bf16 v[188:191], a[88:91], a[248:251], v[188:191]
  v_mov_b32 v30, s92
  v_mul_f32 v54, v54, v31
  v_mfma_f32_16x16x32_bf16 v[188:191], a[92:95], a[252:255], v[188:191]
  ds_read_b64_tr_b16 a[138:139], v5 offset:1024
  v_cvt_pk_bf16_f32 v22, v54, v60
  v_mfma_f32_16x16x32_bf16 v[192:195], a[192:195], a[96:99], v[192:195]
  buffer_load_dwordx4 v10, s[12:15], s74 offen offset:2048 lds
  v_mfma_f32_16x16x32_bf16 v[192:195], a[196:199], a[100:103], v[192:195]
  ds_read_b128 a[80:83], v2 offset:4096
  ds_read_b128 a[84:87], v3 offset:4096
  v_mfma_f32_16x16x32_bf16 v[196:199], a[200:203], a[96:99], v[196:199]
  ds_read_b64_tr_b16 a[140:141], v5 offset:4096
  v_and_b32 v61, 0xffff0000, v40
  v_mfma_f32_16x16x32_bf16 v[196:199], a[204:207], a[100:103], v[196:199]
  ds_read_b64_tr_b16 a[142:143], v5 offset:5120
  v_mul_f32 v60, v62, v27
  v_mfma_f32_16x16x32_bf16 v[200:203], a[208:211], a[96:99], v[200:203]
  v_fmac_f32 v60, v63, v26
  v_and_b32 v31, 0xffff0000, v49
  v_mfma_f32_16x16x32_bf16 v[200:203], a[212:215], a[100:103], v[200:203]
  buffer_load_dwordx4 v10, s[12:15], s75 offen offset:3072 lds
  v_mfma_f32_16x16x32_bf16 v[204:207], a[216:219], a[96:99], v[204:207]
  s_add_u32 m0, s80, 36864
  ds_read_b128 a[88:91], v2 offset:6144
  ds_read_b128 a[92:95], v3 offset:6144
  v_mfma_f32_16x16x32_bf16 v[204:207], a[220:223], a[100:103], v[204:207]
  ds_read_b64_tr_b16 a[144:145], v6 offset:0
  ds_read_b64_tr_b16 a[146:147], v6 offset:1024
  v_mfma_f32_16x16x32_bf16 v[208:211], a[96:99], a[224:227], v[208:211]
  v_fmac_f32 v60, v28, v25
  v_fmac_f32 v60, v61, v24
  v_mfma_f32_16x16x32_bf16 v[208:211], a[100:103], a[228:231], v[208:211]
  ds_read_b64_tr_b16 a[148:149], v6 offset:4096
  v_mul_f32 v60, v60, v31
  v_mfma_f32_16x16x32_bf16 v[212:215], a[96:99], a[232:235], v[212:215]
  buffer_load_dwordx4 v10, s[12:15], s76 offen offset:0 lds
  v_mfma_f32_16x16x32_bf16 v[212:215], a[100:103], a[236:239], v[212:215]
  ds_read_b64_tr_b16 a[150:151], v6 offset:5120
  v_cvt_pk_bf16_f32 v17, v60, v54
  v_mfma_f32_16x16x32_bf16 v[216:219], a[96:99], a[240:243], v[216:219]
  v_and_b32 v62, 0xffff0000, v41
  v_mul_f32 v54, v63, v27
  v_mfma_f32_16x16x32_bf16 v[216:219], a[100:103], a[244:247], v[216:219]
  ds_read_b64_tr_b16 a[152:153], v7 offset:0
  v_fmac_f32 v54, v28, v26
  v_mfma_f32_16x16x32_bf16 v[220:223], a[96:99], a[248:251], v[220:223]
  v_and_b32 v31, 0xffff0000, v50
  v_fmac_f32 v54, v61, v25
  v_mfma_f32_16x16x32_bf16 v[220:223], a[100:103], a[252:255], v[220:223]
  buffer_load_dwordx4 v10, s[12:15], s77 offen offset:1024 lds
  v_mfma_f32_16x16x32_bf16 v[224:227], a[192:195], a[104:107], v[224:227]
  ds_read_b128 a[96:99], v2 offset:8192
  ds_read_b128 a[100:103], v3 offset:8192
  v_mfma_f32_16x16x32_bf16 v[224:227], a[196:199], a[108:111], v[224:227]
  ds_read_b64_tr_b16 a[154:155], v7 offset:1024
  ds_read_b64_tr_b16 a[156:157], v7 offset:4096
  v_mfma_f32_16x16x32_bf16 v[228:231], a[200:203], a[104:107], v[228:231]
  v_fmac_f32 v54, v62, v24
  v_mul_f32 v54, v54, v31
  v_mfma_f32_16x16x32_bf16 v[228:231], a[204:207], a[108:111], v[228:231]
  ds_read_b64_tr_b16 a[158:159], v7 offset:5120
  v_cvt_pk_bf16_f32 v21, v54, v60
  v_mfma_f32_16x16x32_bf16 v[232:235], a[208:211], a[104:107], v[232:235]
  buffer_load_dwordx4 v10, s[12:15], s78 offen offset:2048 lds
  v_mfma_f32_16x16x32_bf16 v[232:235], a[212:215], a[108:111], v[232:235]
  ds_read_b64_tr_b16 a[160:161], v4 offset:16384
  v_and_b32 v63, 0xffff0000, v42
  v_mfma_f32_16x16x32_bf16 v[236:239], a[216:219], a[104:107], v[236:239]
  ds_read_b64_tr_b16 a[162:163], v4 offset:17408
  v_mul_f32 v60, v28, v27
  v_mfma_f32_16x16x32_bf16 v[236:239], a[220:223], a[108:111], v[236:239]
  v_fmac_f32 v60, v61, v26
  v_and_b32 v31, 0xffff0000, v51
  v_mfma_f32_16x16x32_bf16 v[240:243], a[104:107], a[224:227], v[240:243]
  ds_read_b64_tr_b16 a[164:165], v4 offset:20480
  v_fmac_f32 v60, v62, v25
  v_mfma_f32_16x16x32_bf16 v[240:243], a[108:111], a[228:231], v[240:243]
  buffer_load_dwordx4 v10, s[12:15], s79 offen offset:3072 lds
  v_mfma_f32_16x16x32_bf16 v[244:247], a[104:107], a[232:235], v[244:247]
  ds_read_b64_tr_b16 a[166:167], v4 offset:21504
  v_add_u32 v10, 0x80000, v10
  v_mfma_f32_16x16x32_bf16 v[244:247], a[108:111], a[236:239], v[244:247]
  s_add_u32 m0, s80, 0
  v_fmac_f32 v60, v63, v24
  v_mul_f32 v60, v60, v31
  v_mfma_f32_16x16x32_bf16 v[248:251], a[104:107], a[240:243], v[248:251]
  ds_read_b64_tr_b16 a[168:169], v5 offset:16384
  v_cvt_pk_bf16_f32 v16, v60, v54
  v_mfma_f32_16x16x32_bf16 v[248:251], a[108:111], a[244:247], v[248:251]
  v_and_b32 v28, 0xffff0000, v43
  v_mul_f32 v54, v61, v27
  v_mfma_f32_16x16x32_bf16 v[252:255], a[104:107], a[248:251], v[252:255]
  buffer_load_dwordx4 v8, s[8:11], s64 offen offset:0 lds
  v_mfma_f32_16x16x32_bf16 v[252:255], a[108:111], a[252:255], v[252:255]
  ds_read_b64_tr_b16 a[170:171], v5 offset:17408
  v_fmac_f32 v54, v62, v26
  v_mfma_f32_16x16x32_bf16 a[0:3], a[192:195], a[112:115], a[0:3]
  ds_read_b128 a[104:107], v2 offset:10240
  ds_read_b128 a[108:111], v3 offset:10240
  v_mfma_f32_16x16x32_bf16 a[0:3], a[196:199], a[116:119], a[0:3]
  ds_read_b64_tr_b16 a[172:173], v5 offset:20480
  v_and_b32 v31, 0xffff0000, v52
  v_mfma_f32_16x16x32_bf16 a[4:7], a[200:203], a[112:115], a[4:7]
  ds_read_b64_tr_b16 a[174:175], v5 offset:21504
  v_fmac_f32 v54, v63, v25
  v_mfma_f32_16x16x32_bf16 a[4:7], a[204:207], a[116:119], a[4:7]
  buffer_load_dwordx4 v9, s[8:11], s65 offen offset:1024 lds
  v_mfma_f32_16x16x32_bf16 a[8:11], a[208:211], a[112:115], a[8:11]
  ds_read_b64_tr_b16 a[176:177], v6 offset:16384
  v_fmac_f32 v54, v28, v24
  v_mfma_f32_16x16x32_bf16 a[8:11], a[212:215], a[116:119], a[8:11]
  v_mul_f32 v54, v54, v31
  v_cvt_pk_bf16_f32 v20, v54, v60
  v_mfma_f32_16x16x32_bf16 a[12:15], a[216:219], a[112:115], a[12:15]
  s_mov_b32 s24, 8192
  ds_read_b64_tr_b16 a[178:179], v6 offset:17408
  v_mfma_f32_16x16x32_bf16 a[12:15], a[220:223], a[116:119], a[12:15]
  v_mfma_f32_16x16x32_bf16 a[16:19], a[112:115], a[224:227], a[16:19]
  buffer_load_dwordx4 v8, s[8:11], s66 offen offset:2048 lds
  v_mfma_f32_16x16x32_bf16 a[16:19], a[116:119], a[228:231], a[16:19]
  ds_read_b64_tr_b16 a[180:181], v6 offset:20480
  v_mfma_f32_16x16x32_bf16 a[20:23], a[112:115], a[232:235], a[20:23]
  ds_read_b64_tr_b16 a[182:183], v6 offset:21504
  v_mfma_f32_16x16x32_bf16 a[20:23], a[116:119], a[236:239], a[20:23]
  buffer_store_dwordx4 v[16:19], v53, s[20:23], s24 offen
  v_mfma_f32_16x16x32_bf16 a[24:27], a[112:115], a[240:243], a[24:27]
  s_mov_b32 s24, 12288
  ds_read_b64_tr_b16 a[184:185], v7 offset:16384
  v_mfma_f32_16x16x32_bf16 a[24:27], a[116:119], a[244:247], a[24:27]
  buffer_load_dwordx4 v9, s[8:11], s67 offen offset:3072 lds
  v_mfma_f32_16x16x32_bf16 a[28:31], a[112:115], a[248:251], a[28:31]
  s_add_u32 m0, s80, 4096
  ds_read_b64_tr_b16 a[186:187], v7 offset:17408
  v_mfma_f32_16x16x32_bf16 a[28:31], a[116:119], a[252:255], a[28:31]
  buffer_store_dwordx4 v[20:23], v53, s[20:23], s24 offen
  v_mfma_f32_16x16x32_bf16 a[32:35], a[192:195], a[120:123], a[32:35]
  ds_read_b128 a[112:115], v2 offset:12288
  ds_read_b128 a[116:119], v3 offset:12288
  v_mfma_f32_16x16x32_bf16 a[32:35], a[196:199], a[124:127], a[32:35]
  ds_read_b64_tr_b16 a[188:189], v7 offset:20480
  v_mfma_f32_16x16x32_bf16 a[36:39], a[200:203], a[120:123], a[36:39]
  buffer_load_dwordx4 v11, s[8:11], s64 offen offset:0 lds
  v_mfma_f32_16x16x32_bf16 a[36:39], a[204:207], a[124:127], a[36:39]
  ds_read_b64_tr_b16 a[190:191], v7 offset:21504
  v_mfma_f32_16x16x32_bf16 a[40:43], a[208:211], a[120:123], a[40:43]
  v_mfma_f32_16x16x32_bf16 a[40:43], a[212:215], a[124:127], a[40:43]
  v_mfma_f32_16x16x32_bf16 a[44:47], a[216:219], a[120:123], a[44:47]
  v_mfma_f32_16x16x32_bf16 a[44:47], a[220:223], a[124:127], a[44:47]
  buffer_load_dwordx4 v12, s[8:11], s65 offen offset:1024 lds
  v_mfma_f32_16x16x32_bf16 a[48:51], a[120:123], a[224:227], a[48:51]
  v_mfma_f32_16x16x32_bf16 a[48:51], a[124:127], a[228:231], a[48:51]
  v_mfma_f32_16x16x32_bf16 a[52:55], a[120:123], a[232:235], a[52:55]
  v_mfma_f32_16x16x32_bf16 a[52:55], a[124:127], a[236:239], a[52:55]
  v_mfma_f32_16x16x32_bf16 a[56:59], a[120:123], a[240:243], a[56:59]
  buffer_load_dwordx4 v11, s[8:11], s66 offen offset:2048 lds
  v_mfma_f32_16x16x32_bf16 a[56:59], a[124:127], a[244:247], a[56:59]
  v_mfma_f32_16x16x32_bf16 a[60:63], a[120:123], a[248:251], a[60:63]
  v_mfma_f32_16x16x32_bf16 a[60:63], a[124:127], a[252:255], a[60:63]
  s_waitcnt lgkmcnt(0)
  v_mfma_f32_16x16x32_bf16 v[64:67], a[128:131], a[64:67], v[64:67]
  ds_read_b128 a[120:123], v2 offset:14336
  ds_read_b128 a[124:127], v3 offset:14336
  v_mfma_f32_16x16x32_bf16 v[64:67], a[132:135], a[68:71], v[64:67]
  buffer_load_dwordx4 v12, s[8:11], s67 offen offset:3072 lds
  v_mfma_f32_16x16x32_bf16 v[68:71], a[136:139], a[64:67], v[68:71]
  s_mov_b32 s16, s54
  v_xor_b32 v2, 0x10000, v2
  v_xor_b32 v3, 0x10000, v3
  v_mfma_f32_16x16x32_bf16 v[68:71], a[140:143], a[68:71], v[68:71]
  s_mov_b32 s17, s55
  v_xor_b32 v4, 0x10000, v4
  v_xor_b32 v5, 0x10000, v5
  v_mfma_f32_16x16x32_bf16 v[72:75], a[144:147], a[64:67], v[72:75]
  s_mov_b32 s18, 4194304
  v_xor_b32 v6, 0x10000, v6
  v_xor_b32 v7, 0x10000, v7
  v_mfma_f32_16x16x32_bf16 v[72:75], a[148:151], a[68:71], v[72:75]
  v_add_u32 v8, 128, v8
  v_add_u32 v9, 128, v9
  v_mfma_f32_16x16x32_bf16 v[76:79], a[152:155], a[64:67], v[76:79]
  v_add_u32 v11, 128, v11
  v_add_u32 v12, 128, v12
  v_mfma_f32_16x16x32_bf16 v[76:79], a[156:159], a[68:71], v[76:79]
  s_xor_b32 s80, s80, 0x10000
  v_lshlrev_b32 v55, 8, v29
  v_mfma_f32_16x16x32_bf16 v[80:83], a[64:67], a[160:163], v[80:83]
  s_mov_b32 m0, 0x27000
  v_mfma_f32_16x16x32_bf16 v[80:83], a[68:71], a[164:167], v[80:83]
  buffer_load_dword v55, s[16:19], s36 offen lds
  v_mfma_f32_16x16x32_bf16 v[84:87], a[64:67], a[168:171], v[84:87]
  v_mfma_f32_16x16x32_bf16 v[84:87], a[68:71], a[172:175], v[84:87]
  buffer_store_dword v30, v29, s[20:23], s93 offen sc1
  v_mfma_f32_16x16x32_bf16 v[88:91], a[64:67], a[176:179], v[88:91]
  v_mfma_f32_16x16x32_bf16 v[88:91], a[68:71], a[180:183], v[88:91]
  v_mfma_f32_16x16x32_bf16 v[92:95], a[64:67], a[184:187], v[92:95]
  v_mfma_f32_16x16x32_bf16 v[92:95], a[68:71], a[188:191], v[92:95]
  v_mfma_f32_16x16x32_bf16 v[96:99], a[128:131], a[72:75], v[96:99]
  v_mfma_f32_16x16x32_bf16 v[96:99], a[132:135], a[76:79], v[96:99]
  v_mfma_f32_16x16x32_bf16 v[100:103], a[136:139], a[72:75], v[100:103]
  v_mfma_f32_16x16x32_bf16 v[100:103], a[140:143], a[76:79], v[100:103]
  v_mfma_f32_16x16x32_bf16 v[104:107], a[144:147], a[72:75], v[104:107]
  v_mfma_f32_16x16x32_bf16 v[104:107], a[148:151], a[76:79], v[104:107]
  v_mfma_f32_16x16x32_bf16 v[108:111], a[152:155], a[72:75], v[108:111]
  v_mfma_f32_16x16x32_bf16 v[108:111], a[156:159], a[76:79], v[108:111]
  v_mfma_f32_16x16x32_bf16 v[112:115], a[72:75], a[160:163], v[112:115]
  v_mfma_f32_16x16x32_bf16 v[112:115], a[76:79], a[164:167], v[112:115]
  v_mfma_f32_16x16x32_bf16 v[116:119], a[72:75], a[168:171], v[116:119]
  v_mfma_f32_16x16x32_bf16 v[116:119], a[76:79], a[172:175], v[116:119]
  v_mfma_f32_16x16x32_bf16 v[120:123], a[72:75], a[176:179], v[120:123]
  v_mfma_f32_16x16x32_bf16 v[120:123], a[76:79], a[180:183], v[120:123]
  v_mfma_f32_16x16x32_bf16 v[124:127], a[72:75], a[184:187], v[124:127]
  v_mfma_f32_16x16x32_bf16 v[124:127], a[76:79], a[188:191], v[124:127]
  v_mfma_f32_16x16x32_bf16 v[128:131], a[128:131], a[80:83], v[128:131]
  v_mfma_f32_16x16x32_bf16 v[128:131], a[132:135], a[84:87], v[128:131]
  v_mfma_f32_16x16x32_bf16 v[132:135], a[136:139], a[80:83], v[132:135]
  v_mfma_f32_16x16x32_bf16 v[132:135], a[140:143], a[84:87], v[132:135]
  v_mfma_f32_16x16x32_bf16 v[136:139], a[144:147], a[80:83], v[136:139]
  v_mfma_f32_16x16x32_bf16 v[136:139], a[148:151], a[84:87], v[136:139]
  v_mfma_f32_16x16x32_bf16 v[140:143], a[152:155], a[80:83], v[140:143]
  v_mfma_f32_16x16x32_bf16 v[140:143], a[156:159], a[84:87], v[140:143]
  v_mfma_f32_16x16x32_bf16 v[144:147], a[80:83], a[160:163], v[144:147]
  v_mfma_f32_16x16x32_bf16 v[144:147], a[84:87], a[164:167], v[144:147]
  v_mfma_f32_16x16x32_bf16 v[148:151], a[80:83], a[168:171], v[148:151]
  v_mfma_f32_16x16x32_bf16 v[148:151], a[84:87], a[172:175], v[148:151]
  v_mfma_f32_16x16x32_bf16 v[152:155], a[80:83], a[176:179], v[152:155]
  v_mfma_f32_16x16x32_bf16 v[152:155], a[84:87], a[180:183], v[152:155]
  v_mfma_f32_16x16x32_bf16 v[156:159], a[80:83], a[184:187], v[156:159]
  s_waitcnt vmcnt(2) lgkmcnt(0)
  s_barrier
  v_mfma_f32_16x16x32_bf16 v[156:159], a[84:87], a[188:191], v[156:159]
  s_add_u32 m0, s80, 32768
  v_mfma_f32_16x16x32_bf16 v[160:163], a[128:131], a[88:91], v[160:163]
  buffer_load_dwordx4 v10, s[12:15], s72 offen offset:0 lds
  v_mfma_f32_16x16x32_bf16 v[160:163], a[132:135], a[92:95], v[160:163]
  ds_read_b128 a[64:67], v2 offset:0
  ds_read_b128 a[68:71], v3 offset:0
  v_mfma_f32_16x16x32_bf16 v[164:167], a[136:139], a[88:91], v[164:167]
  ds_read_b64_tr_b16 a[192:193], v4 offset:0
  ds_read_b64_tr_b16 a[194:195], v4 offset:1024
  v_mfma_f32_16x16x32_bf16 v[164:167], a[140:143], a[92:95], v[164:167]
  v_mfma_f32_16x16x32_bf16 v[168:171], a[144:147], a[88:91], v[168:171]
  ds_read_b64_tr_b16 a[196:197], v4 offset:4096
  v_mfma_f32_16x16x32_bf16 v[168:171], a[148:151], a[92:95], v[168:171]
  buffer_load_dwordx4 v10, s[12:15], s73 offen offset:1024 lds
  v_mfma_f32_16x16x32_bf16 v[172:175], a[152:155], a[88:91], v[172:175]
  ds_read_b128 a[72:75], v2 offset:2048
  ds_read_b128 a[76:79], v3 offset:2048
  v_mfma_f32_16x16x32_bf16 v[172:175], a[156:159], a[92:95], v[172:175]
  ds_read_b64_tr_b16 a[198:199], v4 offset:5120
  v_mfma_f32_16x16x32_bf16 v[176:179], a[88:91], a[160:163], v[176:179]
  ds_read_b64_tr_b16 a[200:201], v5 offset:0
  v_mfma_f32_16x16x32_bf16 v[176:179], a[92:95], a[164:167], v[176:179]
  v_mfma_f32_16x16x32_bf16 v[180:183], a[88:91], a[168:171], v[180:183]
  buffer_load_dwordx4 v10, s[12:15], s74 offen offset:2048 lds
  v_mfma_f32_16x16x32_bf16 v[180:183], a[92:95], a[172:175], v[180:183]
  ds_read_b128 a[80:83], v2 offset:4096
  ds_read_b128 a[84:87], v3 offset:4096
  v_mfma_f32_16x16x32_bf16 v[184:187], a[88:91], a[176:179], v[184:187]
  ds_read_b64_tr_b16 a[202:203], v5 offset:1024
  ds_read_b64_tr_b16 a[204:205], v5 offset:4096
  v_mfma_f32_16x16x32_bf16 v[184:187], a[92:95], a[180:183], v[184:187]
  v_mfma_f32_16x16x32_bf16 v[188:191], a[88:91], a[184:187], v[188:191]
  ds_read_b64_tr_b16 a[206:207], v5 offset:5120
  v_mfma_f32_16x16x32_bf16 v[188:191], a[92:95], a[188:191], v[188:191]
  buffer_load_dwordx4 v10, s[12:15], s75 offen offset:3072 lds
  v_mfma_f32_16x16x32_bf16 v[192:195], a[128:131], a[96:99], v[192:195]
  s_add_u32 m0, s80, 36864
  ds_read_b128 a[88:91], v2 offset:6144
  ds_read_b128 a[92:95], v3 offset:6144
  v_mfma_f32_16x16x32_bf16 v[192:195], a[132:135], a[100:103], v[192:195]
  ds_read_b64_tr_b16 a[208:209], v6 offset:0
  v_mfma_f32_16x16x32_bf16 v[196:199], a[136:139], a[96:99], v[196:199]
  v_mfma_f32_16x16x32_bf16 v[196:199], a[140:143], a[100:103], v[196:199]
  ds_read_b64_tr_b16 a[210:211], v6 offset:1024
  v_mfma_f32_16x16x32_bf16 v[200:203], a[144:147], a[96:99], v[200:203]
  buffer_load_dwordx4 v10, s[12:15], s76 offen offset:0 lds
  v_mfma_f32_16x16x32_bf16 v[200:203], a[148:151], a[100:103], v[200:203]
  ds_read_b64_tr_b16 a[212:213], v6 offset:4096
  v_mfma_f32_16x16x32_bf16 v[204:207], a[152:155], a[96:99], v[204:207]
  v_mfma_f32_16x16x32_bf16 v[204:207], a[156:159], a[100:103], v[204:207]
  ds_read_b64_tr_b16 a[214:215], v6 offset:5120
  v_mfma_f32_16x16x32_bf16 v[208:211], a[96:99], a[160:163], v[208:211]
  v_mfma_f32_16x16x32_bf16 v[208:211], a[100:103], a[164:167], v[208:211]
  buffer_load_dwordx4 v10, s[12:15], s77 offen offset:1024 lds
  v_mfma_f32_16x16x32_bf16 v[212:215], a[96:99], a[168:171], v[212:215]
  ds_read_b64_tr_b16 a[216:217], v7 offset:0
  v_mfma_f32_16x16x32_bf16 v[212:215], a[100:103], a[172:175], v[212:215]
  ds_read_b64_tr_b16 a[218:219], v7 offset:1024
  v_mfma_f32_16x16x32_bf16 v[216:219], a[96:99], a[176:179], v[216:219]
  v_mfma_f32_16x16x32_bf16 v[216:219], a[100:103], a[180:183], v[216:219]
  ds_read_b64_tr_b16 a[220:221], v7 offset:4096
  v_mfma_f32_16x16x32_bf16 v[220:223], a[96:99], a[184:187], v[220:223]
  buffer_load_dwordx4 v10, s[12:15], s78 offen offset:2048 lds
  v_mfma_f32_16x16x32_bf16 v[220:223], a[100:103], a[188:191], v[220:223]
  ds_read_b64_tr_b16 a[222:223], v7 offset:5120
  v_mfma_f32_16x16x32_bf16 v[224:227], a[128:131], a[104:107], v[224:227]
  ds_read_b128 a[96:99], v2 offset:8192
  ds_read_b128 a[100:103], v3 offset:8192
  v_mfma_f32_16x16x32_bf16 v[224:227], a[132:135], a[108:111], v[224:227]
  v_mfma_f32_16x16x32_bf16 v[228:231], a[136:139], a[104:107], v[228:231]
  ds_read_b64_tr_b16 a[224:225], v4 offset:16384
  v_mfma_f32_16x16x32_bf16 v[228:231], a[140:143], a[108:111], v[228:231]
  buffer_load_dwordx4 v10, s[12:15], s79 offen offset:3072 lds
  v_mfma_f32_16x16x32_bf16 v[232:235], a[144:147], a[104:107], v[232:235]
  ds_read_b64_tr_b16 a[226:227], v4 offset:17408
  v_add_u32 v10, 0x80000, v10
  v_mfma_f32_16x16x32_bf16 v[232:235], a[148:151], a[108:111], v[232:235]
  s_add_u32 m0, s80, 0
  v_mfma_f32_16x16x32_bf16 v[236:239], a[152:155], a[104:107], v[236:239]
  ds_read_b64_tr_b16 a[228:229], v4 offset:20480
  v_mfma_f32_16x16x32_bf16 v[236:239], a[156:159], a[108:111], v[236:239]
  v_mfma_f32_16x16x32_bf16 v[240:243], a[104:107], a[160:163], v[240:243]
  buffer_load_dwordx4 v8, s[8:11], s64 offen offset:0 lds
  v_mfma_f32_16x16x32_bf16 v[240:243], a[108:111], a[164:167], v[240:243]
  ds_read_b64_tr_b16 a[230:231], v4 offset:21504
  v_mfma_f32_16x16x32_bf16 v[244:247], a[104:107], a[168:171], v[244:247]
  ds_read_b64_tr_b16 a[232:233], v5 offset:16384
  v_mfma_f32_16x16x32_bf16 v[244:247], a[108:111], a[172:175], v[244:247]
  v_mfma_f32_16x16x32_bf16 v[248:251], a[104:107], a[176:179], v[248:251]
  ds_read_b64_tr_b16 a[234:235], v5 offset:17408
  v_mfma_f32_16x16x32_bf16 v[248:251], a[108:111], a[180:183], v[248:251]
  buffer_load_dwordx4 v9, s[8:11], s65 offen offset:1024 lds
  v_mfma_f32_16x16x32_bf16 v[252:255], a[104:107], a[184:187], v[252:255]
  ds_read_b64_tr_b16 a[236:237], v5 offset:20480
  v_mfma_f32_16x16x32_bf16 v[252:255], a[108:111], a[188:191], v[252:255]
  v_mfma_f32_16x16x32_bf16 a[0:3], a[128:131], a[112:115], a[0:3]
  ds_read_b128 a[104:107], v2 offset:10240
  ds_read_b128 a[108:111], v3 offset:10240
  v_mfma_f32_16x16x32_bf16 a[0:3], a[132:135], a[116:119], a[0:3]
  ds_read_b64_tr_b16 a[238:239], v5 offset:21504
  v_mfma_f32_16x16x32_bf16 a[4:7], a[136:139], a[112:115], a[4:7]
  buffer_load_dwordx4 v8, s[8:11], s66 offen offset:2048 lds
  v_mfma_f32_16x16x32_bf16 a[4:7], a[140:143], a[116:119], a[4:7]
  ds_read_b64_tr_b16 a[240:241], v6 offset:16384
  v_mfma_f32_16x16x32_bf16 a[8:11], a[144:147], a[112:115], a[8:11]
  v_mfma_f32_16x16x32_bf16 a[8:11], a[148:151], a[116:119], a[8:11]
  ds_read_b64_tr_b16 a[242:243], v6 offset:17408
  v_mfma_f32_16x16x32_bf16 a[12:15], a[152:155], a[112:115], a[12:15]
  v_mfma_f32_16x16x32_bf16 a[12:15], a[156:159], a[116:119], a[12:15]
  buffer_load_dwordx4 v9, s[8:11], s67 offen offset:3072 lds
  v_mfma_f32_16x16x32_bf16 a[16:19], a[112:115], a[160:163], a[16:19]
  s_add_u32 m0, s80, 4096
  ds_read_b64_tr_b16 a[244:245], v6 offset:20480
  v_mfma_f32_16x16x32_bf16 a[16:19], a[116:119], a[164:167], a[16:19]
  ds_read_b64_tr_b16 a[246:247], v6 offset:21504
  v_mfma_f32_16x16x32_bf16 a[20:23], a[112:115], a[168:171], a[20:23]
  v_mfma_f32_16x16x32_bf16 a[20:23], a[116:119], a[172:175], a[20:23]
  ds_read_b64_tr_b16 a[248:249], v7 offset:16384
  v_mfma_f32_16x16x32_bf16 a[24:27], a[112:115], a[176:179], a[24:27]
  buffer_load_dwordx4 v11, s[8:11], s64 offen offset:0 lds
  v_mfma_f32_16x16x32_bf16 a[24:27], a[116:119], a[180:183], a[24:27]
  ds_read_b64_tr_b16 a[250:251], v7 offset:17408
  v_mfma_f32_16x16x32_bf16 a[28:31], a[112:115], a[184:187], a[28:31]
  v_mfma_f32_16x16x32_bf16 a[28:31], a[116:119], a[188:191], a[28:31]
  ds_read_b64_tr_b16 a[252:253], v7 offset:20480
  v_mfma_f32_16x16x32_bf16 a[32:35], a[128:131], a[120:123], a[32:35]
  ds_read_b128 a[112:115], v2 offset:12288
  ds_read_b128 a[116:119], v3 offset:12288
  v_mfma_f32_16x16x32_bf16 a[32:35], a[132:135], a[124:127], a[32:35]
  buffer_load_dwordx4 v12, s[8:11], s65 offen offset:1024 lds
  v_mfma_f32_16x16x32_bf16 a[36:39], a[136:139], a[120:123], a[36:39]
  ds_read_b64_tr_b16 a[254:255], v7 offset:21504
  v_mfma_f32_16x16x32_bf16 a[36:39], a[140:143], a[124:127], a[36:39]
  v_mfma_f32_16x16x32_bf16 a[40:43], a[144:147], a[120:123], a[40:43]
  v_mfma_f32_16x16x32_bf16 a[40:43], a[148:151], a[124:127], a[40:43]
  v_mfma_f32_16x16x32_bf16 a[44:47], a[152:155], a[120:123], a[44:47]
  buffer_load_dwordx4 v11, s[8:11], s66 offen offset:2048 lds
  v_mfma_f32_16x16x32_bf16 a[44:47], a[156:159], a[124:127], a[44:47]
  v_mfma_f32_16x16x32_bf16 a[48:51], a[120:123], a[160:163], a[48:51]
  v_mfma_f32_16x16x32_bf16 a[48:51], a[124:127], a[164:167], a[48:51]
  v_mfma_f32_16x16x32_bf16 a[52:55], a[120:123], a[168:171], a[52:55]
  v_mfma_f32_16x16x32_bf16 a[52:55], a[124:127], a[172:175], a[52:55]
  buffer_load_dwordx4 v12, s[8:11], s67 offen offset:3072 lds
  v_mfma_f32_16x16x32_bf16 a[56:59], a[120:123], a[176:179], a[56:59]
  s_lshl_b32 s24, s5, 8
  v_add_u32 v8, 128, v8
  v_add_u32 v9, 128, v9
  v_mfma_f32_16x16x32_bf16 a[56:59], a[124:127], a[180:183], a[56:59]
  s_lshl_b32 s25, s6, 2
  v_add_u32 v11, 128, v11
  v_add_u32 v12, 128, v12
  v_mfma_f32_16x16x32_bf16 a[60:63], a[120:123], a[184:187], a[60:63]
  s_xor_b32 s80, s80, 0x10000
  s_add_u32 s24, s24, s25
  s_add_u32 s24, s24, s4
  v_mfma_f32_16x16x32_bf16 a[60:63], a[124:127], a[188:191], a[60:63]
  s_waitcnt lgkmcnt(0)
  s_add_u32 s24, s24, 0
  s_lshl_b32 s24, s24, 12
  v_mfma_f32_16x16x32_bf16 v[64:67], a[192:195], a[64:67], v[64:67]
  ds_read_b128 a[120:123], v2 offset:14336
  ds_read_b128 a[124:127], v3 offset:14336
  v_mfma_f32_16x16x32_bf16 v[64:67], a[196:199], a[68:71], v[64:67]
  v_lshlrev_b32 v55, 5, v29
  v_mfma_f32_16x16x32_bf16 v[68:71], a[200:203], a[64:67], v[68:71]
  v_xor_b32 v2, 0x10000, v2
  v_xor_b32 v3, 0x10000, v3
  v_mfma_f32_16x16x32_bf16 v[68:71], a[204:207], a[68:71], v[68:71]
  v_xor_b32 v4, 0x10000, v4
  v_xor_b32 v5, 0x10000, v5
  v_mfma_f32_16x16x32_bf16 v[72:75], a[208:211], a[64:67], v[72:75]
  v_xor_b32 v6, 0x10000, v6
  v_xor_b32 v7, 0x10000, v7
  v_mfma_f32_16x16x32_bf16 v[72:75], a[212:215], a[68:71], v[72:75]
  buffer_load_dword v16, v55, s[20:23], s24 offen
  v_mfma_f32_16x16x32_bf16 v[76:79], a[216:219], a[64:67], v[76:79]
  v_mfma_f32_16x16x32_bf16 v[76:79], a[220:223], a[68:71], v[76:79]
  v_mfma_f32_16x16x32_bf16 v[80:83], a[64:67], a[224:227], v[80:83]
  v_mfma_f32_16x16x32_bf16 v[80:83], a[68:71], a[228:231], v[80:83]
  v_mfma_f32_16x16x32_bf16 v[84:87], a[64:67], a[232:235], v[84:87]
  v_mfma_f32_16x16x32_bf16 v[84:87], a[68:71], a[236:239], v[84:87]
  v_mfma_f32_16x16x32_bf16 v[88:91], a[64:67], a[240:243], v[88:91]
  v_mfma_f32_16x16x32_bf16 v[88:91], a[68:71], a[244:247], v[88:91]
  v_mfma_f32_16x16x32_bf16 v[92:95], a[64:67], a[248:251], v[92:95]
  v_mfma_f32_16x16x32_bf16 v[92:95], a[68:71], a[252:255], v[92:95]
  v_mfma_f32_16x16x32_bf16 v[96:99], a[192:195], a[72:75], v[96:99]
  v_mfma_f32_16x16x32_bf16 v[96:99], a[196:199], a[76:79], v[96:99]
  v_mfma_f32_16x16x32_bf16 v[100:103], a[200:203], a[72:75], v[100:103]
  v_mfma_f32_16x16x32_bf16 v[100:103], a[204:207], a[76:79], v[100:103]
  v_mfma_f32_16x16x32_bf16 v[104:107], a[208:211], a[72:75], v[104:107]
  v_mfma_f32_16x16x32_bf16 v[104:107], a[212:215], a[76:79], v[104:107]
  v_mfma_f32_16x16x32_bf16 v[108:111], a[216:219], a[72:75], v[108:111]
  v_mfma_f32_16x16x32_bf16 v[108:111], a[220:223], a[76:79], v[108:111]
  v_mfma_f32_16x16x32_bf16 v[112:115], a[72:75], a[224:227], v[112:115]
  v_mfma_f32_16x16x32_bf16 v[112:115], a[76:79], a[228:231], v[112:115]
  v_mfma_f32_16x16x32_bf16 v[116:119], a[72:75], a[232:235], v[116:119]
  v_mfma_f32_16x16x32_bf16 v[116:119], a[76:79], a[236:239], v[116:119]
  v_mfma_f32_16x16x32_bf16 v[120:123], a[72:75], a[240:243], v[120:123]
  v_mfma_f32_16x16x32_bf16 v[120:123], a[76:79], a[244:247], v[120:123]
  v_mfma_f32_16x16x32_bf16 v[124:127], a[72:75], a[248:251], v[124:127]
  v_mfma_f32_16x16x32_bf16 v[124:127], a[76:79], a[252:255], v[124:127]
  v_mfma_f32_16x16x32_bf16 v[128:131], a[192:195], a[80:83], v[128:131]
  v_mfma_f32_16x16x32_bf16 v[128:131], a[196:199], a[84:87], v[128:131]
  v_mfma_f32_16x16x32_bf16 v[132:135], a[200:203], a[80:83], v[132:135]
  v_mfma_f32_16x16x32_bf16 v[132:135], a[204:207], a[84:87], v[132:135]
  v_mfma_f32_16x16x32_bf16 v[136:139], a[208:211], a[80:83], v[136:139]
  v_mfma_f32_16x16x32_bf16 v[136:139], a[212:215], a[84:87], v[136:139]
  v_mfma_f32_16x16x32_bf16 v[140:143], a[216:219], a[80:83], v[140:143]
  v_mfma_f32_16x16x32_bf16 v[140:143], a[220:223], a[84:87], v[140:143]
  v_mfma_f32_16x16x32_bf16 v[144:147], a[80:83], a[224:227], v[144:147]
  s_waitcnt vmcnt(1) lgkmcnt(0)
  s_barrier
  v_mfma_f32_16x16x32_bf16 v[144:147], a[84:87], a[228:231], v[144:147]
  s_add_u32 m0, s80, 32768
  v_mfma_f32_16x16x32_bf16 v[148:151], a[80:83], a[232:235], v[148:151]
  buffer_load_dwordx4 v10, s[12:15], s72 offen offset:0 lds
  v_mfma_f32_16x16x32_bf16 v[148:151], a[84:87], a[236:239], v[148:151]
  ds_read_b128 a[64:67], v2 offset:0
  ds_read_b128 a[68:71], v3 offset:0
  v_mfma_f32_16x16x32_bf16 v[152:155], a[80:83], a[240:243], v[152:155]
  ds_read_b64_tr_b16 a[128:129], v4 offset:0
  ds_read_b64_tr_b16 a[130:131], v4 offset:1024
  v_mfma_f32_16x16x32_bf16 v[152:155], a[84:87], a[244:247], v[152:155]
  v_mfma_f32_16x16x32_bf16 v[156:159], a[80:83], a[248:251], v[156:159]
  ds_read_b64_tr_b16 a[132:133], v4 offset:4096
  v_mfma_f32_16x16x32_bf16 v[156:159], a[84:87], a[252:255], v[156:159]
  buffer_load_dwordx4 v10, s[12:15], s73 offen offset:1024 lds
  v_mfma_f32_16x16x32_bf16 v[160:163], a[192:195], a[88:91], v[160:163]
  ds_read_b128 a[72:75], v2 offset:2048
  ds_read_b128 a[76:79], v3 offset:2048
  v_mfma_f32_16x16x32_bf16 v[160:163], a[196:199], a[92:95], v[160:163]
  ds_read_b64_tr_b16 a[134:135], v4 offset:5120
  v_mfma_f32_16x16x32_bf16 v[164:167], a[200:203], a[88:91], v[164:167]
  v_mfma_f32_16x16x32_bf16 v[164:167], a[204:207], a[92:95], v[164:167]
  ds_read_b64_tr_b16 a[136:137], v5 offset:0
  v_mfma_f32_16x16x32_bf16 v[168:171], a[208:211], a[88:91], v[168:171]
  buffer_load_dwordx4 v10, s[12:15], s74 offen offset:2048 lds
  v_mfma_f32_16x16x32_bf16 v[168:171], a[212:215], a[92:95], v[168:171]
  ds_read_b128 a[80:83], v2 offset:4096
  ds_read_b128 a[84:87], v3 offset:4096
  v_mfma_f32_16x16x32_bf16 v[172:175], a[216:219], a[88:91], v[172:175]
  ds_read_b64_tr_b16 a[138:139], v5 offset:1024
  v_mfma_f32_16x16x32_bf16 v[172:175], a[220:223], a[92:95], v[172:175]
  ds_read_b64_tr_b16 a[140:141], v5 offset:4096
  v_mfma_f32_16x16x32_bf16 v[176:179], a[88:91], a[224:227], v[176:179]
  v_mfma_f32_16x16x32_bf16 v[176:179], a[92:95], a[228:231], v[176:179]
  buffer_load_dwordx4 v10, s[12:15], s75 offen offset:3072 lds
  v_mfma_f32_16x16x32_bf16 v[180:183], a[88:91], a[232:235], v[180:183]
  s_add_u32 m0, s80, 36864
  ds_read_b64_tr_b16 a[142:143], v5 offset:5120
  v_mfma_f32_16x16x32_bf16 v[180:183], a[92:95], a[236:239], v[180:183]
  v_mfma_f32_16x16x32_bf16 v[184:187], a[88:91], a[240:243], v[184:187]
  ds_read_b64_tr_b16 a[144:145], v6 offset:0
  v_mfma_f32_16x16x32_bf16 v[184:187], a[92:95], a[244:247], v[184:187]
  v_mfma_f32_16x16x32_bf16 v[188:191], a[88:91], a[248:251], v[188:191]
  buffer_load_dwordx4 v10, s[12:15], s76 offen offset:0 lds
  v_mfma_f32_16x16x32_bf16 v[188:191], a[92:95], a[252:255], v[188:191]
  ds_read_b64_tr_b16 a[146:147], v6 offset:1024
  v_mfma_f32_16x16x32_bf16 v[192:195], a[192:195], a[96:99], v[192:195]
  ds_read_b128 a[88:91], v2 offset:6144
  ds_read_b128 a[92:95], v3 offset:6144
  v_mfma_f32_16x16x32_bf16 v[192:195], a[196:199], a[100:103], v[192:195]
  ds_read_b64_tr_b16 a[148:149], v6 offset:4096
  v_mfma_f32_16x16x32_bf16 v[196:199], a[200:203], a[96:99], v[196:199]
  v_mfma_f32_16x16x32_bf16 v[196:199], a[204:207], a[100:103], v[196:199]
  buffer_load_dwordx4 v10, s[12:15], s77 offen offset:1024 lds
  v_mfma_f32_16x16x32_bf16 v[200:203], a[208:211], a[96:99], v[200:203]
  ds_read_b64_tr_b16 a[150:151], v6 offset:5120
  v_mfma_f32_16x16x32_bf16 v[200:203], a[212:215], a[100:103], v[200:203]
  ds_read_b64_tr_b16 a[152:153], v7 offset:0
  v_mfma_f32_16x16x32_bf16 v[204:207], a[216:219], a[96:99], v[204:207]
  v_mfma_f32_16x16x32_bf16 v[204:207], a[220:223], a[100:103], v[204:207]
  v_mfma_f32_16x16x32_bf16 v[208:211], a[96:99], a[224:227], v[208:211]
  buffer_load_dwordx4 v10, s[12:15], s78 offen offset:2048 lds
  v_mfma_f32_16x16x32_bf16 v[208:211], a[100:103], a[228:231], v[208:211]
  ds_read_b64_tr_b16 a[154:155], v7 offset:1024
  v_mfma_f32_16x16x32_bf16 v[212:215], a[96:99], a[232:235], v[212:215]
  ds_read_b64_tr_b16 a[156:157], v7 offset:4096
  v_mfma_f32_16x16x32_bf16 v[212:215], a[100:103], a[236:239], v[212:215]
  v_mfma_f32_16x16x32_bf16 v[216:219], a[96:99], a[240:243], v[216:219]
  ds_read_b64_tr_b16 a[158:159], v7 offset:5120
  v_mfma_f32_16x16x32_bf16 v[216:219], a[100:103], a[244:247], v[216:219]
  buffer_load_dwordx4 v10, s[12:15], s79 offen offset:3072 lds
  v_mfma_f32_16x16x32_bf16 v[220:223], a[96:99], a[248:251], v[220:223]
  v_add_u32 v10, 0x80000, v10
  v_mfma_f32_16x16x32_bf16 v[220:223], a[100:103], a[252:255], v[220:223]
  s_add_u32 m0, s80, 0
  ds_read_b64_tr_b16 a[160:161], v4 offset:16384
  v_mfma_f32_16x16x32_bf16 v[224:227], a[192:195], a[104:107], v[224:227]
  ds_read_b128 a[96:99], v2 offset:8192
  ds_read_b128 a[100:103], v3 offset:8192
  v_mfma_f32_16x16x32_bf16 v[224:227], a[196:199], a[108:111], v[224:227]
  ds_read_b64_tr_b16 a[162:163], v4 offset:17408
  v_mfma_f32_16x16x32_bf16 v[228:231], a[200:203], a[104:107], v[228:231]
  buffer_load_dwordx4 v8, s[8:11], s64 offen offset:0 lds
  v_mfma_f32_16x16x32_bf16 v[228:231], a[204:207], a[108:111], v[228:231]
  ds_read_b64_tr_b16 a[164:165], v4 offset:20480
  v_mfma_f32_16x16x32_bf16 v[232:235], a[208:211], a[104:107], v[232:235]
  v_mfma_f32_16x16x32_bf16 v[232:235], a[212:215], a[108:111], v[232:235]
  ds_read_b64_tr_b16 a[166:167], v4 offset:21504
  v_mfma_f32_16x16x32_bf16 v[236:239], a[216:219], a[104:107], v[236:239]
  v_mfma_f32_16x16x32_bf16 v[236:239], a[220:223], a[108:111], v[236:239]
  buffer_load_dwordx4 v9, s[8:11], s65 offen offset:1024 lds
  v_mfma_f32_16x16x32_bf16 v[240:243], a[104:107], a[224:227], v[240:243]
  ds_read_b64_tr_b16 a[168:169], v5 offset:16384
  v_mfma_f32_16x16x32_bf16 v[240:243], a[108:111], a[228:231], v[240:243]
  v_mfma_f32_16x16x32_bf16 v[244:247], a[104:107], a[232:235], v[244:247]
  ds_read_b64_tr_b16 a[170:171], v5 offset:17408
  v_mfma_f32_16x16x32_bf16 v[244:247], a[108:111], a[236:239], v[244:247]
  v_mfma_f32_16x16x32_bf16 v[248:251], a[104:107], a[240:243], v[248:251]
  buffer_load_dwordx4 v8, s[8:11], s66 offen offset:2048 lds
  v_mfma_f32_16x16x32_bf16 v[248:251], a[108:111], a[244:247], v[248:251]
  ds_read_b64_tr_b16 a[172:173], v5 offset:20480
  v_mfma_f32_16x16x32_bf16 v[252:255], a[104:107], a[248:251], v[252:255]
  v_mfma_f32_16x16x32_bf16 v[252:255], a[108:111], a[252:255], v[252:255]
  ds_read_b64_tr_b16 a[174:175], v5 offset:21504
  v_mfma_f32_16x16x32_bf16 a[0:3], a[192:195], a[112:115], a[0:3]
  ds_read_b128 a[104:107], v2 offset:10240
  ds_read_b128 a[108:111], v3 offset:10240
  v_mfma_f32_16x16x32_bf16 a[0:3], a[196:199], a[116:119], a[0:3]
  buffer_load_dwordx4 v9, s[8:11], s67 offen offset:3072 lds
  v_mfma_f32_16x16x32_bf16 a[4:7], a[200:203], a[112:115], a[4:7]
  s_add_u32 m0, s80, 4096
  ds_read_b64_tr_b16 a[176:177], v6 offset:16384
  v_mfma_f32_16x16x32_bf16 a[4:7], a[204:207], a[116:119], a[4:7]
  ds_read_b64_tr_b16 a[178:179], v6 offset:17408
  v_mfma_f32_16x16x32_bf16 a[8:11], a[208:211], a[112:115], a[8:11]
  v_mfma_f32_16x16x32_bf16 a[8:11], a[212:215], a[116:119], a[8:11]
  v_mfma_f32_16x16x32_bf16 a[12:15], a[216:219], a[112:115], a[12:15]
  buffer_load_dwordx4 v11, s[8:11], s64 offen offset:0 lds
  v_mfma_f32_16x16x32_bf16 a[12:15], a[220:223], a[116:119], a[12:15]
  ds_read_b64_tr_b16 a[180:181], v6 offset:20480
  v_mfma_f32_16x16x32_bf16 a[16:19], a[112:115], a[224:227], a[16:19]
  ds_read_b64_tr_b16 a[182:183], v6 offset:21504
  v_mfma_f32_16x16x32_bf16 a[16:19], a[116:119], a[228:231], a[16:19]
  v_mfma_f32_16x16x32_bf16 a[20:23], a[112:115], a[232:235], a[20:23]
  ds_read_b64_tr_b16 a[184:185], v7 offset:16384
  v_mfma_f32_16x16x32_bf16 a[20:23], a[116:119], a[236:239], a[20:23]
  buffer_load_dwordx4 v12, s[8:11], s65 offen offset:1024 lds
  v_mfma_f32_16x16x32_bf16 a[24:27], a[112:115], a[240:243], a[24:27]
  v_mfma_f32_16x16x32_bf16 a[24:27], a[116:119], a[244:247], a[24:27]
  ds_read_b64_tr_b16 a[186:187], v7 offset:17408
  v_mfma_f32_16x16x32_bf16 a[28:31], a[112:115], a[248:251], a[28:31]
  v_mfma_f32_16x16x32_bf16 a[28:31], a[116:119], a[252:255], a[28:31]
  ds_read_b64_tr_b16 a[188:189], v7 offset:20480
  v_mfma_f32_16x16x32_bf16 a[32:35], a[192:195], a[120:123], a[32:35]
  ds_read_b128 a[112:115], v2 offset:12288
  ds_read_b128 a[116:119], v3 offset:12288
  v_mfma_f32_16x16x32_bf16 a[32:35], a[196:199], a[124:127], a[32:35]
  buffer_load_dwordx4 v11, s[8:11], s66 offen offset:2048 lds
  v_mfma_f32_16x16x32_bf16 a[36:39], a[200:203], a[120:123], a[36:39]
  ds_read_b64_tr_b16 a[190:191], v7 offset:21504
  v_mfma_f32_16x16x32_bf16 a[36:39], a[204:207], a[124:127], a[36:39]
  v_mfma_f32_16x16x32_bf16 a[40:43], a[208:211], a[120:123], a[40:43]
  v_mfma_f32_16x16x32_bf16 a[40:43], a[212:215], a[124:127], a[40:43]
  v_mfma_f32_16x16x32_bf16 a[44:47], a[216:219], a[120:123], a[44:47]
  buffer_load_dwordx4 v12, s[8:11], s67 offen offset:3072 lds
  v_mfma_f32_16x16x32_bf16 a[44:47], a[220:223], a[124:127], a[44:47]
  v_add_u32 v8, 128, v8
  v_add_u32 v9, 128, v9
  v_mfma_f32_16x16x32_bf16 a[48:51], a[120:123], a[224:227], a[48:51]
  v_add_u32 v11, 128, v11
  v_add_u32 v12, 128, v12
  v_mfma_f32_16x16x32_bf16 a[48:51], a[124:127], a[228:231], a[48:51]
  s_xor_b32 s80, s80, 0x10000
  v_lshlrev_b32 v27, 5, v29
  v_mfma_f32_16x16x32_bf16 a[52:55], a[120:123], a[232:235], a[52:55]
  s_andn2_b32 s26, s93, 0xf80
  v_mfma_f32_16x16x32_bf16 a[52:55], a[124:127], a[236:239], a[52:55]
  buffer_load_dword v27, v27, s[20:23], s26 offen sc1
  v_mfma_f32_16x16x32_bf16 a[56:59], a[120:123], a[240:243], a[56:59]
  s_lshl_b32 s24, s5, 8
  s_lshl_b32 s25, s6, 2
  s_add_u32 s24, s24, s25
  v_mfma_f32_16x16x32_bf16 a[56:59], a[124:127], a[244:247], a[56:59]
  s_add_u32 s24, s24, s4
  s_add_u32 s24, s24, 32
  s_lshl_b32 s24, s24, 12
  v_mfma_f32_16x16x32_bf16 a[60:63], a[120:123], a[248:251], a[60:63]
  v_lshlrev_b32 v55, 5, v29
  v_mfma_f32_16x16x32_bf16 a[60:63], a[124:127], a[252:255], a[60:63]
  s_waitcnt lgkmcnt(0)
  v_mfma_f32_16x16x32_bf16 v[64:67], a[128:131], a[64:67], v[64:67]
  ds_read_b128 a[120:123], v2 offset:14336
  ds_read_b128 a[124:127], v3 offset:14336
  v_mfma_f32_16x16x32_bf16 v[64:67], a[132:135], a[68:71], v[64:67]
  buffer_load_dword v17, v55, s[20:23], s24 offen
  v_mfma_f32_16x16x32_bf16 v[68:71], a[136:139], a[64:67], v[68:71]
  v_xor_b32 v2, 0x10000, v2
  v_xor_b32 v3, 0x10000, v3
  v_mfma_f32_16x16x32_bf16 v[68:71], a[140:143], a[68:71], v[68:71]
  v_xor_b32 v4, 0x10000, v4
  v_xor_b32 v5, 0x10000, v5
  v_mfma_f32_16x16x32_bf16 v[72:75], a[144:147], a[64:67], v[72:75]
  v_xor_b32 v6, 0x10000, v6
  v_xor_b32 v7, 0x10000, v7
  v_mfma_f32_16x16x32_bf16 v[72:75], a[148:151], a[68:71], v[72:75]
  v_mfma_f32_16x16x32_bf16 v[76:79], a[152:155], a[64:67], v[76:79]
  v_mfma_f32_16x16x32_bf16 v[76:79], a[156:159], a[68:71], v[76:79]
  v_mfma_f32_16x16x32_bf16 v[80:83], a[64:67], a[160:163], v[80:83]
  v_mfma_f32_16x16x32_bf16 v[80:83], a[68:71], a[164:167], v[80:83]
  v_mfma_f32_16x16x32_bf16 v[84:87], a[64:67], a[168:171], v[84:87]
  v_mfma_f32_16x16x32_bf16 v[84:87], a[68:71], a[172:175], v[84:87]
  v_mfma_f32_16x16x32_bf16 v[88:91], a[64:67], a[176:179], v[88:91]
  v_mfma_f32_16x16x32_bf16 v[88:91], a[68:71], a[180:183], v[88:91]
  v_mfma_f32_16x16x32_bf16 v[92:95], a[64:67], a[184:187], v[92:95]
  v_mfma_f32_16x16x32_bf16 v[92:95], a[68:71], a[188:191], v[92:95]
  v_mfma_f32_16x16x32_bf16 v[96:99], a[128:131], a[72:75], v[96:99]
  v_mfma_f32_16x16x32_bf16 v[96:99], a[132:135], a[76:79], v[96:99]
  v_mfma_f32_16x16x32_bf16 v[100:103], a[136:139], a[72:75], v[100:103]
  v_mfma_f32_16x16x32_bf16 v[100:103], a[140:143], a[76:79], v[100:103]
  v_mfma_f32_16x16x32_bf16 v[104:107], a[144:147], a[72:75], v[104:107]
  v_mfma_f32_16x16x32_bf16 v[104:107], a[148:151], a[76:79], v[104:107]
  v_mfma_f32_16x16x32_bf16 v[108:111], a[152:155], a[72:75], v[108:111]
  v_mfma_f32_16x16x32_bf16 v[108:111], a[156:159], a[76:79], v[108:111]
  v_mfma_f32_16x16x32_bf16 v[112:115], a[72:75], a[160:163], v[112:115]
  v_mfma_f32_16x16x32_bf16 v[112:115], a[76:79], a[164:167], v[112:115]
  v_mfma_f32_16x16x32_bf16 v[116:119], a[72:75], a[168:171], v[116:119]
  v_mfma_f32_16x16x32_bf16 v[116:119], a[76:79], a[172:175], v[116:119]
  v_mfma_f32_16x16x32_bf16 v[120:123], a[72:75], a[176:179], v[120:123]
  v_mfma_f32_16x16x32_bf16 v[120:123], a[76:79], a[180:183], v[120:123]
  v_mfma_f32_16x16x32_bf16 v[124:127], a[72:75], a[184:187], v[124:127]
  s_lshl_b32 s76, s4, 13
  s_lshl_b32 s77, s4, 12
  v_mfma_f32_16x16x32_bf16 v[124:127], a[76:79], a[188:191], v[124:127]
  v_mfma_f32_16x16x32_bf16 v[128:131], a[128:131], a[80:83], v[128:131]
  v_mfma_f32_16x16x32_bf16 v[128:131], a[132:135], a[84:87], v[128:131]
  v_mfma_f32_16x16x32_bf16 v[132:135], a[136:139], a[80:83], v[132:135]
  s_waitcnt vmcnt(2) lgkmcnt(0)
  s_barrier
  v_mfma_f32_16x16x32_bf16 v[132:135], a[140:143], a[84:87], v[132:135]
  s_add_u32 m0, s77, 131072
  v_mfma_f32_16x16x32_bf16 v[136:139], a[144:147], a[80:83], v[136:139]
  s_mov_b32 s80, 0
  s_lshl_b32 s62, s6, 16
  ds_read_b64_tr_b16 a[192:193], v4 offset:0
  v_mfma_f32_16x16x32_bf16 v[136:139], a[148:151], a[84:87], v[136:139]
  s_sub_u32 s63, 983040, s62
  ds_read_b128 a[64:67], v2 offset:0
  ds_read_b128 a[68:71], v3 offset:0
  v_mfma_f32_16x16x32_bf16 v[140:143], a[152:155], a[80:83], v[140:143]
  s_lshr_b32 s25, s4, 1
  s_lshl_b32 s25, s25, 14
  ds_read_b64_tr_b16 a[194:195], v4 offset:1024
  v_mfma_f32_16x16x32_bf16 v[140:143], a[156:159], a[84:87], v[140:143]
  buffer_load_dwordx4 v15, s[88:91], s72 offen offset:0 lds
  v_mfma_f32_16x16x32_bf16 v[144:147], a[80:83], a[160:163], v[144:147]
  s_and_b32 s82, s4, 1
  s_lshl_b32 s82, s82, 11
  s_add_u32 s98, s62, s82
  v_mfma_f32_16x16x32_bf16 v[144:147], a[84:87], a[164:167], v[144:147]
  s_add_u32 s98, s98, s25
  s_add_u32 s99, s98, 32768
  ds_read_b64_tr_b16 a[196:197], v4 offset:4096
  v_mfma_f32_16x16x32_bf16 v[148:151], a[80:83], a[168:171], v[148:151]
  s_add_u32 s100, s63, s82
  ds_read_b128 a[72:75], v2 offset:2048
  ds_read_b128 a[76:79], v3 offset:2048
  v_mfma_f32_16x16x32_bf16 v[148:151], a[84:87], a[172:175], v[148:151]
  s_sub_u32 s101, s100, s25
  s_add_u32 s101, s101, 32768
  ds_read_b64_tr_b16 a[198:199], v4 offset:5120
  v_mfma_f32_16x16x32_bf16 v[152:155], a[80:83], a[176:179], v[152:155]
  buffer_load_dwordx4 v15, s[88:91], s73 offen offset:1024 lds
  v_mfma_f32_16x16x32_bf16 v[152:155], a[84:87], a[180:183], v[152:155]
  s_mul_i32 s24, s25, 3
  s_add_u32 s100, s100, s24
  v_lshlrev_b32 v12, 4, v0
  v_mfma_f32_16x16x32_bf16 v[156:159], a[80:83], a[184:187], v[156:159]
  s_add_u32 s83, s25, 0x10000
  s_add_u32 s24, s83, s25
  ds_read_b64_tr_b16 a[200:201], v5 offset:0
  v_mfma_f32_16x16x32_bf16 v[156:159], a[84:87], a[188:191], v[156:159]
  s_add_u32 s24, s24, s82
  v_add_u32 v24, s24, v12
  v_mfma_f32_16x16x32_bf16 v[160:163], a[128:131], a[88:91], v[160:163]
  s_add_u32 s82, s82, 8192
  ds_read_b128 a[80:83], v2 offset:4096
  ds_read_b128 a[84:87], v3 offset:4096
  v_mfma_f32_16x16x32_bf16 v[160:163], a[132:135], a[92:95], v[160:163]
  ds_read_b64_tr_b16 a[202:203], v5 offset:1024
  v_add_u32 v25, s82, v24
  v_mfma_f32_16x16x32_bf16 v[164:167], a[136:139], a[88:91], v[164:167]
  buffer_load_dwordx4 v15, s[88:91], s74 offen offset:2048 lds
  v_mfma_f32_16x16x32_bf16 v[164:167], a[140:143], a[92:95], v[164:167]
  s_mov_b32 s81, 0
  s_add_u32 s79, s62, 65536
  ds_read_b64_tr_b16 a[204:205], v5 offset:4096
  v_mfma_f32_16x16x32_bf16 v[168:171], a[144:147], a[88:91], v[168:171]
  v_add_u32 v28, s77, v12
  v_mfma_f32_16x16x32_bf16 v[168:171], a[148:151], a[92:95], v[168:171]
  s_mov_b32 s30, 0x3e0293ee
  s_lshl_b32 s25, s5, 20
  ds_read_b64_tr_b16 a[206:207], v5 offset:5120
  v_mfma_f32_16x16x32_bf16 v[172:175], a[152:155], a[88:91], v[172:175]
  s_add_u32 s16, s60, s25
  s_addc_u32 s17, s61, 0
  s_mov_b32 s18, 1048576
  v_mfma_f32_16x16x32_bf16 v[172:175], a[156:159], a[92:95], v[172:175]
  buffer_load_dwordx4 v15, s[88:91], s75 offen offset:3072 lds
  v_mfma_f32_16x16x32_bf16 v[176:179], a[88:91], a[160:163], v[176:179]
  s_mov_b32 s12, s54
  ds_read_b64_tr_b16 a[208:209], v6 offset:0
  v_add_u32 v15, 0x80000, v15
  v_mfma_f32_16x16x32_bf16 v[176:179], a[92:95], a[164:167], v[176:179]
  s_add_u32 m0, s76, 0
  s_mov_b32 s13, s55
  v_bfe_u32 v26, v0, 1, 2
  v_mfma_f32_16x16x32_bf16 v[180:183], a[88:91], a[168:171], v[180:183]
  ds_read_b64_tr_b16 a[210:211], v6 offset:1024
  v_bfe_u32 v31, v0, 4, 2
  v_mfma_f32_16x16x32_bf16 v[180:183], a[92:95], a[172:175], v[180:183]
  v_xor_b32 v26, v26, v31
  v_lshlrev_b32 v26, 5, v26
  v_mfma_f32_16x16x32_bf16 v[184:187], a[88:91], a[176:179], v[184:187]
  buffer_load_dwordx4 v13, s[84:87], s64 offen offset:0 lds
  v_mfma_f32_16x16x32_bf16 v[184:187], a[92:95], a[180:183], v[184:187]
  ds_read_b64_tr_b16 a[212:213], v6 offset:4096
  v_and_b32 v31, 1, v0
  v_mfma_f32_16x16x32_bf16 v[188:191], a[88:91], a[184:187], v[188:191]
  v_lshl_add_u32 v26, v31, 4, v26
  v_lshrrev_b32 v31, 3, v0
  v_mfma_f32_16x16x32_bf16 v[188:191], a[92:95], a[188:191], v[188:191]
  ds_read_b64_tr_b16 a[214:215], v6 offset:5120
  v_lshl_add_u32 v26, v31, 10, v26
  v_mfma_f32_16x16x32_bf16 v[192:195], a[128:131], a[96:99], v[192:195]
  ds_read_b128 a[88:91], v2 offset:6144
  ds_read_b128 a[92:95], v3 offset:6144
  v_mfma_f32_16x16x32_bf16 v[192:195], a[132:135], a[100:103], v[192:195]
  buffer_load_dwordx4 v14, s[84:87], s65 offen offset:1024 lds
  v_mfma_f32_16x16x32_bf16 v[196:199], a[136:139], a[96:99], v[196:199]
  ds_read_b64_tr_b16 a[216:217], v7 offset:0
  v_add_u32 v26, s36, v26
  v_mfma_f32_16x16x32_bf16 v[196:199], a[140:143], a[100:103], v[196:199]
  s_waitcnt vmcnt(7)
  v_xor_b32 v27, s92, v27
  v_cmp_ne_u32 vcc, 0, v27
  v_mfma_f32_16x16x32_bf16 v[200:203], a[144:147], a[96:99], v[200:203]
  ds_read_b64_tr_b16 a[218:219], v7 offset:1024
  v_mfma_f32_16x16x32_bf16 v[200:203], a[148:151], a[100:103], v[200:203]
  s_cbranch_vccnz xspin
xspun:
  v_mfma_f32_16x16x32_bf16 v[204:207], a[152:155], a[96:99], v[204:207]
  buffer_load_dwordx4 v13, s[84:87], s66 offen offset:2048 lds
  v_mfma_f32_16x16x32_bf16 v[204:207], a[156:159], a[100:103], v[204:207]
  ds_read_b64_tr_b16 a[220:221], v7 offset:4096
  v_mfma_f32_16x16x32_bf16 v[208:211], a[96:99], a[160:163], v[208:211]
  v_mfma_f32_16x16x32_bf16 v[208:211], a[100:103], a[164:167], v[208:211]
  ds_read_b64_tr_b16 a[222:223], v7 offset:5120
  v_mfma_f32_16x16x32_bf16 v[212:215], a[96:99], a[168:171], v[212:215]
  v_mfma_f32_16x16x32_bf16 v[212:215], a[100:103], a[172:175], v[212:215]
  buffer_load_dwordx4 v14, s[84:87], s67 offen offset:3072 lds
  v_mfma_f32_16x16x32_bf16 v[216:219], a[96:99], a[176:179], v[216:219]
  s_add_u32 m0, s76, 4096
  ds_read_b64_tr_b16 a[224:225], v4 offset:16384
  v_mfma_f32_16x16x32_bf16 v[216:219], a[100:103], a[180:183], v[216:219]
  v_mfma_f32_16x16x32_bf16 v[220:223], a[96:99], a[184:187], v[220:223]
  ds_read_b64_tr_b16 a[226:227], v4 offset:17408
  v_mfma_f32_16x16x32_bf16 v[220:223], a[100:103], a[188:191], v[220:223]
  v_mfma_f32_16x16x32_bf16 v[224:227], a[128:131], a[104:107], v[224:227]
  ds_read_b128 a[96:99], v2 offset:8192
  ds_read_b128 a[100:103], v3 offset:8192
  v_mfma_f32_16x16x32_bf16 v[224:227], a[132:135], a[108:111], v[224:227]
  ds_read_b64_tr_b16 a[228:229], v4 offset:20480
  v_mfma_f32_16x16x32_bf16 v[228:231], a[136:139], a[104:107], v[228:231]
  buffer_load_dwordx4 v13, s[84:87], s68 offen offset:0 lds
  v_mfma_f32_16x16x32_bf16 v[228:231], a[140:143], a[108:111], v[228:231]
  ds_read_b64_tr_b16 a[230:231], v4 offset:21504
  v_mfma_f32_16x16x32_bf16 v[232:235], a[144:147], a[104:107], v[232:235]
  v_mfma_f32_16x16x32_bf16 v[232:235], a[148:151], a[108:111], v[232:235]
  v_mfma_f32_16x16x32_bf16 v[236:239], a[152:155], a[104:107], v[236:239]
  ds_read_b64_tr_b16 a[232:233], v5 offset:16384
  v_mfma_f32_16x16x32_bf16 v[236:239], a[156:159], a[108:111], v[236:239]
  buffer_load_dwordx4 v14, s[84:87], s69 offen offset:1024 lds
  v_mfma_f32_16x16x32_bf16 v[240:243], a[104:107], a[160:163], v[240:243]
  ds_read_b64_tr_b16 a[234:235], v5 offset:17408
  v_mfma_f32_16x16x32_bf16 v[240:243], a[108:111], a[164:167], v[240:243]
  v_mfma_f32_16x16x32_bf16 v[244:247], a[104:107], a[168:171], v[244:247]
  v_mfma_f32_16x16x32_bf16 v[244:247], a[108:111], a[172:175], v[244:247]
  ds_read_b64_tr_b16 a[236:237], v5 offset:20480
  v_mfma_f32_16x16x32_bf16 v[248:251], a[104:107], a[176:179], v[248:251]
  buffer_load_dwordx4 v13, s[84:87], s70 offen offset:2048 lds
  v_mfma_f32_16x16x32_bf16 v[248:251], a[108:111], a[180:183], v[248:251]
  ds_read_b64_tr_b16 a[238:239], v5 offset:21504
  v_mfma_f32_16x16x32_bf16 v[252:255], a[104:107], a[184:187], v[252:255]
  v_mfma_f32_16x16x32_bf16 v[252:255], a[108:111], a[188:191], v[252:255]
  v_mfma_f32_16x16x32_bf16 a[0:3], a[128:131], a[112:115], a[0:3]
  ds_read_b128 a[104:107], v2 offset:10240
  ds_read_b128 a[108:111], v3 offset:10240
  v_mfma_f32_16x16x32_bf16 a[0:3], a[132:135], a[116:119], a[0:3]
  ds_read_b64_tr_b16 a[240:241], v6 offset:16384
  v_mfma_f32_16x16x32_bf16 a[4:7], a[136:139], a[112:115], a[4:7]
  ds_read_b64_tr_b16 a[242:243], v6 offset:17408
  v_mfma_f32_16x16x32_bf16 a[4:7], a[140:143], a[116:119], a[4:7]
  buffer_load_dwordx4 v14, s[84:87], s71 offen offset:3072 lds
  v_mfma_f32_16x16x32_bf16 a[8:11], a[144:147], a[112:115], a[8:11]
  v_add_u32 v13, 128, v13
  v_add_u32 v14, 128, v14
  v_mfma_f32_16x16x32_bf16 a[8:11], a[148:151], a[116:119], a[8:11]
  s_add_u32 m0, s77, 147456
  ds_read_b64_tr_b16 a[244:245], v6 offset:20480
  v_mfma_f32_16x16x32_bf16 a[12:15], a[152:155], a[112:115], a[12:15]
  v_mfma_f32_16x16x32_bf16 a[12:15], a[156:159], a[116:119], a[12:15]
  ds_read_b64_tr_b16 a[246:247], v6 offset:21504
  v_mfma_f32_16x16x32_bf16 a[16:19], a[112:115], a[160:163], a[16:19]
  buffer_load_dwordx4 v15, s[88:91], s72 offen offset:0 lds
  v_mfma_f32_16x16x32_bf16 a[16:19], a[116:119], a[164:167], a[16:19]
  v_mfma_f32_16x16x32_bf16 a[20:23], a[112:115], a[168:171], a[20:23]
  ds_read_b64_tr_b16 a[248:249], v7 offset:16384
  v_mfma_f32_16x16x32_bf16 a[20:23], a[116:119], a[172:175], a[20:23]
  v_mfma_f32_16x16x32_bf16 a[24:27], a[112:115], a[176:179], a[24:27]
  ds_read_b64_tr_b16 a[250:251], v7 offset:17408
  v_mfma_f32_16x16x32_bf16 a[24:27], a[116:119], a[180:183], a[24:27]
  buffer_load_dwordx4 v15, s[88:91], s73 offen offset:1024 lds
  v_mfma_f32_16x16x32_bf16 a[28:31], a[112:115], a[184:187], a[28:31]
  v_mfma_f32_16x16x32_bf16 a[28:31], a[116:119], a[188:191], a[28:31]
  ds_read_b64_tr_b16 a[252:253], v7 offset:20480
  v_mfma_f32_16x16x32_bf16 a[32:35], a[128:131], a[120:123], a[32:35]
  ds_read_b128 a[112:115], v2 offset:12288
  ds_read_b128 a[116:119], v3 offset:12288
  v_mfma_f32_16x16x32_bf16 a[32:35], a[132:135], a[124:127], a[32:35]
  ds_read_b64_tr_b16 a[254:255], v7 offset:21504
  v_mfma_f32_16x16x32_bf16 a[36:39], a[136:139], a[120:123], a[36:39]
  buffer_load_dwordx4 v15, s[88:91], s74 offen offset:2048 lds
  v_mfma_f32_16x16x32_bf16 a[36:39], a[140:143], a[124:127], a[36:39]
  v_mfma_f32_16x16x32_bf16 a[40:43], a[144:147], a[120:123], a[40:43]
  v_mfma_f32_16x16x32_bf16 a[40:43], a[148:151], a[124:127], a[40:43]
  v_mfma_f32_16x16x32_bf16 a[44:47], a[152:155], a[120:123], a[44:47]
  v_mfma_f32_16x16x32_bf16 a[44:47], a[156:159], a[124:127], a[44:47]
  buffer_load_dwordx4 v15, s[88:91], s75 offen offset:3072 lds
  v_mfma_f32_16x16x32_bf16 a[48:51], a[120:123], a[160:163], a[48:51]
  v_add_u32 v15, 0x80000, v15
  v_mfma_f32_16x16x32_bf16 a[48:51], a[124:127], a[164:167], a[48:51]
  s_add_u32 m0, s76, 32768
  v_mfma_f32_16x16x32_bf16 a[52:55], a[120:123], a[168:171], a[52:55]
  v_mfma_f32_16x16x32_bf16 a[52:55], a[124:127], a[172:175], a[52:55]
  v_mfma_f32_16x16x32_bf16 a[56:59], a[120:123], a[176:179], a[56:59]
  buffer_load_dwordx4 v13, s[84:87], s64 offen offset:0 lds
  v_mfma_f32_16x16x32_bf16 a[56:59], a[124:127], a[180:183], a[56:59]
  v_mfma_f32_16x16x32_bf16 a[60:63], a[120:123], a[184:187], a[60:63]
  v_mfma_f32_16x16x32_bf16 a[60:63], a[124:127], a[188:191], a[60:63]
  s_waitcnt lgkmcnt(0)
  v_mfma_f32_16x16x32_bf16 v[64:67], a[192:195], a[64:67], v[64:67]
  ds_read_b128 a[120:123], v2 offset:14336
  ds_read_b128 a[124:127], v3 offset:14336
  v_mfma_f32_16x16x32_bf16 v[64:67], a[196:199], a[68:71], v[64:67]
  buffer_load_dwordx4 v14, s[84:87], s65 offen offset:1024 lds
  v_mfma_f32_16x16x32_bf16 v[68:71], a[200:203], a[64:67], v[68:71]
  s_lshl_b32 s24, s4, 13
  v_and_b32 v2, 0x7ff, v2
  v_add_u32 v2, s24, v2
  v_mfma_f32_16x16x32_bf16 v[68:71], a[204:207], a[68:71], v[68:71]
  v_xor_b32 v3, 64, v2
  v_mfma_f32_16x16x32_bf16 v[72:75], a[208:211], a[64:67], v[72:75]
  s_and_b32 s24, s4, 1
  s_lshl_b32 s24, s24, 7
  v_and_b32 v4, 0x3fff, v4
  v_mfma_f32_16x16x32_bf16 v[72:75], a[212:215], a[68:71], v[72:75]
  v_xor_b32 v4, s24, v4
  v_add_u32 v4, 98304, v4
  v_mfma_f32_16x16x32_bf16 v[76:79], a[216:219], a[64:67], v[76:79]
  buffer_load_dwordx4 v13, s[84:87], s66 offen offset:2048 lds
  v_mfma_f32_16x16x32_bf16 v[76:79], a[220:223], a[68:71], v[76:79]
  v_xor_b32 v5, 32, v4
  v_xor_b32 v6, 64, v4
  v_mfma_f32_16x16x32_bf16 v[80:83], a[64:67], a[224:227], v[80:83]
  v_xor_b32 v7, 96, v4
  v_xor_b32 v8, 128, v4
  v_mfma_f32_16x16x32_bf16 v[80:83], a[68:71], a[228:231], v[80:83]
  v_xor_b32 v9, 160, v4
  v_xor_b32 v10, 192, v4
  v_mfma_f32_16x16x32_bf16 v[84:87], a[64:67], a[232:235], v[84:87]
  v_xor_b32 v11, 224, v4
  v_mul_f32 v64, s30, v64
  v_mfma_f32_16x16x32_bf16 v[84:87], a[68:71], a[236:239], v[84:87]
  buffer_load_dwordx4 v14, s[84:87], s67 offen offset:3072 lds
  v_mfma_f32_16x16x32_bf16 v[88:91], a[64:67], a[240:243], v[88:91]
  s_add_u32 m0, s76, 36864
  v_mul_f32 v65, s30, v65
  v_mul_f32 v66, s30, v66
  v_mfma_f32_16x16x32_bf16 v[88:91], a[68:71], a[244:247], v[88:91]
  v_mul_f32 v67, s30, v67
  v_cvt_pk_bf16_f32 v32, v64, v65
  v_mfma_f32_16x16x32_bf16 v[92:95], a[64:67], a[248:251], v[92:95]
  v_cvt_pk_bf16_f32 v33, v66, v67
  v_mul_f32 v68, s30, v68
  v_mfma_f32_16x16x32_bf16 v[92:95], a[68:71], a[252:255], v[92:95]
  v_mul_f32 v69, s30, v69
  v_mul_f32 v70, s30, v70
  v_mfma_f32_16x16x32_bf16 v[96:99], a[192:195], a[72:75], v[96:99]
  buffer_load_dwordx4 v13, s[84:87], s68 offen offset:0 lds
  v_mfma_f32_16x16x32_bf16 v[96:99], a[196:199], a[76:79], v[96:99]
  v_mul_f32 v71, s30, v71
  v_cvt_pk_bf16_f32 v34, v68, v69
  v_mfma_f32_16x16x32_bf16 v[100:103], a[200:203], a[72:75], v[100:103]
  v_cvt_pk_bf16_f32 v35, v70, v71
  v_mul_f32 v72, s30, v72
  v_mfma_f32_16x16x32_bf16 v[100:103], a[204:207], a[76:79], v[100:103]
  v_mul_f32 v73, s30, v73
  v_mul_f32 v74, s30, v74
  v_mfma_f32_16x16x32_bf16 v[104:107], a[208:211], a[72:75], v[104:107]
  v_mul_f32 v75, s30, v75
  v_cvt_pk_bf16_f32 v36, v72, v73
  v_mfma_f32_16x16x32_bf16 v[104:107], a[212:215], a[76:79], v[104:107]
  buffer_load_dwordx4 v14, s[84:87], s69 offen offset:1024 lds
  v_mfma_f32_16x16x32_bf16 v[108:111], a[216:219], a[72:75], v[108:111]
  v_cvt_pk_bf16_f32 v37, v74, v75
  v_mul_f32 v76, s30, v76
  v_mfma_f32_16x16x32_bf16 v[108:111], a[220:223], a[76:79], v[108:111]
  v_mul_f32 v77, s30, v77
  v_mul_f32 v78, s30, v78
  v_mfma_f32_16x16x32_bf16 v[112:115], a[72:75], a[224:227], v[112:115]
  v_mul_f32 v79, s30, v79
  v_cvt_pk_bf16_f32 v38, v76, v77
  v_mfma_f32_16x16x32_bf16 v[112:115], a[76:79], a[228:231], v[112:115]
  v_cvt_pk_bf16_f32 v39, v78, v79
  v_mul_f32 v96, s30, v96
  v_mfma_f32_16x16x32_bf16 v[116:119], a[72:75], a[232:235], v[116:119]
  buffer_load_dwordx4 v13, s[84:87], s70 offen offset:2048 lds
  v_mfma_f32_16x16x32_bf16 v[116:119], a[76:79], a[236:239], v[116:119]
  v_mul_f32 v97, s30, v97
  v_mul_f32 v98, s30, v98
  v_mfma_f32_16x16x32_bf16 v[120:123], a[72:75], a[240:243], v[120:123]
  v_mul_f32 v99, s30, v99
  v_cvt_pk_bf16_f32 v40, v96, v97
  v_mfma_f32_16x16x32_bf16 v[120:123], a[76:79], a[244:247], v[120:123]
  v_cvt_pk_bf16_f32 v41, v98, v99
  v_mul_f32 v100, s30, v100
  v_mfma_f32_16x16x32_bf16 v[124:127], a[72:75], a[248:251], v[124:127]
  v_mul_f32 v101, s30, v101
  v_mul_f32 v102, s30, v102
  v_mfma_f32_16x16x32_bf16 v[124:127], a[76:79], a[252:255], v[124:127]
  buffer_load_dwordx4 v14, s[84:87], s71 offen offset:3072 lds
  v_mfma_f32_16x16x32_bf16 v[128:131], a[192:195], a[80:83], v[128:131]
  v_add_u32 v13, 128, v13
  v_add_u32 v14, 128, v14
  v_mfma_f32_16x16x32_bf16 v[128:131], a[196:199], a[84:87], v[128:131]
  v_mul_f32 v103, s30, v103
  v_cvt_pk_bf16_f32 v42, v100, v101
  v_mfma_f32_16x16x32_bf16 v[132:135], a[200:203], a[80:83], v[132:135]
  buffer_store_dwordx4 v[32:35], v12, s[16:19], s98 offen offset:0
  v_mfma_f32_16x16x32_bf16 v[132:135], a[204:207], a[84:87], v[132:135]
  v_cvt_pk_bf16_f32 v43, v102, v103
  v_mul_f32 v104, s30, v104
  v_mfma_f32_16x16x32_bf16 v[136:139], a[208:211], a[80:83], v[136:139]
  v_mul_f32 v105, s30, v105
  v_mul_f32 v106, s30, v106
  v_mfma_f32_16x16x32_bf16 v[136:139], a[212:215], a[84:87], v[136:139]
  v_mul_f32 v107, s30, v107
  v_cvt_pk_bf16_f32 v44, v104, v105
  v_mfma_f32_16x16x32_bf16 v[140:143], a[216:219], a[80:83], v[140:143]
  v_cvt_pk_bf16_f32 v45, v106, v107
  v_mul_f32 v108, s30, v108
  v_mfma_f32_16x16x32_bf16 v[140:143], a[220:223], a[84:87], v[140:143]
  v_mul_f32 v109, s30, v109
  v_mul_f32 v110, s30, v110
  v_mfma_f32_16x16x32_bf16 v[144:147], a[80:83], a[224:227], v[144:147]
  v_mul_f32 v111, s30, v111
  v_cvt_pk_bf16_f32 v46, v108, v109
  v_mfma_f32_16x16x32_bf16 v[144:147], a[84:87], a[228:231], v[144:147]
  v_cvt_pk_bf16_f32 v47, v110, v111
  v_cvt_pk_bf16_f32 v48, v80, v81
  v_mfma_f32_16x16x32_bf16 v[148:151], a[80:83], a[232:235], v[148:151]
  v_cvt_pk_bf16_f32 v49, v82, v83
  v_cvt_pk_bf16_f32 v50, v112, v113
  v_mfma_f32_16x16x32_bf16 v[148:151], a[84:87], a[236:239], v[148:151]
  v_cvt_pk_bf16_f32 v51, v114, v115
  v_cvt_pk_bf16_f32 v52, v84, v85
  v_mfma_f32_16x16x32_bf16 v[152:155], a[80:83], a[240:243], v[152:155]
  v_cvt_pk_bf16_f32 v53, v86, v87
  v_cvt_pk_bf16_f32 v54, v116, v117
  v_mfma_f32_16x16x32_bf16 v[152:155], a[84:87], a[244:247], v[152:155]
  v_cvt_pk_bf16_f32 v55, v118, v119
  v_cvt_pk_bf16_f32 v56, v88, v89
  v_mfma_f32_16x16x32_bf16 v[156:159], a[80:83], a[248:251], v[156:159]
  buffer_store_dwordx4 v[36:39], v12, s[16:19], s98 offen offset:1024
  v_mfma_f32_16x16x32_bf16 v[156:159], a[84:87], a[252:255], v[156:159]
  v_cvt_pk_bf16_f32 v57, v90, v91
  v_cvt_pk_bf16_f32 v58, v120, v121
  v_mfma_f32_16x16x32_bf16 v[160:163], a[192:195], a[88:91], v[160:163]
  v_cvt_pk_bf16_f32 v59, v122, v123
  v_cvt_pk_bf16_f32 v60, v92, v93
  v_mfma_f32_16x16x32_bf16 v[160:163], a[196:199], a[92:95], v[160:163]
  v_cvt_pk_bf16_f32 v61, v94, v95
  v_cvt_pk_bf16_f32 v62, v124, v125
  v_mfma_f32_16x16x32_bf16 v[164:167], a[200:203], a[88:91], v[164:167]
  v_cvt_pk_bf16_f32 v63, v126, v127
  v_mul_f32 v128, s30, v128
  v_mfma_f32_16x16x32_bf16 v[164:167], a[204:207], a[92:95], v[164:167]
  v_mul_f32 v129, s30, v129
  v_mul_f32 v130, s30, v130
  v_mfma_f32_16x16x32_bf16 v[168:171], a[208:211], a[88:91], v[168:171]
  v_mul_f32 v131, s30, v131
  v_cvt_pk_bf16_f32 v64, v128, v129
  v_mfma_f32_16x16x32_bf16 v[168:171], a[212:215], a[92:95], v[168:171]
  v_cvt_pk_bf16_f32 v65, v130, v131
  v_mul_f32 v132, s30, v132
  v_mfma_f32_16x16x32_bf16 v[172:175], a[216:219], a[88:91], v[172:175]
  v_mul_f32 v133, s30, v133
  v_mul_f32 v134, s30, v134
  v_mfma_f32_16x16x32_bf16 v[172:175], a[220:223], a[92:95], v[172:175]
  v_mul_f32 v135, s30, v135
  v_cvt_pk_bf16_f32 v66, v132, v133
  v_mfma_f32_16x16x32_bf16 v[176:179], a[88:91], a[224:227], v[176:179]
  v_cvt_pk_bf16_f32 v67, v134, v135
  v_mul_f32 v136, s30, v136
  v_mfma_f32_16x16x32_bf16 v[176:179], a[92:95], a[228:231], v[176:179]
  v_mul_f32 v137, s30, v137
  v_mul_f32 v138, s30, v138
  v_mfma_f32_16x16x32_bf16 v[180:183], a[88:91], a[232:235], v[180:183]
  v_mul_f32 v139, s30, v139
  v_cvt_pk_bf16_f32 v68, v136, v137
  v_mfma_f32_16x16x32_bf16 v[180:183], a[92:95], a[236:239], v[180:183]
  v_cvt_pk_bf16_f32 v69, v138, v139
  v_mul_f32 v140, s30, v140
  v_mfma_f32_16x16x32_bf16 v[184:187], a[88:91], a[240:243], v[184:187]
  v_mul_f32 v141, s30, v141
  v_mul_f32 v142, s30, v142
  v_mfma_f32_16x16x32_bf16 v[184:187], a[92:95], a[244:247], v[184:187]
  v_mul_f32 v143, s30, v143
  v_cvt_pk_bf16_f32 v70, v140, v141
  v_mfma_f32_16x16x32_bf16 v[188:191], a[88:91], a[248:251], v[188:191]
  v_cvt_pk_bf16_f32 v71, v142, v143
  v_mul_f32 v160, s30, v160
  v_mfma_f32_16x16x32_bf16 v[188:191], a[92:95], a[252:255], v[188:191]
  v_mul_f32 v161, s30, v161
  v_mul_f32 v162, s30, v162
  v_mfma_f32_16x16x32_bf16 v[192:195], a[192:195], a[96:99], v[192:195]
  v_mul_f32 v163, s30, v163
  v_cvt_pk_bf16_f32 v72, v160, v161
  v_mfma_f32_16x16x32_bf16 v[192:195], a[196:199], a[100:103], v[192:195]
  v_cvt_pk_bf16_f32 v73, v162, v163
  v_mul_f32 v164, s30, v164
  v_mfma_f32_16x16x32_bf16 v[196:199], a[200:203], a[96:99], v[196:199]
  v_mul_f32 v165, s30, v165
  v_mul_f32 v166, s30, v166
  v_mfma_f32_16x16x32_bf16 v[196:199], a[204:207], a[100:103], v[196:199]
  v_mul_f32 v167, s30, v167
  v_cvt_pk_bf16_f32 v74, v164, v165
  v_mfma_f32_16x16x32_bf16 v[200:203], a[208:211], a[96:99], v[200:203]
  v_cvt_pk_bf16_f32 v75, v166, v167
  v_mul_f32 v168, s30, v168
  v_mfma_f32_16x16x32_bf16 v[200:203], a[212:215], a[100:103], v[200:203]
  v_mul_f32 v169, s30, v169
  v_mul_f32 v170, s30, v170
  v_mfma_f32_16x16x32_bf16 v[204:207], a[216:219], a[96:99], v[204:207]
  v_mul_f32 v171, s30, v171
  v_cvt_pk_bf16_f32 v76, v168, v169
  v_mfma_f32_16x16x32_bf16 v[204:207], a[220:223], a[100:103], v[204:207]
  v_cvt_pk_bf16_f32 v77, v170, v171
  v_mul_f32 v172, s30, v172
  v_mfma_f32_16x16x32_bf16 v[208:211], a[96:99], a[224:227], v[208:211]
  v_mul_f32 v173, s30, v173
  v_mul_f32 v174, s30, v174
  v_mfma_f32_16x16x32_bf16 v[208:211], a[100:103], a[228:231], v[208:211]
  s_add_u32 s29, s98, 4096
  v_mul_f32 v175, s30, v175
  v_cvt_pk_bf16_f32 v78, v172, v173
  v_mfma_f32_16x16x32_bf16 v[212:215], a[96:99], a[232:235], v[212:215]
  buffer_store_dwordx4 v[40:43], v12, s[16:19], s29 offen offset:0
  v_mfma_f32_16x16x32_bf16 v[212:215], a[100:103], a[236:239], v[212:215]
  v_cvt_pk_bf16_f32 v79, v174, v175
  v_cvt_pk_bf16_f32 v80, v144, v145
  v_mfma_f32_16x16x32_bf16 v[216:219], a[96:99], a[240:243], v[216:219]
  v_cvt_pk_bf16_f32 v81, v146, v147
  v_cvt_pk_bf16_f32 v82, v176, v177
  v_mfma_f32_16x16x32_bf16 v[216:219], a[100:103], a[244:247], v[216:219]
  v_cvt_pk_bf16_f32 v83, v178, v179
  v_cvt_pk_bf16_f32 v84, v148, v149
  v_mfma_f32_16x16x32_bf16 v[220:223], a[96:99], a[248:251], v[220:223]
  v_cvt_pk_bf16_f32 v85, v150, v151
  v_cvt_pk_bf16_f32 v86, v180, v181
  v_mfma_f32_16x16x32_bf16 v[220:223], a[100:103], a[252:255], v[220:223]
  v_cvt_pk_bf16_f32 v87, v182, v183
  v_cvt_pk_bf16_f32 v88, v152, v153
  v_mfma_f32_16x16x32_bf16 v[224:227], a[192:195], a[104:107], v[224:227]
  v_cvt_pk_bf16_f32 v89, v154, v155
  v_cvt_pk_bf16_f32 v90, v184, v185
  v_mfma_f32_16x16x32_bf16 v[224:227], a[196:199], a[108:111], v[224:227]
  v_cvt_pk_bf16_f32 v91, v186, v187
  v_cvt_pk_bf16_f32 v92, v156, v157
  v_mfma_f32_16x16x32_bf16 v[228:231], a[200:203], a[104:107], v[228:231]
  v_cvt_pk_bf16_f32 v93, v158, v159
  v_cvt_pk_bf16_f32 v94, v188, v189
  v_mfma_f32_16x16x32_bf16 v[228:231], a[204:207], a[108:111], v[228:231]
  v_cvt_pk_bf16_f32 v95, v190, v191
  v_mul_f32 v192, s30, v192
  v_mfma_f32_16x16x32_bf16 v[232:235], a[208:211], a[104:107], v[232:235]
  v_mul_f32 v193, s30, v193
  v_mul_f32 v194, s30, v194
  v_mfma_f32_16x16x32_bf16 v[232:235], a[212:215], a[108:111], v[232:235]
  v_mul_f32 v195, s30, v195
  v_cvt_pk_bf16_f32 v96, v192, v193
  v_mfma_f32_16x16x32_bf16 v[236:239], a[216:219], a[104:107], v[236:239]
  v_cvt_pk_bf16_f32 v97, v194, v195
  v_mul_f32 v196, s30, v196
  v_mfma_f32_16x16x32_bf16 v[236:239], a[220:223], a[108:111], v[236:239]
  v_mul_f32 v197, s30, v197
  v_mul_f32 v198, s30, v198
  v_mfma_f32_16x16x32_bf16 v[240:243], a[104:107], a[224:227], v[240:243]
  v_mul_f32 v199, s30, v199
  v_cvt_pk_bf16_f32 v98, v196, v197
  v_mfma_f32_16x16x32_bf16 v[240:243], a[108:111], a[228:231], v[240:243]
  v_cvt_pk_bf16_f32 v99, v198, v199
  v_mul_f32 v200, s30, v200
  v_mfma_f32_16x16x32_bf16 v[244:247], a[104:107], a[232:235], v[244:247]
  v_mul_f32 v201, s30, v201
  v_mul_f32 v202, s30, v202
  v_mfma_f32_16x16x32_bf16 v[244:247], a[108:111], a[236:239], v[244:247]
  v_mul_f32 v203, s30, v203
  v_cvt_pk_bf16_f32 v100, v200, v201
  v_mfma_f32_16x16x32_bf16 v[248:251], a[104:107], a[240:243], v[248:251]
  v_cvt_pk_bf16_f32 v101, v202, v203
  v_mul_f32 v204, s30, v204
  v_mfma_f32_16x16x32_bf16 v[248:251], a[108:111], a[244:247], v[248:251]
  v_mul_f32 v205, s30, v205
  v_mul_f32 v206, s30, v206
  v_mfma_f32_16x16x32_bf16 v[252:255], a[104:107], a[248:251], v[252:255]
  v_mul_f32 v207, s30, v207
  v_cvt_pk_bf16_f32 v102, v204, v205
  v_mfma_f32_16x16x32_bf16 v[252:255], a[108:111], a[252:255], v[252:255]
  v_cvt_pk_bf16_f32 v103, v206, v207
  v_mul_f32 v224, s30, v224
  v_mfma_f32_16x16x32_bf16 a[0:3], a[192:195], a[112:115], a[0:3]
  v_mul_f32 v225, s30, v225
  v_mul_f32 v226, s30, v226
  v_mfma_f32_16x16x32_bf16 a[0:3], a[196:199], a[116:119], a[0:3]
  v_mul_f32 v227, s30, v227
  v_cvt_pk_bf16_f32 v104, v224, v225
  v_mfma_f32_16x16x32_bf16 a[4:7], a[200:203], a[112:115], a[4:7]
  v_cvt_pk_bf16_f32 v105, v226, v227
  v_mul_f32 v228, s30, v228
  v_mfma_f32_16x16x32_bf16 a[4:7], a[204:207], a[116:119], a[4:7]
  v_mul_f32 v229, s30, v229
  v_mul_f32 v230, s30, v230
  v_mfma_f32_16x16x32_bf16 a[8:11], a[208:211], a[112:115], a[8:11]
  s_waitcnt vmcnt(15) lgkmcnt(0)
  s_barrier
  v_mul_f32 v231, s30, v231
  v_mfma_f32_16x16x32_bf16 a[8:11], a[212:215], a[116:119], a[8:11]
  v_cvt_pk_bf16_f32 v106, v228, v229
  v_cvt_pk_bf16_f32 v107, v230, v231
  v_mfma_f32_16x16x32_bf16 a[12:15], a[216:219], a[112:115], a[12:15]
  buffer_store_dwordx4 v[44:47], v12, s[16:19], s29 offen offset:1024
  v_mfma_f32_16x16x32_bf16 a[12:15], a[220:223], a[116:119], a[12:15]
  s_add_u32 m0, s77, 98304
  v_mul_f32 v232, s30, v232
  v_mul_f32 v233, s30, v233
  v_mfma_f32_16x16x32_bf16 a[16:19], a[112:115], a[224:227], a[16:19]
  ds_read_b64_tr_b16 a[160:161], v4 offset:32768
  ds_read_b64_tr_b16 a[162:163], v4 offset:33792
  v_mfma_f32_16x16x32_bf16 a[16:19], a[116:119], a[228:231], a[16:19]
  ds_read_b64_tr_b16 a[164:165], v4 offset:36864
  ds_read_b64_tr_b16 a[166:167], v4 offset:37888
  v_mfma_f32_16x16x32_bf16 a[20:23], a[112:115], a[232:235], a[20:23]
  buffer_load_dwordx4 v15, s[88:91], s72 offen offset:0 lds
  v_mfma_f32_16x16x32_bf16 a[20:23], a[116:119], a[236:239], a[20:23]
  ds_read_b128 a[128:131], v2 offset:0
  ds_read_b128 a[132:135], v3 offset:0
  v_mfma_f32_16x16x32_bf16 a[24:27], a[112:115], a[240:243], a[24:27]
  ds_read_b128 a[136:139], v2 offset:2048
  ds_read_b128 a[140:143], v3 offset:2048
  v_mfma_f32_16x16x32_bf16 a[24:27], a[116:119], a[244:247], a[24:27]
  buffer_load_dwordx4 v15, s[88:91], s73 offen offset:1024 lds
  v_mfma_f32_16x16x32_bf16 a[28:31], a[112:115], a[248:251], a[28:31]
  v_mul_f32 v234, s30, v234
  v_mul_f32 v235, s30, v235
  v_mfma_f32_16x16x32_bf16 a[28:31], a[116:119], a[252:255], a[28:31]
  buffer_load_dwordx4 v15, s[88:91], s74 offen offset:2048 lds
  v_mfma_f32_16x16x32_bf16 a[32:35], a[192:195], a[120:123], a[32:35]
  ds_read_b64_tr_b16 a[168:169], v5 offset:32768
  ds_read_b64_tr_b16 a[170:171], v5 offset:33792
  v_mfma_f32_16x16x32_bf16 a[32:35], a[196:199], a[124:127], a[32:35]
  ds_read_b64_tr_b16 a[172:173], v5 offset:36864
  ds_read_b64_tr_b16 a[174:175], v5 offset:37888
  v_mfma_f32_16x16x32_bf16 a[36:39], a[200:203], a[120:123], a[36:39]
  buffer_load_dwordx4 v15, s[88:91], s75 offen offset:3072 lds
  v_mfma_f32_16x16x32_bf16 a[36:39], a[204:207], a[124:127], a[36:39]
  ds_read_b128 a[144:147], v2 offset:4096
  ds_read_b128 a[148:151], v3 offset:4096
  v_mfma_f32_16x16x32_bf16 a[40:43], a[208:211], a[120:123], a[40:43]
  ds_read_b128 a[152:155], v2 offset:6144
  ds_read_b128 a[156:159], v3 offset:6144
  v_mfma_f32_16x16x32_bf16 a[40:43], a[212:215], a[124:127], a[40:43]
  v_add_u32 v2, 32768, v2
  v_add_u32 v3, 32768, v3
  v_mfma_f32_16x16x32_bf16 a[44:47], a[216:219], a[120:123], a[44:47]
  v_add_u32 v15, 0x80000, v15
  v_cvt_pk_bf16_f32 v108, v232, v233
  v_mfma_f32_16x16x32_bf16 a[44:47], a[220:223], a[124:127], a[44:47]
  s_add_u32 m0, s76, 65536
  v_cvt_pk_bf16_f32 v109, v234, v235
  v_mul_f32 v236, s30, v236
  v_mfma_f32_16x16x32_bf16 a[48:51], a[120:123], a[224:227], a[48:51]
  ds_read_b64_tr_b16 a[176:177], v6 offset:32768
  ds_read_b64_tr_b16 a[178:179], v6 offset:33792
  v_mfma_f32_16x16x32_bf16 a[48:51], a[124:127], a[228:231], a[48:51]
  ds_read_b64_tr_b16 a[180:181], v6 offset:36864
  ds_read_b64_tr_b16 a[182:183], v6 offset:37888
  v_mfma_f32_16x16x32_bf16 a[52:55], a[120:123], a[232:235], a[52:55]
  buffer_load_dwordx4 v13, s[84:87], s64 offen offset:0 lds
  v_mfma_f32_16x16x32_bf16 a[52:55], a[124:127], a[236:239], a[52:55]
  v_mul_f32 v237, s30, v237
  v_mul_f32 v238, s30, v238
  v_mfma_f32_16x16x32_bf16 a[56:59], a[120:123], a[240:243], a[56:59]
  buffer_load_dwordx4 v14, s[84:87], s65 offen offset:1024 lds
  v_mfma_f32_16x16x32_bf16 a[56:59], a[124:127], a[244:247], a[56:59]
  v_mul_f32 v239, s30, v239
  v_cvt_pk_bf16_f32 v110, v236, v237
  v_mfma_f32_16x16x32_bf16 a[60:63], a[120:123], a[248:251], a[60:63]
  buffer_load_dwordx4 v13, s[84:87], s66 offen offset:2048 lds
  v_mfma_f32_16x16x32_bf16 a[60:63], a[124:127], a[252:255], a[60:63]
  s_waitcnt lgkmcnt(4)
  v_cvt_pk_bf16_f32 v111, v238, v239
  v_cvt_pk_bf16_f32 v112, v208, v209
  v_mfma_f32_16x16x32_bf16 v[128:131], a[160:163], a[128:131], 0
  ds_read_b64_tr_b16 a[184:185], v7 offset:32768
  ds_read_b64_tr_b16 a[186:187], v7 offset:33792
  v_mfma_f32_16x16x32_bf16 v[128:131], a[164:167], a[132:135], v[128:131]
  s_add_u32 s28, s98, s82
  ds_read_b64_tr_b16 a[188:189], v7 offset:36864
  ds_read_b64_tr_b16 a[190:191], v7 offset:37888
  v_mfma_f32_16x16x32_bf16 v[160:163], a[160:163], a[136:139], 0
  buffer_store_dwordx4 v[48:51], v12, s[16:19], s28 offen offset:0
  v_mfma_f32_16x16x32_bf16 v[160:163], a[164:167], a[140:143], v[160:163]
  v_cvt_pk_bf16_f32 v113, v210, v211
  v_cvt_pk_bf16_f32 v114, v240, v241
  v_mfma_f32_16x16x32_bf16 v[192:195], a[160:163], a[144:147], 0
  buffer_load_dwordx4 v14, s[84:87], s67 offen offset:3072 lds
  v_mfma_f32_16x16x32_bf16 v[192:195], a[164:167], a[148:151], v[192:195]
  s_add_u32 m0, s76, 69632
  v_cvt_pk_bf16_f32 v115, v242, v243
  v_cvt_pk_bf16_f32 v116, v212, v213
  v_mfma_f32_16x16x32_bf16 v[224:227], a[160:163], a[152:155], 0
  buffer_load_dwordx4 v13, s[84:87], s68 offen offset:0 lds
  v_mfma_f32_16x16x32_bf16 v[224:227], a[164:167], a[156:159], v[224:227]
  v_cvt_pk_bf16_f32 v117, v214, v215
  v_cvt_pk_bf16_f32 v118, v244, v245
  v_mfma_f32_16x16x32_bf16 v[132:135], a[168:171], a[128:131], 0
  s_lshl_b32 s24, s6, 2
  ds_read_b64_tr_b16 a[160:161], v8 offset:32768
  ds_read_b64_tr_b16 a[162:163], v8 offset:33792
  v_mfma_f32_16x16x32_bf16 v[132:135], a[172:175], a[132:135], v[132:135]
  s_add_u32 s24, s24, s4
  ds_read_b64_tr_b16 a[164:165], v8 offset:36864
  ds_read_b64_tr_b16 a[166:167], v8 offset:37888
  v_mfma_f32_16x16x32_bf16 v[164:167], a[168:171], a[136:139], 0
  buffer_load_dwordx4 v14, s[84:87], s69 offen offset:1024 lds
  v_mfma_f32_16x16x32_bf16 v[164:167], a[172:175], a[140:143], v[164:167]
  s_lshl_b32 s24, s24, 5
  v_cvt_pk_bf16_f32 v119, v246, v247
  v_cvt_pk_bf16_f32 v120, v216, v217
  v_mfma_f32_16x16x32_bf16 v[196:199], a[168:171], a[144:147], 0
  buffer_load_dwordx4 v13, s[84:87], s70 offen offset:2048 lds
  v_mfma_f32_16x16x32_bf16 v[196:199], a[172:175], a[148:151], v[196:199]
  s_sub_u32 s25, 2016, s24
  v_cvt_pk_bf16_f32 v121, v218, v219
  v_cvt_pk_bf16_f32 v122, v248, v249
  v_mfma_f32_16x16x32_bf16 v[228:231], a[168:171], a[152:155], 0
  s_add_u32 s34, s24, s5
  v_cvt_pk_bf16_f32 v123, v250, v251
  v_cvt_pk_bf16_f32 v124, v220, v221
  v_mfma_f32_16x16x32_bf16 v[228:231], a[172:175], a[156:159], v[228:231]
  s_waitcnt lgkmcnt(8)
  v_cvt_pk_bf16_f32 v125, v222, v223
  v_cvt_pk_bf16_f32 v126, v252, v253
  v_mfma_f32_16x16x32_bf16 v[136:139], a[176:179], a[128:131], 0
  s_add_u32 s35, s25, s5
  ds_read_b64_tr_b16 a[168:169], v9 offset:32768
  ds_read_b64_tr_b16 a[170:171], v9 offset:33792
  v_mfma_f32_16x16x32_bf16 v[136:139], a[180:183], a[132:135], v[136:139]
  s_add_u32 s24, s24, s34
  ds_read_b64_tr_b16 a[172:173], v9 offset:36864
  ds_read_b64_tr_b16 a[174:175], v9 offset:37888
  v_mfma_f32_16x16x32_bf16 v[168:171], a[176:179], a[136:139], 0
  buffer_load_dwordx4 v14, s[84:87], s71 offen offset:3072 lds
  v_mfma_f32_16x16x32_bf16 v[168:171], a[180:183], a[140:143], v[168:171]
  s_add_u32 s25, s25, s35
  v_add_u32 v13, 128, v13
  v_add_u32 v14, 128, v14
  v_mfma_f32_16x16x32_bf16 v[200:203], a[176:179], a[144:147], 0
  s_add_u32 m0, s77, 114688
  v_cvt_pk_bf16_f32 v127, v254, v255
  v_accvgpr_read_b32 v16, a0
  v_mfma_f32_16x16x32_bf16 v[200:203], a[180:183], a[148:151], v[200:203]
  buffer_load_dwordx4 v26, s[12:15], s64 offen offset:0 lds
  v_mfma_f32_16x16x32_bf16 v[232:235], a[176:179], a[152:155], 0
  s_lshl_b32 s24, s24, 12
  v_accvgpr_read_b32 v17, a1
  v_accvgpr_read_b32 v18, a2
  v_mfma_f32_16x16x32_bf16 v[232:235], a[180:183], a[156:159], v[232:235]
  s_waitcnt lgkmcnt(8)
  v_accvgpr_read_b32 v19, a3
  v_mul_f32 v16, s30, v16
  v_mfma_f32_16x16x32_bf16 v[140:143], a[184:187], a[128:131], 0
  s_lshl_b32 s25, s25, 12
  ds_read_b64_tr_b16 a[176:177], v10 offset:32768
  ds_read_b64_tr_b16 a[178:179], v10 offset:33792
  v_mfma_f32_16x16x32_bf16 v[140:143], a[188:191], a[132:135], v[140:143]
  s_add_u32 s52, s24, 33554432
  ds_read_b64_tr_b16 a[180:181], v10 offset:36864
  ds_read_b64_tr_b16 a[182:183], v10 offset:37888
  v_mfma_f32_16x16x32_bf16 v[172:175], a[184:187], a[136:139], 0
  buffer_load_dwordx4 v26, s[12:15], s65 offen offset:1024 lds
  v_mfma_f32_16x16x32_bf16 v[172:175], a[188:191], a[140:143], v[172:175]
  s_add_u32 s53, s25, 33554432
  v_mul_f32 v17, s30, v17
  v_mul_f32 v18, s30, v18
  v_mfma_f32_16x16x32_bf16 v[204:207], a[184:187], a[144:147], 0
  buffer_load_dwordx4 v26, s[12:15], s66 offen offset:2048 lds
  v_mfma_f32_16x16x32_bf16 v[204:207], a[188:191], a[148:151], v[204:207]
  s_lshl_b32 s34, s34, 7
  v_mul_f32 v19, s30, v19
  v_cvt_pk_bf16_f32 v20, v16, v17
  v_mfma_f32_16x16x32_bf16 v[236:239], a[184:187], a[152:155], 0
  buffer_store_dwordx4 v[52:55], v12, s[16:19], s28 offen offset:1024
  v_mfma_f32_16x16x32_bf16 v[236:239], a[188:191], a[156:159], v[236:239]
  s_waitcnt lgkmcnt(8)
  v_cvt_pk_bf16_f32 v21, v18, v19
  v_accvgpr_read_b32 v16, a4
  v_mfma_f32_16x16x32_bf16 v[144:147], a[160:163], a[128:131], 0
  s_lshl_b32 s35, s35, 7
  ds_read_b64_tr_b16 a[184:185], v11 offset:32768
  ds_read_b64_tr_b16 a[186:187], v11 offset:33792
  v_mfma_f32_16x16x32_bf16 v[144:147], a[164:167], a[132:135], v[144:147]
  s_add_u32 s34, s34, 60030976
  ds_read_b64_tr_b16 a[188:189], v11 offset:36864
  ds_read_b64_tr_b16 a[190:191], v11 offset:37888
  v_mfma_f32_16x16x32_bf16 v[176:179], a[160:163], a[136:139], 0
  buffer_load_dwordx4 v26, s[12:15], s67 offen offset:3072 lds
  v_mfma_f32_16x16x32_bf16 v[176:179], a[164:167], a[140:143], v[176:179]
  s_add_u32 s35, s35, 60030976
  v_accvgpr_read_b32 v17, a5
  v_accvgpr_read_b32 v18, a6
  v_mfma_f32_16x16x32_bf16 v[208:211], a[160:163], a[144:147], 0
  v_accvgpr_read_b32 v19, a7
  v_mul_f32 v16, s30, v16
  v_mfma_f32_16x16x32_bf16 v[208:211], a[164:167], a[148:151], v[208:211]
  v_mul_f32 v17, s30, v17
  v_mul_f32 v18, s30, v18
  v_mfma_f32_16x16x32_bf16 v[240:243], a[160:163], a[152:155], 0
  v_mul_f32 v19, s30, v19
  v_cvt_pk_bf16_f32 v22, v16, v17
  v_mfma_f32_16x16x32_bf16 v[240:243], a[164:167], a[156:159], v[240:243]
  s_waitcnt vmcnt(22) lgkmcnt(0)
  s_barrier
  v_cvt_pk_bf16_f32 v23, v18, v19
  v_mfma_f32_16x16x32_bf16 v[148:151], a[168:171], a[128:131], 0
  ds_read_b64_tr_b16 a[160:161], v4 offset:49152
  ds_read_b64_tr_b16 a[162:163], v4 offset:50176
  v_mfma_f32_16x16x32_bf16 v[148:151], a[172:175], a[132:135], v[148:151]
  ds_read_b64_tr_b16 a[164:165], v4 offset:53248
  ds_read_b64_tr_b16 a[166:167], v4 offset:54272
  v_mfma_f32_16x16x32_bf16 v[180:183], a[168:171], a[136:139], 0
  s_add_u32 m0, s77, 131072
  v_accvgpr_write_b32 a0, v20
  v_accvgpr_write_b32 a1, v21
  v_mfma_f32_16x16x32_bf16 v[180:183], a[172:175], a[140:143], v[180:183]
  ds_read_b128 a[192:195], v2 offset:0
  ds_read_b128 a[196:199], v3 offset:0
  v_mfma_f32_16x16x32_bf16 v[212:215], a[168:171], a[144:147], 0
  ds_read_b128 a[200:203], v2 offset:2048
  ds_read_b128 a[204:207], v3 offset:2048
  v_mfma_f32_16x16x32_bf16 v[212:215], a[172:175], a[148:151], v[212:215]
  buffer_load_dwordx4 v15, s[88:91], s72 offen offset:0 lds
  v_mfma_f32_16x16x32_bf16 v[244:247], a[168:171], a[152:155], 0
  v_accvgpr_write_b32 a2, v22
  v_accvgpr_write_b32 a3, v23
  v_mfma_f32_16x16x32_bf16 v[244:247], a[172:175], a[156:159], v[244:247]
  v_accvgpr_read_b32 v16, a8
  v_accvgpr_read_b32 v17, a9
  v_mfma_f32_16x16x32_bf16 v[152:155], a[176:179], a[128:131], 0
  ds_read_b64_tr_b16 a[168:169], v5 offset:49152
  ds_read_b64_tr_b16 a[170:171], v5 offset:50176
  v_mfma_f32_16x16x32_bf16 v[152:155], a[180:183], a[132:135], v[152:155]
  ds_read_b64_tr_b16 a[172:173], v5 offset:53248
  ds_read_b64_tr_b16 a[174:175], v5 offset:54272
  v_mfma_f32_16x16x32_bf16 v[184:187], a[176:179], a[136:139], 0
  buffer_load_dwordx4 v15, s[88:91], s73 offen offset:1024 lds
  v_mfma_f32_16x16x32_bf16 v[184:187], a[180:183], a[140:143], v[184:187]
  ds_read_b128 a[208:211], v2 offset:4096
  ds_read_b128 a[212:215], v3 offset:4096
  v_mfma_f32_16x16x32_bf16 v[216:219], a[176:179], a[144:147], 0
  ds_read_b128 a[216:219], v2 offset:6144
  ds_read_b128 a[220:223], v3 offset:6144
  v_mfma_f32_16x16x32_bf16 v[216:219], a[180:183], a[148:151], v[216:219]
  v_add_u32 v2, 32768, v2
  v_add_u32 v3, 32768, v3
  v_mfma_f32_16x16x32_bf16 v[248:251], a[176:179], a[152:155], 0
  buffer_load_dwordx4 v15, s[88:91], s74 offen offset:2048 lds
  v_mfma_f32_16x16x32_bf16 v[248:251], a[180:183], a[156:159], v[248:251]
  v_accvgpr_read_b32 v18, a10
  v_accvgpr_read_b32 v19, a11
  v_mfma_f32_16x16x32_bf16 v[156:159], a[184:187], a[128:131], 0
  ds_read_b64_tr_b16 a[176:177], v6 offset:49152
  ds_read_b64_tr_b16 a[178:179], v6 offset:50176
  v_mfma_f32_16x16x32_bf16 v[156:159], a[188:191], a[132:135], v[156:159]
  ds_read_b64_tr_b16 a[180:181], v6 offset:53248
  ds_read_b64_tr_b16 a[182:183], v6 offset:54272
  v_mfma_f32_16x16x32_bf16 v[188:191], a[184:187], a[136:139], 0
  buffer_store_dwordx4 v[56:59], v12, s[16:19], s28 offen offset:2048
  v_mfma_f32_16x16x32_bf16 v[188:191], a[188:191], a[140:143], v[188:191]
  v_mul_f32 v16, s30, v16
  v_mul_f32 v17, s30, v17
  v_mfma_f32_16x16x32_bf16 v[220:223], a[184:187], a[144:147], 0
  buffer_load_dwordx4 v15, s[88:91], s75 offen offset:3072 lds
  v_mfma_f32_16x16x32_bf16 v[220:223], a[188:191], a[148:151], v[220:223]
  v_add_u32 v15, 0x80000, v15
  v_mul_f32 v18, s30, v18
  v_mfma_f32_16x16x32_bf16 v[252:255], a[184:187], a[152:155], 0
  s_add_u32 m0, s76, 0
  v_mul_f32 v19, s30, v19
  v_cvt_pk_bf16_f32 v20, v16, v17
  v_mfma_f32_16x16x32_bf16 v[252:255], a[188:191], a[156:159], v[252:255]
  s_waitcnt lgkmcnt(4)
  v_cvt_pk_bf16_f32 v21, v18, v19
  v_accvgpr_read_b32 v16, a12
  v_mfma_f32_16x16x32_bf16 v[128:131], a[160:163], a[192:195], v[128:131]
  ds_read_b64_tr_b16 a[184:185], v7 offset:49152
  ds_read_b64_tr_b16 a[186:187], v7 offset:50176
  v_mfma_f32_16x16x32_bf16 v[128:131], a[164:167], a[196:199], v[128:131]
  ds_read_b64_tr_b16 a[188:189], v7 offset:53248
  ds_read_b64_tr_b16 a[190:191], v7 offset:54272
  v_mfma_f32_16x16x32_bf16 v[160:163], a[160:163], a[200:203], v[160:163]
  buffer_load_dwordx4 v13, s[84:87], s64 offen offset:0 lds
  v_mfma_f32_16x16x32_bf16 v[160:163], a[164:167], a[204:207], v[160:163]
  v_accvgpr_read_b32 v17, a13
  v_accvgpr_read_b32 v18, a14
  v_mfma_f32_16x16x32_bf16 v[192:195], a[160:163], a[208:211], v[192:195]
  buffer_load_dwordx4 v14, s[84:87], s65 offen offset:1024 lds
  v_mfma_f32_16x16x32_bf16 v[192:195], a[164:167], a[212:215], v[192:195]
  v_accvgpr_read_b32 v19, a15
  v_mul_f32 v16, s30, v16
  v_mfma_f32_16x16x32_bf16 v[224:227], a[160:163], a[216:219], v[224:227]
  v_mul_f32 v17, s30, v17
  v_mul_f32 v18, s30, v18
  v_mfma_f32_16x16x32_bf16 v[224:227], a[164:167], a[220:223], v[224:227]
  v_mul_f32 v19, s30, v19
  v_cvt_pk_bf16_f32 v22, v16, v17
  v_mfma_f32_16x16x32_bf16 v[132:135], a[168:171], a[192:195], v[132:135]
  ds_read_b64_tr_b16 a[160:161], v8 offset:49152
  ds_read_b64_tr_b16 a[162:163], v8 offset:50176
  v_mfma_f32_16x16x32_bf16 v[132:135], a[172:175], a[196:199], v[132:135]
  ds_read_b64_tr_b16 a[164:165], v8 offset:53248
  ds_read_b64_tr_b16 a[166:167], v8 offset:54272
  v_mfma_f32_16x16x32_bf16 v[164:167], a[168:171], a[200:203], v[164:167]
  buffer_load_dwordx4 v13, s[84:87], s66 offen offset:2048 lds
  v_mfma_f32_16x16x32_bf16 v[164:167], a[172:175], a[204:207], v[164:167]
  v_cvt_pk_bf16_f32 v23, v18, v19
  v_accvgpr_write_b32 a8, v20
  v_mfma_f32_16x16x32_bf16 v[196:199], a[168:171], a[208:211], v[196:199]
  buffer_load_dwordx4 v14, s[84:87], s67 offen offset:3072 lds
  v_mfma_f32_16x16x32_bf16 v[196:199], a[172:175], a[212:215], v[196:199]
  v_accvgpr_write_b32 a9, v21
  v_accvgpr_write_b32 a10, v22
  v_mfma_f32_16x16x32_bf16 v[228:231], a[168:171], a[216:219], v[228:231]
  v_accvgpr_write_b32 a11, v23
  v_accvgpr_read_b32 v16, a32
  v_mfma_f32_16x16x32_bf16 v[228:231], a[172:175], a[220:223], v[228:231]
  s_waitcnt lgkmcnt(8)
  v_accvgpr_read_b32 v17, a33
  v_accvgpr_read_b32 v18, a34
  v_mfma_f32_16x16x32_bf16 v[136:139], a[176:179], a[192:195], v[136:139]
  s_add_u32 m0, s76, 4096
  ds_read_b64_tr_b16 a[168:169], v9 offset:49152
  ds_read_b64_tr_b16 a[170:171], v9 offset:50176
  v_mfma_f32_16x16x32_bf16 v[136:139], a[180:183], a[196:199], v[136:139]
  ds_read_b64_tr_b16 a[172:173], v9 offset:53248
  ds_read_b64_tr_b16 a[174:175], v9 offset:54272
  v_mfma_f32_16x16x32_bf16 v[168:171], a[176:179], a[200:203], v[168:171]
  buffer_load_dwordx4 v13, s[84:87], s68 offen offset:0 lds
  v_mfma_f32_16x16x32_bf16 v[168:171], a[180:183], a[204:207], v[168:171]
  v_accvgpr_read_b32 v19, a35
  v_mul_f32 v16, s30, v16
  v_mfma_f32_16x16x32_bf16 v[200:203], a[176:179], a[208:211], v[200:203]
  v_mul_f32 v17, s30, v17
  v_mul_f32 v18, s30, v18
  v_mfma_f32_16x16x32_bf16 v[200:203], a[180:183], a[212:215], v[200:203]
  v_mul_f32 v19, s30, v19
  v_cvt_pk_bf16_f32 v20, v16, v17
  v_mfma_f32_16x16x32_bf16 v[232:235], a[176:179], a[216:219], v[232:235]
  buffer_store_dwordx4 v[60:63], v12, s[16:19], s28 offen offset:3072
  v_mfma_f32_16x16x32_bf16 v[232:235], a[180:183], a[220:223], v[232:235]
  s_waitcnt lgkmcnt(8)
  v_cvt_pk_bf16_f32 v21, v18, v19
  v_accvgpr_read_b32 v16, a36
  v_mfma_f32_16x16x32_bf16 v[140:143], a[184:187], a[192:195], v[140:143]
  ds_read_b64_tr_b16 a[176:177], v10 offset:49152
  ds_read_b64_tr_b16 a[178:179], v10 offset:50176
  v_mfma_f32_16x16x32_bf16 v[140:143], a[188:191], a[196:199], v[140:143]
  ds_read_b64_tr_b16 a[180:181], v10 offset:53248
  ds_read_b64_tr_b16 a[182:183], v10 offset:54272
  v_mfma_f32_16x16x32_bf16 v[172:175], a[184:187], a[200:203], v[172:175]
  buffer_load_dwordx4 v14, s[84:87], s69 offen offset:1024 lds
  v_mfma_f32_16x16x32_bf16 v[172:175], a[188:191], a[204:207], v[172:175]
  v_accvgpr_read_b32 v17, a37
  v_accvgpr_read_b32 v18, a38
  v_mfma_f32_16x16x32_bf16 v[204:207], a[184:187], a[208:211], v[204:207]
  buffer_load_dwordx4 v13, s[84:87], s70 offen offset:2048 lds
  v_mfma_f32_16x16x32_bf16 v[204:207], a[188:191], a[212:215], v[204:207]
  v_accvgpr_read_b32 v19, a39
  v_mul_f32 v16, s30, v16
  v_mfma_f32_16x16x32_bf16 v[236:239], a[184:187], a[216:219], v[236:239]
  v_mul_f32 v17, s30, v17
  v_mul_f32 v18, s30, v18
  v_mfma_f32_16x16x32_bf16 v[236:239], a[188:191], a[220:223], v[236:239]
  s_waitcnt lgkmcnt(8)
  v_mul_f32 v19, s30, v19
  v_cvt_pk_bf16_f32 v22, v16, v17
  v_mfma_f32_16x16x32_bf16 v[144:147], a[160:163], a[192:195], v[144:147]
  ds_read_b64_tr_b16 a[184:185], v11 offset:49152
  ds_read_b64_tr_b16 a[186:187], v11 offset:50176
  v_mfma_f32_16x16x32_bf16 v[144:147], a[164:167], a[196:199], v[144:147]
  ds_read_b64_tr_b16 a[188:189], v11 offset:53248
  ds_read_b64_tr_b16 a[190:191], v11 offset:54272
  v_mfma_f32_16x16x32_bf16 v[176:179], a[160:163], a[200:203], v[176:179]
  buffer_load_dwordx4 v14, s[84:87], s71 offen offset:3072 lds
  v_mfma_f32_16x16x32_bf16 v[176:179], a[164:167], a[204:207], v[176:179]
  v_add_u32 v13, 128, v13
  v_add_u32 v14, 128, v14
  v_mfma_f32_16x16x32_bf16 v[208:211], a[160:163], a[208:211], v[208:211]
  v_cvt_pk_bf16_f32 v23, v18, v19
  v_accvgpr_write_b32 a32, v20
  v_mfma_f32_16x16x32_bf16 v[208:211], a[164:167], a[212:215], v[208:211]
  v_accvgpr_write_b32 a33, v21
  v_accvgpr_write_b32 a34, v22
  v_mfma_f32_16x16x32_bf16 v[240:243], a[160:163], a[216:219], v[240:243]
  v_accvgpr_write_b32 a35, v23
  v_accvgpr_read_b32 v16, a40
  v_mfma_f32_16x16x32_bf16 v[240:243], a[164:167], a[220:223], v[240:243]
  s_waitcnt vmcnt(19) lgkmcnt(0)
  s_barrier
  v_accvgpr_read_b32 v17, a41
  v_mfma_f32_16x16x32_bf16 v[148:151], a[168:171], a[192:195], v[148:151]
  ds_read_b64_tr_b16 a[160:161], v4 offset:0
  ds_read_b64_tr_b16 a[162:163], v4 offset:1024
  v_mfma_f32_16x16x32_bf16 v[148:151], a[172:175], a[196:199], v[148:151]
  ds_read_b64_tr_b16 a[164:165], v4 offset:4096
  ds_read_b64_tr_b16 a[166:167], v4 offset:5120
  v_mfma_f32_16x16x32_bf16 v[180:183], a[168:171], a[200:203], v[180:183]
  s_add_u32 m0, s77, 147456
  v_accvgpr_read_b32 v18, a42
  v_accvgpr_read_b32 v19, a43
  v_mfma_f32_16x16x32_bf16 v[180:183], a[172:175], a[204:207], v[180:183]
  ds_read_b128 a[128:131], v2 offset:0
  ds_read_b128 a[132:135], v3 offset:0
  v_mfma_f32_16x16x32_bf16 v[212:215], a[168:171], a[208:211], v[212:215]
  ds_read_b128 a[136:139], v2 offset:2048
  ds_read_b128 a[140:143], v3 offset:2048
  v_mfma_f32_16x16x32_bf16 v[212:215], a[172:175], a[212:215], v[212:215]
  buffer_load_dwordx4 v15, s[88:91], s72 offen offset:0 lds
  v_mfma_f32_16x16x32_bf16 v[244:247], a[168:171], a[216:219], v[244:247]
  v_mul_f32 v16, s30, v16
  v_mul_f32 v17, s30, v17
  v_mfma_f32_16x16x32_bf16 v[244:247], a[172:175], a[220:223], v[244:247]
  v_mul_f32 v18, s30, v18
  v_mul_f32 v19, s30, v19
  v_mfma_f32_16x16x32_bf16 v[152:155], a[176:179], a[192:195], v[152:155]
  ds_read_b64_tr_b16 a[168:169], v5 offset:0
  ds_read_b64_tr_b16 a[170:171], v5 offset:1024
  v_mfma_f32_16x16x32_bf16 v[152:155], a[180:183], a[196:199], v[152:155]
  ds_read_b64_tr_b16 a[172:173], v5 offset:4096
  ds_read_b64_tr_b16 a[174:175], v5 offset:5120
  v_mfma_f32_16x16x32_bf16 v[184:187], a[176:179], a[200:203], v[184:187]
  buffer_store_dwordx4 v[64:67], v12, s[16:19], s99 offen offset:0
  v_mfma_f32_16x16x32_bf16 v[184:187], a[180:183], a[204:207], v[184:187]
  ds_read_b128 a[144:147], v2 offset:4096
  ds_read_b128 a[148:151], v3 offset:4096
  v_mfma_f32_16x16x32_bf16 v[216:219], a[176:179], a[208:211], v[216:219]
  ds_read_b128 a[152:155], v2 offset:6144
  ds_read_b128 a[156:159], v3 offset:6144
  v_mfma_f32_16x16x32_bf16 v[216:219], a[180:183], a[212:215], v[216:219]
  v_subrev_u32 v2, 65536, v2
  v_subrev_u32 v3, 65536, v3
  v_mfma_f32_16x16x32_bf16 v[248:251], a[176:179], a[216:219], v[248:251]
  buffer_load_dwordx4 v15, s[88:91], s73 offen offset:1024 lds
  v_mfma_f32_16x16x32_bf16 v[248:251], a[180:183], a[220:223], v[248:251]
  v_cvt_pk_bf16_f32 v20, v16, v17
  v_cvt_pk_bf16_f32 v21, v18, v19
  v_mfma_f32_16x16x32_bf16 v[156:159], a[184:187], a[192:195], v[156:159]
  ds_read_b64_tr_b16 a[176:177], v6 offset:0
  ds_read_b64_tr_b16 a[178:179], v6 offset:1024
  v_mfma_f32_16x16x32_bf16 v[156:159], a[188:191], a[196:199], v[156:159]
  ds_read_b64_tr_b16 a[180:181], v6 offset:4096
  ds_read_b64_tr_b16 a[182:183], v6 offset:5120
  v_mfma_f32_16x16x32_bf16 v[188:191], a[184:187], a[200:203], v[188:191]
  buffer_load_dwordx4 v15, s[88:91], s74 offen offset:2048 lds
  v_mfma_f32_16x16x32_bf16 v[188:191], a[188:191], a[204:207], v[188:191]
  v_accvgpr_read_b32 v16, a44
  v_accvgpr_read_b32 v17, a45
  v_mfma_f32_16x16x32_bf16 v[220:223], a[184:187], a[208:211], v[220:223]
  buffer_load_dwordx4 v15, s[88:91], s75 offen offset:3072 lds
  v_mfma_f32_16x16x32_bf16 v[220:223], a[188:191], a[212:215], v[220:223]
  v_add_u32 v15, 0x80000, v15
  v_accvgpr_read_b32 v18, a46
  v_mfma_f32_16x16x32_bf16 v[252:255], a[184:187], a[216:219], v[252:255]
  s_add_u32 m0, s76, 32768
  v_accvgpr_read_b32 v19, a47
  v_mul_f32 v16, s30, v16
  v_mfma_f32_16x16x32_bf16 v[252:255], a[188:191], a[220:223], v[252:255]
  s_waitcnt lgkmcnt(4)
  v_mul_f32 v17, s30, v17
  v_mul_f32 v18, s30, v18
  v_mfma_f32_16x16x32_bf16 v[128:131], a[160:163], a[128:131], v[128:131]
  ds_read_b64_tr_b16 a[184:185], v7 offset:0
  ds_read_b64_tr_b16 a[186:187], v7 offset:1024
  v_mfma_f32_16x16x32_bf16 v[128:131], a[164:167], a[132:135], v[128:131]
  ds_read_b64_tr_b16 a[188:189], v7 offset:4096
  ds_read_b64_tr_b16 a[190:191], v7 offset:5120
  v_mfma_f32_16x16x32_bf16 v[160:163], a[160:163], a[136:139], v[160:163]
  buffer_load_dwordx4 v13, s[84:87], s64 offen offset:0 lds
  v_mfma_f32_16x16x32_bf16 v[160:163], a[164:167], a[140:143], v[160:163]
  v_mul_f32 v19, s30, v19
  v_cvt_pk_bf16_f32 v22, v16, v17
  v_mfma_f32_16x16x32_bf16 v[192:195], a[160:163], a[144:147], v[192:195]
  buffer_load_dwordx4 v14, s[84:87], s65 offen offset:1024 lds
  v_mfma_f32_16x16x32_bf16 v[192:195], a[164:167], a[148:151], v[192:195]
  v_cvt_pk_bf16_f32 v23, v18, v19
  v_accvgpr_write_b32 a40, v20
  v_mfma_f32_16x16x32_bf16 v[224:227], a[160:163], a[152:155], v[224:227]
  v_accvgpr_write_b32 a41, v21
  v_accvgpr_write_b32 a42, v22
  v_mfma_f32_16x16x32_bf16 v[224:227], a[164:167], a[156:159], v[224:227]
  v_accvgpr_write_b32 a43, v23
  v_accvgpr_read_b32 v16, a16
  v_mfma_f32_16x16x32_bf16 v[132:135], a[168:171], a[128:131], v[132:135]
  ds_read_b64_tr_b16 a[160:161], v8 offset:0
  ds_read_b64_tr_b16 a[162:163], v8 offset:1024
  v_mfma_f32_16x16x32_bf16 v[132:135], a[172:175], a[132:135], v[132:135]
  ds_read_b64_tr_b16 a[164:165], v8 offset:4096
  ds_read_b64_tr_b16 a[166:167], v8 offset:5120
  v_mfma_f32_16x16x32_bf16 v[164:167], a[168:171], a[136:139], v[164:167]
  buffer_load_dwordx4 v13, s[84:87], s66 offen offset:2048 lds
  v_mfma_f32_16x16x32_bf16 v[164:167], a[172:175], a[140:143], v[164:167]
  v_accvgpr_read_b32 v17, a17
  v_accvgpr_read_b32 v18, a18
  v_mfma_f32_16x16x32_bf16 v[196:199], a[168:171], a[144:147], v[196:199]
  buffer_load_dwordx4 v14, s[84:87], s67 offen offset:3072 lds
  v_mfma_f32_16x16x32_bf16 v[196:199], a[172:175], a[148:151], v[196:199]
  v_accvgpr_read_b32 v19, a19
  v_cvt_pk_bf16_f32 v20, v16, v17
  v_mfma_f32_16x16x32_bf16 v[228:231], a[168:171], a[152:155], v[228:231]
  buffer_store_dwordx4 v[68:71], v12, s[16:19], s99 offen offset:1024
  v_mfma_f32_16x16x32_bf16 v[228:231], a[172:175], a[156:159], v[228:231]
  s_waitcnt lgkmcnt(8)
  v_cvt_pk_bf16_f32 v21, v18, v19
  v_accvgpr_read_b32 v16, a48
  v_mfma_f32_16x16x32_bf16 v[136:139], a[176:179], a[128:131], v[136:139]
  s_add_u32 m0, s76, 36864
  ds_read_b64_tr_b16 a[168:169], v9 offset:0
  ds_read_b64_tr_b16 a[170:171], v9 offset:1024
  v_mfma_f32_16x16x32_bf16 v[136:139], a[180:183], a[132:135], v[136:139]
  ds_read_b64_tr_b16 a[172:173], v9 offset:4096
  ds_read_b64_tr_b16 a[174:175], v9 offset:5120
  v_mfma_f32_16x16x32_bf16 v[168:171], a[176:179], a[136:139], v[168:171]
  buffer_load_dwordx4 v13, s[84:87], s68 offen offset:0 lds
  v_mfma_f32_16x16x32_bf16 v[168:171], a[180:183], a[140:143], v[168:171]
  v_accvgpr_read_b32 v17, a49
  v_accvgpr_read_b32 v18, a50
  v_mfma_f32_16x16x32_bf16 v[200:203], a[176:179], a[144:147], v[200:203]
  v_accvgpr_read_b32 v19, a51
  v_cvt_pk_bf16_f32 v22, v16, v17
  v_mfma_f32_16x16x32_bf16 v[200:203], a[180:183], a[148:151], v[200:203]
  v_cvt_pk_bf16_f32 v23, v18, v19
  v_accvgpr_write_b32 a16, v20
  v_mfma_f32_16x16x32_bf16 v[232:235], a[176:179], a[152:155], v[232:235]
  buffer_load_dwordx4 v14, s[84:87], s69 offen offset:1024 lds
  v_mfma_f32_16x16x32_bf16 v[232:235], a[180:183], a[156:159], v[232:235]
  s_waitcnt lgkmcnt(8)
  v_accvgpr_write_b32 a17, v21
  v_accvgpr_write_b32 a18, v22
  v_mfma_f32_16x16x32_bf16 v[140:143], a[184:187], a[128:131], v[140:143]
  ds_read_b64_tr_b16 a[176:177], v10 offset:0
  ds_read_b64_tr_b16 a[178:179], v10 offset:1024
  v_mfma_f32_16x16x32_bf16 v[140:143], a[188:191], a[132:135], v[140:143]
  ds_read_b64_tr_b16 a[180:181], v10 offset:4096
  ds_read_b64_tr_b16 a[182:183], v10 offset:5120
  v_mfma_f32_16x16x32_bf16 v[172:175], a[184:187], a[136:139], v[172:175]
  v_accvgpr_write_b32 a19, v23
  v_accvgpr_read_b32 v16, a20
  v_mfma_f32_16x16x32_bf16 v[172:175], a[188:191], a[140:143], v[172:175]
  buffer_load_dwordx4 v13, s[84:87], s70 offen offset:2048 lds
  v_mfma_f32_16x16x32_bf16 v[204:207], a[184:187], a[144:147], v[204:207]
  v_accvgpr_read_b32 v17, a21
  v_accvgpr_read_b32 v18, a22
  v_mfma_f32_16x16x32_bf16 v[204:207], a[188:191], a[148:151], v[204:207]
  v_accvgpr_read_b32 v19, a23
  v_cvt_pk_bf16_f32 v20, v16, v17
  v_mfma_f32_16x16x32_bf16 v[236:239], a[184:187], a[152:155], v[236:239]
  v_cvt_pk_bf16_f32 v21, v18, v19
  v_accvgpr_read_b32 v16, a52
  v_mfma_f32_16x16x32_bf16 v[236:239], a[188:191], a[156:159], v[236:239]
  s_waitcnt lgkmcnt(8)
  v_accvgpr_read_b32 v17, a53
  v_accvgpr_read_b32 v18, a54
  v_mfma_f32_16x16x32_bf16 v[144:147], a[160:163], a[128:131], v[144:147]
  ds_read_b64_tr_b16 a[184:185], v11 offset:0
  ds_read_b64_tr_b16 a[186:187], v11 offset:1024
  v_mfma_f32_16x16x32_bf16 v[144:147], a[164:167], a[132:135], v[144:147]
  ds_read_b64_tr_b16 a[188:189], v11 offset:4096
  ds_read_b64_tr_b16 a[190:191], v11 offset:5120
  v_mfma_f32_16x16x32_bf16 v[176:179], a[160:163], a[136:139], v[176:179]
  buffer_load_dwordx4 v14, s[84:87], s71 offen offset:3072 lds
  v_mfma_f32_16x16x32_bf16 v[176:179], a[164:167], a[140:143], v[176:179]
  v_add_u32 v13, 128, v13
  v_add_u32 v14, 128, v14
  v_mfma_f32_16x16x32_bf16 v[208:211], a[160:163], a[144:147], v[208:211]
  v_accvgpr_read_b32 v19, a55
  v_cvt_pk_bf16_f32 v22, v16, v17
  v_mfma_f32_16x16x32_bf16 v[208:211], a[164:167], a[148:151], v[208:211]
  v_cvt_pk_bf16_f32 v23, v18, v19
  v_accvgpr_write_b32 a20, v20
  v_mfma_f32_16x16x32_bf16 v[240:243], a[160:163], a[152:155], v[240:243]
  v_accvgpr_write_b32 a21, v21
  v_accvgpr_write_b32 a22, v22
  v_mfma_f32_16x16x32_bf16 v[240:243], a[164:167], a[156:159], v[240:243]
  s_waitcnt vmcnt(14) lgkmcnt(0)
  s_barrier
  v_accvgpr_write_b32 a23, v23
  v_mfma_f32_16x16x32_bf16 v[148:151], a[168:171], a[128:131], v[148:151]
  ds_read_b64_tr_b16 a[160:161], v4 offset:32768
  ds_read_b64_tr_b16 a[162:163], v4 offset:33792
  v_mfma_f32_16x16x32_bf16 v[148:151], a[172:175], a[132:135], v[148:151]
  s_add_u32 s29, s99, 4096
  ds_read_b64_tr_b16 a[164:165], v4 offset:36864
  ds_read_b64_tr_b16 a[166:167], v4 offset:37888
  v_mfma_f32_16x16x32_bf16 v[180:183], a[168:171], a[136:139], v[180:183]
  buffer_store_dwordx4 v[72:75], v12, s[16:19], s29 offen offset:0
  v_mfma_f32_16x16x32_bf16 v[180:183], a[172:175], a[140:143], v[180:183]
  s_add_u32 m0, s77, 98304
  ds_read_b128 a[192:195], v2 offset:0
  ds_read_b128 a[196:199], v3 offset:0
  v_mfma_f32_16x16x32_bf16 v[212:215], a[168:171], a[144:147], v[212:215]
  ds_read_b128 a[200:203], v2 offset:2048
  ds_read_b128 a[204:207], v3 offset:2048
  v_mfma_f32_16x16x32_bf16 v[212:215], a[172:175], a[148:151], v[212:215]
  buffer_load_dwordx4 v15, s[88:91], s72 offen offset:0 lds
  v_mfma_f32_16x16x32_bf16 v[244:247], a[168:171], a[152:155], v[244:247]
  v_accvgpr_read_b32 v16, a24
  v_accvgpr_read_b32 v17, a25
  v_mfma_f32_16x16x32_bf16 v[244:247], a[172:175], a[156:159], v[244:247]
  v_accvgpr_read_b32 v18, a26
  v_accvgpr_read_b32 v19, a27
  v_mfma_f32_16x16x32_bf16 v[152:155], a[176:179], a[128:131], v[152:155]
  ds_read_b64_tr_b16 a[168:169], v5 offset:32768
  ds_read_b64_tr_b16 a[170:171], v5 offset:33792
  v_mfma_f32_16x16x32_bf16 v[152:155], a[180:183], a[132:135], v[152:155]
  ds_read_b64_tr_b16 a[172:173], v5 offset:36864
  ds_read_b64_tr_b16 a[174:175], v5 offset:37888
  v_mfma_f32_16x16x32_bf16 v[184:187], a[176:179], a[136:139], v[184:187]
  buffer_load_dwordx4 v15, s[88:91], s73 offen offset:1024 lds
  v_mfma_f32_16x16x32_bf16 v[184:187], a[180:183], a[140:143], v[184:187]
  ds_read_b128 a[208:211], v2 offset:4096
  ds_read_b128 a[212:215], v3 offset:4096
  v_mfma_f32_16x16x32_bf16 v[216:219], a[176:179], a[144:147], v[216:219]
  ds_read_b128 a[216:219], v2 offset:6144
  ds_read_b128 a[220:223], v3 offset:6144
  v_mfma_f32_16x16x32_bf16 v[216:219], a[180:183], a[148:151], v[216:219]
  v_add_u32 v2, 32768, v2
  v_add_u32 v3, 32768, v3
  v_mfma_f32_16x16x32_bf16 v[248:251], a[176:179], a[152:155], v[248:251]
  buffer_load_dwordx4 v15, s[88:91], s74 offen offset:2048 lds
  v_mfma_f32_16x16x32_bf16 v[248:251], a[180:183], a[156:159], v[248:251]
  v_cvt_pk_bf16_f32 v20, v16, v17
  v_cvt_pk_bf16_f32 v21, v18, v19
  v_mfma_f32_16x16x32_bf16 v[156:159], a[184:187], a[128:131], v[156:159]
  ds_read_b64_tr_b16 a[176:177], v6 offset:32768
  ds_read_b64_tr_b16 a[178:179], v6 offset:33792
  v_mfma_f32_16x16x32_bf16 v[156:159], a[188:191], a[132:135], v[156:159]
  ds_read_b64_tr_b16 a[180:181], v6 offset:36864
  ds_read_b64_tr_b16 a[182:183], v6 offset:37888
  v_mfma_f32_16x16x32_bf16 v[188:191], a[184:187], a[136:139], v[188:191]
  buffer_load_dwordx4 v15, s[88:91], s75 offen offset:3072 lds
  v_mfma_f32_16x16x32_bf16 v[188:191], a[188:191], a[140:143], v[188:191]
  v_add_u32 v15, 0x80000, v15
  v_accvgpr_read_b32 v16, a56
  v_mfma_f32_16x16x32_bf16 v[220:223], a[184:187], a[144:147], v[220:223]
  s_add_u32 m0, s76, 65536
  v_accvgpr_read_b32 v17, a57
  v_accvgpr_read_b32 v18, a58
  v_mfma_f32_16x16x32_bf16 v[220:223], a[188:191], a[148:151], v[220:223]
  buffer_load_dwordx4 v13, s[84:87], s64 offen offset:0 lds
  v_mfma_f32_16x16x32_bf16 v[252:255], a[184:187], a[152:155], v[252:255]
  v_accvgpr_read_b32 v19, a59
  v_cvt_pk_bf16_f32 v22, v16, v17
  v_mfma_f32_16x16x32_bf16 v[252:255], a[188:191], a[156:159], v[252:255]
  s_waitcnt lgkmcnt(4)
  v_cvt_pk_bf16_f32 v23, v18, v19
  v_accvgpr_write_b32 a24, v20
  v_mfma_f32_16x16x32_bf16 v[128:131], a[160:163], a[192:195], v[128:131]
  ds_read_b64_tr_b16 a[184:185], v7 offset:32768
  ds_read_b64_tr_b16 a[186:187], v7 offset:33792
  v_mfma_f32_16x16x32_bf16 v[128:131], a[164:167], a[196:199], v[128:131]
  ds_read_b64_tr_b16 a[188:189], v7 offset:36864
  ds_read_b64_tr_b16 a[190:191], v7 offset:37888
  v_mfma_f32_16x16x32_bf16 v[160:163], a[160:163], a[200:203], v[160:163]
  buffer_load_dwordx4 v14, s[84:87], s65 offen offset:1024 lds
  v_mfma_f32_16x16x32_bf16 v[160:163], a[164:167], a[204:207], v[160:163]
  v_accvgpr_write_b32 a25, v21
  v_accvgpr_write_b32 a26, v22
  v_mfma_f32_16x16x32_bf16 v[192:195], a[160:163], a[208:211], v[192:195]
  v_accvgpr_write_b32 a27, v23
  v_accvgpr_read_b32 v16, a28
  v_mfma_f32_16x16x32_bf16 v[192:195], a[164:167], a[212:215], v[192:195]
  v_accvgpr_read_b32 v17, a29
  v_accvgpr_read_b32 v18, a30
  v_mfma_f32_16x16x32_bf16 v[224:227], a[160:163], a[216:219], v[224:227]
  buffer_store_dwordx4 v[76:79], v12, s[16:19], s29 offen offset:1024
  v_mfma_f32_16x16x32_bf16 v[224:227], a[164:167], a[220:223], v[224:227]
  v_accvgpr_read_b32 v19, a31
  v_cvt_pk_bf16_f32 v20, v16, v17
  v_mfma_f32_16x16x32_bf16 v[132:135], a[168:171], a[192:195], v[132:135]
  ds_read_b64_tr_b16 a[160:161], v8 offset:32768
  ds_read_b64_tr_b16 a[162:163], v8 offset:33792
  v_mfma_f32_16x16x32_bf16 v[132:135], a[172:175], a[196:199], v[132:135]
  ds_read_b64_tr_b16 a[164:165], v8 offset:36864
  ds_read_b64_tr_b16 a[166:167], v8 offset:37888
  v_mfma_f32_16x16x32_bf16 v[164:167], a[168:171], a[200:203], v[164:167]
  buffer_load_dwordx4 v13, s[84:87], s66 offen offset:2048 lds
  v_mfma_f32_16x16x32_bf16 v[164:167], a[172:175], a[204:207], v[164:167]
  v_cvt_pk_bf16_f32 v21, v18, v19
  v_accvgpr_read_b32 v16, a60
  v_mfma_f32_16x16x32_bf16 v[196:199], a[168:171], a[208:211], v[196:199]
  buffer_load_dwordx4 v14, s[84:87], s67 offen offset:3072 lds
  v_mfma_f32_16x16x32_bf16 v[196:199], a[172:175], a[212:215], v[196:199]
  v_accvgpr_read_b32 v17, a61
  v_accvgpr_read_b32 v18, a62
  v_mfma_f32_16x16x32_bf16 v[228:231], a[168:171], a[216:219], v[228:231]
  v_accvgpr_read_b32 v19, a63
  v_cvt_pk_bf16_f32 v22, v16, v17
  v_mfma_f32_16x16x32_bf16 v[228:231], a[172:175], a[220:223], v[228:231]
  s_waitcnt lgkmcnt(8)
  v_cvt_pk_bf16_f32 v23, v18, v19
  v_accvgpr_write_b32 a28, v20
  v_mfma_f32_16x16x32_bf16 v[136:139], a[176:179], a[192:195], v[136:139]
  s_add_u32 m0, s76, 69632
  ds_read_b64_tr_b16 a[168:169], v9 offset:32768
  ds_read_b64_tr_b16 a[170:171], v9 offset:33792
  v_mfma_f32_16x16x32_bf16 v[136:139], a[180:183], a[196:199], v[136:139]
  ds_read_b64_tr_b16 a[172:173], v9 offset:36864
  ds_read_b64_tr_b16 a[174:175], v9 offset:37888
  v_mfma_f32_16x16x32_bf16 v[168:171], a[176:179], a[200:203], v[168:171]
  buffer_load_dwordx4 v13, s[84:87], s68 offen offset:0 lds
  v_mfma_f32_16x16x32_bf16 v[168:171], a[180:183], a[204:207], v[168:171]
  v_accvgpr_write_b32 a29, v21
  v_accvgpr_write_b32 a30, v22
  v_mfma_f32_16x16x32_bf16 v[200:203], a[176:179], a[208:211], v[200:203]
  v_accvgpr_write_b32 a31, v23
  v_mfma_f32_16x16x32_bf16 v[200:203], a[180:183], a[212:215], v[200:203]
  s_add_u32 s24, s77, 114688
  v_bfe_u32 v16, v0, 3, 2
  v_lshlrev_b32 v16, 5, v16
  v_mfma_f32_16x16x32_bf16 v[232:235], a[176:179], a[216:219], v[232:235]
  buffer_load_dwordx4 v14, s[84:87], s69 offen offset:1024 lds
  v_mfma_f32_16x16x32_bf16 v[232:235], a[180:183], a[220:223], v[232:235]
  s_waitcnt lgkmcnt(8)
  v_and_b32 v17, 3, v0
  v_lshl_add_u32 v16, v17, 3, v16
  v_mfma_f32_16x16x32_bf16 v[140:143], a[184:187], a[192:195], v[140:143]
  ds_read_b64_tr_b16 a[176:177], v10 offset:32768
  ds_read_b64_tr_b16 a[178:179], v10 offset:33792
  v_mfma_f32_16x16x32_bf16 v[140:143], a[188:191], a[196:199], v[140:143]
  ds_read_b64_tr_b16 a[180:181], v10 offset:36864
  ds_read_b64_tr_b16 a[182:183], v10 offset:37888
  v_mfma_f32_16x16x32_bf16 v[172:175], a[184:187], a[200:203], v[172:175]
  v_lshrrev_b32 v17, 2, v0
  v_lshl_add_u32 v16, v17, 7, v16
  v_mfma_f32_16x16x32_bf16 v[172:175], a[188:191], a[204:207], v[172:175]
  buffer_load_dwordx4 v13, s[84:87], s70 offen offset:2048 lds
  v_mfma_f32_16x16x32_bf16 v[204:207], a[184:187], a[208:211], v[204:207]
  v_add_u32 v16, s24, v16
  v_xor_b32 v17, 32, v16
  v_mfma_f32_16x16x32_bf16 v[204:207], a[188:191], a[212:215], v[204:207]
  v_xor_b32 v18, 64, v16
  v_xor_b32 v19, 96, v16
  v_mfma_f32_16x16x32_bf16 v[236:239], a[184:187], a[216:219], v[236:239]
  ds_read_b64_tr_b16 a[96:97], v16 offset:0
  ds_read_b64_tr_b16 a[98:99], v16 offset:2048
  v_mfma_f32_16x16x32_bf16 v[236:239], a[188:191], a[220:223], v[236:239]
  s_waitcnt lgkmcnt(10)
  ds_read_b64_tr_b16 a[100:101], v17 offset:0
  ds_read_b64_tr_b16 a[102:103], v17 offset:2048
  v_mfma_f32_16x16x32_bf16 v[144:147], a[160:163], a[192:195], v[144:147]
  ds_read_b64_tr_b16 a[184:185], v11 offset:32768
  ds_read_b64_tr_b16 a[186:187], v11 offset:33792
  v_mfma_f32_16x16x32_bf16 v[144:147], a[164:167], a[196:199], v[144:147]
  s_add_u32 s28, s99, s82
  ds_read_b64_tr_b16 a[188:189], v11 offset:36864
  ds_read_b64_tr_b16 a[190:191], v11 offset:37888
  v_mfma_f32_16x16x32_bf16 v[176:179], a[160:163], a[200:203], v[176:179]
  buffer_store_dwordx4 v[80:83], v12, s[16:19], s28 offen offset:0
  v_mfma_f32_16x16x32_bf16 v[176:179], a[164:167], a[204:207], v[176:179]
  ds_read_b64_tr_b16 a[104:105], v18 offset:0
  ds_read_b64_tr_b16 a[106:107], v18 offset:2048
  v_mfma_f32_16x16x32_bf16 v[208:211], a[160:163], a[208:211], v[208:211]
  buffer_load_dwordx4 v14, s[84:87], s71 offen offset:3072 lds
  v_mfma_f32_16x16x32_bf16 v[208:211], a[164:167], a[212:215], v[208:211]
  v_add_u32 v13, 128, v13
  v_add_u32 v14, 128, v14
  v_mfma_f32_16x16x32_bf16 v[240:243], a[160:163], a[216:219], v[240:243]
  ds_read_b64_tr_b16 a[108:109], v19 offset:0
  ds_read_b64_tr_b16 a[110:111], v19 offset:2048
  v_mfma_f32_16x16x32_bf16 v[240:243], a[164:167], a[220:223], v[240:243]
  s_waitcnt vmcnt(15) lgkmcnt(0)
  s_barrier
  v_mov_b32 v27, 0x3f803f80
  v_mfma_f32_16x16x32_bf16 v[148:151], a[168:171], a[192:195], v[148:151]
  ds_read_b64_tr_b16 a[160:161], v4 offset:49152
  ds_read_b64_tr_b16 a[162:163], v4 offset:50176
  v_mfma_f32_16x16x32_bf16 v[148:151], a[172:175], a[196:199], v[148:151]
  ds_read_b64_tr_b16 a[164:165], v4 offset:53248
  ds_read_b64_tr_b16 a[166:167], v4 offset:54272
  v_mfma_f32_16x16x32_bf16 v[180:183], a[168:171], a[200:203], v[180:183]
  s_add_u32 m0, s77, 131072
  v_and_b32 v26, 15, v0
  v_lshrrev_b32 v31, 4, v0
  v_mfma_f32_16x16x32_bf16 v[180:183], a[172:175], a[204:207], v[180:183]
  ds_read_b128 a[128:131], v2 offset:0
  ds_read_b128 a[132:135], v3 offset:0
  v_mfma_f32_16x16x32_bf16 v[212:215], a[168:171], a[208:211], v[212:215]
  ds_read_b128 a[136:139], v2 offset:2048
  ds_read_b128 a[140:143], v3 offset:2048
  v_mfma_f32_16x16x32_bf16 v[212:215], a[172:175], a[212:215], v[212:215]
  buffer_load_dwordx4 v15, s[88:91], s72 offen offset:0 lds
  v_mfma_f32_16x16x32_bf16 v[244:247], a[168:171], a[216:219], v[244:247]
  v_lshlrev_b32 v31, 2, v31
  v_sub_u32 v31, v26, v31
  v_mfma_f32_16x16x32_bf16 v[244:247], a[172:175], a[220:223], v[244:247]
  v_accvgpr_write_b32 a224, v27
  v_mov_b32 v20, 0xf149f2ca
  v_mfma_f32_16x16x32_bf16 v[152:155], a[176:179], a[192:195], v[152:155]
  ds_read_b64_tr_b16 a[168:169], v5 offset:49152
  ds_read_b64_tr_b16 a[170:171], v5 offset:50176
  v_mfma_f32_16x16x32_bf16 v[152:155], a[180:183], a[196:199], v[152:155]
  ds_read_b64_tr_b16 a[172:173], v5 offset:53248
  ds_read_b64_tr_b16 a[174:175], v5 offset:54272
  v_mfma_f32_16x16x32_bf16 v[184:187], a[176:179], a[200:203], v[184:187]
  buffer_load_dwordx4 v15, s[88:91], s73 offen offset:1024 lds
  v_mfma_f32_16x16x32_bf16 v[184:187], a[180:183], a[204:207], v[184:187]
  ds_read_b128 a[144:147], v2 offset:4096
  ds_read_b128 a[148:151], v3 offset:4096
  v_mfma_f32_16x16x32_bf16 v[216:219], a[176:179], a[208:211], v[216:219]
  ds_read_b128 a[152:155], v2 offset:6144
  ds_read_b128 a[156:159], v3 offset:6144
  v_mfma_f32_16x16x32_bf16 v[216:219], a[180:183], a[212:215], v[216:219]
  v_add_u32 v2, 32768, v2
  v_add_u32 v3, 32768, v3
  v_mfma_f32_16x16x32_bf16 v[248:251], a[176:179], a[216:219], v[248:251]
  buffer_load_dwordx4 v15, s[88:91], s74 offen offset:2048 lds
  v_mfma_f32_16x16x32_bf16 v[248:251], a[180:183], a[220:223], v[248:251]
  v_accvgpr_write_b32 a225, v27
  v_mov_b32 v21, 0xf149f2ca
  v_mfma_f32_16x16x32_bf16 v[156:159], a[184:187], a[192:195], v[156:159]
  ds_read_b64_tr_b16 a[176:177], v6 offset:49152
  ds_read_b64_tr_b16 a[178:179], v6 offset:50176
  v_mfma_f32_16x16x32_bf16 v[156:159], a[188:191], a[196:199], v[156:159]
  ds_read_b64_tr_b16 a[180:181], v6 offset:53248
  ds_read_b64_tr_b16 a[182:183], v6 offset:54272
  v_mfma_f32_16x16x32_bf16 v[188:191], a[184:187], a[200:203], v[188:191]
  buffer_load_dwordx4 v15, s[88:91], s75 offen offset:3072 lds
  v_mfma_f32_16x16x32_bf16 v[188:191], a[188:191], a[204:207], v[188:191]
  v_add_u32 v15, 0x80000, v15
  v_accvgpr_write_b32 a226, v27
  v_mfma_f32_16x16x32_bf16 v[220:223], a[184:187], a[208:211], v[220:223]
  s_add_u32 m0, s76, 0
  v_mov_b32 v22, 0xf149f2ca
  v_accvgpr_write_b32 a227, v27
  v_mfma_f32_16x16x32_bf16 v[220:223], a[188:191], a[212:215], v[220:223]
  v_mov_b32 v23, 0xf149f2ca
  v_cmp_gt_i32 vcc, 0, v31
  v_mfma_f32_16x16x32_bf16 v[252:255], a[184:187], a[216:219], v[252:255]
  buffer_store_dwordx4 v[84:87], v12, s[16:19], s28 offen offset:1024
  v_mfma_f32_16x16x32_bf16 v[252:255], a[188:191], a[220:223], v[252:255]
  s_waitcnt lgkmcnt(4)
  s_nop 0
  v_cndmask_b32 v16, 0, v20, vcc
  v_mfma_f32_16x16x32_bf16 v[128:131], a[160:163], a[128:131], v[128:131]
  ds_read_b64_tr_b16 a[184:185], v7 offset:49152
  ds_read_b64_tr_b16 a[186:187], v7 offset:50176
  v_mfma_f32_16x16x32_bf16 v[128:131], a[164:167], a[132:135], v[128:131]
  ds_read_b64_tr_b16 a[188:189], v7 offset:53248
  ds_read_b64_tr_b16 a[190:191], v7 offset:54272
  v_mfma_f32_16x16x32_bf16 v[160:163], a[160:163], a[136:139], v[160:163]
  buffer_load_dwordx4 v13, s[84:87], s64 offen offset:0 lds
  v_mfma_f32_16x16x32_bf16 v[160:163], a[164:167], a[140:143], v[160:163]
  v_cmp_gt_i32 vcc, 1, v31
  v_mfma_f32_16x16x32_bf16 v[192:195], a[160:163], a[144:147], v[192:195]
  buffer_load_dwordx4 v14, s[84:87], s65 offen offset:1024 lds
  v_mfma_f32_16x16x32_bf16 v[192:195], a[164:167], a[148:151], v[192:195]
  s_nop 0
  v_cndmask_b32 v17, 0, v20, vcc
  v_cmp_gt_i32 vcc, 2, v31
  v_mfma_f32_16x16x32_bf16 v[224:227], a[160:163], a[152:155], v[224:227]
  s_nop 0
  v_cndmask_b32 v18, 0, v20, vcc
  v_cmp_gt_i32 vcc, 3, v31
  v_mfma_f32_16x16x32_bf16 v[224:227], a[164:167], a[156:159], v[224:227]
  s_nop 0
  v_cndmask_b32 v19, 0, v20, vcc
  v_mfma_f32_16x16x32_bf16 v[132:135], a[168:171], a[128:131], v[132:135]
  ds_read_b64_tr_b16 a[160:161], v8 offset:49152
  ds_read_b64_tr_b16 a[162:163], v8 offset:50176
  v_mfma_f32_16x16x32_bf16 v[132:135], a[172:175], a[132:135], v[132:135]
  ds_read_b64_tr_b16 a[164:165], v8 offset:53248
  ds_read_b64_tr_b16 a[166:167], v8 offset:54272
  v_mfma_f32_16x16x32_bf16 v[164:167], a[168:171], a[136:139], v[164:167]
  buffer_load_dwordx4 v13, s[84:87], s66 offen offset:2048 lds
  v_mfma_f32_16x16x32_bf16 v[164:167], a[172:175], a[140:143], v[164:167]
  v_mfma_f32_16x16x32_bf16 v[196:199], a[168:171], a[144:147], v[196:199]
  buffer_load_dwordx4 v14, s[84:87], s67 offen offset:3072 lds
  v_mfma_f32_16x16x32_bf16 v[196:199], a[172:175], a[148:151], v[196:199]
  v_mfma_f32_16x16x32_bf16 v[228:231], a[168:171], a[152:155], v[228:231]
  v_mfma_f32_16x16x32_bf16 v[228:231], a[172:175], a[156:159], v[228:231]
  s_waitcnt lgkmcnt(8)
  v_mfma_f32_16x16x32_bf16 v[136:139], a[176:179], a[128:131], v[136:139]
  s_add_u32 m0, s76, 4096
  ds_read_b64_tr_b16 a[168:169], v9 offset:49152
  ds_read_b64_tr_b16 a[170:171], v9 offset:50176
  v_mfma_f32_16x16x32_bf16 v[136:139], a[180:183], a[132:135], v[136:139]
  ds_read_b64_tr_b16 a[172:173], v9 offset:53248
  ds_read_b64_tr_b16 a[174:175], v9 offset:54272
  v_mfma_f32_16x16x32_bf16 v[168:171], a[176:179], a[136:139], v[168:171]
  buffer_load_dwordx4 v13, s[84:87], s68 offen offset:0 lds
  v_mfma_f32_16x16x32_bf16 v[168:171], a[180:183], a[140:143], v[168:171]
  v_mfma_f32_16x16x32_bf16 v[200:203], a[176:179], a[144:147], v[200:203]
  v_mfma_f32_16x16x32_bf16 v[200:203], a[180:183], a[148:151], v[200:203]
  v_mfma_f32_16x16x32_bf16 v[232:235], a[176:179], a[152:155], v[232:235]
  buffer_load_dwordx4 v14, s[84:87], s69 offen offset:1024 lds
  v_mfma_f32_16x16x32_bf16 v[232:235], a[180:183], a[156:159], v[232:235]
  s_waitcnt lgkmcnt(8)
  v_mfma_f32_16x16x32_bf16 v[140:143], a[184:187], a[128:131], v[140:143]
  ds_read_b64_tr_b16 a[176:177], v10 offset:49152
  ds_read_b64_tr_b16 a[178:179], v10 offset:50176
  v_mfma_f32_16x16x32_bf16 v[140:143], a[188:191], a[132:135], v[140:143]
  ds_read_b64_tr_b16 a[180:181], v10 offset:53248
  ds_read_b64_tr_b16 a[182:183], v10 offset:54272
  v_mfma_f32_16x16x32_bf16 v[172:175], a[184:187], a[136:139], v[172:175]
  buffer_store_dwordx4 v[88:91], v12, s[16:19], s28 offen offset:2048
  v_mfma_f32_16x16x32_bf16 v[172:175], a[188:191], a[140:143], v[172:175]
  v_mfma_f32_16x16x32_bf16 v[204:207], a[184:187], a[144:147], v[204:207]
  buffer_load_dwordx4 v13, s[84:87], s70 offen offset:2048 lds
  v_mfma_f32_16x16x32_bf16 v[204:207], a[188:191], a[148:151], v[204:207]
  v_mfma_f32_16x16x32_bf16 v[236:239], a[184:187], a[152:155], v[236:239]
  v_mfma_f32_16x16x32_bf16 v[236:239], a[188:191], a[156:159], v[236:239]
  s_waitcnt lgkmcnt(8)
  v_mfma_f32_16x16x32_bf16 v[144:147], a[160:163], a[128:131], v[144:147]
  ds_read_b64_tr_b16 a[184:185], v11 offset:49152
  ds_read_b64_tr_b16 a[186:187], v11 offset:50176
  v_mfma_f32_16x16x32_bf16 v[144:147], a[164:167], a[132:135], v[144:147]
  ds_read_b64_tr_b16 a[188:189], v11 offset:53248
  ds_read_b64_tr_b16 a[190:191], v11 offset:54272
  v_mfma_f32_16x16x32_bf16 v[176:179], a[160:163], a[136:139], v[176:179]
  buffer_load_dwordx4 v14, s[84:87], s71 offen offset:3072 lds
  v_mfma_f32_16x16x32_bf16 v[176:179], a[164:167], a[140:143], v[176:179]
  v_add_u32 v13, 128, v13
  v_add_u32 v14, 128, v14
  v_mfma_f32_16x16x32_bf16 v[208:211], a[160:163], a[144:147], v[208:211]
  v_mfma_f32_16x16x32_bf16 v[208:211], a[164:167], a[148:151], v[208:211]
  v_mfma_f32_16x16x32_bf16 v[240:243], a[160:163], a[152:155], v[240:243]
  v_mfma_f32_16x16x32_bf16 v[240:243], a[164:167], a[156:159], v[240:243]
  s_waitcnt vmcnt(14) lgkmcnt(0)
  s_barrier
  v_mfma_f32_16x16x32_bf16 v[148:151], a[168:171], a[128:131], v[148:151]
  ds_read_b64_tr_b16 a[160:161], v4 offset:0
  ds_read_b64_tr_b16 a[162:163], v4 offset:1024
  v_mfma_f32_16x16x32_bf16 v[148:151], a[172:175], a[132:135], v[148:151]
  ds_read_b64_tr_b16 a[164:165], v4 offset:4096
  ds_read_b64_tr_b16 a[166:167], v4 offset:5120
  v_mfma_f32_16x16x32_bf16 v[180:183], a[168:171], a[136:139], v[180:183]
  s_add_u32 m0, s77, 147456
  v_mfma_f32_16x16x32_bf16 v[180:183], a[172:175], a[140:143], v[180:183]
  ds_read_b128 a[192:195], v2 offset:0
  ds_read_b128 a[196:199], v3 offset:0
  v_mfma_f32_16x16x32_bf16 v[212:215], a[168:171], a[144:147], v[212:215]
  ds_read_b128 a[200:203], v2 offset:2048
  ds_read_b128 a[204:207], v3 offset:2048
  v_mfma_f32_16x16x32_bf16 v[212:215], a[172:175], a[148:151], v[212:215]
  buffer_load_dwordx4 v15, s[88:91], s72 offen offset:0 lds
  v_mfma_f32_16x16x32_bf16 v[244:247], a[168:171], a[152:155], v[244:247]
  v_mfma_f32_16x16x32_bf16 v[244:247], a[172:175], a[156:159], v[244:247]
  v_mfma_f32_16x16x32_bf16 v[152:155], a[176:179], a[128:131], v[152:155]
  ds_read_b64_tr_b16 a[168:169], v5 offset:0
  ds_read_b64_tr_b16 a[170:171], v5 offset:1024
  v_mfma_f32_16x16x32_bf16 v[152:155], a[180:183], a[132:135], v[152:155]
  ds_read_b64_tr_b16 a[172:173], v5 offset:4096
  ds_read_b64_tr_b16 a[174:175], v5 offset:5120
  v_mfma_f32_16x16x32_bf16 v[184:187], a[176:179], a[136:139], v[184:187]
  buffer_load_dwordx4 v15, s[88:91], s73 offen offset:1024 lds
  v_mfma_f32_16x16x32_bf16 v[184:187], a[180:183], a[140:143], v[184:187]
  ds_read_b128 a[208:211], v2 offset:4096
  ds_read_b128 a[212:215], v3 offset:4096
  v_mfma_f32_16x16x32_bf16 v[216:219], a[176:179], a[144:147], v[216:219]
  ds_read_b128 a[216:219], v2 offset:6144
  ds_read_b128 a[220:223], v3 offset:6144
  v_mfma_f32_16x16x32_bf16 v[216:219], a[180:183], a[148:151], v[216:219]
  v_subrev_u32 v2, 65536, v2
  v_subrev_u32 v3, 65536, v3
  v_mfma_f32_16x16x32_bf16 v[248:251], a[176:179], a[152:155], v[248:251]
  buffer_store_dwordx4 v[92:95], v12, s[16:19], s28 offen offset:3072
  v_mfma_f32_16x16x32_bf16 v[248:251], a[180:183], a[156:159], v[248:251]
  v_mfma_f32_16x16x32_bf16 v[156:159], a[184:187], a[128:131], v[156:159]
  ds_read_b64_tr_b16 a[176:177], v6 offset:0
  ds_read_b64_tr_b16 a[178:179], v6 offset:1024
  v_mfma_f32_16x16x32_bf16 v[156:159], a[188:191], a[132:135], v[156:159]
  ds_read_b64_tr_b16 a[180:181], v6 offset:4096
  ds_read_b64_tr_b16 a[182:183], v6 offset:5120
  v_mfma_f32_16x16x32_bf16 v[188:191], a[184:187], a[136:139], v[188:191]
  buffer_load_dwordx4 v15, s[88:91], s74 offen offset:2048 lds
  v_mfma_f32_16x16x32_bf16 v[188:191], a[188:191], a[140:143], v[188:191]
  v_mfma_f32_16x16x32_bf16 v[220:223], a[184:187], a[144:147], v[220:223]
  buffer_load_dwordx4 v15, s[88:91], s75 offen offset:3072 lds
  v_mfma_f32_16x16x32_bf16 v[220:223], a[188:191], a[148:151], v[220:223]
  v_add_u32 v15, 0x80000, v15
  v_mfma_f32_16x16x32_bf16 v[252:255], a[184:187], a[152:155], v[252:255]
  s_add_u32 m0, s76, 32768
  v_mfma_f32_16x16x32_bf16 v[252:255], a[188:191], a[156:159], v[252:255]
  s_waitcnt lgkmcnt(4)
  v_mfma_f32_16x16x32_bf16 v[128:131], a[160:163], a[192:195], v[128:131]
  s_add_u32 s39, s93, 32768
  ds_read_b64_tr_b16 a[184:185], v7 offset:0
  ds_read_b64_tr_b16 a[186:187], v7 offset:1024
  v_mfma_f32_16x16x32_bf16 v[128:131], a[164:167], a[196:199], v[128:131]
  s_add_u32 s38, s93, 524288
  ds_read_b64_tr_b16 a[188:189], v7 offset:4096
  ds_read_b64_tr_b16 a[190:191], v7 offset:5120
  v_mfma_f32_16x16x32_bf16 v[160:163], a[160:163], a[200:203], v[160:163]
  buffer_load_dwordx4 v13, s[84:87], s64 offen offset:0 lds
  v_mfma_f32_16x16x32_bf16 v[160:163], a[164:167], a[204:207], v[160:163]
  v_mfma_f32_16x16x32_bf16 v[192:195], a[160:163], a[208:211], v[192:195]
  buffer_load_dwordx4 v14, s[84:87], s65 offen offset:1024 lds
  v_mfma_f32_16x16x32_bf16 v[192:195], a[164:167], a[212:215], v[192:195]
  v_mfma_f32_16x16x32_bf16 v[224:227], a[160:163], a[216:219], v[224:227]
  v_mfma_f32_16x16x32_bf16 v[224:227], a[164:167], a[220:223], v[224:227]
  v_mfma_f32_16x16x32_bf16 v[132:135], a[168:171], a[192:195], v[132:135]
  ds_read_b64_tr_b16 a[160:161], v8 offset:0
  ds_read_b64_tr_b16 a[162:163], v8 offset:1024
  v_mfma_f32_16x16x32_bf16 v[132:135], a[172:175], a[196:199], v[132:135]
  ds_read_b64_tr_b16 a[164:165], v8 offset:4096
  ds_read_b64_tr_b16 a[166:167], v8 offset:5120
  v_mfma_f32_16x16x32_bf16 v[164:167], a[168:171], a[200:203], v[164:167]
  buffer_load_dwordx4 v13, s[84:87], s66 offen offset:2048 lds
  v_mfma_f32_16x16x32_bf16 v[164:167], a[172:175], a[204:207], v[164:167]
  v_mfma_f32_16x16x32_bf16 v[196:199], a[168:171], a[208:211], v[196:199]
  buffer_load_dwordx4 v14, s[84:87], s67 offen offset:3072 lds
  v_mfma_f32_16x16x32_bf16 v[196:199], a[172:175], a[212:215], v[196:199]
  v_mfma_f32_16x16x32_bf16 v[228:231], a[168:171], a[216:219], v[228:231]
  v_mfma_f32_16x16x32_bf16 v[228:231], a[172:175], a[220:223], v[228:231]
  s_waitcnt lgkmcnt(8)
  v_mfma_f32_16x16x32_bf16 v[136:139], a[176:179], a[192:195], v[136:139]
  s_add_u32 m0, s76, 36864
  ds_read_b64_tr_b16 a[168:169], v9 offset:0
  ds_read_b64_tr_b16 a[170:171], v9 offset:1024
  v_mfma_f32_16x16x32_bf16 v[136:139], a[180:183], a[196:199], v[136:139]
  ds_read_b64_tr_b16 a[172:173], v9 offset:4096
  ds_read_b64_tr_b16 a[174:175], v9 offset:5120
  v_mfma_f32_16x16x32_bf16 v[168:171], a[176:179], a[200:203], v[168:171]
  buffer_load_dwordx4 v13, s[84:87], s68 offen offset:0 lds
  v_mfma_f32_16x16x32_bf16 v[168:171], a[180:183], a[204:207], v[168:171]
  v_mfma_f32_16x16x32_bf16 v[200:203], a[176:179], a[208:211], v[200:203]
  s_getpc_b64 s[26:27]
L_pc1:
  v_mfma_f32_16x16x32_bf16 v[200:203], a[180:183], a[212:215], v[200:203]
  s_lshl_b32 s24, s3, 2
  s_add_u32 s24, s24, s4
  s_lshl_b32 s24, s24, 10
  v_mfma_f32_16x16x32_bf16 v[232:235], a[176:179], a[216:219], v[232:235]
  buffer_load_dwordx4 v14, s[84:87], s69 offen offset:1024 lds
  v_mfma_f32_16x16x32_bf16 v[232:235], a[180:183], a[220:223], v[232:235]
  s_waitcnt lgkmcnt(8)
  s_add_u32 s24, s24, diag0-L_pc1
  v_and_b32 v26, 7, v0
  v_mfma_f32_16x16x32_bf16 v[140:143], a[184:187], a[192:195], v[140:143]
  ds_read_b64_tr_b16 a[176:177], v10 offset:0
  ds_read_b64_tr_b16 a[178:179], v10 offset:1024
  v_mfma_f32_16x16x32_bf16 v[140:143], a[188:191], a[196:199], v[140:143]
  ds_read_b64_tr_b16 a[180:181], v10 offset:4096
  ds_read_b64_tr_b16 a[182:183], v10 offset:5120
  v_mfma_f32_16x16x32_bf16 v[172:175], a[184:187], a[200:203], v[172:175]
  v_lshlrev_b32 v26, 7, v26
  v_add_u32 v26, s24, v26
  v_mfma_f32_16x16x32_bf16 v[172:175], a[188:191], a[204:207], v[172:175]
  buffer_load_dwordx4 v13, s[84:87], s70 offen offset:2048 lds
  v_mfma_f32_16x16x32_bf16 v[204:207], a[184:187], a[208:211], v[204:207]
  v_min_u32 v26, slow-L_pc1-4, v26
  v_mfma_f32_16x16x32_bf16 v[204:207], a[188:191], a[212:215], v[204:207]
  v_mfma_f32_16x16x32_bf16 v[236:239], a[184:187], a[216:219], v[236:239]
  v_mfma_f32_16x16x32_bf16 v[236:239], a[188:191], a[220:223], v[236:239]
  s_waitcnt lgkmcnt(8)
  v_mfma_f32_16x16x32_bf16 v[144:147], a[160:163], a[192:195], v[144:147]
  ds_read_b64_tr_b16 a[184:185], v11 offset:0
  ds_read_b64_tr_b16 a[186:187], v11 offset:1024
  v_mfma_f32_16x16x32_bf16 v[144:147], a[164:167], a[196:199], v[144:147]
  ds_read_b64_tr_b16 a[188:189], v11 offset:4096
  ds_read_b64_tr_b16 a[190:191], v11 offset:5120
  v_mfma_f32_16x16x32_bf16 v[176:179], a[160:163], a[200:203], v[176:179]
  buffer_load_dwordx4 v14, s[84:87], s71 offen offset:3072 lds
  v_mfma_f32_16x16x32_bf16 v[176:179], a[164:167], a[204:207], v[176:179]
  v_add_u32 v13, 128, v13
  v_add_u32 v14, 128, v14
  v_mfma_f32_16x16x32_bf16 v[208:211], a[160:163], a[208:211], v[208:211]
  v_mfma_f32_16x16x32_bf16 v[208:211], a[164:167], a[212:215], v[208:211]
  v_mfma_f32_16x16x32_bf16 v[240:243], a[160:163], a[216:219], v[240:243]
  v_mfma_f32_16x16x32_bf16 v[240:243], a[164:167], a[220:223], v[240:243]
  s_waitcnt vmcnt(10) lgkmcnt(0)
  s_barrier
  v_mfma_f32_16x16x32_bf16 v[148:151], a[168:171], a[192:195], v[148:151]
  s_cmp_lg_u32 s80, 0
  ds_read_b64_tr_b16 a[160:161], v4 offset:32768
  ds_read_b64_tr_b16 a[162:163], v4 offset:33792
  v_mfma_f32_16x16x32_bf16 v[148:151], a[172:175], a[196:199], v[148:151]
  s_cbranch_scc1 xwb
xwb_ok:
  ds_read_b64_tr_b16 a[164:165], v4 offset:36864
  ds_read_b64_tr_b16 a[166:167], v4 offset:37888
  v_mfma_f32_16x16x32_bf16 v[180:183], a[168:171], a[200:203], v[180:183]
  buffer_store_dword v30, v29, s[20:23], s39 offen sc1
  v_mfma_f32_16x16x32_bf16 v[180:183], a[172:175], a[204:207], v[180:183]
  ds_read_b128 a[128:131], v2 offset:0
  ds_read_b128 a[132:135], v3 offset:0
  v_mfma_f32_16x16x32_bf16 v[212:215], a[168:171], a[208:211], v[212:215]
  ds_read_b128 a[136:139], v2 offset:2048
  ds_read_b128 a[140:143], v3 offset:2048
  v_mfma_f32_16x16x32_bf16 v[212:215], a[172:175], a[212:215], v[212:215]
  global_load_dword v27, v26, s[26:27]
  v_mfma_f32_16x16x32_bf16 v[244:247], a[168:171], a[216:219], v[244:247]
  buffer_store_dwordx4 a[96:99], v12, s[20:23], s37 offen offset:0 sc1
  v_mfma_f32_16x16x32_bf16 v[244:247], a[172:175], a[220:223], v[244:247]
  v_mfma_f32_16x16x32_bf16 v[152:155], a[176:179], a[192:195], v[152:155]
  ds_read_b64_tr_b16 a[168:169], v5 offset:32768
  ds_read_b64_tr_b16 a[170:171], v5 offset:33792
  v_mfma_f32_16x16x32_bf16 v[152:155], a[180:183], a[196:199], v[152:155]
  s_and_b32 s27, s2, 127
  ds_read_b64_tr_b16 a[172:173], v5 offset:36864
  ds_read_b64_tr_b16 a[174:175], v5 offset:37888
  v_mfma_f32_16x16x32_bf16 v[184:187], a[176:179], a[200:203], v[184:187]
  s_lshl_b32 s27, s27, 2
  ds_write_b128 v24, v[32:35] offset:0
  v_mfma_f32_16x16x32_bf16 v[184:187], a[180:183], a[204:207], v[184:187]
  s_add_u32 s27, s27, s4
  ds_read_b128 a[144:147], v2 offset:4096
  ds_read_b128 a[148:151], v3 offset:4096
  v_mfma_f32_16x16x32_bf16 v[216:219], a[176:179], a[208:211], v[216:219]
  s_lshl_b32 s27, s27, 12
  ds_read_b128 a[152:155], v2 offset:6144
  ds_read_b128 a[156:159], v3 offset:6144
  v_mfma_f32_16x16x32_bf16 v[216:219], a[180:183], a[212:215], v[216:219]
  v_add_u32 v2, 32768, v2
  v_add_u32 v3, 32768, v3
  v_mfma_f32_16x16x32_bf16 v[248:251], a[176:179], a[216:219], v[248:251]
  ds_write_b128 v24, v[36:39] offset:1024
  v_mfma_f32_16x16x32_bf16 v[248:251], a[180:183], a[220:223], v[248:251]
  v_lshlrev_b32 v13, 5, v29
  v_add_u32 v13, s27, v13
  v_mfma_f32_16x16x32_bf16 v[156:159], a[184:187], a[192:195], v[156:159]
  s_mov_b32 s8, s32
  ds_read_b64_tr_b16 a[176:177], v6 offset:32768
  ds_read_b64_tr_b16 a[178:179], v6 offset:33792
  v_mfma_f32_16x16x32_bf16 v[156:159], a[188:191], a[196:199], v[156:159]
  s_mov_b32 s9, s33
  ds_read_b64_tr_b16 a[180:181], v6 offset:36864
  ds_read_b64_tr_b16 a[182:183], v6 offset:37888
  v_mfma_f32_16x16x32_bf16 v[188:191], a[184:187], a[200:203], v[188:191]
  buffer_store_dwordx4 a[100:103], v12, s[20:23], s37 offen offset:1024 sc1
  v_mfma_f32_16x16x32_bf16 v[188:191], a[188:191], a[204:207], v[188:191]
  s_and_b32 s26, s3, 3
  ds_write_b128 v24, v[40:43] offset:4096
  v_mfma_f32_16x16x32_bf16 v[220:223], a[184:187], a[208:211], v[220:223]
  v_mov_b32 v15, s26
  v_mov_b32 v14, s4
  v_mfma_f32_16x16x32_bf16 v[220:223], a[188:191], a[212:215], v[220:223]
  v_cmp_lt_u32 vcc, 28, v29
  v_mfma_f32_16x16x32_bf16 v[252:255], a[184:187], a[216:219], v[252:255]
  s_lshl_b32 s26, s7, 5
  ds_write_b128 v24, v[44:47] offset:5120
  v_mfma_f32_16x16x32_bf16 v[252:255], a[188:191], a[220:223], v[252:255]
  s_waitcnt lgkmcnt(7)
  v_cndmask_b32 v15, v15, v14, vcc
  v_and_b32 v14, 28, v29
  v_mfma_f32_16x16x32_bf16 v[128:131], a[160:163], a[128:131], v[128:131]
  ds_read_b64_tr_b16 a[184:185], v7 offset:32768
  ds_read_b64_tr_b16 a[186:187], v7 offset:33792
  v_mfma_f32_16x16x32_bf16 v[128:131], a[164:167], a[132:135], v[128:131]
  ds_read_b64_tr_b16 a[188:189], v7 offset:36864
  ds_read_b64_tr_b16 a[190:191], v7 offset:37888
  v_mfma_f32_16x16x32_bf16 v[160:163], a[160:163], a[136:139], v[160:163]
  ds_write_b128 v25, v[48:51] offset:0
  v_mfma_f32_16x16x32_bf16 v[160:163], a[164:167], a[140:143], v[160:163]
  v_add3_u32 v15, v15, v14, s26
  v_lshlrev_b32 v15, 7, v15
  v_mfma_f32_16x16x32_bf16 v[192:195], a[160:163], a[144:147], v[192:195]
  s_and_b32 s26, s7, 1
  s_lshl_b32 s26, s26, 2
  s_add_u32 s26, s26, s4
  v_mfma_f32_16x16x32_bf16 v[192:195], a[164:167], a[148:151], v[192:195]
  s_lshl_b32 s26, s26, 5
  ds_write_b128 v25, v[52:55] offset:1024
  v_mfma_f32_16x16x32_bf16 v[224:227], a[160:163], a[152:155], v[224:227]
  buffer_store_dwordx4 a[104:107], v12, s[20:23], s37 offen offset:2048 sc1
  v_mfma_f32_16x16x32_bf16 v[224:227], a[164:167], a[156:159], v[224:227]
  s_lshr_b32 s27, s6, 2
  s_add_u32 s26, s26, s27
  v_mfma_f32_16x16x32_bf16 v[132:135], a[168:171], a[128:131], v[132:135]
  ds_read_b64_tr_b16 a[160:161], v8 offset:32768
  ds_read_b64_tr_b16 a[162:163], v8 offset:33792
  v_mfma_f32_16x16x32_bf16 v[132:135], a[172:175], a[132:135], v[132:135]
  ds_read_b64_tr_b16 a[164:165], v8 offset:36864
  ds_read_b64_tr_b16 a[166:167], v8 offset:37888
  v_mfma_f32_16x16x32_bf16 v[164:167], a[168:171], a[136:139], v[164:167]
  ds_write_b128 v25, v[56:59] offset:2048
  v_mfma_f32_16x16x32_bf16 v[164:167], a[172:175], a[140:143], v[164:167]
  v_and_b32 v14, 15, v0
  v_lshl_add_u32 v14, v14, 1, s26
  v_mfma_f32_16x16x32_bf16 v[196:199], a[168:171], a[144:147], v[196:199]
  v_lshlrev_b32 v14, 7, v14
  v_mfma_f32_16x16x32_bf16 v[196:199], a[172:175], a[148:151], v[196:199]
  s_add_u32 s65, s77, 32768
  ds_write_b128 v25, v[60:63] offset:3072
  v_mfma_f32_16x16x32_bf16 v[228:231], a[168:171], a[152:155], v[228:231]
  s_mov_b32 s64, 16384
  s_mov_b32 s66, s6
  v_mfma_f32_16x16x32_bf16 v[228:231], a[172:175], a[156:159], v[228:231]
  s_waitcnt lgkmcnt(14)
  v_mfma_f32_16x16x32_bf16 v[136:139], a[176:179], a[128:131], v[136:139]
  ds_read_b64_tr_b16 a[168:169], v9 offset:32768
  ds_read_b64_tr_b16 a[170:171], v9 offset:33792
  v_mfma_f32_16x16x32_bf16 v[136:139], a[180:183], a[132:135], v[136:139]
  ds_read_b64_tr_b16 a[172:173], v9 offset:36864
  ds_read_b64_tr_b16 a[174:175], v9 offset:37888
  v_mfma_f32_16x16x32_bf16 v[168:171], a[176:179], a[136:139], v[168:171]
  buffer_store_dwordx4 a[108:111], v12, s[20:23], s37 offen offset:3072 sc1
  v_mfma_f32_16x16x32_bf16 v[168:171], a[180:183], a[140:143], v[168:171]
  ds_write_b128 v24, v[96:99] offset:16384
  v_mfma_f32_16x16x32_bf16 v[200:203], a[176:179], a[144:147], v[200:203]
  s_cmp_ge_u32 s6, 4
  s_cselect_b32 s68, 52, 48
  v_mfma_f32_16x16x32_bf16 v[200:203], a[180:183], a[148:151], v[200:203]
  s_lshl_b32 s69, s6, 2
  s_add_u32 s69, s69, s4
  s_add_u32 s69, s69, 16
  v_mfma_f32_16x16x32_bf16 v[232:235], a[176:179], a[152:155], v[232:235]
  s_lshl_b32 s69, s69, 13
  ds_write_b128 v24, v[100:103] offset:17408
  v_mfma_f32_16x16x32_bf16 v[232:235], a[180:183], a[156:159], v[232:235]
  s_waitcnt lgkmcnt(14)
  s_max_u32 s70, s6, 1
  s_lshl_b32 s70, s70, 1
  v_mfma_f32_16x16x32_bf16 v[140:143], a[184:187], a[128:131], v[140:143]
  s_sub_u32 s70, 14, s70
  ds_read_b64_tr_b16 a[176:177], v10 offset:32768
  ds_read_b64_tr_b16 a[178:179], v10 offset:33792
  v_mfma_f32_16x16x32_bf16 v[140:143], a[188:191], a[132:135], v[140:143]
  s_lshl_b32 s24, s6, 1
  ds_read_b64_tr_b16 a[180:181], v10 offset:36864
  ds_read_b64_tr_b16 a[182:183], v10 offset:37888
  v_mfma_f32_16x16x32_bf16 v[172:175], a[184:187], a[136:139], v[172:175]
  s_and_b32 s25, s7, 1
  ds_write_b128 v24, v[104:107] offset:20480
  v_mfma_f32_16x16x32_bf16 v[172:175], a[188:191], a[140:143], v[172:175]
  s_add_u32 s24, s24, s25
  s_lshl_b32 s24, s24, 18
  s_add_u32 s67, s24, 60817408
  v_mfma_f32_16x16x32_bf16 v[204:207], a[184:187], a[144:147], v[204:207]
  s_lshl_b32 s25, s5, 20
  s_sub_u32 s18, 0x4000000, s25
  s_sub_u32 s25, s67, s25
  v_mfma_f32_16x16x32_bf16 v[204:207], a[188:191], a[148:151], v[204:207]
  s_add_u32 s94, s25, 131072
  ds_write_b128 v24, v[108:111] offset:21504
  v_mfma_f32_16x16x32_bf16 v[236:239], a[184:187], a[152:155], v[236:239]
  buffer_store_dwordx4 v[96:99], v12, s[16:19], s100 offen offset:0 sc1
  v_mfma_f32_16x16x32_bf16 v[236:239], a[188:191], a[156:159], v[236:239]
  s_waitcnt lgkmcnt(14)
  v_mfma_f32_16x16x32_bf16 v[144:147], a[160:163], a[128:131], v[144:147]
  ds_read_b64_tr_b16 a[184:185], v11 offset:32768
  ds_read_b64_tr_b16 a[186:187], v11 offset:33792
  v_mfma_f32_16x16x32_bf16 v[144:147], a[164:167], a[132:135], v[144:147]
  ds_read_b64_tr_b16 a[188:189], v11 offset:36864
  ds_read_b64_tr_b16 a[190:191], v11 offset:37888
  v_mfma_f32_16x16x32_bf16 v[176:179], a[160:163], a[136:139], v[176:179]
  ds_write_b128 v25, v[112:115] offset:16384
  v_mfma_f32_16x16x32_bf16 v[176:179], a[164:167], a[140:143], v[176:179]
  s_cmp_lt_u32 s6, 5
  s_cselect_b32 s25, 0, 20
  v_mfma_f32_16x16x32_bf16 v[208:211], a[160:163], a[144:147], v[208:211]
  s_lshl_b32 s24, s6, 2
  s_sub_u32 s24, s24, s25
  s_lshr_b32 s24, 0x13024, s24
  v_mfma_f32_16x16x32_bf16 v[208:211], a[164:167], a[148:151], v[208:211]
  s_and_b32 s24, s24, 15
  ds_write_b128 v25, v[116:119] offset:17408
  v_mfma_f32_16x16x32_bf16 v[240:243], a[160:163], a[152:155], v[240:243]
  s_lshl_b32 s84, s24, 15
  s_add_u32 s85, s84, 32768
  s_sub_u32 s24, s85, 163840
  v_mfma_f32_16x16x32_bf16 v[240:243], a[164:167], a[156:159], v[240:243]
  s_waitcnt vmcnt(7) lgkmcnt(0)
  s_barrier
  s_min_u32 s85, s85, s24
  v_mfma_f32_16x16x32_bf16 v[148:151], a[168:171], a[128:131], v[148:151]
  s_add_u32 s86, s85, 32768
  ds_read_b64_tr_b16 a[160:161], v4 offset:49152
  ds_read_b64_tr_b16 a[162:163], v4 offset:50176
  v_mfma_f32_16x16x32_bf16 v[148:151], a[172:175], a[132:135], v[148:151]
  s_sub_u32 s24, s86, 163840
  ds_read_b64_tr_b16 a[164:165], v4 offset:53248
  ds_read_b64_tr_b16 a[166:167], v4 offset:54272
  v_mfma_f32_16x16x32_bf16 v[180:183], a[168:171], a[136:139], v[180:183]
  buffer_store_dwordx4 v[100:103], v12, s[16:19], s100 offen offset:1024 sc1
  v_mfma_f32_16x16x32_bf16 v[180:183], a[172:175], a[140:143], v[180:183]
  s_min_u32 s86, s86, s24
  ds_read_b128 a[192:195], v2 offset:0
  ds_read_b128 a[196:199], v3 offset:0
  v_mfma_f32_16x16x32_bf16 v[212:215], a[168:171], a[144:147], v[212:215]
  s_add_u32 s87, s86, 32768
  ds_read_b128 a[200:203], v2 offset:2048
  ds_read_b128 a[204:207], v3 offset:2048
  v_mfma_f32_16x16x32_bf16 v[212:215], a[172:175], a[148:151], v[212:215]
  s_sub_u32 s24, s87, 163840
  ds_write_b128 v25, v[120:123] offset:18432
  v_mfma_f32_16x16x32_bf16 v[244:247], a[168:171], a[152:155], v[244:247]
  s_min_u32 s87, s87, s24
  s_add_u32 s88, s87, 32768
  s_sub_u32 s24, s88, 163840
  v_mfma_f32_16x16x32_bf16 v[244:247], a[172:175], a[156:159], v[244:247]
  s_min_u32 s88, s88, s24
  s_lshl_b32 s44, s7, 5
  v_mfma_f32_16x16x32_bf16 v[152:155], a[176:179], a[128:131], v[152:155]
  s_add_u32 s44, s44, s3
  ds_read_b64_tr_b16 a[168:169], v5 offset:49152
  ds_read_b64_tr_b16 a[170:171], v5 offset:50176
  v_mfma_f32_16x16x32_bf16 v[152:155], a[180:183], a[132:135], v[152:155]
  s_lshr_b32 s25, s4, 1
  ds_read_b64_tr_b16 a[172:173], v5 offset:53248
  ds_read_b64_tr_b16 a[174:175], v5 offset:54272
  v_mfma_f32_16x16x32_bf16 v[184:187], a[176:179], a[136:139], v[184:187]
  s_lshl_b32 s51, s44, 1
  ds_write_b128 v25, v[124:127] offset:19456
  v_mfma_f32_16x16x32_bf16 v[184:187], a[180:183], a[140:143], v[184:187]
  s_add_u32 s51, s51, s25
  ds_read_b128 a[208:211], v2 offset:4096
  ds_read_b128 a[212:215], v3 offset:4096
  v_mfma_f32_16x16x32_bf16 v[216:219], a[176:179], a[144:147], v[216:219]
  s_and_b32 s45, s4, 1
  ds_read_b128 a[216:219], v2 offset:6144
  ds_read_b128 a[220:223], v3 offset:6144
  v_mfma_f32_16x16x32_bf16 v[216:219], a[180:183], a[148:151], v[216:219]
  s_add_u32 s29, s100, 4096
  v_subrev_u32 v24, s83, v24
  v_subrev_u32 v25, s83, v25
  v_mfma_f32_16x16x32_bf16 v[248:251], a[176:179], a[152:155], v[248:251]
  buffer_store_dwordx4 v[104:107], v12, s[16:19], s29 offen offset:0 sc1
  v_mfma_f32_16x16x32_bf16 v[248:251], a[180:183], a[156:159], v[248:251]
  v_mfma_f32_16x16x32_bf16 v[156:159], a[184:187], a[128:131], v[156:159]
  ds_read_b64_tr_b16 a[176:177], v6 offset:49152
  ds_read_b64_tr_b16 a[178:179], v6 offset:50176
  v_mfma_f32_16x16x32_bf16 v[156:159], a[188:191], a[132:135], v[156:159]
  ds_read_b64_tr_b16 a[180:181], v6 offset:53248
  ds_read_b64_tr_b16 a[182:183], v6 offset:54272
  v_mfma_f32_16x16x32_bf16 v[188:191], a[184:187], a[136:139], v[188:191]
  ds_write_b128 v24, v[64:67] offset:0
  v_mfma_f32_16x16x32_bf16 v[188:191], a[188:191], a[140:143], v[188:191]
  s_cmp_eq_u32 s25, 0
  s_cselect_b32 s46, s87, s88
  v_add_u32 v4, 0x10000, v12
  v_mfma_f32_16x16x32_bf16 v[220:223], a[184:187], a[144:147], v[220:223]
  s_lshl_b32 s24, s51, 12
  s_lshl_b32 s25, s45, 3
  s_add_u32 s24, s24, s25
  v_mfma_f32_16x16x32_bf16 v[220:223], a[188:191], a[148:151], v[220:223]
  s_add_u32 s48, s24, 4
  ds_write_b128 v24, v[68:71] offset:1024
  v_mfma_f32_16x16x32_bf16 v[252:255], a[184:187], a[152:155], v[252:255]
  s_mul_i32 s24, s45, 8320
  s_add_u32 s49, s24, s46
  s_lshl_b32 s24, s51, 1
  v_mfma_f32_16x16x32_bf16 v[252:255], a[188:191], a[156:159], v[252:255]
  s_waitcnt lgkmcnt(6)
  s_add_u32 s24, s24, s45
  s_lshl_b32 s24, s24, 12
  v_mfma_f32_16x16x32_bf16 v[128:131], a[160:163], a[192:195], v[128:131]
  s_add_u32 s50, s24, 50331648
  ds_read_b64_tr_b16 a[184:185], v7 offset:49152
  ds_read_b64_tr_b16 a[186:187], v7 offset:50176
  v_mfma_f32_16x16x32_bf16 v[128:131], a[164:167], a[196:199], v[128:131]
  s_mul_i32 s24, s45, 4640
  ds_read_b64_tr_b16 a[188:189], v7 offset:53248
  ds_read_b64_tr_b16 a[190:191], v7 offset:54272
  v_mfma_f32_16x16x32_bf16 v[160:163], a[160:163], a[200:203], v[160:163]
  buffer_store_dwordx4 v[108:111], v12, s[16:19], s29 offen offset:1024 sc1
  v_mfma_f32_16x16x32_bf16 v[160:163], a[164:167], a[204:207], v[160:163]
  s_add_u32 s24, s24, s46
  ds_write_b128 v24, v[72:75] offset:4096
  v_mfma_f32_16x16x32_bf16 v[192:195], a[160:163], a[208:211], v[192:195]
  s_add_u32 s47, s24, 16640
  s_mov_b32 s12, s42
  s_mov_b32 s13, s43
  v_mfma_f32_16x16x32_bf16 v[192:195], a[164:167], a[212:215], v[192:195]
  s_mov_b32 s14, 1024
  v_add_u32 v5, 0x20000, v12
  v_mfma_f32_16x16x32_bf16 v[224:227], a[160:163], a[216:219], v[224:227]
  ds_write_b128 v24, v[76:79] offset:5120
  v_mfma_f32_16x16x32_bf16 v[224:227], a[164:167], a[220:223], v[224:227]
  v_mfma_f32_16x16x32_bf16 v[132:135], a[168:171], a[192:195], v[132:135]
  ds_read_b64_tr_b16 a[160:161], v8 offset:49152
  ds_read_b64_tr_b16 a[162:163], v8 offset:50176
  v_mfma_f32_16x16x32_bf16 v[132:135], a[172:175], a[196:199], v[132:135]
  ds_read_b64_tr_b16 a[164:165], v8 offset:53248
  ds_read_b64_tr_b16 a[166:167], v8 offset:54272
  v_mfma_f32_16x16x32_bf16 v[164:167], a[168:171], a[200:203], v[164:167]
  ds_write_b128 v25, v[80:83] offset:0
  v_mfma_f32_16x16x32_bf16 v[164:167], a[172:175], a[204:207], v[164:167]
  v_mfma_f32_16x16x32_bf16 v[196:199], a[168:171], a[208:211], v[196:199]
  v_mfma_f32_16x16x32_bf16 v[196:199], a[172:175], a[212:215], v[196:199]
  s_add_u32 s28, s100, s82
  ds_write_b128 v25, v[84:87] offset:1024
  v_mfma_f32_16x16x32_bf16 v[228:231], a[168:171], a[216:219], v[228:231]
  buffer_store_dwordx4 v[112:115], v12, s[16:19], s28 offen offset:0 sc1
  v_mfma_f32_16x16x32_bf16 v[228:231], a[172:175], a[220:223], v[228:231]
  s_waitcnt lgkmcnt(14)
  v_cvt_pk_bf16_f32 v128, v128, v129
  v_cvt_pk_bf16_f32 v129, v130, v131
  v_mfma_f32_16x16x32_bf16 v[136:139], a[176:179], a[192:195], v[136:139]
  ds_read_b64_tr_b16 a[168:169], v9 offset:49152
  ds_read_b64_tr_b16 a[170:171], v9 offset:50176
  v_mfma_f32_16x16x32_bf16 v[136:139], a[180:183], a[196:199], v[136:139]
  ds_read_b64_tr_b16 a[172:173], v9 offset:53248
  ds_read_b64_tr_b16 a[174:175], v9 offset:54272
  v_mfma_f32_16x16x32_bf16 v[168:171], a[176:179], a[200:203], v[168:171]
  ds_write_b128 v25, v[88:91] offset:2048
  v_mfma_f32_16x16x32_bf16 v[168:171], a[180:183], a[204:207], v[168:171]
  v_cvt_pk_bf16_f32 v130, v132, v133
  v_cvt_pk_bf16_f32 v131, v134, v135
  v_mfma_f32_16x16x32_bf16 v[200:203], a[176:179], a[208:211], v[200:203]
  v_cvt_pk_bf16_f32 v160, v160, v161
  v_cvt_pk_bf16_f32 v161, v162, v163
  v_mfma_f32_16x16x32_bf16 v[200:203], a[180:183], a[212:215], v[200:203]
  ds_write_b128 v25, v[92:95] offset:3072
  v_mfma_f32_16x16x32_bf16 v[232:235], a[176:179], a[216:219], v[232:235]
  v_add_u32 v24, 0x20000, v24
  v_add_u32 v25, 0x20000, v25
  v_mfma_f32_16x16x32_bf16 v[232:235], a[180:183], a[220:223], v[232:235]
  s_waitcnt lgkmcnt(14)
  v_cvt_pk_bf16_f32 v162, v164, v165
  v_cvt_pk_bf16_f32 v163, v166, v167
  v_mfma_f32_16x16x32_bf16 v[140:143], a[184:187], a[192:195], v[140:143]
  ds_read_b64_tr_b16 a[176:177], v10 offset:49152
  ds_read_b64_tr_b16 a[178:179], v10 offset:50176
  v_mfma_f32_16x16x32_bf16 v[140:143], a[188:191], a[196:199], v[140:143]
  ds_read_b64_tr_b16 a[180:181], v10 offset:53248
  ds_read_b64_tr_b16 a[182:183], v10 offset:54272
  v_mfma_f32_16x16x32_bf16 v[172:175], a[184:187], a[200:203], v[172:175]
  buffer_store_dwordx4 v[116:119], v12, s[16:19], s28 offen offset:1024 sc1
  v_mfma_f32_16x16x32_bf16 v[172:175], a[188:191], a[204:207], v[172:175]
  v_cvt_pk_bf16_f32 v192, v192, v193
  v_cvt_pk_bf16_f32 v193, v194, v195
  v_mfma_f32_16x16x32_bf16 v[204:207], a[184:187], a[208:211], v[204:207]
  v_cvt_pk_bf16_f32 v194, v196, v197
  v_cvt_pk_bf16_f32 v195, v198, v199
  v_mfma_f32_16x16x32_bf16 v[204:207], a[188:191], a[212:215], v[204:207]
  v_cvt_pk_bf16_f32 v224, v224, v225
  v_cvt_pk_bf16_f32 v225, v226, v227
  v_mfma_f32_16x16x32_bf16 v[236:239], a[184:187], a[216:219], v[236:239]
  v_cvt_pk_bf16_f32 v226, v228, v229
  v_cvt_pk_bf16_f32 v227, v230, v231
  v_mfma_f32_16x16x32_bf16 v[236:239], a[188:191], a[220:223], v[236:239]
  s_waitcnt lgkmcnt(12)
  v_cvt_pk_bf16_f32 v136, v136, v137
  v_cvt_pk_bf16_f32 v137, v138, v139
  v_mfma_f32_16x16x32_bf16 v[144:147], a[160:163], a[192:195], v[144:147]
  ds_read_b64_tr_b16 a[184:185], v11 offset:49152
  ds_read_b64_tr_b16 a[186:187], v11 offset:50176
  v_mfma_f32_16x16x32_bf16 v[144:147], a[164:167], a[196:199], v[144:147]
  ds_read_b64_tr_b16 a[188:189], v11 offset:53248
  ds_read_b64_tr_b16 a[190:191], v11 offset:54272
  v_mfma_f32_16x16x32_bf16 v[176:179], a[160:163], a[200:203], v[176:179]
  v_cvt_pk_bf16_f32 v138, v140, v141
  v_cvt_pk_bf16_f32 v139, v142, v143
  v_mfma_f32_16x16x32_bf16 v[176:179], a[164:167], a[204:207], v[176:179]
  v_cvt_pk_bf16_f32 v168, v168, v169
  v_cvt_pk_bf16_f32 v169, v170, v171
  v_mfma_f32_16x16x32_bf16 v[208:211], a[160:163], a[208:211], v[208:211]
  v_cvt_pk_bf16_f32 v170, v172, v173
  v_cvt_pk_bf16_f32 v171, v174, v175
  v_mfma_f32_16x16x32_bf16 v[208:211], a[164:167], a[212:215], v[208:211]
  v_cvt_pk_bf16_f32 v200, v200, v201
  v_cvt_pk_bf16_f32 v201, v202, v203
  v_mfma_f32_16x16x32_bf16 v[240:243], a[160:163], a[216:219], v[240:243]
  buffer_store_dwordx4 v[120:123], v12, s[16:19], s28 offen offset:2048 sc1
  v_mfma_f32_16x16x32_bf16 v[240:243], a[164:167], a[220:223], v[240:243]
  s_waitcnt vmcnt(7) lgkmcnt(0)
  s_barrier
  v_cvt_pk_bf16_f32 v202, v204, v205
  v_mfma_f32_16x16x32_bf16 v[148:151], a[168:171], a[192:195], v[148:151]
  ds_read_b128 a[64:67], v4 offset:0
  ds_read_b128 a[68:71], v4 offset:1024
  v_mfma_f32_16x16x32_bf16 v[148:151], a[172:175], a[196:199], v[148:151]
  ds_write_b128 v24, a[0:3] offset:0
  v_mfma_f32_16x16x32_bf16 v[180:183], a[168:171], a[200:203], v[180:183]
  ds_read_b128 a[72:75], v4 offset:2048
  ds_read_b128 a[76:79], v4 offset:3072
  v_mfma_f32_16x16x32_bf16 v[180:183], a[172:175], a[204:207], v[180:183]
  ds_write_b128 v24, a[8:11] offset:1024
  v_mfma_f32_16x16x32_bf16 v[212:215], a[168:171], a[208:211], v[212:215]
  buffer_store_dword v30, v29, s[20:23], s38 offen sc1
  v_mfma_f32_16x16x32_bf16 v[212:215], a[172:175], a[212:215], v[212:215]
  ds_write_b128 v24, a[32:35] offset:4096
  v_mfma_f32_16x16x32_bf16 v[244:247], a[168:171], a[216:219], v[244:247]
  ds_read_b128 a[80:83], v4 offset:4096
  ds_read_b128 a[84:87], v4 offset:5120
  v_mfma_f32_16x16x32_bf16 v[244:247], a[172:175], a[220:223], v[244:247]
  ds_read_b128 a[88:91], v4 offset:6144
  ds_read_b128 a[92:95], v4 offset:7168
  v_mfma_f32_16x16x32_bf16 v[152:155], a[176:179], a[192:195], v[152:155]
  ds_write_b128 v24, a[40:43] offset:5120
  v_mfma_f32_16x16x32_bf16 v[152:155], a[180:183], a[196:199], v[152:155]
  v_cvt_pk_bf16_f32 v203, v206, v207
  v_cvt_pk_bf16_f32 v232, v232, v233
  v_mfma_f32_16x16x32_bf16 v[184:187], a[176:179], a[200:203], v[184:187]
  buffer_store_dwordx4 v[124:127], v12, s[16:19], s28 offen offset:3072 sc1
  v_mfma_f32_16x16x32_bf16 v[184:187], a[180:183], a[204:207], v[184:187]
  ds_write_b128 v25, a[16:19] offset:0
  v_mfma_f32_16x16x32_bf16 v[216:219], a[176:179], a[208:211], v[216:219]
  v_cvt_pk_bf16_f32 v233, v234, v235
  v_cvt_pk_bf16_f32 v234, v236, v237
  v_mfma_f32_16x16x32_bf16 v[216:219], a[180:183], a[212:215], v[216:219]
  ds_write_b128 v25, a[20:23] offset:1024
  v_mfma_f32_16x16x32_bf16 v[248:251], a[176:179], a[216:219], v[248:251]
  v_cvt_pk_bf16_f32 v235, v238, v239
  v_cvt_pk_bf16_f32 v144, v144, v145
  v_mfma_f32_16x16x32_bf16 v[248:251], a[180:183], a[220:223], v[248:251]
  v_cvt_pk_bf16_f32 v145, v146, v147
  v_cvt_pk_bf16_f32 v146, v148, v149
  v_mfma_f32_16x16x32_bf16 v[156:159], a[184:187], a[192:195], v[156:159]
  ds_write_b128 v25, a[24:27] offset:2048
  v_mfma_f32_16x16x32_bf16 v[156:159], a[188:191], a[196:199], v[156:159]
  v_cvt_pk_bf16_f32 v147, v150, v151
  v_cvt_pk_bf16_f32 v176, v176, v177
  v_mfma_f32_16x16x32_bf16 v[188:191], a[184:187], a[200:203], v[188:191]
  ds_write_b128 v25, a[28:31] offset:3072
  v_mfma_f32_16x16x32_bf16 v[188:191], a[188:191], a[204:207], v[188:191]
  v_cvt_pk_bf16_f32 v177, v178, v179
  v_cvt_pk_bf16_f32 v178, v180, v181
  v_mfma_f32_16x16x32_bf16 v[220:223], a[184:187], a[208:211], v[220:223]
  v_cvt_pk_bf16_f32 v179, v182, v183
  v_mfma_f32_16x16x32_bf16 v[220:223], a[188:191], a[212:215], v[220:223]
  v_mfma_f32_16x16x32_bf16 v[252:255], a[184:187], a[216:219], v[252:255]
  v_mfma_f32_16x16x32_bf16 v[252:255], a[188:191], a[220:223], v[252:255]
  v_cvt_pk_bf16_f32 v208, v208, v209
  v_cvt_pk_bf16_f32 v209, v210, v211
  v_cvt_pk_bf16_f32 v210, v212, v213
  v_cvt_pk_bf16_f32 v211, v214, v215
  v_cvt_pk_bf16_f32 v240, v240, v241
  v_cvt_pk_bf16_f32 v241, v242, v243
  v_cvt_pk_bf16_f32 v242, v244, v245
  v_cvt_pk_bf16_f32 v243, v246, v247
  v_cvt_pk_bf16_f32 v152, v152, v153
  v_cvt_pk_bf16_f32 v153, v154, v155
  v_cvt_pk_bf16_f32 v154, v156, v157
  v_cvt_pk_bf16_f32 v155, v158, v159
  v_cvt_pk_bf16_f32 v184, v184, v185
  v_cvt_pk_bf16_f32 v185, v186, v187
  v_cvt_pk_bf16_f32 v186, v188, v189
  v_cvt_pk_bf16_f32 v187, v190, v191
  v_cvt_pk_bf16_f32 v216, v216, v217
  v_cvt_pk_bf16_f32 v217, v218, v219
  v_cvt_pk_bf16_f32 v218, v220, v221
  v_cvt_pk_bf16_f32 v219, v222, v223
  v_cvt_pk_bf16_f32 v248, v248, v249
  v_cvt_pk_bf16_f32 v249, v250, v251
  v_cvt_pk_bf16_f32 v250, v252, v253
  v_cvt_pk_bf16_f32 v251, v254, v255
  s_cmp_eq_u32 s4, 1
  s_cbranch_scc1 diag1
  s_cmp_eq_u32 s4, 2
  s_cbranch_scc1 diag2
  s_cmp_eq_u32 s4, 3
  s_cbranch_scc1 diag3
diag0:
  s_waitcnt lgkmcnt(15)
  v_mfma_f32_16x16x32_bf16 v[48:51], a[64:67], v[128:131], v[16:19]
  ds_read_b128 a[96:99], v4 offset:8192
  ds_read_b128 a[100:103], v4 offset:9216
  s_waitcnt lgkmcnt(15)
  v_mfma_f32_16x16x32_bf16 v[48:51], a[68:71], v[136:139], v[48:51]
  buffer_store_dwordx4 a[0:3], v12, s[16:19], s101 offen offset:0 sc1
  s_waitcnt lgkmcnt(14)
  v_mfma_f32_16x16x32_bf16 v[48:51], a[72:75], v[144:147], v[48:51]
  ds_read_b128 a[104:107], v4 offset:10240
  s_waitcnt lgkmcnt(14)
  v_mfma_f32_16x16x32_bf16 v[48:51], a[76:79], v[152:155], v[48:51]
  s_waitcnt lgkmcnt(11)
  v_mfma_f32_16x16x32_bf16 v[52:55], a[80:83], v[128:131], v[20:23]
  ds_read_b128 a[108:111], v4 offset:11264
  ds_read_b128 a[112:115], v4 offset:12288
  s_waitcnt lgkmcnt(12)
  v_mfma_f32_16x16x32_bf16 v[52:55], a[84:87], v[136:139], v[52:55]
  s_waitcnt lgkmcnt(11)
  v_mfma_f32_16x16x32_bf16 v[52:55], a[88:91], v[144:147], v[52:55]
  ds_read_b128 a[116:119], v4 offset:13312
  s_waitcnt lgkmcnt(11)
  v_mfma_f32_16x16x32_bf16 v[52:55], a[92:95], v[152:155], v[52:55]
  buffer_store_dwordx4 a[8:11], v12, s[16:19], s101 offen offset:1024 sc1
  v_mfma_f32_16x16x32_bf16 v[56:59], a[64:67], v[160:163], 0
  s_add_u32 s29, s101, 4096
  ds_read_b128 a[120:123], v4 offset:14336
  ds_read_b128 a[124:127], v4 offset:15360
  v_mfma_f32_16x16x32_bf16 v[56:59], a[68:71], v[168:171], v[56:59]
  v_exp_f32 v48, v48
  v_mfma_f32_16x16x32_bf16 v[56:59], a[72:75], v[176:179], v[56:59]
  v_mfma_f32_16x16x32_bf16 v[56:59], a[76:79], v[184:187], v[56:59]
  v_exp_f32 v49, v49
  v_mfma_f32_16x16x32_bf16 v[60:63], a[80:83], v[160:163], v[16:19]
  v_cvt_pk_bf16_f32 v48, v48, v49
  v_mfma_f32_16x16x32_bf16 v[60:63], a[84:87], v[168:171], v[60:63]
  v_exp_f32 v50, v50
  v_mfma_f32_16x16x32_bf16 v[60:63], a[88:91], v[176:179], v[60:63]
  v_mfma_f32_16x16x32_bf16 v[60:63], a[92:95], v[184:187], v[60:63]
  s_waitcnt lgkmcnt(0)
  v_exp_f32 v51, v51
  s_nop 0
  v_cvt_pk_bf16_f32 v49, v50, v51
  v_exp_f32 v52, v52
  v_exp_f32 v53, v53
  s_nop 0
  v_cvt_pk_bf16_f32 v50, v52, v53
  v_exp_f32 v54, v54
  v_exp_f32 v55, v55
  s_nop 0
  v_cvt_pk_bf16_f32 v51, v54, v55
  v_exp_f32 v56, v56
  v_exp_f32 v57, v57
  s_nop 0
  v_cvt_pk_bf16_f32 v56, v56, v57
  v_exp_f32 v58, v58
  v_exp_f32 v59, v59
  s_nop 0
  v_cvt_pk_bf16_f32 v57, v58, v59
  v_exp_f32 v60, v60
  v_mfma_f32_16x16x32_bf16 v[32:35], a[64:67], v[192:195], 0
  v_mfma_f32_16x16x32_bf16 v[32:35], a[68:71], v[200:203], v[32:35]
  v_exp_f32 v61, v61
  v_mfma_f32_16x16x32_bf16 v[32:35], a[72:75], v[208:211], v[32:35]
  v_cvt_pk_bf16_f32 v58, v60, v61
  v_mfma_f32_16x16x32_bf16 v[32:35], a[76:79], v[216:219], v[32:35]
  v_exp_f32 v62, v62
  v_mfma_f32_16x16x32_bf16 v[36:39], a[80:83], v[192:195], 0
  buffer_store_dwordx4 a[32:35], v12, s[16:19], s29 offen offset:0 sc1
  v_mfma_f32_16x16x32_bf16 v[36:39], a[84:87], v[200:203], v[36:39]
  v_exp_f32 v63, v63
  v_mfma_f32_16x16x32_bf16 v[36:39], a[88:91], v[208:211], v[36:39]
  v_cvt_pk_bf16_f32 v59, v62, v63
  v_mfma_f32_16x16x32_bf16 v[36:39], a[92:95], v[216:219], v[36:39]
  v_mfma_f32_16x16x32_bf16 v[40:43], a[64:67], v[224:227], 0
  v_and_b32 v6, 7, v0
  v_lshlrev_b32 v6, 9, v6
  v_mfma_f32_16x16x32_bf16 v[40:43], a[68:71], v[232:235], v[40:43]
  s_andn2_b32 s26, s93, 0xe00
  v_exp_f32 v32, v32
  v_mfma_f32_16x16x32_bf16 v[40:43], a[72:75], v[240:243], v[40:43]
  v_mfma_f32_16x16x32_bf16 v[40:43], a[76:79], v[248:251], v[40:43]
  s_add_u32 s26, s26, 32768
  v_exp_f32 v33, v33
  v_mfma_f32_16x16x32_bf16 v[44:47], a[80:83], v[224:227], 0
  v_cvt_pk_bf16_f32 v32, v32, v33
  v_mfma_f32_16x16x32_bf16 v[44:47], a[84:87], v[232:235], v[44:47]
  v_exp_f32 v34, v34
  v_mfma_f32_16x16x32_bf16 v[44:47], a[88:91], v[240:243], v[44:47]
  buffer_load_dword v6, v6, s[20:23], s26 offen sc1
  v_mfma_f32_16x16x32_bf16 v[44:47], a[92:95], v[248:251], v[44:47]
  v_exp_f32 v35, v35
  v_mfma_f32_16x16x32_bf16 v[64:67], a[96:99], v[48:51], 0
  v_cvt_pk_bf16_f32 v33, v34, v35
  v_mfma_f32_16x16x32_bf16 v[132:135], a[100:103], v[48:51], 0
  v_exp_f32 v36, v36
  v_mfma_f32_16x16x32_bf16 v[68:71], a[104:107], v[48:51], 0
  ds_read_b128 a[64:67], v4 offset:16384
  ds_read_b128 a[68:71], v4 offset:17408
  v_mfma_f32_16x16x32_bf16 v[140:143], a[108:111], v[48:51], 0
  v_exp_f32 v37, v37
  v_mfma_f32_16x16x32_bf16 v[72:75], a[112:115], v[48:51], 0
  ds_read_b128 a[72:75], v4 offset:18432
  v_cvt_pk_bf16_f32 v34, v36, v37
  v_mfma_f32_16x16x32_bf16 v[148:151], a[116:119], v[48:51], 0
  v_exp_f32 v38, v38
  v_mfma_f32_16x16x32_bf16 v[76:79], a[120:123], v[48:51], 0
  ds_read_b128 a[76:79], v4 offset:19456
  ds_read_b128 a[80:83], v4 offset:20480
  v_mfma_f32_16x16x32_bf16 v[156:159], a[124:127], v[48:51], 0
  buffer_store_dwordx4 a[40:43], v12, s[16:19], s29 offen offset:1024 sc1
  v_exp_f32 v39, v39
  v_mfma_f32_16x16x32_bf16 a[160:163], a[224:227], v[48:51], 0
  s_add_u32 s28, s101, s82
  ds_read_b128 a[84:87], v4 offset:21504
  v_cvt_pk_bf16_f32 v35, v38, v39
  v_mfma_f32_16x16x32_bf16 v[80:83], a[96:99], v[56:59], 0
  v_exp_f32 v40, v40
  v_mfma_f32_16x16x32_bf16 v[164:167], a[100:103], v[56:59], 0
  ds_read_b128 a[88:91], v4 offset:22528
  ds_read_b128 a[92:95], v4 offset:23552
  v_mfma_f32_16x16x32_bf16 v[84:87], a[104:107], v[56:59], 0
  v_exp_f32 v41, v41
  v_mfma_f32_16x16x32_bf16 v[172:175], a[108:111], v[56:59], 0
  v_cvt_pk_bf16_f32 v40, v40, v41
  v_mfma_f32_16x16x32_bf16 v[88:91], a[112:115], v[56:59], 0
  v_exp_f32 v42, v42
  v_mfma_f32_16x16x32_bf16 v[180:183], a[116:119], v[56:59], 0
  buffer_store_dwordx4 a[16:19], v12, s[16:19], s28 offen offset:0 sc1
  v_mfma_f32_16x16x32_bf16 v[92:95], a[120:123], v[56:59], 0
  v_exp_f32 v43, v43
  v_mfma_f32_16x16x32_bf16 v[188:191], a[124:127], v[56:59], 0
  v_cvt_pk_bf16_f32 v41, v42, v43
  v_mfma_f32_16x16x32_bf16 a[164:167], a[224:227], v[56:59], 0
  s_waitcnt lgkmcnt(0)
  v_exp_f32 v44, v44
  v_mfma_f32_16x16x32_bf16 v[48:51], a[64:67], v[192:195], 0
  ds_read_b128 a[128:131], v4 offset:24576
  ds_read_b128 a[132:135], v4 offset:25600
  v_mfma_f32_16x16x32_bf16 v[48:51], a[68:71], v[200:203], v[48:51]
  v_exp_f32 v45, v45
  v_mfma_f32_16x16x32_bf16 v[48:51], a[72:75], v[208:211], v[48:51]
  ds_read_b128 a[136:139], v4 offset:26624
  v_cvt_pk_bf16_f32 v42, v44, v45
  v_mfma_f32_16x16x32_bf16 v[48:51], a[76:79], v[216:219], v[48:51]
  v_exp_f32 v46, v46
  v_mfma_f32_16x16x32_bf16 v[52:55], a[80:83], v[192:195], 0
  ds_read_b128 a[140:143], v4 offset:27648
  ds_read_b128 a[144:147], v4 offset:28672
  v_mfma_f32_16x16x32_bf16 v[52:55], a[84:87], v[200:203], v[52:55]
  v_exp_f32 v47, v47
  v_mfma_f32_16x16x32_bf16 v[52:55], a[88:91], v[208:211], v[52:55]
  ds_read_b128 a[148:151], v4 offset:29696
  v_cvt_pk_bf16_f32 v43, v46, v47
  v_mfma_f32_16x16x32_bf16 v[52:55], a[92:95], v[216:219], v[52:55]
  buffer_store_dwordx4 a[20:23], v12, s[16:19], s28 offen offset:1024 sc1
  v_mfma_f32_16x16x32_bf16 v[56:59], a[64:67], v[224:227], 0
  ds_read_b128 a[152:155], v4 offset:30720
  ds_read_b128 a[156:159], v4 offset:31744
  v_mfma_f32_16x16x32_bf16 v[56:59], a[68:71], v[232:235], v[56:59]
  v_exp_f32 v48, v48
  v_mfma_f32_16x16x32_bf16 v[56:59], a[72:75], v[240:243], v[56:59]
  v_mfma_f32_16x16x32_bf16 v[56:59], a[76:79], v[248:251], v[56:59]
  v_exp_f32 v49, v49
  v_mfma_f32_16x16x32_bf16 v[60:63], a[80:83], v[224:227], 0
  v_cvt_pk_bf16_f32 v48, v48, v49
  v_mfma_f32_16x16x32_bf16 v[60:63], a[84:87], v[232:235], v[60:63]
  v_exp_f32 v50, v50
  v_mfma_f32_16x16x32_bf16 v[60:63], a[88:91], v[240:243], v[60:63]
  v_mfma_f32_16x16x32_bf16 v[60:63], a[92:95], v[248:251], v[60:63]
  v_exp_f32 v51, v51
  v_mfma_f32_16x16x32_bf16 v[96:99], a[96:99], v[32:35], 0
  v_cvt_pk_bf16_f32 v49, v50, v51
  v_mfma_f32_16x16x32_bf16 v[196:199], a[100:103], v[32:35], 0
  v_exp_f32 v52, v52
  v_mfma_f32_16x16x32_bf16 v[100:103], a[104:107], v[32:35], 0
  ds_read_b128 a[64:67], v4 offset:49152
  ds_read_b128 a[68:71], v4 offset:50176
  v_mfma_f32_16x16x32_bf16 v[204:207], a[108:111], v[32:35], 0
  v_exp_f32 v53, v53
  v_mfma_f32_16x16x32_bf16 v[104:107], a[112:115], v[32:35], 0
  ds_read_b128 a[72:75], v4 offset:51200
  v_cvt_pk_bf16_f32 v50, v52, v53
  v_mfma_f32_16x16x32_bf16 v[212:215], a[116:119], v[32:35], 0
  v_exp_f32 v54, v54
  v_mfma_f32_16x16x32_bf16 v[108:111], a[120:123], v[32:35], 0
  ds_read_b128 a[76:79], v4 offset:52224
  ds_read_b128 a[80:83], v4 offset:53248
  v_mfma_f32_16x16x32_bf16 v[220:223], a[124:127], v[32:35], 0
  v_exp_f32 v55, v55
  v_mfma_f32_16x16x32_bf16 a[168:171], a[224:227], v[32:35], 0
  ds_read_b128 a[84:87], v4 offset:54272
  v_cvt_pk_bf16_f32 v51, v54, v55
  v_mfma_f32_16x16x32_bf16 v[112:115], a[96:99], v[40:43], 0
  v_exp_f32 v56, v56
  v_mfma_f32_16x16x32_bf16 v[228:231], a[100:103], v[40:43], 0
  ds_read_b128 a[88:91], v4 offset:55296
  ds_read_b128 a[92:95], v4 offset:56320
  v_mfma_f32_16x16x32_bf16 v[116:119], a[104:107], v[40:43], 0
  buffer_store_dwordx4 a[24:27], v12, s[16:19], s28 offen offset:2048 sc1
  v_exp_f32 v57, v57
  v_mfma_f32_16x16x32_bf16 v[236:239], a[108:111], v[40:43], 0
  v_cvt_pk_bf16_f32 v56, v56, v57
  v_mfma_f32_16x16x32_bf16 v[120:123], a[112:115], v[40:43], 0
  v_exp_f32 v58, v58
  v_mfma_f32_16x16x32_bf16 v[244:247], a[116:119], v[40:43], 0
  s_waitcnt vmcnt(4)
  v_xor_b32 v6, s92, v6
  v_cmp_lt_u32 vcc, 15, v6
  v_mfma_f32_16x16x32_bf16 v[124:127], a[120:123], v[40:43], 0
  v_exp_f32 v59, v59
  v_mfma_f32_16x16x32_bf16 v[252:255], a[124:127], v[40:43], 0
  v_cvt_pk_bf16_f32 v57, v58, v59
  v_mfma_f32_16x16x32_bf16 a[172:175], a[224:227], v[40:43], 0
  s_cbranch_vccnz spin0
spun0:
  s_waitcnt lgkmcnt(0)
  v_exp_f32 v60, v60
  v_mfma_f32_16x16x32_bf16 v[32:35], a[64:67], v[192:195], v[16:19]
  s_mov_b32 s78, 0
  ds_read_b128 a[96:99], v4 offset:57344
  ds_read_b128 a[100:103], v4 offset:58368
  v_mfma_f32_16x16x32_bf16 v[32:35], a[68:71], v[200:203], v[32:35]
  s_cmp_eq_u32 s78, s62
  v_exp_f32 v61, v61
  v_mfma_f32_16x16x32_bf16 v[32:35], a[72:75], v[208:211], v[32:35]
  s_cmov_b32 s78, s79
  ds_read_b128 a[104:107], v4 offset:59392
  v_cvt_pk_bf16_f32 v58, v60, v61
  v_mfma_f32_16x16x32_bf16 v[32:35], a[76:79], v[216:219], v[32:35]
  s_cmp_eq_u32 s78, s63
  v_exp_f32 v62, v62
  v_mfma_f32_16x16x32_bf16 v[36:39], a[80:83], v[192:195], v[20:23]
  s_cmov_b32 s78, s94
  ds_read_b128 a[108:111], v4 offset:60416
  ds_read_b128 a[112:115], v4 offset:61440
  v_mfma_f32_16x16x32_bf16 v[36:39], a[84:87], v[200:203], v[36:39]
  s_mov_b32 m0, s65
  buffer_store_dwordx4 a[28:31], v12, s[16:19], s28 offen offset:3072 sc1
  v_exp_f32 v63, v63
  v_mfma_f32_16x16x32_bf16 v[36:39], a[88:91], v[208:211], v[36:39]
  s_add_u32 s65, s65, 16384
  ds_read_b128 a[116:119], v4 offset:62464
  v_cvt_pk_bf16_f32 v59, v62, v63
  v_mfma_f32_16x16x32_bf16 v[36:39], a[92:95], v[216:219], v[36:39]
  buffer_load_dwordx4 v28, s[16:19], s78 offen offset:0 sc1 lds
  v_mfma_f32_16x16x32_bf16 v[40:43], a[64:67], v[224:227], 0
  ds_read_b128 a[120:123], v4 offset:63488
  ds_read_b128 a[124:127], v4 offset:64512
  v_mfma_f32_16x16x32_bf16 v[40:43], a[68:71], v[232:235], v[40:43]
  v_exp_f32 v32, v32
  v_mfma_f32_16x16x32_bf16 v[40:43], a[72:75], v[240:243], v[40:43]
  buffer_load_dwordx4 v28, s[16:19], s78 offen offset:1024 sc1 lds
  v_mfma_f32_16x16x32_bf16 v[40:43], a[76:79], v[248:251], v[40:43]
  v_exp_f32 v33, v33
  v_mfma_f32_16x16x32_bf16 v[44:47], a[80:83], v[224:227], v[16:19]
  v_cvt_pk_bf16_f32 v32, v32, v33
  v_mfma_f32_16x16x32_bf16 v[44:47], a[84:87], v[232:235], v[44:47]
  s_sub_u32 s25, s65, 163840
  v_exp_f32 v34, v34
  v_mfma_f32_16x16x32_bf16 v[44:47], a[88:91], v[240:243], v[44:47]
  buffer_load_dwordx4 v28, s[16:19], s78 offen offset:2048 sc1 lds
  v_mfma_f32_16x16x32_bf16 v[44:47], a[92:95], v[248:251], v[44:47]
  s_min_u32 s65, s65, s25
  v_exp_f32 v35, v35
  v_mfma_f32_16x16x32_bf16 v[96:99], a[128:131], v[48:51], v[96:99]
  v_cvt_pk_bf16_f32 v33, v34, v35
  v_mfma_f32_16x16x32_bf16 v[196:199], a[132:135], v[48:51], v[196:199]
  v_exp_f32 v36, v36
  v_mfma_f32_16x16x32_bf16 v[100:103], a[136:139], v[48:51], v[100:103]
  ds_read_b128 a[64:67], v4 offset:32768
  ds_read_b128 a[68:71], v4 offset:33792
  v_mfma_f32_16x16x32_bf16 v[204:207], a[140:143], v[48:51], v[204:207]
  v_exp_f32 v37, v37
  v_mfma_f32_16x16x32_bf16 v[104:107], a[144:147], v[48:51], v[104:107]
  ds_read_b128 a[72:75], v4 offset:34816
  v_cvt_pk_bf16_f32 v34, v36, v37
  v_mfma_f32_16x16x32_bf16 v[212:215], a[148:151], v[48:51], v[212:215]
  v_exp_f32 v38, v38
  v_mfma_f32_16x16x32_bf16 v[108:111], a[152:155], v[48:51], v[108:111]
  ds_read_b128 a[76:79], v4 offset:35840
  ds_read_b128 a[80:83], v4 offset:36864
  v_mfma_f32_16x16x32_bf16 v[220:223], a[156:159], v[48:51], v[220:223]
  v_exp_f32 v39, v39
  v_mfma_f32_16x16x32_bf16 a[168:171], a[224:227], v[48:51], a[168:171]
  ds_read_b128 a[84:87], v4 offset:37888
  v_cvt_pk_bf16_f32 v35, v38, v39
  v_mfma_f32_16x16x32_bf16 v[112:115], a[128:131], v[56:59], v[112:115]
  v_exp_f32 v40, v40
  v_mfma_f32_16x16x32_bf16 v[228:231], a[132:135], v[56:59], v[228:231]
  ds_read_b128 a[88:91], v4 offset:38912
  ds_read_b128 a[92:95], v4 offset:39936
  v_mfma_f32_16x16x32_bf16 v[116:119], a[136:139], v[56:59], v[116:119]
  v_exp_f32 v41, v41
  v_mfma_f32_16x16x32_bf16 v[236:239], a[140:143], v[56:59], v[236:239]
  v_cvt_pk_bf16_f32 v40, v40, v41
  v_mfma_f32_16x16x32_bf16 v[120:123], a[144:147], v[56:59], v[120:123]
  v_exp_f32 v42, v42
  v_mfma_f32_16x16x32_bf16 v[244:247], a[148:151], v[56:59], v[244:247]
  buffer_load_dwordx4 v28, s[16:19], s78 offen offset:3072 sc1 lds
  v_mfma_f32_16x16x32_bf16 v[124:127], a[152:155], v[56:59], v[124:127]
  v_exp_f32 v43, v43
  v_mfma_f32_16x16x32_bf16 v[252:255], a[156:159], v[56:59], v[252:255]
  v_cvt_pk_bf16_f32 v41, v42, v43
  v_mfma_f32_16x16x32_bf16 a[172:175], a[224:227], v[56:59], a[172:175]
  s_waitcnt lgkmcnt(0)
  v_exp_f32 v44, v44
  v_mfma_f32_16x16x32_bf16 v[48:51], a[64:67], v[192:195], 0
  s_add_u32 s78, s78, 16384
  ds_read_b128 a[128:131], v4 offset:40960
  ds_read_b128 a[132:135], v4 offset:41984
  v_mfma_f32_16x16x32_bf16 v[48:51], a[68:71], v[200:203], v[48:51]
  s_cmp_eq_u32 s78, s62
  v_exp_f32 v45, v45
  v_mfma_f32_16x16x32_bf16 v[48:51], a[72:75], v[208:211], v[48:51]
  s_cmov_b32 s78, s79
  ds_read_b128 a[136:139], v4 offset:43008
  v_cvt_pk_bf16_f32 v42, v44, v45
  v_mfma_f32_16x16x32_bf16 v[48:51], a[76:79], v[216:219], v[48:51]
  s_cmp_eq_u32 s78, s63
  v_exp_f32 v46, v46
  v_mfma_f32_16x16x32_bf16 v[52:55], a[80:83], v[192:195], 0
  s_cmov_b32 s78, s94
  ds_read_b128 a[140:143], v4 offset:44032
  ds_read_b128 a[144:147], v4 offset:45056
  v_mfma_f32_16x16x32_bf16 v[52:55], a[84:87], v[200:203], v[52:55]
  s_mov_b32 m0, s65
  v_exp_f32 v47, v47
  v_mfma_f32_16x16x32_bf16 v[52:55], a[88:91], v[208:211], v[52:55]
  s_add_u32 s65, s65, 16384
  ds_read_b128 a[148:151], v4 offset:46080
  v_cvt_pk_bf16_f32 v43, v46, v47
  v_mfma_f32_16x16x32_bf16 v[52:55], a[92:95], v[216:219], v[52:55]
  buffer_load_dwordx4 v28, s[16:19], s78 offen offset:0 sc1 lds
  v_mfma_f32_16x16x32_bf16 v[56:59], a[64:67], v[224:227], 0
  ds_read_b128 a[152:155], v4 offset:47104
  ds_read_b128 a[156:159], v4 offset:48128
  v_mfma_f32_16x16x32_bf16 v[56:59], a[68:71], v[232:235], v[56:59]
  v_exp_f32 v48, v48
  v_mfma_f32_16x16x32_bf16 v[56:59], a[72:75], v[240:243], v[56:59]
  buffer_load_dwordx4 v28, s[16:19], s78 offen offset:1024 sc1 lds
  v_mfma_f32_16x16x32_bf16 v[56:59], a[76:79], v[248:251], v[56:59]
  v_exp_f32 v49, v49
  v_mfma_f32_16x16x32_bf16 v[60:63], a[80:83], v[224:227], 0
  v_cvt_pk_bf16_f32 v48, v48, v49
  v_mfma_f32_16x16x32_bf16 v[60:63], a[84:87], v[232:235], v[60:63]
  s_sub_u32 s25, s65, 163840
  v_exp_f32 v50, v50
  v_mfma_f32_16x16x32_bf16 v[60:63], a[88:91], v[240:243], v[60:63]
  buffer_load_dwordx4 v28, s[16:19], s78 offen offset:2048 sc1 lds
  v_mfma_f32_16x16x32_bf16 v[60:63], a[92:95], v[248:251], v[60:63]
  s_min_u32 s65, s65, s25
  v_exp_f32 v51, v51
  v_mfma_f32_16x16x32_bf16 v[96:99], a[96:99], v[32:35], v[96:99]
  s_waitcnt lgkmcnt(0)
  s_barrier
  v_cvt_pk_bf16_f32 v49, v50, v51
  v_mfma_f32_16x16x32_bf16 v[196:199], a[100:103], v[32:35], v[196:199]
  v_exp_f32 v52, v52
  v_mfma_f32_16x16x32_bf16 v[100:103], a[104:107], v[32:35], v[100:103]
  ds_read_b128 a[64:67], v5 offset:0
  ds_read_b128 a[68:71], v5 offset:1024
  v_mfma_f32_16x16x32_bf16 v[204:207], a[108:111], v[32:35], v[204:207]
  v_exp_f32 v53, v53
  v_mfma_f32_16x16x32_bf16 v[104:107], a[112:115], v[32:35], v[104:107]
  ds_read_b128 a[72:75], v5 offset:2048
  v_cvt_pk_bf16_f32 v50, v52, v53
  v_mfma_f32_16x16x32_bf16 v[212:215], a[116:119], v[32:35], v[212:215]
  v_exp_f32 v54, v54
  v_mfma_f32_16x16x32_bf16 v[108:111], a[120:123], v[32:35], v[108:111]
  ds_read_b128 a[76:79], v5 offset:3072
  ds_read_b128 a[80:83], v5 offset:4096
  v_mfma_f32_16x16x32_bf16 v[220:223], a[124:127], v[32:35], v[220:223]
  v_exp_f32 v55, v55
  v_mfma_f32_16x16x32_bf16 a[168:171], a[224:227], v[32:35], a[168:171]
  ds_read_b128 a[84:87], v5 offset:5120
  v_cvt_pk_bf16_f32 v51, v54, v55
  v_mfma_f32_16x16x32_bf16 v[112:115], a[96:99], v[40:43], v[112:115]
  v_exp_f32 v56, v56
  v_mfma_f32_16x16x32_bf16 v[228:231], a[100:103], v[40:43], v[228:231]
  ds_read_b128 a[88:91], v5 offset:6144
  ds_read_b128 a[92:95], v5 offset:7168
  v_mfma_f32_16x16x32_bf16 v[116:119], a[104:107], v[40:43], v[116:119]
  v_exp_f32 v57, v57
  v_mfma_f32_16x16x32_bf16 v[236:239], a[108:111], v[40:43], v[236:239]
  v_cvt_pk_bf16_f32 v56, v56, v57
  v_mfma_f32_16x16x32_bf16 v[120:123], a[112:115], v[40:43], v[120:123]
  v_exp_f32 v58, v58
  v_mfma_f32_16x16x32_bf16 v[244:247], a[116:119], v[40:43], v[244:247]
  buffer_load_dwordx4 v28, s[16:19], s78 offen offset:3072 sc1 lds
  v_mfma_f32_16x16x32_bf16 v[124:127], a[120:123], v[40:43], v[124:127]
  v_exp_f32 v59, v59
  v_mfma_f32_16x16x32_bf16 v[252:255], a[124:127], v[40:43], v[252:255]
  v_cvt_pk_bf16_f32 v57, v58, v59
  v_mfma_f32_16x16x32_bf16 a[172:175], a[224:227], v[40:43], a[172:175]
  s_waitcnt lgkmcnt(0)
  v_exp_f32 v60, v60
  v_mfma_f32_16x16x32_bf16 v[32:35], a[64:67], v[192:195], 0
  s_add_u32 s78, s78, 16384
  ds_read_b128 a[96:99], v5 offset:8192
  ds_read_b128 a[100:103], v5 offset:9216
  v_mfma_f32_16x16x32_bf16 v[32:35], a[68:71], v[200:203], v[32:35]
  s_cmp_eq_u32 s78, s62
  v_exp_f32 v61, v61
  v_mfma_f32_16x16x32_bf16 v[32:35], a[72:75], v[208:211], v[32:35]
  s_cmov_b32 s78, s79
  ds_read_b128 a[104:107], v5 offset:10240
  v_cvt_pk_bf16_f32 v58, v60, v61
  v_mfma_f32_16x16x32_bf16 v[32:35], a[76:79], v[216:219], v[32:35]
  s_cmp_eq_u32 s78, s63
  v_exp_f32 v62, v62
  v_mfma_f32_16x16x32_bf16 v[36:39], a[80:83], v[192:195], 0
  s_cmov_b32 s78, s94
  ds_read_b128 a[108:111], v5 offset:11264
  ds_read_b128 a[112:115], v5 offset:12288
  v_mfma_f32_16x16x32_bf16 v[36:39], a[84:87], v[200:203], v[36:39]
  s_mov_b32 m0, s65
  v_exp_f32 v63, v63
  v_mfma_f32_16x16x32_bf16 v[36:39], a[88:91], v[208:211], v[36:39]
  s_add_u32 s65, s65, 16384
  ds_read_b128 a[116:119], v5 offset:13312
  v_cvt_pk_bf16_f32 v59, v62, v63
  v_mfma_f32_16x16x32_bf16 v[36:39], a[92:95], v[216:219], v[36:39]
  buffer_load_dwordx4 v28, s[16:19], s78 offen offset:0 sc1 lds
  v_mfma_f32_16x16x32_bf16 v[40:43], a[64:67], v[224:227], 0
  ds_read_b128 a[120:123], v5 offset:14336
  ds_read_b128 a[124:127], v5 offset:15360
  v_mfma_f32_16x16x32_bf16 v[40:43], a[68:71], v[232:235], v[40:43]
  v_exp_f32 v32, v32
  v_mfma_f32_16x16x32_bf16 v[40:43], a[72:75], v[240:243], v[40:43]
  buffer_load_dwordx4 v28, s[16:19], s78 offen offset:1024 sc1 lds
  v_mfma_f32_16x16x32_bf16 v[40:43], a[76:79], v[248:251], v[40:43]
  v_exp_f32 v33, v33
  v_mfma_f32_16x16x32_bf16 v[44:47], a[80:83], v[224:227], 0
  v_cvt_pk_bf16_f32 v32, v32, v33
  v_mfma_f32_16x16x32_bf16 v[44:47], a[84:87], v[232:235], v[44:47]
  s_sub_u32 s25, s65, 163840
  v_exp_f32 v34, v34
  v_mfma_f32_16x16x32_bf16 v[44:47], a[88:91], v[240:243], v[44:47]
  buffer_load_dwordx4 v28, s[16:19], s78 offen offset:2048 sc1 lds
  v_mfma_f32_16x16x32_bf16 v[44:47], a[92:95], v[248:251], v[44:47]
  s_min_u32 s65, s65, s25
  v_exp_f32 v35, v35
  v_mfma_f32_16x16x32_bf16 v[96:99], a[128:131], v[48:51], v[96:99]
  v_cvt_pk_bf16_f32 v33, v34, v35
  v_mfma_f32_16x16x32_bf16 v[196:199], a[132:135], v[48:51], v[196:199]
  v_exp_f32 v36, v36
  v_mfma_f32_16x16x32_bf16 v[100:103], a[136:139], v[48:51], v[100:103]
  ds_read_b128 a[64:67], v12 offset:0
  ds_read_b128 a[68:71], v12 offset:1024
  v_mfma_f32_16x16x32_bf16 v[204:207], a[140:143], v[48:51], v[204:207]
  v_exp_f32 v37, v37
  v_mfma_f32_16x16x32_bf16 v[104:107], a[144:147], v[48:51], v[104:107]
  ds_read_b128 a[72:75], v12 offset:2048
  v_cvt_pk_bf16_f32 v34, v36, v37
  v_mfma_f32_16x16x32_bf16 v[212:215], a[148:151], v[48:51], v[212:215]
  v_exp_f32 v38, v38
  v_mfma_f32_16x16x32_bf16 v[108:111], a[152:155], v[48:51], v[108:111]
  ds_read_b128 a[76:79], v12 offset:3072
  ds_read_b128 a[80:83], v12 offset:4096
  v_mfma_f32_16x16x32_bf16 v[220:223], a[156:159], v[48:51], v[220:223]
  v_exp_f32 v39, v39
  v_mfma_f32_16x16x32_bf16 a[168:171], a[224:227], v[48:51], a[168:171]
  ds_read_b128 a[84:87], v12 offset:5120
  v_cvt_pk_bf16_f32 v35, v38, v39
  v_mfma_f32_16x16x32_bf16 v[112:115], a[128:131], v[56:59], v[112:115]
  v_exp_f32 v40, v40
  v_mfma_f32_16x16x32_bf16 v[228:231], a[132:135], v[56:59], v[228:231]
  ds_read_b128 a[88:91], v12 offset:6144
  ds_read_b128 a[92:95], v12 offset:7168
  v_mfma_f32_16x16x32_bf16 v[116:119], a[136:139], v[56:59], v[116:119]
  v_exp_f32 v41, v41
  v_mfma_f32_16x16x32_bf16 v[236:239], a[140:143], v[56:59], v[236:239]
  v_cvt_pk_bf16_f32 v40, v40, v41
  v_mfma_f32_16x16x32_bf16 v[120:123], a[144:147], v[56:59], v[120:123]
  v_exp_f32 v42, v42
  v_mfma_f32_16x16x32_bf16 v[244:247], a[148:151], v[56:59], v[244:247]
  buffer_load_dwordx4 v28, s[16:19], s78 offen offset:3072 sc1 lds
  v_mfma_f32_16x16x32_bf16 v[124:127], a[152:155], v[56:59], v[124:127]
  v_exp_f32 v43, v43
  v_mfma_f32_16x16x32_bf16 v[252:255], a[156:159], v[56:59], v[252:255]
  v_cvt_pk_bf16_f32 v41, v42, v43
  v_mfma_f32_16x16x32_bf16 a[172:175], a[224:227], v[56:59], a[172:175]
  s_waitcnt lgkmcnt(0)
  v_exp_f32 v44, v44
  v_mfma_f32_16x16x32_bf16 v[48:51], a[64:67], v[192:195], 0
  s_add_u32 s78, s78, 16384
  ds_read_b128 a[128:131], v12 offset:8192
  ds_read_b128 a[132:135], v12 offset:9216
  v_mfma_f32_16x16x32_bf16 v[48:51], a[68:71], v[200:203], v[48:51]
  s_cmp_eq_u32 s78, s62
  v_exp_f32 v45, v45
  v_mfma_f32_16x16x32_bf16 v[48:51], a[72:75], v[208:211], v[48:51]
  s_cmov_b32 s78, s79
  ds_read_b128 a[136:139], v12 offset:10240
  v_cvt_pk_bf16_f32 v42, v44, v45
  v_mfma_f32_16x16x32_bf16 v[48:51], a[76:79], v[216:219], v[48:51]
  s_cmp_eq_u32 s78, s63
  v_exp_f32 v46, v46
  v_mfma_f32_16x16x32_bf16 v[52:55], a[80:83], v[192:195], 0
  s_cmov_b32 s78, s94
  ds_read_b128 a[140:143], v12 offset:11264
  ds_read_b128 a[144:147], v12 offset:12288
  v_mfma_f32_16x16x32_bf16 v[52:55], a[84:87], v[200:203], v[52:55]
  s_mov_b32 m0, s65
  v_exp_f32 v47, v47
  v_mfma_f32_16x16x32_bf16 v[52:55], a[88:91], v[208:211], v[52:55]
  s_add_u32 s65, s65, 16384
  ds_read_b128 a[148:151], v12 offset:13312
  v_cvt_pk_bf16_f32 v43, v46, v47
  v_mfma_f32_16x16x32_bf16 v[52:55], a[92:95], v[216:219], v[52:55]
  buffer_load_dwordx4 v28, s[16:19], s78 offen offset:0 sc1 lds
  v_mfma_f32_16x16x32_bf16 v[56:59], a[64:67], v[224:227], 0
  ds_read_b128 a[152:155], v12 offset:14336
  ds_read_b128 a[156:159], v12 offset:15360
  v_mfma_f32_16x16x32_bf16 v[56:59], a[68:71], v[232:235], v[56:59]
  v_exp_f32 v48, v48
  v_mfma_f32_16x16x32_bf16 v[56:59], a[72:75], v[240:243], v[56:59]
  buffer_load_dwordx4 v28, s[16:19], s78 offen offset:1024 sc1 lds
  v_mfma_f32_16x16x32_bf16 v[56:59], a[76:79], v[248:251], v[56:59]
  v_exp_f32 v49, v49
  v_mfma_f32_16x16x32_bf16 v[60:63], a[80:83], v[224:227], 0
  v_cvt_pk_bf16_f32 v48, v48, v49
  v_mfma_f32_16x16x32_bf16 v[60:63], a[84:87], v[232:235], v[60:63]
  s_sub_u32 s25, s65, 163840
  v_exp_f32 v50, v50
  v_mfma_f32_16x16x32_bf16 v[60:63], a[88:91], v[240:243], v[60:63]
  buffer_load_dwordx4 v28, s[16:19], s78 offen offset:2048 sc1 lds
  v_mfma_f32_16x16x32_bf16 v[60:63], a[92:95], v[248:251], v[60:63]
  s_min_u32 s65, s65, s25
  v_exp_f32 v51, v51
  v_mfma_f32_16x16x32_bf16 v[96:99], a[96:99], v[32:35], v[96:99]
  v_cvt_pk_bf16_f32 v49, v50, v51
  v_mfma_f32_16x16x32_bf16 v[196:199], a[100:103], v[32:35], v[196:199]
  s_mov_b32 s26, 60293120
  v_exp_f32 v52, v52
  v_mfma_f32_16x16x32_bf16 v[100:103], a[104:107], v[32:35], v[100:103]
  ds_read_b128 a[64:67], v5 offset:16384
  ds_read_b128 a[68:71], v5 offset:17408
  v_mfma_f32_16x16x32_bf16 v[204:207], a[108:111], v[32:35], v[204:207]
  v_exp_f32 v53, v53
  v_mfma_f32_16x16x32_bf16 v[104:107], a[112:115], v[32:35], v[104:107]
  ds_read_b128 a[72:75], v5 offset:18432
  v_cvt_pk_bf16_f32 v50, v52, v53
  v_mfma_f32_16x16x32_bf16 v[212:215], a[116:119], v[32:35], v[212:215]
  v_exp_f32 v54, v54
  v_mfma_f32_16x16x32_bf16 v[108:111], a[120:123], v[32:35], v[108:111]
  ds_read_b128 a[76:79], v5 offset:19456
  ds_read_b128 a[80:83], v5 offset:20480
  v_mfma_f32_16x16x32_bf16 v[220:223], a[124:127], v[32:35], v[220:223]
  v_exp_f32 v55, v55
  v_mfma_f32_16x16x32_bf16 a[168:171], a[224:227], v[32:35], a[168:171]
  ds_read_b128 a[84:87], v5 offset:21504
  v_cvt_pk_bf16_f32 v51, v54, v55
  v_mfma_f32_16x16x32_bf16 v[112:115], a[96:99], v[40:43], v[112:115]
  v_exp_f32 v56, v56
  v_mfma_f32_16x16x32_bf16 v[228:231], a[100:103], v[40:43], v[228:231]
  ds_read_b128 a[88:91], v5 offset:22528
  ds_read_b128 a[92:95], v5 offset:23552
  v_mfma_f32_16x16x32_bf16 v[116:119], a[104:107], v[40:43], v[116:119]
  v_exp_f32 v57, v57
  v_mfma_f32_16x16x32_bf16 v[236:239], a[108:111], v[40:43], v[236:239]
  buffer_load_dword v6, v14, s[20:23], s26 offen sc1
  v_cvt_pk_bf16_f32 v56, v56, v57
  v_mfma_f32_16x16x32_bf16 v[120:123], a[112:115], v[40:43], v[120:123]
  v_exp_f32 v58, v58
  v_mfma_f32_16x16x32_bf16 v[244:247], a[116:119], v[40:43], v[244:247]
  buffer_load_dwordx4 v28, s[16:19], s78 offen offset:3072 sc1 lds
  v_mfma_f32_16x16x32_bf16 v[124:127], a[120:123], v[40:43], v[124:127]
  v_exp_f32 v59, v59
  v_mfma_f32_16x16x32_bf16 v[252:255], a[124:127], v[40:43], v[252:255]
  v_cvt_pk_bf16_f32 v57, v58, v59
  v_mfma_f32_16x16x32_bf16 a[172:175], a[224:227], v[40:43], a[172:175]
  s_waitcnt lgkmcnt(0)
  v_exp_f32 v60, v60
  v_mfma_f32_16x16x32_bf16 v[32:35], a[64:67], v[192:195], 0
  s_add_u32 s78, s78, 16384
  ds_read_b128 a[96:99], v5 offset:24576
  ds_read_b128 a[100:103], v5 offset:25600
  v_mfma_f32_16x16x32_bf16 v[32:35], a[68:71], v[200:203], v[32:35]
  s_cmp_eq_u32 s78, s62
  v_exp_f32 v61, v61
  v_mfma_f32_16x16x32_bf16 v[32:35], a[72:75], v[208:211], v[32:35]
  s_cmov_b32 s78, s79
  ds_read_b128 a[104:107], v5 offset:26624
  v_cvt_pk_bf16_f32 v58, v60, v61
  v_mfma_f32_16x16x32_bf16 v[32:35], a[76:79], v[216:219], v[32:35]
  s_cmp_eq_u32 s78, s63
  v_exp_f32 v62, v62
  v_mfma_f32_16x16x32_bf16 v[36:39], a[80:83], v[192:195], 0
  s_cmov_b32 s78, s94
  ds_read_b128 a[108:111], v5 offset:27648
  ds_read_b128 a[112:115], v5 offset:28672
  v_mfma_f32_16x16x32_bf16 v[36:39], a[84:87], v[200:203], v[36:39]
  s_mov_b32 m0, s65
  v_exp_f32 v63, v63
  v_mfma_f32_16x16x32_bf16 v[36:39], a[88:91], v[208:211], v[36:39]
  s_add_u32 s65, s65, 16384
  ds_read_b128 a[116:119], v5 offset:29696
  v_cvt_pk_bf16_f32 v59, v62, v63
  v_mfma_f32_16x16x32_bf16 v[36:39], a[92:95], v[216:219], v[36:39]
  buffer_load_dwordx4 v28, s[16:19], s78 offen offset:0 sc1 lds
  v_mfma_f32_16x16x32_bf16 v[40:43], a[64:67], v[224:227], 0
  ds_read_b128 a[120:123], v5 offset:30720
  ds_read_b128 a[124:127], v5 offset:31744
  v_mfma_f32_16x16x32_bf16 v[40:43], a[68:71], v[232:235], v[40:43]
  v_exp_f32 v32, v32
  v_mfma_f32_16x16x32_bf16 v[40:43], a[72:75], v[240:243], v[40:43]
  buffer_load_dwordx4 v28, s[16:19], s78 offen offset:1024 sc1 lds
  v_mfma_f32_16x16x32_bf16 v[40:43], a[76:79], v[248:251], v[40:43]
  v_exp_f32 v33, v33
  v_mfma_f32_16x16x32_bf16 v[44:47], a[80:83], v[224:227], 0
  v_cvt_pk_bf16_f32 v32, v32, v33
  v_mfma_f32_16x16x32_bf16 v[44:47], a[84:87], v[232:235], v[44:47]
  s_sub_u32 s25, s65, 163840
  v_exp_f32 v34, v34
  v_mfma_f32_16x16x32_bf16 v[44:47], a[88:91], v[240:243], v[44:47]
  buffer_load_dwordx4 v28, s[16:19], s78 offen offset:2048 sc1 lds
  v_mfma_f32_16x16x32_bf16 v[44:47], a[92:95], v[248:251], v[44:47]
  s_min_u32 s65, s65, s25
  v_exp_f32 v35, v35
  v_mfma_f32_16x16x32_bf16 v[96:99], a[128:131], v[48:51], v[96:99]
  v_cvt_pk_bf16_f32 v33, v34, v35
  v_mfma_f32_16x16x32_bf16 v[196:199], a[132:135], v[48:51], v[196:199]
  v_exp_f32 v36, v36
  v_mfma_f32_16x16x32_bf16 v[100:103], a[136:139], v[48:51], v[100:103]
  ds_read_b128 a[64:67], v12 offset:16384
  ds_read_b128 a[68:71], v12 offset:17408
  v_mfma_f32_16x16x32_bf16 v[204:207], a[140:143], v[48:51], v[204:207]
  v_exp_f32 v37, v37
  v_mfma_f32_16x16x32_bf16 v[104:107], a[144:147], v[48:51], v[104:107]
  ds_read_b128 a[72:75], v12 offset:18432
  v_cvt_pk_bf16_f32 v34, v36, v37
  v_mfma_f32_16x16x32_bf16 v[212:215], a[148:151], v[48:51], v[212:215]
  v_exp_f32 v38, v38
  v_mfma_f32_16x16x32_bf16 v[108:111], a[152:155], v[48:51], v[108:111]
  ds_read_b128 a[76:79], v12 offset:19456
  ds_read_b128 a[80:83], v12 offset:20480
  v_mfma_f32_16x16x32_bf16 v[220:223], a[156:159], v[48:51], v[220:223]
  v_exp_f32 v39, v39
  v_mfma_f32_16x16x32_bf16 a[168:171], a[224:227], v[48:51], a[168:171]
  ds_read_b128 a[84:87], v12 offset:21504
  v_cvt_pk_bf16_f32 v35, v38, v39
  v_mfma_f32_16x16x32_bf16 v[112:115], a[128:131], v[56:59], v[112:115]
  v_exp_f32 v40, v40
  v_mfma_f32_16x16x32_bf16 v[228:231], a[132:135], v[56:59], v[228:231]
  ds_read_b128 a[88:91], v12 offset:22528
  ds_read_b128 a[92:95], v12 offset:23552
  v_mfma_f32_16x16x32_bf16 v[116:119], a[136:139], v[56:59], v[116:119]
  v_exp_f32 v41, v41
  v_mfma_f32_16x16x32_bf16 v[236:239], a[140:143], v[56:59], v[236:239]
  v_cvt_pk_bf16_f32 v40, v40, v41
  v_mfma_f32_16x16x32_bf16 v[120:123], a[144:147], v[56:59], v[120:123]
  v_exp_f32 v42, v42
  v_mfma_f32_16x16x32_bf16 v[244:247], a[148:151], v[56:59], v[244:247]
  buffer_load_dwordx4 v28, s[16:19], s78 offen offset:3072 sc1 lds
  v_mfma_f32_16x16x32_bf16 v[124:127], a[152:155], v[56:59], v[124:127]
  v_exp_f32 v43, v43
  v_mfma_f32_16x16x32_bf16 v[252:255], a[156:159], v[56:59], v[252:255]
  v_cvt_pk_bf16_f32 v41, v42, v43
  v_mfma_f32_16x16x32_bf16 a[172:175], a[224:227], v[56:59], a[172:175]
  s_waitcnt lgkmcnt(0)
  v_exp_f32 v44, v44
  v_mfma_f32_16x16x32_bf16 v[48:51], a[64:67], v[192:195], 0
  s_add_u32 s78, s78, 16384
  ds_read_b128 a[128:131], v12 offset:24576
  ds_read_b128 a[132:135], v12 offset:25600
  v_mfma_f32_16x16x32_bf16 v[48:51], a[68:71], v[200:203], v[48:51]
  s_cmp_eq_u32 s78, s62
  v_exp_f32 v45, v45
  v_mfma_f32_16x16x32_bf16 v[48:51], a[72:75], v[208:211], v[48:51]
  s_cmov_b32 s78, s79
  ds_read_b128 a[136:139], v12 offset:26624
  v_cvt_pk_bf16_f32 v42, v44, v45
  v_mfma_f32_16x16x32_bf16 v[48:51], a[76:79], v[216:219], v[48:51]
  s_cmp_eq_u32 s78, s63
  v_exp_f32 v46, v46
  v_mfma_f32_16x16x32_bf16 v[52:55], a[80:83], v[192:195], 0
  s_cmov_b32 s78, s94
  ds_read_b128 a[140:143], v12 offset:27648
  ds_read_b128 a[144:147], v12 offset:28672
  v_mfma_f32_16x16x32_bf16 v[52:55], a[84:87], v[200:203], v[52:55]
  s_mov_b32 m0, s65
  v_exp_f32 v47, v47
  v_mfma_f32_16x16x32_bf16 v[52:55], a[88:91], v[208:211], v[52:55]
  s_add_u32 s65, s65, 16384
  ds_read_b128 a[148:151], v12 offset:29696
  v_cvt_pk_bf16_f32 v43, v46, v47
  v_mfma_f32_16x16x32_bf16 v[52:55], a[92:95], v[216:219], v[52:55]
  buffer_load_dwordx4 v28, s[16:19], s78 offen offset:0 sc1 lds
  v_mfma_f32_16x16x32_bf16 v[56:59], a[64:67], v[224:227], 0
  s_add_u32 s64, s64, 16384
  ds_read_b128 a[152:155], v12 offset:30720
  ds_read_b128 a[156:159], v12 offset:31744
  v_mfma_f32_16x16x32_bf16 v[56:59], a[68:71], v[232:235], v[56:59]
  s_sub_u32 s24, s64, 163840
  v_exp_f32 v48, v48
  v_mfma_f32_16x16x32_bf16 v[56:59], a[72:75], v[240:243], v[56:59]
  buffer_load_dwordx4 v28, s[16:19], s78 offen offset:1024 sc1 lds
  v_mfma_f32_16x16x32_bf16 v[56:59], a[76:79], v[248:251], v[56:59]
  s_min_u32 s64, s64, s24
  v_exp_f32 v49, v49
  v_mfma_f32_16x16x32_bf16 v[60:63], a[80:83], v[224:227], 0
  v_add_u32 v3, s64, v12
  v_cvt_pk_bf16_f32 v48, v48, v49
  v_mfma_f32_16x16x32_bf16 v[60:63], a[84:87], v[232:235], v[60:63]
  s_sub_u32 s25, s65, 163840
  v_exp_f32 v50, v50
  v_mfma_f32_16x16x32_bf16 v[60:63], a[88:91], v[240:243], v[60:63]
  buffer_load_dwordx4 v28, s[16:19], s78 offen offset:2048 sc1 lds
  v_mfma_f32_16x16x32_bf16 v[60:63], a[92:95], v[248:251], v[60:63]
  s_min_u32 s65, s65, s25
  v_exp_f32 v51, v51
  v_mfma_f32_16x16x32_bf16 v[96:99], a[96:99], v[32:35], v[96:99]
  s_waitcnt vmcnt(7) lgkmcnt(0)
  s_barrier
  v_cvt_pk_bf16_f32 v49, v50, v51
  v_mfma_f32_16x16x32_bf16 v[196:199], a[100:103], v[32:35], v[196:199]
  s_add_u32 s26, s93, 65536
  v_exp_f32 v52, v52
  v_mfma_f32_16x16x32_bf16 v[100:103], a[104:107], v[32:35], v[100:103]
  ds_read_b128 a[64:67], v3 offset:0
  ds_read_b128 a[68:71], v3 offset:1024
  v_mfma_f32_16x16x32_bf16 v[204:207], a[108:111], v[32:35], v[204:207]
  v_exp_f32 v53, v53
  v_mfma_f32_16x16x32_bf16 v[104:107], a[112:115], v[32:35], v[104:107]
  ds_read_b128 a[72:75], v3 offset:2048
  v_cvt_pk_bf16_f32 v50, v52, v53
  v_mfma_f32_16x16x32_bf16 v[212:215], a[116:119], v[32:35], v[212:215]
  v_exp_f32 v54, v54
  v_mfma_f32_16x16x32_bf16 v[108:111], a[120:123], v[32:35], v[108:111]
  ds_read_b128 a[76:79], v3 offset:3072
  ds_read_b128 a[80:83], v3 offset:4096
  v_mfma_f32_16x16x32_bf16 v[220:223], a[124:127], v[32:35], v[220:223]
  v_exp_f32 v55, v55
  v_mfma_f32_16x16x32_bf16 a[168:171], a[224:227], v[32:35], a[168:171]
  ds_read_b128 a[84:87], v3 offset:5120
  v_cvt_pk_bf16_f32 v51, v54, v55
  v_mfma_f32_16x16x32_bf16 v[112:115], a[96:99], v[40:43], v[112:115]
  v_exp_f32 v56, v56
  v_mfma_f32_16x16x32_bf16 v[228:231], a[100:103], v[40:43], v[228:231]
  ds_read_b128 a[88:91], v3 offset:6144
  ds_read_b128 a[92:95], v3 offset:7168
  v_mfma_f32_16x16x32_bf16 v[116:119], a[104:107], v[40:43], v[116:119]
  v_exp_f32 v57, v57
  v_mfma_f32_16x16x32_bf16 v[236:239], a[108:111], v[40:43], v[236:239]
  buffer_store_dword v30, v29, s[20:23], s26 offen sc1
  v_cvt_pk_bf16_f32 v56, v56, v57
  v_mfma_f32_16x16x32_bf16 v[120:123], a[112:115], v[40:43], v[120:123]
  v_exp_f32 v58, v58
  v_mfma_f32_16x16x32_bf16 v[244:247], a[116:119], v[40:43], v[244:247]
  buffer_load_dwordx4 v28, s[16:19], s78 offen offset:3072 sc1 lds
  v_mfma_f32_16x16x32_bf16 v[124:127], a[120:123], v[40:43], v[124:127]
  v_exp_f32 v59, v59
  v_mfma_f32_16x16x32_bf16 v[252:255], a[124:127], v[40:43], v[252:255]
  v_cvt_pk_bf16_f32 v57, v58, v59
  v_mfma_f32_16x16x32_bf16 a[172:175], a[224:227], v[40:43], a[172:175]
  s_waitcnt lgkmcnt(0)
  v_exp_f32 v60, v60
  s_branch diag_done
diag1:
  s_waitcnt lgkmcnt(15)
  v_mfma_f32_16x16x32_bf16 v[48:51], a[64:67], v[128:131], 0
  ds_read_b128 a[128:131], v4 offset:8192
  ds_read_b128 a[132:135], v4 offset:9216
  s_waitcnt lgkmcnt(15)
  v_mfma_f32_16x16x32_bf16 v[48:51], a[68:71], v[136:139], v[48:51]
  buffer_store_dwordx4 a[0:3], v12, s[16:19], s101 offen offset:0 sc1
  s_waitcnt lgkmcnt(14)
  v_mfma_f32_16x16x32_bf16 v[48:51], a[72:75], v[144:147], v[48:51]
  ds_read_b128 a[136:139], v4 offset:10240
  s_waitcnt lgkmcnt(14)
  v_mfma_f32_16x16x32_bf16 v[48:51], a[76:79], v[152:155], v[48:51]
  s_waitcnt lgkmcnt(11)
  v_mfma_f32_16x16x32_bf16 v[52:55], a[80:83], v[128:131], 0
  ds_read_b128 a[140:143], v4 offset:11264
  ds_read_b128 a[144:147], v4 offset:12288
  s_waitcnt lgkmcnt(12)
  v_mfma_f32_16x16x32_bf16 v[52:55], a[84:87], v[136:139], v[52:55]
  s_waitcnt lgkmcnt(11)
  v_mfma_f32_16x16x32_bf16 v[52:55], a[88:91], v[144:147], v[52:55]
  ds_read_b128 a[148:151], v4 offset:13312
  s_waitcnt lgkmcnt(11)
  v_mfma_f32_16x16x32_bf16 v[52:55], a[92:95], v[152:155], v[52:55]
  buffer_store_dwordx4 a[8:11], v12, s[16:19], s101 offen offset:1024 sc1
  v_mfma_f32_16x16x32_bf16 v[56:59], a[64:67], v[160:163], 0
  s_add_u32 s29, s101, 4096
  ds_read_b128 a[152:155], v4 offset:14336
  ds_read_b128 a[156:159], v4 offset:15360
  v_mfma_f32_16x16x32_bf16 v[56:59], a[68:71], v[168:171], v[56:59]
  v_exp_f32 v48, v48
  v_mfma_f32_16x16x32_bf16 v[56:59], a[72:75], v[176:179], v[56:59]
  v_mfma_f32_16x16x32_bf16 v[56:59], a[76:79], v[184:187], v[56:59]
  v_exp_f32 v49, v49
  v_mfma_f32_16x16x32_bf16 v[60:63], a[80:83], v[160:163], 0
  v_cvt_pk_bf16_f32 v48, v48, v49
  v_mfma_f32_16x16x32_bf16 v[60:63], a[84:87], v[168:171], v[60:63]
  v_exp_f32 v50, v50
  v_mfma_f32_16x16x32_bf16 v[60:63], a[88:91], v[176:179], v[60:63]
  v_mfma_f32_16x16x32_bf16 v[60:63], a[92:95], v[184:187], v[60:63]
  s_waitcnt lgkmcnt(0)
  v_exp_f32 v51, v51
  s_nop 0
  v_cvt_pk_bf16_f32 v49, v50, v51
  v_exp_f32 v52, v52
  v_exp_f32 v53, v53
  s_nop 0
  v_cvt_pk_bf16_f32 v50, v52, v53
  v_exp_f32 v54, v54
  v_exp_f32 v55, v55
  s_nop 0
  v_cvt_pk_bf16_f32 v51, v54, v55
  v_exp_f32 v56, v56
  v_exp_f32 v57, v57
  s_nop 0
  v_cvt_pk_bf16_f32 v56, v56, v57
  v_exp_f32 v58, v58
  v_exp_f32 v59, v59
  s_nop 0
  v_cvt_pk_bf16_f32 v57, v58, v59
  v_exp_f32 v60, v60
  v_mfma_f32_16x16x32_bf16 v[32:35], a[64:67], v[192:195], 0
  v_mfma_f32_16x16x32_bf16 v[32:35], a[68:71], v[200:203], v[32:35]
  v_exp_f32 v61, v61
  v_mfma_f32_16x16x32_bf16 v[32:35], a[72:75], v[208:211], v[32:35]
  v_cvt_pk_bf16_f32 v58, v60, v61
  v_mfma_f32_16x16x32_bf16 v[32:35], a[76:79], v[216:219], v[32:35]
  v_exp_f32 v62, v62
  v_mfma_f32_16x16x32_bf16 v[36:39], a[80:83], v[192:195], 0
  buffer_store_dwordx4 a[32:35], v12, s[16:19], s29 offen offset:0 sc1
  v_mfma_f32_16x16x32_bf16 v[36:39], a[84:87], v[200:203], v[36:39]
  v_exp_f32 v63, v63
  v_mfma_f32_16x16x32_bf16 v[36:39], a[88:91], v[208:211], v[36:39]
  v_cvt_pk_bf16_f32 v59, v62, v63
  v_mfma_f32_16x16x32_bf16 v[36:39], a[92:95], v[216:219], v[36:39]
  v_mfma_f32_16x16x32_bf16 v[40:43], a[64:67], v[224:227], 0
  v_and_b32 v6, 7, v0
  v_lshlrev_b32 v6, 9, v6
  v_mfma_f32_16x16x32_bf16 v[40:43], a[68:71], v[232:235], v[40:43]
  s_andn2_b32 s26, s93, 0xe00
  v_exp_f32 v32, v32
  v_mfma_f32_16x16x32_bf16 v[40:43], a[72:75], v[240:243], v[40:43]
  v_mfma_f32_16x16x32_bf16 v[40:43], a[76:79], v[248:251], v[40:43]
  s_add_u32 s26, s26, 32768
  v_exp_f32 v33, v33
  v_mfma_f32_16x16x32_bf16 v[44:47], a[80:83], v[224:227], 0
  v_cvt_pk_bf16_f32 v32, v32, v33
  v_mfma_f32_16x16x32_bf16 v[44:47], a[84:87], v[232:235], v[44:47]
  v_exp_f32 v34, v34
  v_mfma_f32_16x16x32_bf16 v[44:47], a[88:91], v[240:243], v[44:47]
  buffer_load_dword v6, v6, s[20:23], s26 offen sc1
  v_mfma_f32_16x16x32_bf16 v[44:47], a[92:95], v[248:251], v[44:47]
  v_exp_f32 v35, v35
  v_mfma_f32_16x16x32_bf16 v[64:67], a[128:131], v[48:51], 0
  v_cvt_pk_bf16_f32 v33, v34, v35
  v_mfma_f32_16x16x32_bf16 v[132:135], a[132:135], v[48:51], 0
  v_exp_f32 v36, v36
  v_mfma_f32_16x16x32_bf16 v[68:71], a[136:139], v[48:51], 0
  ds_read_b128 a[64:67], v4 offset:16384
  ds_read_b128 a[68:71], v4 offset:17408
  v_mfma_f32_16x16x32_bf16 v[140:143], a[140:143], v[48:51], 0
  v_exp_f32 v37, v37
  v_mfma_f32_16x16x32_bf16 v[72:75], a[144:147], v[48:51], 0
  ds_read_b128 a[72:75], v4 offset:18432
  v_cvt_pk_bf16_f32 v34, v36, v37
  v_mfma_f32_16x16x32_bf16 v[148:151], a[148:151], v[48:51], 0
  v_exp_f32 v38, v38
  v_mfma_f32_16x16x32_bf16 v[76:79], a[152:155], v[48:51], 0
  ds_read_b128 a[76:79], v4 offset:19456
  ds_read_b128 a[80:83], v4 offset:20480
  v_mfma_f32_16x16x32_bf16 v[156:159], a[156:159], v[48:51], 0
  buffer_store_dwordx4 a[40:43], v12, s[16:19], s29 offen offset:1024 sc1
  v_exp_f32 v39, v39
  v_mfma_f32_16x16x32_bf16 a[160:163], a[224:227], v[48:51], 0
  s_add_u32 s28, s101, s82
  ds_read_b128 a[84:87], v4 offset:21504
  v_cvt_pk_bf16_f32 v35, v38, v39
  v_mfma_f32_16x16x32_bf16 v[80:83], a[128:131], v[56:59], 0
  v_exp_f32 v40, v40
  v_mfma_f32_16x16x32_bf16 v[164:167], a[132:135], v[56:59], 0
  ds_read_b128 a[88:91], v4 offset:22528
  ds_read_b128 a[92:95], v4 offset:23552
  v_mfma_f32_16x16x32_bf16 v[84:87], a[136:139], v[56:59], 0
  v_exp_f32 v41, v41
  v_mfma_f32_16x16x32_bf16 v[172:175], a[140:143], v[56:59], 0
  v_cvt_pk_bf16_f32 v40, v40, v41
  v_mfma_f32_16x16x32_bf16 v[88:91], a[144:147], v[56:59], 0
  v_exp_f32 v42, v42
  v_mfma_f32_16x16x32_bf16 v[180:183], a[148:151], v[56:59], 0
  buffer_store_dwordx4 a[16:19], v12, s[16:19], s28 offen offset:0 sc1
  v_mfma_f32_16x16x32_bf16 v[92:95], a[152:155], v[56:59], 0
  v_exp_f32 v43, v43
  v_mfma_f32_16x16x32_bf16 v[188:191], a[156:159], v[56:59], 0
  v_cvt_pk_bf16_f32 v41, v42, v43
  v_mfma_f32_16x16x32_bf16 a[164:167], a[224:227], v[56:59], 0
  s_waitcnt lgkmcnt(0)
  v_exp_f32 v44, v44
  v_mfma_f32_16x16x32_bf16 v[48:51], a[64:67], v[192:195], 0
  ds_read_b128 a[96:99], v4 offset:24576
  ds_read_b128 a[100:103], v4 offset:25600
  v_mfma_f32_16x16x32_bf16 v[48:51], a[68:71], v[200:203], v[48:51]
  v_exp_f32 v45, v45
  v_mfma_f32_16x16x32_bf16 v[48:51], a[72:75], v[208:211], v[48:51]
  ds_read_b128 a[104:107], v4 offset:26624
  v_cvt_pk_bf16_f32 v42, v44, v45
  v_mfma_f32_16x16x32_bf16 v[48:51], a[76:79], v[216:219], v[48:51]
  v_exp_f32 v46, v46
  v_mfma_f32_16x16x32_bf16 v[52:55], a[80:83], v[192:195], 0
  ds_read_b128 a[108:111], v4 offset:27648
  ds_read_b128 a[112:115], v4 offset:28672
  v_mfma_f32_16x16x32_bf16 v[52:55], a[84:87], v[200:203], v[52:55]
  v_exp_f32 v47, v47
  v_mfma_f32_16x16x32_bf16 v[52:55], a[88:91], v[208:211], v[52:55]
  ds_read_b128 a[116:119], v4 offset:29696
  v_cvt_pk_bf16_f32 v43, v46, v47
  v_mfma_f32_16x16x32_bf16 v[52:55], a[92:95], v[216:219], v[52:55]
  buffer_store_dwordx4 a[20:23], v12, s[16:19], s28 offen offset:1024 sc1
  v_mfma_f32_16x16x32_bf16 v[56:59], a[64:67], v[224:227], 0
  ds_read_b128 a[120:123], v4 offset:30720
  ds_read_b128 a[124:127], v4 offset:31744
  v_mfma_f32_16x16x32_bf16 v[56:59], a[68:71], v[232:235], v[56:59]
  v_exp_f32 v48, v48
  v_mfma_f32_16x16x32_bf16 v[56:59], a[72:75], v[240:243], v[56:59]
  v_mfma_f32_16x16x32_bf16 v[56:59], a[76:79], v[248:251], v[56:59]
  v_exp_f32 v49, v49
  v_mfma_f32_16x16x32_bf16 v[60:63], a[80:83], v[224:227], 0
  v_cvt_pk_bf16_f32 v48, v48, v49
  v_mfma_f32_16x16x32_bf16 v[60:63], a[84:87], v[232:235], v[60:63]
  v_exp_f32 v50, v50
  v_mfma_f32_16x16x32_bf16 v[60:63], a[88:91], v[240:243], v[60:63]
  v_mfma_f32_16x16x32_bf16 v[60:63], a[92:95], v[248:251], v[60:63]
  v_exp_f32 v51, v51
  v_mfma_f32_16x16x32_bf16 v[96:99], a[128:131], v[32:35], 0
  v_cvt_pk_bf16_f32 v49, v50, v51
  v_mfma_f32_16x16x32_bf16 v[196:199], a[132:135], v[32:35], 0
  v_exp_f32 v52, v52
  v_mfma_f32_16x16x32_bf16 v[100:103], a[136:139], v[32:35], 0
  ds_read_b128 a[64:67], v4 offset:32768
  ds_read_b128 a[68:71], v4 offset:33792
  v_mfma_f32_16x16x32_bf16 v[204:207], a[140:143], v[32:35], 0
  v_exp_f32 v53, v53
  v_mfma_f32_16x16x32_bf16 v[104:107], a[144:147], v[32:35], 0
  ds_read_b128 a[72:75], v4 offset:34816
  v_cvt_pk_bf16_f32 v50, v52, v53
  v_mfma_f32_16x16x32_bf16 v[212:215], a[148:151], v[32:35], 0
  v_exp_f32 v54, v54
  v_mfma_f32_16x16x32_bf16 v[108:111], a[152:155], v[32:35], 0
  ds_read_b128 a[76:79], v4 offset:35840
  ds_read_b128 a[80:83], v4 offset:36864
  v_mfma_f32_16x16x32_bf16 v[220:223], a[156:159], v[32:35], 0
  v_exp_f32 v55, v55
  v_mfma_f32_16x16x32_bf16 a[168:171], a[224:227], v[32:35], 0
  ds_read_b128 a[84:87], v4 offset:37888
  v_cvt_pk_bf16_f32 v51, v54, v55
  v_mfma_f32_16x16x32_bf16 v[112:115], a[128:131], v[40:43], 0
  v_exp_f32 v56, v56
  v_mfma_f32_16x16x32_bf16 v[228:231], a[132:135], v[40:43], 0
  ds_read_b128 a[88:91], v4 offset:38912
  ds_read_b128 a[92:95], v4 offset:39936
  v_mfma_f32_16x16x32_bf16 v[116:119], a[136:139], v[40:43], 0
  buffer_store_dwordx4 a[24:27], v12, s[16:19], s28 offen offset:2048 sc1
  v_exp_f32 v57, v57
  v_mfma_f32_16x16x32_bf16 v[236:239], a[140:143], v[40:43], 0
  v_cvt_pk_bf16_f32 v56, v56, v57
  v_mfma_f32_16x16x32_bf16 v[120:123], a[144:147], v[40:43], 0
  v_exp_f32 v58, v58
  v_mfma_f32_16x16x32_bf16 v[244:247], a[148:151], v[40:43], 0
  s_waitcnt vmcnt(4)
  v_xor_b32 v6, s92, v6
  v_cmp_lt_u32 vcc, 15, v6
  v_mfma_f32_16x16x32_bf16 v[124:127], a[152:155], v[40:43], 0
  v_exp_f32 v59, v59
  v_mfma_f32_16x16x32_bf16 v[252:255], a[156:159], v[40:43], 0
  v_cvt_pk_bf16_f32 v57, v58, v59
  v_mfma_f32_16x16x32_bf16 a[172:175], a[224:227], v[40:43], 0
  s_cbranch_vccnz spin1
spun1:
  s_waitcnt lgkmcnt(0)
  v_exp_f32 v60, v60
  v_mfma_f32_16x16x32_bf16 v[32:35], a[64:67], v[128:131], v[16:19]
  s_mov_b32 s78, 0
  ds_read_b128 a[128:131], v4 offset:40960
  ds_read_b128 a[132:135], v4 offset:41984
  v_mfma_f32_16x16x32_bf16 v[32:35], a[68:71], v[136:139], v[32:35]
  s_cmp_eq_u32 s78, s62
  v_exp_f32 v61, v61
  v_mfma_f32_16x16x32_bf16 v[32:35], a[72:75], v[144:147], v[32:35]
  s_cmov_b32 s78, s79
  ds_read_b128 a[136:139], v4 offset:43008
  v_cvt_pk_bf16_f32 v58, v60, v61
  v_mfma_f32_16x16x32_bf16 v[32:35], a[76:79], v[152:155], v[32:35]
  s_cmp_eq_u32 s78, s63
  v_exp_f32 v62, v62
  v_mfma_f32_16x16x32_bf16 v[36:39], a[80:83], v[128:131], v[20:23]
  s_cmov_b32 s78, s94
  ds_read_b128 a[140:143], v4 offset:44032
  ds_read_b128 a[144:147], v4 offset:45056
  v_mfma_f32_16x16x32_bf16 v[36:39], a[84:87], v[136:139], v[36:39]
  s_mov_b32 m0, s65
  buffer_store_dwordx4 a[28:31], v12, s[16:19], s28 offen offset:3072 sc1
  v_exp_f32 v63, v63
  v_mfma_f32_16x16x32_bf16 v[36:39], a[88:91], v[144:147], v[36:39]
  s_add_u32 s65, s65, 16384
  ds_read_b128 a[148:151], v4 offset:46080
  v_cvt_pk_bf16_f32 v59, v62, v63
  v_mfma_f32_16x16x32_bf16 v[36:39], a[92:95], v[152:155], v[36:39]
  buffer_load_dwordx4 v28, s[16:19], s78 offen offset:0 sc1 lds
  v_mfma_f32_16x16x32_bf16 v[40:43], a[64:67], v[160:163], 0
  ds_read_b128 a[152:155], v4 offset:47104
  ds_read_b128 a[156:159], v4 offset:48128
  v_mfma_f32_16x16x32_bf16 v[40:43], a[68:71], v[168:171], v[40:43]
  v_exp_f32 v32, v32
  v_mfma_f32_16x16x32_bf16 v[40:43], a[72:75], v[176:179], v[40:43]
  buffer_load_dwordx4 v28, s[16:19], s78 offen offset:1024 sc1 lds
  v_mfma_f32_16x16x32_bf16 v[40:43], a[76:79], v[184:187], v[40:43]
  v_exp_f32 v33, v33
  v_mfma_f32_16x16x32_bf16 v[44:47], a[80:83], v[160:163], v[16:19]
  v_cvt_pk_bf16_f32 v32, v32, v33
  v_mfma_f32_16x16x32_bf16 v[44:47], a[84:87], v[168:171], v[44:47]
  s_sub_u32 s25, s65, 163840
  v_exp_f32 v34, v34
  v_mfma_f32_16x16x32_bf16 v[44:47], a[88:91], v[176:179], v[44:47]
  buffer_load_dwordx4 v28, s[16:19], s78 offen offset:2048 sc1 lds
  v_mfma_f32_16x16x32_bf16 v[44:47], a[92:95], v[184:187], v[44:47]
  s_min_u32 s65, s65, s25
  v_exp_f32 v35, v35
  v_mfma_f32_16x16x32_bf16 v[96:99], a[96:99], v[48:51], v[96:99]
  v_cvt_pk_bf16_f32 v33, v34, v35
  v_mfma_f32_16x16x32_bf16 v[196:199], a[100:103], v[48:51], v[196:199]
  v_exp_f32 v36, v36
  v_mfma_f32_16x16x32_bf16 v[100:103], a[104:107], v[48:51], v[100:103]
  v_mfma_f32_16x16x32_bf16 v[204:207], a[108:111], v[48:51], v[204:207]
  v_exp_f32 v37, v37
  v_mfma_f32_16x16x32_bf16 v[104:107], a[112:115], v[48:51], v[104:107]
  v_cvt_pk_bf16_f32 v34, v36, v37
  v_mfma_f32_16x16x32_bf16 v[212:215], a[116:119], v[48:51], v[212:215]
  v_exp_f32 v38, v38
  v_mfma_f32_16x16x32_bf16 v[108:111], a[120:123], v[48:51], v[108:111]
  v_mfma_f32_16x16x32_bf16 v[220:223], a[124:127], v[48:51], v[220:223]
  v_exp_f32 v39, v39
  v_mfma_f32_16x16x32_bf16 a[168:171], a[224:227], v[48:51], a[168:171]
  v_cvt_pk_bf16_f32 v35, v38, v39
  v_mfma_f32_16x16x32_bf16 v[112:115], a[96:99], v[56:59], v[112:115]
  v_exp_f32 v40, v40
  v_mfma_f32_16x16x32_bf16 v[228:231], a[100:103], v[56:59], v[228:231]
  v_mfma_f32_16x16x32_bf16 v[116:119], a[104:107], v[56:59], v[116:119]
  v_exp_f32 v41, v41
  v_mfma_f32_16x16x32_bf16 v[236:239], a[108:111], v[56:59], v[236:239]
  v_cvt_pk_bf16_f32 v40, v40, v41
  v_mfma_f32_16x16x32_bf16 v[120:123], a[112:115], v[56:59], v[120:123]
  v_exp_f32 v42, v42
  v_mfma_f32_16x16x32_bf16 v[244:247], a[116:119], v[56:59], v[244:247]
  buffer_load_dwordx4 v28, s[16:19], s78 offen offset:3072 sc1 lds
  v_mfma_f32_16x16x32_bf16 v[124:127], a[120:123], v[56:59], v[124:127]
  v_exp_f32 v43, v43
  v_mfma_f32_16x16x32_bf16 v[252:255], a[124:127], v[56:59], v[252:255]
  v_cvt_pk_bf16_f32 v41, v42, v43
  v_mfma_f32_16x16x32_bf16 a[172:175], a[224:227], v[56:59], a[172:175]
  s_waitcnt lgkmcnt(0)
  v_exp_f32 v44, v44
  v_mfma_f32_16x16x32_bf16 v[48:51], a[64:67], v[192:195], 0
  s_add_u32 s78, s78, 16384
  v_mfma_f32_16x16x32_bf16 v[48:51], a[68:71], v[200:203], v[48:51]
  s_cmp_eq_u32 s78, s62
  v_exp_f32 v45, v45
  v_mfma_f32_16x16x32_bf16 v[48:51], a[72:75], v[208:211], v[48:51]
  s_cmov_b32 s78, s79
  v_cvt_pk_bf16_f32 v42, v44, v45
  v_mfma_f32_16x16x32_bf16 v[48:51], a[76:79], v[216:219], v[48:51]
  s_cmp_eq_u32 s78, s63
  v_exp_f32 v46, v46
  v_mfma_f32_16x16x32_bf16 v[52:55], a[80:83], v[192:195], 0
  s_cmov_b32 s78, s94
  v_mfma_f32_16x16x32_bf16 v[52:55], a[84:87], v[200:203], v[52:55]
  s_mov_b32 m0, s65
  v_exp_f32 v47, v47
  v_mfma_f32_16x16x32_bf16 v[52:55], a[88:91], v[208:211], v[52:55]
  s_add_u32 s65, s65, 16384
  v_cvt_pk_bf16_f32 v43, v46, v47
  v_mfma_f32_16x16x32_bf16 v[52:55], a[92:95], v[216:219], v[52:55]
  buffer_load_dwordx4 v28, s[16:19], s78 offen offset:0 sc1 lds
  v_mfma_f32_16x16x32_bf16 v[56:59], a[64:67], v[224:227], 0
  v_mfma_f32_16x16x32_bf16 v[56:59], a[68:71], v[232:235], v[56:59]
  v_exp_f32 v48, v48
  v_mfma_f32_16x16x32_bf16 v[56:59], a[72:75], v[240:243], v[56:59]
  buffer_load_dwordx4 v28, s[16:19], s78 offen offset:1024 sc1 lds
  v_mfma_f32_16x16x32_bf16 v[56:59], a[76:79], v[248:251], v[56:59]
  v_exp_f32 v49, v49
  v_mfma_f32_16x16x32_bf16 v[60:63], a[80:83], v[224:227], 0
  v_cvt_pk_bf16_f32 v48, v48, v49
  v_mfma_f32_16x16x32_bf16 v[60:63], a[84:87], v[232:235], v[60:63]
  s_sub_u32 s25, s65, 163840
  v_exp_f32 v50, v50
  v_mfma_f32_16x16x32_bf16 v[60:63], a[88:91], v[240:243], v[60:63]
  buffer_load_dwordx4 v28, s[16:19], s78 offen offset:2048 sc1 lds
  v_mfma_f32_16x16x32_bf16 v[60:63], a[92:95], v[248:251], v[60:63]
  s_min_u32 s65, s65, s25
  v_exp_f32 v51, v51
  v_mfma_f32_16x16x32_bf16 v[64:67], a[128:131], v[32:35], v[64:67]
  s_waitcnt lgkmcnt(0)
  s_barrier
  v_cvt_pk_bf16_f32 v49, v50, v51
  v_mfma_f32_16x16x32_bf16 v[132:135], a[132:135], v[32:35], v[132:135]
  v_exp_f32 v52, v52
  v_mfma_f32_16x16x32_bf16 v[68:71], a[136:139], v[32:35], v[68:71]
  ds_read_b128 a[64:67], v5 offset:0
  ds_read_b128 a[68:71], v5 offset:1024
  v_mfma_f32_16x16x32_bf16 v[140:143], a[140:143], v[32:35], v[140:143]
  v_exp_f32 v53, v53
  v_mfma_f32_16x16x32_bf16 v[72:75], a[144:147], v[32:35], v[72:75]
  ds_read_b128 a[72:75], v5 offset:2048
  v_cvt_pk_bf16_f32 v50, v52, v53
  v_mfma_f32_16x16x32_bf16 v[148:151], a[148:151], v[32:35], v[148:151]
  v_exp_f32 v54, v54
  v_mfma_f32_16x16x32_bf16 v[76:79], a[152:155], v[32:35], v[76:79]
  ds_read_b128 a[76:79], v5 offset:3072
  ds_read_b128 a[80:83], v5 offset:4096
  v_mfma_f32_16x16x32_bf16 v[156:159], a[156:159], v[32:35], v[156:159]
  v_exp_f32 v55, v55
  v_mfma_f32_16x16x32_bf16 a[160:163], a[224:227], v[32:35], a[160:163]
  ds_read_b128 a[84:87], v5 offset:5120
  v_cvt_pk_bf16_f32 v51, v54, v55
  v_mfma_f32_16x16x32_bf16 v[80:83], a[128:131], v[40:43], v[80:83]
  v_exp_f32 v56, v56
  v_mfma_f32_16x16x32_bf16 v[164:167], a[132:135], v[40:43], v[164:167]
  ds_read_b128 a[88:91], v5 offset:6144
  ds_read_b128 a[92:95], v5 offset:7168
  v_mfma_f32_16x16x32_bf16 v[84:87], a[136:139], v[40:43], v[84:87]
  v_exp_f32 v57, v57
  v_mfma_f32_16x16x32_bf16 v[172:175], a[140:143], v[40:43], v[172:175]
  v_cvt_pk_bf16_f32 v56, v56, v57
  v_mfma_f32_16x16x32_bf16 v[88:91], a[144:147], v[40:43], v[88:91]
  v_exp_f32 v58, v58
  v_mfma_f32_16x16x32_bf16 v[180:183], a[148:151], v[40:43], v[180:183]
  buffer_load_dwordx4 v28, s[16:19], s78 offen offset:3072 sc1 lds
  v_mfma_f32_16x16x32_bf16 v[92:95], a[152:155], v[40:43], v[92:95]
  v_exp_f32 v59, v59
  v_mfma_f32_16x16x32_bf16 v[188:191], a[156:159], v[40:43], v[188:191]
  v_cvt_pk_bf16_f32 v57, v58, v59
  v_mfma_f32_16x16x32_bf16 a[164:167], a[224:227], v[40:43], a[164:167]
  s_waitcnt lgkmcnt(0)
  v_exp_f32 v60, v60
  v_mfma_f32_16x16x32_bf16 v[32:35], a[64:67], v[192:195], v[16:19]
  s_add_u32 s78, s78, 16384
  ds_read_b128 a[96:99], v5 offset:8192
  ds_read_b128 a[100:103], v5 offset:9216
  v_mfma_f32_16x16x32_bf16 v[32:35], a[68:71], v[200:203], v[32:35]
  s_cmp_eq_u32 s78, s62
  v_exp_f32 v61, v61
  v_mfma_f32_16x16x32_bf16 v[32:35], a[72:75], v[208:211], v[32:35]
  s_cmov_b32 s78, s79
  ds_read_b128 a[104:107], v5 offset:10240
  v_cvt_pk_bf16_f32 v58, v60, v61
  v_mfma_f32_16x16x32_bf16 v[32:35], a[76:79], v[216:219], v[32:35]
  s_cmp_eq_u32 s78, s63
  v_exp_f32 v62, v62
  v_mfma_f32_16x16x32_bf16 v[36:39], a[80:83], v[192:195], v[20:23]
  s_cmov_b32 s78, s94
  ds_read_b128 a[108:111], v5 offset:11264
  ds_read_b128 a[112:115], v5 offset:12288
  v_mfma_f32_16x16x32_bf16 v[36:39], a[84:87], v[200:203], v[36:39]
  s_mov_b32 m0, s65
  v_exp_f32 v63, v63
  v_mfma_f32_16x16x32_bf16 v[36:39], a[88:91], v[208:211], v[36:39]
  s_add_u32 s65, s65, 16384
  ds_read_b128 a[116:119], v5 offset:13312
  v_cvt_pk_bf16_f32 v59, v62, v63
  v_mfma_f32_16x16x32_bf16 v[36:39], a[92:95], v[216:219], v[36:39]
  buffer_load_dwordx4 v28, s[16:19], s78 offen offset:0 sc1 lds
  v_mfma_f32_16x16x32_bf16 v[40:43], a[64:67], v[224:227], 0
  ds_read_b128 a[120:123], v5 offset:14336
  ds_read_b128 a[124:127], v5 offset:15360
  v_mfma_f32_16x16x32_bf16 v[40:43], a[68:71], v[232:235], v[40:43]
  v_exp_f32 v32, v32
  v_mfma_f32_16x16x32_bf16 v[40:43], a[72:75], v[240:243], v[40:43]
  buffer_load_dwordx4 v28, s[16:19], s78 offen offset:1024 sc1 lds
  v_mfma_f32_16x16x32_bf16 v[40:43], a[76:79], v[248:251], v[40:43]
  v_exp_f32 v33, v33
  v_mfma_f32_16x16x32_bf16 v[44:47], a[80:83], v[224:227], v[16:19]
  v_cvt_pk_bf16_f32 v32, v32, v33
  v_mfma_f32_16x16x32_bf16 v[44:47], a[84:87], v[232:235], v[44:47]
  s_sub_u32 s25, s65, 163840
  v_exp_f32 v34, v34
  v_mfma_f32_16x16x32_bf16 v[44:47], a[88:91], v[240:243], v[44:47]
  buffer_load_dwordx4 v28, s[16:19], s78 offen offset:2048 sc1 lds
  v_mfma_f32_16x16x32_bf16 v[44:47], a[92:95], v[248:251], v[44:47]
  s_min_u32 s65, s65, s25
  v_exp_f32 v35, v35
  v_mfma_f32_16x16x32_bf16 v[96:99], a[128:131], v[48:51], v[96:99]
  v_cvt_pk_bf16_f32 v33, v34, v35
  v_mfma_f32_16x16x32_bf16 v[196:199], a[132:135], v[48:51], v[196:199]
  v_exp_f32 v36, v36
  v_mfma_f32_16x16x32_bf16 v[100:103], a[136:139], v[48:51], v[100:103]
  ds_read_b128 a[64:67], v12 offset:0
  ds_read_b128 a[68:71], v12 offset:1024
  v_mfma_f32_16x16x32_bf16 v[204:207], a[140:143], v[48:51], v[204:207]
  v_exp_f32 v37, v37
  v_mfma_f32_16x16x32_bf16 v[104:107], a[144:147], v[48:51], v[104:107]
  ds_read_b128 a[72:75], v12 offset:2048
  v_cvt_pk_bf16_f32 v34, v36, v37
  v_mfma_f32_16x16x32_bf16 v[212:215], a[148:151], v[48:51], v[212:215]
  v_exp_f32 v38, v38
  v_mfma_f32_16x16x32_bf16 v[108:111], a[152:155], v[48:51], v[108:111]
  ds_read_b128 a[76:79], v12 offset:3072
  ds_read_b128 a[80:83], v12 offset:4096
  v_mfma_f32_16x16x32_bf16 v[220:223], a[156:159], v[48:51], v[220:223]
  v_exp_f32 v39, v39
  v_mfma_f32_16x16x32_bf16 a[168:171], a[224:227], v[48:51], a[168:171]
  ds_read_b128 a[84:87], v12 offset:5120
  v_cvt_pk_bf16_f32 v35, v38, v39
  v_mfma_f32_16x16x32_bf16 v[112:115], a[128:131], v[56:59], v[112:115]
  v_exp_f32 v40, v40
  v_mfma_f32_16x16x32_bf16 v[228:231], a[132:135], v[56:59], v[228:231]
  ds_read_b128 a[88:91], v12 offset:6144
  ds_read_b128 a[92:95], v12 offset:7168
  v_mfma_f32_16x16x32_bf16 v[116:119], a[136:139], v[56:59], v[116:119]
  v_exp_f32 v41, v41
  v_mfma_f32_16x16x32_bf16 v[236:239], a[140:143], v[56:59], v[236:239]
  v_cvt_pk_bf16_f32 v40, v40, v41
  v_mfma_f32_16x16x32_bf16 v[120:123], a[144:147], v[56:59], v[120:123]
  v_exp_f32 v42, v42
  v_mfma_f32_16x16x32_bf16 v[244:247], a[148:151], v[56:59], v[244:247]
  buffer_load_dwordx4 v28, s[16:19], s78 offen offset:3072 sc1 lds
  v_mfma_f32_16x16x32_bf16 v[124:127], a[152:155], v[56:59], v[124:127]
  v_exp_f32 v43, v43
  v_mfma_f32_16x16x32_bf16 v[252:255], a[156:159], v[56:59], v[252:255]
  v_cvt_pk_bf16_f32 v41, v42, v43
  v_mfma_f32_16x16x32_bf16 a[172:175], a[224:227], v[56:59], a[172:175]
  s_waitcnt lgkmcnt(0)
  v_exp_f32 v44, v44
  v_mfma_f32_16x16x32_bf16 v[48:51], a[64:67], v[192:195], 0
  s_add_u32 s78, s78, 16384
  ds_read_b128 a[128:131], v12 offset:8192
  ds_read_b128 a[132:135], v12 offset:9216
  v_mfma_f32_16x16x32_bf16 v[48:51], a[68:71], v[200:203], v[48:51]
  s_cmp_eq_u32 s78, s62
  v_exp_f32 v45, v45
  v_mfma_f32_16x16x32_bf16 v[48:51], a[72:75], v[208:211], v[48:51]
  s_cmov_b32 s78, s79
  ds_read_b128 a[136:139], v12 offset:10240
  v_cvt_pk_bf16_f32 v42, v44, v45
  v_mfma_f32_16x16x32_bf16 v[48:51], a[76:79], v[216:219], v[48:51]
  s_cmp_eq_u32 s78, s63
  v_exp_f32 v46, v46
  v_mfma_f32_16x16x32_bf16 v[52:55], a[80:83], v[192:195], 0
  s_cmov_b32 s78, s94
  ds_read_b128 a[140:143], v12 offset:11264
  ds_read_b128 a[144:147], v12 offset:12288
  v_mfma_f32_16x16x32_bf16 v[52:55], a[84:87], v[200:203], v[52:55]
  s_mov_b32 m0, s65
  v_exp_f32 v47, v47
  v_mfma_f32_16x16x32_bf16 v[52:55], a[88:91], v[208:211], v[52:55]
  s_add_u32 s65, s65, 16384
  ds_read_b128 a[148:151], v12 offset:13312
  v_cvt_pk_bf16_f32 v43, v46, v47
  v_mfma_f32_16x16x32_bf16 v[52:55], a[92:95], v[216:219], v[52:55]
  buffer_load_dwordx4 v28, s[16:19], s78 offen offset:0 sc1 lds
  v_mfma_f32_16x16x32_bf16 v[56:59], a[64:67], v[224:227], 0
  ds_read_b128 a[152:155], v12 offset:14336
  ds_read_b128 a[156:159], v12 offset:15360
  v_mfma_f32_16x16x32_bf16 v[56:59], a[68:71], v[232:235], v[56:59]
  v_exp_f32 v48, v48
  v_mfma_f32_16x16x32_bf16 v[56:59], a[72:75], v[240:243], v[56:59]
  buffer_load_dwordx4 v28, s[16:19], s78 offen offset:1024 sc1 lds
  v_mfma_f32_16x16x32_bf16 v[56:59], a[76:79], v[248:251], v[56:59]
  v_exp_f32 v49, v49
  v_mfma_f32_16x16x32_bf16 v[60:63], a[80:83], v[224:227], 0
  v_cvt_pk_bf16_f32 v48, v48, v49
  v_mfma_f32_16x16x32_bf16 v[60:63], a[84:87], v[232:235], v[60:63]
  s_sub_u32 s25, s65, 163840
  v_exp_f32 v50, v50
  v_mfma_f32_16x16x32_bf16 v[60:63], a[88:91], v[240:243], v[60:63]
  buffer_load_dwordx4 v28, s[16:19], s78 offen offset:2048 sc1 lds
  v_mfma_f32_16x16x32_bf16 v[60:63], a[92:95], v[248:251], v[60:63]
  s_min_u32 s65, s65, s25
  v_exp_f32 v51, v51
  v_mfma_f32_16x16x32_bf16 v[96:99], a[96:99], v[32:35], v[96:99]
  v_cvt_pk_bf16_f32 v49, v50, v51
  v_mfma_f32_16x16x32_bf16 v[196:199], a[100:103], v[32:35], v[196:199]
  s_mov_b32 s26, 60293120
  v_exp_f32 v52, v52
  v_mfma_f32_16x16x32_bf16 v[100:103], a[104:107], v[32:35], v[100:103]
  ds_read_b128 a[64:67], v5 offset:16384
  ds_read_b128 a[68:71], v5 offset:17408
  v_mfma_f32_16x16x32_bf16 v[204:207], a[108:111], v[32:35], v[204:207]
  v_exp_f32 v53, v53
  v_mfma_f32_16x16x32_bf16 v[104:107], a[112:115], v[32:35], v[104:107]
  ds_read_b128 a[72:75], v5 offset:18432
  v_cvt_pk_bf16_f32 v50, v52, v53
  v_mfma_f32_16x16x32_bf16 v[212:215], a[116:119], v[32:35], v[212:215]
  v_exp_f32 v54, v54
  v_mfma_f32_16x16x32_bf16 v[108:111], a[120:123], v[32:35], v[108:111]
  ds_read_b128 a[76:79], v5 offset:19456
  ds_read_b128 a[80:83], v5 offset:20480
  v_mfma_f32_16x16x32_bf16 v[220:223], a[124:127], v[32:35], v[220:223]
  v_exp_f32 v55, v55
  v_mfma_f32_16x16x32_bf16 a[168:171], a[224:227], v[32:35], a[168:171]
  ds_read_b128 a[84:87], v5 offset:21504
  v_cvt_pk_bf16_f32 v51, v54, v55
  v_mfma_f32_16x16x32_bf16 v[112:115], a[96:99], v[40:43], v[112:115]
  v_exp_f32 v56, v56
  v_mfma_f32_16x16x32_bf16 v[228:231], a[100:103], v[40:43], v[228:231]
  ds_read_b128 a[88:91], v5 offset:22528
  ds_read_b128 a[92:95], v5 offset:23552
  v_mfma_f32_16x16x32_bf16 v[116:119], a[104:107], v[40:43], v[116:119]
  v_exp_f32 v57, v57
  v_mfma_f32_16x16x32_bf16 v[236:239], a[108:111], v[40:43], v[236:239]
  buffer_load_dword v6, v14, s[20:23], s26 offen sc1
  v_cvt_pk_bf16_f32 v56, v56, v57
  v_mfma_f32_16x16x32_bf16 v[120:123], a[112:115], v[40:43], v[120:123]
  v_exp_f32 v58, v58
  v_mfma_f32_16x16x32_bf16 v[244:247], a[116:119], v[40:43], v[244:247]
  buffer_load_dwordx4 v28, s[16:19], s78 offen offset:3072 sc1 lds
  v_mfma_f32_16x16x32_bf16 v[124:127], a[120:123], v[40:43], v[124:127]
  v_exp_f32 v59, v59
  v_mfma_f32_16x16x32_bf16 v[252:255], a[124:127], v[40:43], v[252:255]
  v_cvt_pk_bf16_f32 v57, v58, v59
  v_mfma_f32_16x16x32_bf16 a[172:175], a[224:227], v[40:43], a[172:175]
  s_waitcnt lgkmcnt(0)
  v_exp_f32 v60, v60
  v_mfma_f32_16x16x32_bf16 v[32:35], a[64:67], v[192:195], 0
  s_add_u32 s78, s78, 16384
  ds_read_b128 a[96:99], v5 offset:24576
  ds_read_b128 a[100:103], v5 offset:25600
  v_mfma_f32_16x16x32_bf16 v[32:35], a[68:71], v[200:203], v[32:35]
  s_cmp_eq_u32 s78, s62
  v_exp_f32 v61, v61
  v_mfma_f32_16x16x32_bf16 v[32:35], a[72:75], v[208:211], v[32:35]
  s_cmov_b32 s78, s79
  ds_read_b128 a[104:107], v5 offset:26624
  v_cvt_pk_bf16_f32 v58, v60, v61
  v_mfma_f32_16x16x32_bf16 v[32:35], a[76:79], v[216:219], v[32:35]
  s_cmp_eq_u32 s78, s63
  v_exp_f32 v62, v62
  v_mfma_f32_16x16x32_bf16 v[36:39], a[80:83], v[192:195], 0
  s_cmov_b32 s78, s94
  ds_read_b128 a[108:111], v5 offset:27648
  ds_read_b128 a[112:115], v5 offset:28672
  v_mfma_f32_16x16x32_bf16 v[36:39], a[84:87], v[200:203], v[36:39]
  s_mov_b32 m0, s65
  v_exp_f32 v63, v63
  v_mfma_f32_16x16x32_bf16 v[36:39], a[88:91], v[208:211], v[36:39]
  s_add_u32 s65, s65, 16384
  ds_read_b128 a[116:119], v5 offset:29696
  v_cvt_pk_bf16_f32 v59, v62, v63
  v_mfma_f32_16x16x32_bf16 v[36:39], a[92:95], v[216:219], v[36:39]
  buffer_load_dwordx4 v28, s[16:19], s78 offen offset:0 sc1 lds
  v_mfma_f32_16x16x32_bf16 v[40:43], a[64:67], v[224:227], 0
  ds_read_b128 a[120:123], v5 offset:30720
  ds_read_b128 a[124:127], v5 offset:31744
  v_mfma_f32_16x16x32_bf16 v[40:43], a[68:71], v[232:235], v[40:43]
  v_exp_f32 v32, v32
  v_mfma_f32_16x16x32_bf16 v[40:43], a[72:75], v[240:243], v[40:43]
  buffer_load_dwordx4 v28, s[16:19], s78 offen offset:1024 sc1 lds
  v_mfma_f32_16x16x32_bf16 v[40:43], a[76:79], v[248:251], v[40:43]
  v_exp_f32 v33, v33
  v_mfma_f32_16x16x32_bf16 v[44:47], a[80:83], v[224:227], 0
  v_cvt_pk_bf16_f32 v32, v32, v33
  v_mfma_f32_16x16x32_bf16 v[44:47], a[84:87], v[232:235], v[44:47]
  s_sub_u32 s25, s65, 163840
  v_exp_f32 v34, v34
  v_mfma_f32_16x16x32_bf16 v[44:47], a[88:91], v[240:243], v[44:47]
  buffer_load_dwordx4 v28, s[16:19], s78 offen offset:2048 sc1 lds
  v_mfma_f32_16x16x32_bf16 v[44:47], a[92:95], v[248:251], v[44:47]
  s_min_u32 s65, s65, s25
  v_exp_f32 v35, v35
  v_mfma_f32_16x16x32_bf16 v[96:99], a[128:131], v[48:51], v[96:99]
  v_cvt_pk_bf16_f32 v33, v34, v35
  v_mfma_f32_16x16x32_bf16 v[196:199], a[132:135], v[48:51], v[196:199]
  v_exp_f32 v36, v36
  v_mfma_f32_16x16x32_bf16 v[100:103], a[136:139], v[48:51], v[100:103]
  ds_read_b128 a[64:67], v12 offset:16384
  ds_read_b128 a[68:71], v12 offset:17408
  v_mfma_f32_16x16x32_bf16 v[204:207], a[140:143], v[48:51], v[204:207]
  v_exp_f32 v37, v37
  v_mfma_f32_16x16x32_bf16 v[104:107], a[144:147], v[48:51], v[104:107]
  ds_read_b128 a[72:75], v12 offset:18432
  v_cvt_pk_bf16_f32 v34, v36, v37
  v_mfma_f32_16x16x32_bf16 v[212:215], a[148:151], v[48:51], v[212:215]
  v_exp_f32 v38, v38
  v_mfma_f32_16x16x32_bf16 v[108:111], a[152:155], v[48:51], v[108:111]
  ds_read_b128 a[76:79], v12 offset:19456
  ds_read_b128 a[80:83], v12 offset:20480
  v_mfma_f32_16x16x32_bf16 v[220:223], a[156:159], v[48:51], v[220:223]
  v_exp_f32 v39, v39
  v_mfma_f32_16x16x32_bf16 a[168:171], a[224:227], v[48:51], a[168:171]
  ds_read_b128 a[84:87], v12 offset:21504
  v_cvt_pk_bf16_f32 v35, v38, v39
  v_mfma_f32_16x16x32_bf16 v[112:115], a[128:131], v[56:59], v[112:115]
  v_exp_f32 v40, v40
  v_mfma_f32_16x16x32_bf16 v[228:231], a[132:135], v[56:59], v[228:231]
  ds_read_b128 a[88:91], v12 offset:22528
  ds_read_b128 a[92:95], v12 offset:23552
  v_mfma_f32_16x16x32_bf16 v[116:119], a[136:139], v[56:59], v[116:119]
  v_exp_f32 v41, v41
  v_mfma_f32_16x16x32_bf16 v[236:239], a[140:143], v[56:59], v[236:239]
  v_cvt_pk_bf16_f32 v40, v40, v41
  v_mfma_f32_16x16x32_bf16 v[120:123], a[144:147], v[56:59], v[120:123]
  v_exp_f32 v42, v42
  v_mfma_f32_16x16x32_bf16 v[244:247], a[148:151], v[56:59], v[244:247]
  buffer_load_dwordx4 v28, s[16:19], s78 offen offset:3072 sc1 lds
  v_mfma_f32_16x16x32_bf16 v[124:127], a[152:155], v[56:59], v[124:127]
  v_exp_f32 v43, v43
  v_mfma_f32_16x16x32_bf16 v[252:255], a[156:159], v[56:59], v[252:255]
  v_cvt_pk_bf16_f32 v41, v42, v43
  v_mfma_f32_16x16x32_bf16 a[172:175], a[224:227], v[56:59], a[172:175]
  s_waitcnt lgkmcnt(0)
  v_exp_f32 v44, v44
  v_mfma_f32_16x16x32_bf16 v[48:51], a[64:67], v[192:195], 0
  s_add_u32 s78, s78, 16384
  ds_read_b128 a[128:131], v12 offset:24576
  ds_read_b128 a[132:135], v12 offset:25600
  v_mfma_f32_16x16x32_bf16 v[48:51], a[68:71], v[200:203], v[48:51]
  s_cmp_eq_u32 s78, s62
  v_exp_f32 v45, v45
  v_mfma_f32_16x16x32_bf16 v[48:51], a[72:75], v[208:211], v[48:51]
  s_cmov_b32 s78, s79
  ds_read_b128 a[136:139], v12 offset:26624
  v_cvt_pk_bf16_f32 v42, v44, v45
  v_mfma_f32_16x16x32_bf16 v[48:51], a[76:79], v[216:219], v[48:51]
  s_cmp_eq_u32 s78, s63
  v_exp_f32 v46, v46
  v_mfma_f32_16x16x32_bf16 v[52:55], a[80:83], v[192:195], 0
  s_cmov_b32 s78, s94
  ds_read_b128 a[140:143], v12 offset:27648
  ds_read_b128 a[144:147], v12 offset:28672
  v_mfma_f32_16x16x32_bf16 v[52:55], a[84:87], v[200:203], v[52:55]
  s_mov_b32 m0, s65
  v_exp_f32 v47, v47
  v_mfma_f32_16x16x32_bf16 v[52:55], a[88:91], v[208:211], v[52:55]
  s_add_u32 s65, s65, 16384
  ds_read_b128 a[148:151], v12 offset:29696
  v_cvt_pk_bf16_f32 v43, v46, v47
  v_mfma_f32_16x16x32_bf16 v[52:55], a[92:95], v[216:219], v[52:55]
  buffer_load_dwordx4 v28, s[16:19], s78 offen offset:0 sc1 lds
  v_mfma_f32_16x16x32_bf16 v[56:59], a[64:67], v[224:227], 0
  s_add_u32 s64, s64, 16384
  ds_read_b128 a[152:155], v12 offset:30720
  ds_read_b128 a[156:159], v12 offset:31744
  v_mfma_f32_16x16x32_bf16 v[56:59], a[68:71], v[232:235], v[56:59]
  s_sub_u32 s24, s64, 163840
  v_exp_f32 v48, v48
  v_mfma_f32_16x16x32_bf16 v[56:59], a[72:75], v[240:243], v[56:59]
  buffer_load_dwordx4 v28, s[16:19], s78 offen offset:1024 sc1 lds
  v_mfma_f32_16x16x32_bf16 v[56:59], a[76:79], v[248:251], v[56:59]
  s_min_u32 s64, s64, s24
  v_exp_f32 v49, v49
  v_mfma_f32_16x16x32_bf16 v[60:63], a[80:83], v[224:227], 0
  v_add_u32 v3, s64, v12
  v_cvt_pk_bf16_f32 v48, v48, v49
  v_mfma_f32_16x16x32_bf16 v[60:63], a[84:87], v[232:235], v[60:63]
  s_sub_u32 s25, s65, 163840
  v_exp_f32 v50, v50
  v_mfma_f32_16x16x32_bf16 v[60:63], a[88:91], v[240:243], v[60:63]
  buffer_load_dwordx4 v28, s[16:19], s78 offen offset:2048 sc1 lds
  v_mfma_f32_16x16x32_bf16 v[60:63], a[92:95], v[248:251], v[60:63]
  s_min_u32 s65, s65, s25
  v_exp_f32 v51, v51
  v_mfma_f32_16x16x32_bf16 v[96:99], a[96:99], v[32:35], v[96:99]
  s_waitcnt vmcnt(7) lgkmcnt(0)
  s_barrier
  v_cvt_pk_bf16_f32 v49, v50, v51
  v_mfma_f32_16x16x32_bf16 v[196:199], a[100:103], v[32:35], v[196:199]
  s_add_u32 s26, s93, 65536
  v_exp_f32 v52, v52
  v_mfma_f32_16x16x32_bf16 v[100:103], a[104:107], v[32:35], v[100:103]
  ds_read_b128 a[64:67], v3 offset:0
  ds_read_b128 a[68:71], v3 offset:1024
  v_mfma_f32_16x16x32_bf16 v[204:207], a[108:111], v[32:35], v[204:207]
  v_exp_f32 v53, v53
  v_mfma_f32_16x16x32_bf16 v[104:107], a[112:115], v[32:35], v[104:107]
  ds_read_b128 a[72:75], v3 offset:2048
  v_cvt_pk_bf16_f32 v50, v52, v53
  v_mfma_f32_16x16x32_bf16 v[212:215], a[116:119], v[32:35], v[212:215]
  v_exp_f32 v54, v54
  v_mfma_f32_16x16x32_bf16 v[108:111], a[120:123], v[32:35], v[108:111]
  ds_read_b128 a[76:79], v3 offset:3072
  ds_read_b128 a[80:83], v3 offset:4096
  v_mfma_f32_16x16x32_bf16 v[220:223], a[124:127], v[32:35], v[220:223]
  v_exp_f32 v55, v55
  v_mfma_f32_16x16x32_bf16 a[168:171], a[224:227], v[32:35], a[168:171]
  ds_read_b128 a[84:87], v3 offset:5120
  v_cvt_pk_bf16_f32 v51, v54, v55
  v_mfma_f32_16x16x32_bf16 v[112:115], a[96:99], v[40:43], v[112:115]
  v_exp_f32 v56, v56
  v_mfma_f32_16x16x32_bf16 v[228:231], a[100:103], v[40:43], v[228:231]
  ds_read_b128 a[88:91], v3 offset:6144
  ds_read_b128 a[92:95], v3 offset:7168
  v_mfma_f32_16x16x32_bf16 v[116:119], a[104:107], v[40:43], v[116:119]
  v_exp_f32 v57, v57
  v_mfma_f32_16x16x32_bf16 v[236:239], a[108:111], v[40:43], v[236:239]
  buffer_store_dword v30, v29, s[20:23], s26 offen sc1
  v_cvt_pk_bf16_f32 v56, v56, v57
  v_mfma_f32_16x16x32_bf16 v[120:123], a[112:115], v[40:43], v[120:123]
  v_exp_f32 v58, v58
  v_mfma_f32_16x16x32_bf16 v[244:247], a[116:119], v[40:43], v[244:247]
  buffer_load_dwordx4 v28, s[16:19], s78 offen offset:3072 sc1 lds
  v_mfma_f32_16x16x32_bf16 v[124:127], a[120:123], v[40:43], v[124:127]
  v_exp_f32 v59, v59
  v_mfma_f32_16x16x32_bf16 v[252:255], a[124:127], v[40:43], v[252:255]
  v_cvt_pk_bf16_f32 v57, v58, v59
  v_mfma_f32_16x16x32_bf16 a[172:175], a[224:227], v[40:43], a[172:175]
  s_waitcnt lgkmcnt(0)
  v_exp_f32 v60, v60
  s_branch diag_done
diag2:
  s_waitcnt lgkmcnt(15)
  v_mfma_f32_16x16x32_bf16 v[48:51], a[64:67], v[128:131], 0
  ds_read_b128 a[96:99], v4 offset:8192
  ds_read_b128 a[100:103], v4 offset:9216
  s_waitcnt lgkmcnt(15)
  v_mfma_f32_16x16x32_bf16 v[48:51], a[68:71], v[136:139], v[48:51]
  buffer_store_dwordx4 a[0:3], v12, s[16:19], s101 offen offset:0 sc1
  s_waitcnt lgkmcnt(14)
  v_mfma_f32_16x16x32_bf16 v[48:51], a[72:75], v[144:147], v[48:51]
  ds_read_b128 a[104:107], v4 offset:10240
  s_waitcnt lgkmcnt(14)
  v_mfma_f32_16x16x32_bf16 v[48:51], a[76:79], v[152:155], v[48:51]
  s_waitcnt lgkmcnt(11)
  v_mfma_f32_16x16x32_bf16 v[52:55], a[80:83], v[128:131], 0
  ds_read_b128 a[108:111], v4 offset:11264
  ds_read_b128 a[112:115], v4 offset:12288
  s_waitcnt lgkmcnt(12)
  v_mfma_f32_16x16x32_bf16 v[52:55], a[84:87], v[136:139], v[52:55]
  s_waitcnt lgkmcnt(11)
  v_mfma_f32_16x16x32_bf16 v[52:55], a[88:91], v[144:147], v[52:55]
  ds_read_b128 a[116:119], v4 offset:13312
  s_waitcnt lgkmcnt(11)
  v_mfma_f32_16x16x32_bf16 v[52:55], a[92:95], v[152:155], v[52:55]
  buffer_store_dwordx4 a[8:11], v12, s[16:19], s101 offen offset:1024 sc1
  v_mfma_f32_16x16x32_bf16 v[56:59], a[64:67], v[160:163], 0
  s_add_u32 s29, s101, 4096
  ds_read_b128 a[120:123], v4 offset:14336
  ds_read_b128 a[124:127], v4 offset:15360
  v_mfma_f32_16x16x32_bf16 v[56:59], a[68:71], v[168:171], v[56:59]
  v_exp_f32 v48, v48
  v_mfma_f32_16x16x32_bf16 v[56:59], a[72:75], v[176:179], v[56:59]
  v_mfma_f32_16x16x32_bf16 v[56:59], a[76:79], v[184:187], v[56:59]
  v_exp_f32 v49, v49
  v_mfma_f32_16x16x32_bf16 v[60:63], a[80:83], v[160:163], 0
  v_cvt_pk_bf16_f32 v48, v48, v49
  v_mfma_f32_16x16x32_bf16 v[60:63], a[84:87], v[168:171], v[60:63]
  v_exp_f32 v50, v50
  v_mfma_f32_16x16x32_bf16 v[60:63], a[88:91], v[176:179], v[60:63]
  v_mfma_f32_16x16x32_bf16 v[60:63], a[92:95], v[184:187], v[60:63]
  s_waitcnt lgkmcnt(0)
  v_exp_f32 v51, v51
  s_nop 0
  v_cvt_pk_bf16_f32 v49, v50, v51
  v_exp_f32 v52, v52
  v_exp_f32 v53, v53
  s_nop 0
  v_cvt_pk_bf16_f32 v50, v52, v53
  v_exp_f32 v54, v54
  v_exp_f32 v55, v55
  s_nop 0
  v_cvt_pk_bf16_f32 v51, v54, v55
  v_exp_f32 v56, v56
  v_exp_f32 v57, v57
  s_nop 0
  v_cvt_pk_bf16_f32 v56, v56, v57
  v_exp_f32 v58, v58
  v_exp_f32 v59, v59
  s_nop 0
  v_cvt_pk_bf16_f32 v57, v58, v59
  v_exp_f32 v60, v60
  v_mfma_f32_16x16x32_bf16 v[32:35], a[64:67], v[192:195], 0
  v_mfma_f32_16x16x32_bf16 v[32:35], a[68:71], v[200:203], v[32:35]
  v_exp_f32 v61, v61
  v_mfma_f32_16x16x32_bf16 v[32:35], a[72:75], v[208:211], v[32:35]
  v_cvt_pk_bf16_f32 v58, v60, v61
  v_mfma_f32_16x16x32_bf16 v[32:35], a[76:79], v[216:219], v[32:35]
  v_exp_f32 v62, v62
  v_mfma_f32_16x16x32_bf16 v[36:39], a[80:83], v[192:195], 0
  buffer_store_dwordx4 a[32:35], v12, s[16:19], s29 offen offset:0 sc1
  v_mfma_f32_16x16x32_bf16 v[36:39], a[84:87], v[200:203], v[36:39]
  v_exp_f32 v63, v63
  v_mfma_f32_16x16x32_bf16 v[36:39], a[88:91], v[208:211], v[36:39]
  v_cvt_pk_bf16_f32 v59, v62, v63
  v_mfma_f32_16x16x32_bf16 v[36:39], a[92:95], v[216:219], v[36:39]
  v_mfma_f32_16x16x32_bf16 v[40:43], a[64:67], v[224:227], 0
  v_and_b32 v6, 7, v0
  v_lshlrev_b32 v6, 9, v6
  v_mfma_f32_16x16x32_bf16 v[40:43], a[68:71], v[232:235], v[40:43]
  s_andn2_b32 s26, s93, 0xe00
  v_exp_f32 v32, v32
  v_mfma_f32_16x16x32_bf16 v[40:43], a[72:75], v[240:243], v[40:43]
  v_mfma_f32_16x16x32_bf16 v[40:43], a[76:79], v[248:251], v[40:43]
  s_add_u32 s26, s26, 32768
  v_exp_f32 v33, v33
  v_mfma_f32_16x16x32_bf16 v[44:47], a[80:83], v[224:227], 0
  v_cvt_pk_bf16_f32 v32, v32, v33
  v_mfma_f32_16x16x32_bf16 v[44:47], a[84:87], v[232:235], v[44:47]
  v_exp_f32 v34, v34
  v_mfma_f32_16x16x32_bf16 v[44:47], a[88:91], v[240:243], v[44:47]
  buffer_load_dword v6, v6, s[20:23], s26 offen sc1
  v_mfma_f32_16x16x32_bf16 v[44:47], a[92:95], v[248:251], v[44:47]
  v_exp_f32 v35, v35
  v_mfma_f32_16x16x32_bf16 v[64:67], a[96:99], v[48:51], 0
  v_cvt_pk_bf16_f32 v33, v34, v35
  v_mfma_f32_16x16x32_bf16 v[132:135], a[100:103], v[48:51], 0
  v_exp_f32 v36, v36
  v_mfma_f32_16x16x32_bf16 v[68:71], a[104:107], v[48:51], 0
  ds_read_b128 a[64:67], v4 offset:16384
  ds_read_b128 a[68:71], v4 offset:17408
  v_mfma_f32_16x16x32_bf16 v[140:143], a[108:111], v[48:51], 0
  v_exp_f32 v37, v37
  v_mfma_f32_16x16x32_bf16 v[72:75], a[112:115], v[48:51], 0
  ds_read_b128 a[72:75], v4 offset:18432
  v_cvt_pk_bf16_f32 v34, v36, v37
  v_mfma_f32_16x16x32_bf16 v[148:151], a[116:119], v[48:51], 0
  v_exp_f32 v38, v38
  v_mfma_f32_16x16x32_bf16 v[76:79], a[120:123], v[48:51], 0
  ds_read_b128 a[76:79], v4 offset:19456
  ds_read_b128 a[80:83], v4 offset:20480
  v_mfma_f32_16x16x32_bf16 v[156:159], a[124:127], v[48:51], 0
  buffer_store_dwordx4 a[40:43], v12, s[16:19], s29 offen offset:1024 sc1
  v_exp_f32 v39, v39
  v_mfma_f32_16x16x32_bf16 a[160:163], a[224:227], v[48:51], 0
  s_add_u32 s28, s101, s82
  ds_read_b128 a[84:87], v4 offset:21504
  v_cvt_pk_bf16_f32 v35, v38, v39
  v_mfma_f32_16x16x32_bf16 v[80:83], a[96:99], v[56:59], 0
  v_exp_f32 v40, v40
  v_mfma_f32_16x16x32_bf16 v[164:167], a[100:103], v[56:59], 0
  ds_read_b128 a[88:91], v4 offset:22528
  ds_read_b128 a[92:95], v4 offset:23552
  v_mfma_f32_16x16x32_bf16 v[84:87], a[104:107], v[56:59], 0
  v_exp_f32 v41, v41
  v_mfma_f32_16x16x32_bf16 v[172:175], a[108:111], v[56:59], 0
  v_cvt_pk_bf16_f32 v40, v40, v41
  v_mfma_f32_16x16x32_bf16 v[88:91], a[112:115], v[56:59], 0
  v_exp_f32 v42, v42
  v_mfma_f32_16x16x32_bf16 v[180:183], a[116:119], v[56:59], 0
  buffer_store_dwordx4 a[16:19], v12, s[16:19], s28 offen offset:0 sc1
  v_mfma_f32_16x16x32_bf16 v[92:95], a[120:123], v[56:59], 0
  v_exp_f32 v43, v43
  v_mfma_f32_16x16x32_bf16 v[188:191], a[124:127], v[56:59], 0
  v_cvt_pk_bf16_f32 v41, v42, v43
  v_mfma_f32_16x16x32_bf16 a[164:167], a[224:227], v[56:59], 0
  s_waitcnt lgkmcnt(0)
  v_exp_f32 v44, v44
  v_mfma_f32_16x16x32_bf16 v[48:51], a[64:67], v[192:195], 0
  ds_read_b128 a[128:131], v4 offset:24576
  ds_read_b128 a[132:135], v4 offset:25600
  v_mfma_f32_16x16x32_bf16 v[48:51], a[68:71], v[200:203], v[48:51]
  v_exp_f32 v45, v45
  v_mfma_f32_16x16x32_bf16 v[48:51], a[72:75], v[208:211], v[48:51]
  ds_read_b128 a[136:139], v4 offset:26624
  v_cvt_pk_bf16_f32 v42, v44, v45
  v_mfma_f32_16x16x32_bf16 v[48:51], a[76:79], v[216:219], v[48:51]
  v_exp_f32 v46, v46
  v_mfma_f32_16x16x32_bf16 v[52:55], a[80:83], v[192:195], 0
  ds_read_b128 a[140:143], v4 offset:27648
  ds_read_b128 a[144:147], v4 offset:28672
  v_mfma_f32_16x16x32_bf16 v[52:55], a[84:87], v[200:203], v[52:55]
  v_exp_f32 v47, v47
  v_mfma_f32_16x16x32_bf16 v[52:55], a[88:91], v[208:211], v[52:55]
  ds_read_b128 a[148:151], v4 offset:29696
  v_cvt_pk_bf16_f32 v43, v46, v47
  v_mfma_f32_16x16x32_bf16 v[52:55], a[92:95], v[216:219], v[52:55]
  buffer_store_dwordx4 a[20:23], v12, s[16:19], s28 offen offset:1024 sc1
  v_mfma_f32_16x16x32_bf16 v[56:59], a[64:67], v[224:227], 0
  ds_read_b128 a[152:155], v4 offset:30720
  ds_read_b128 a[156:159], v4 offset:31744
  v_mfma_f32_16x16x32_bf16 v[56:59], a[68:71], v[232:235], v[56:59]
  v_exp_f32 v48, v48
  v_mfma_f32_16x16x32_bf16 v[56:59], a[72:75], v[240:243], v[56:59]
  v_mfma_f32_16x16x32_bf16 v[56:59], a[76:79], v[248:251], v[56:59]
  v_exp_f32 v49, v49
  v_mfma_f32_16x16x32_bf16 v[60:63], a[80:83], v[224:227], 0
  v_cvt_pk_bf16_f32 v48, v48, v49
  v_mfma_f32_16x16x32_bf16 v[60:63], a[84:87], v[232:235], v[60:63]
  v_exp_f32 v50, v50
  v_mfma_f32_16x16x32_bf16 v[60:63], a[88:91], v[240:243], v[60:63]
  v_mfma_f32_16x16x32_bf16 v[60:63], a[92:95], v[248:251], v[60:63]
  v_exp_f32 v51, v51
  v_mfma_f32_16x16x32_bf16 v[96:99], a[96:99], v[32:35], 0
  v_cvt_pk_bf16_f32 v49, v50, v51
  v_mfma_f32_16x16x32_bf16 v[196:199], a[100:103], v[32:35], 0
  v_exp_f32 v52, v52
  v_mfma_f32_16x16x32_bf16 v[100:103], a[104:107], v[32:35], 0
  ds_read_b128 a[64:67], v4 offset:32768
  ds_read_b128 a[68:71], v4 offset:33792
  v_mfma_f32_16x16x32_bf16 v[204:207], a[108:111], v[32:35], 0
  v_exp_f32 v53, v53
  v_mfma_f32_16x16x32_bf16 v[104:107], a[112:115], v[32:35], 0
  ds_read_b128 a[72:75], v4 offset:34816
  v_cvt_pk_bf16_f32 v50, v52, v53
  v_mfma_f32_16x16x32_bf16 v[212:215], a[116:119], v[32:35], 0
  v_exp_f32 v54, v54
  v_mfma_f32_16x16x32_bf16 v[108:111], a[120:123], v[32:35], 0
  ds_read_b128 a[76:79], v4 offset:35840
  ds_read_b128 a[80:83], v4 offset:36864
  v_mfma_f32_16x16x32_bf16 v[220:223], a[124:127], v[32:35], 0
  v_exp_f32 v55, v55
  v_mfma_f32_16x16x32_bf16 a[168:171], a[224:227], v[32:35], 0
  ds_read_b128 a[84:87], v4 offset:37888
  v_cvt_pk_bf16_f32 v51, v54, v55
  v_mfma_f32_16x16x32_bf16 v[112:115], a[96:99], v[40:43], 0
  v_exp_f32 v56, v56
  v_mfma_f32_16x16x32_bf16 v[228:231], a[100:103], v[40:43], 0
  ds_read_b128 a[88:91], v4 offset:38912
  ds_read_b128 a[92:95], v4 offset:39936
  v_mfma_f32_16x16x32_bf16 v[116:119], a[104:107], v[40:43], 0
  buffer_store_dwordx4 a[24:27], v12, s[16:19], s28 offen offset:2048 sc1
  v_exp_f32 v57, v57
  v_mfma_f32_16x16x32_bf16 v[236:239], a[108:111], v[40:43], 0
  v_cvt_pk_bf16_f32 v56, v56, v57
  v_mfma_f32_16x16x32_bf16 v[120:123], a[112:115], v[40:43], 0
  v_exp_f32 v58, v58
  v_mfma_f32_16x16x32_bf16 v[244:247], a[116:119], v[40:43], 0
  s_waitcnt vmcnt(4)
  v_xor_b32 v6, s92, v6
  v_cmp_lt_u32 vcc, 15, v6
  v_mfma_f32_16x16x32_bf16 v[124:127], a[120:123], v[40:43], 0
  v_exp_f32 v59, v59
  v_mfma_f32_16x16x32_bf16 v[252:255], a[124:127], v[40:43], 0
  v_cvt_pk_bf16_f32 v57, v58, v59
  v_mfma_f32_16x16x32_bf16 a[172:175], a[224:227], v[40:43], 0
  s_cbranch_vccnz spin2
spun2:
  s_waitcnt lgkmcnt(0)
  v_exp_f32 v60, v60
  v_mfma_f32_16x16x32_bf16 v[32:35], a[64:67], v[128:131], 0
  s_mov_b32 s78, 0
  ds_read_b128 a[96:99], v4 offset:40960
  ds_read_b128 a[100:103], v4 offset:41984
  v_mfma_f32_16x16x32_bf16 v[32:35], a[68:71], v[136:139], v[32:35]
  s_cmp_eq_u32 s78, s62
  v_exp_f32 v61, v61
  v_mfma_f32_16x16x32_bf16 v[32:35], a[72:75], v[144:147], v[32:35]
  s_cmov_b32 s78, s79
  ds_read_b128 a[104:107], v4 offset:43008
  v_cvt_pk_bf16_f32 v58, v60, v61
  v_mfma_f32_16x16x32_bf16 v[32:35], a[76:79], v[152:155], v[32:35]
  s_cmp_eq_u32 s78, s63
  v_exp_f32 v62, v62
  v_mfma_f32_16x16x32_bf16 v[36:39], a[80:83], v[128:131], 0
  s_cmov_b32 s78, s94
  ds_read_b128 a[108:111], v4 offset:44032
  ds_read_b128 a[112:115], v4 offset:45056
  v_mfma_f32_16x16x32_bf16 v[36:39], a[84:87], v[136:139], v[36:39]
  s_mov_b32 m0, s65
  buffer_store_dwordx4 a[28:31], v12, s[16:19], s28 offen offset:3072 sc1
  v_exp_f32 v63, v63
  v_mfma_f32_16x16x32_bf16 v[36:39], a[88:91], v[144:147], v[36:39]
  s_add_u32 s65, s65, 16384
  ds_read_b128 a[116:119], v4 offset:46080
  v_cvt_pk_bf16_f32 v59, v62, v63
  v_mfma_f32_16x16x32_bf16 v[36:39], a[92:95], v[152:155], v[36:39]
  buffer_load_dwordx4 v28, s[16:19], s78 offen offset:0 sc1 lds
  v_mfma_f32_16x16x32_bf16 v[40:43], a[64:67], v[160:163], 0
  ds_read_b128 a[120:123], v4 offset:47104
  ds_read_b128 a[124:127], v4 offset:48128
  v_mfma_f32_16x16x32_bf16 v[40:43], a[68:71], v[168:171], v[40:43]
  v_exp_f32 v32, v32
  v_mfma_f32_16x16x32_bf16 v[40:43], a[72:75], v[176:179], v[40:43]
  buffer_load_dwordx4 v28, s[16:19], s78 offen offset:1024 sc1 lds
  v_mfma_f32_16x16x32_bf16 v[40:43], a[76:79], v[184:187], v[40:43]
  v_exp_f32 v33, v33
  v_mfma_f32_16x16x32_bf16 v[44:47], a[80:83], v[160:163], 0
  v_cvt_pk_bf16_f32 v32, v32, v33
  v_mfma_f32_16x16x32_bf16 v[44:47], a[84:87], v[168:171], v[44:47]
  s_sub_u32 s25, s65, 163840
  v_exp_f32 v34, v34
  v_mfma_f32_16x16x32_bf16 v[44:47], a[88:91], v[176:179], v[44:47]
  buffer_load_dwordx4 v28, s[16:19], s78 offen offset:2048 sc1 lds
  v_mfma_f32_16x16x32_bf16 v[44:47], a[92:95], v[184:187], v[44:47]
  s_min_u32 s65, s65, s25
  v_exp_f32 v35, v35
  v_mfma_f32_16x16x32_bf16 v[96:99], a[128:131], v[48:51], v[96:99]
  v_cvt_pk_bf16_f32 v33, v34, v35
  v_mfma_f32_16x16x32_bf16 v[196:199], a[132:135], v[48:51], v[196:199]
  v_exp_f32 v36, v36
  v_mfma_f32_16x16x32_bf16 v[100:103], a[136:139], v[48:51], v[100:103]
  v_mfma_f32_16x16x32_bf16 v[204:207], a[140:143], v[48:51], v[204:207]
  v_exp_f32 v37, v37
  v_mfma_f32_16x16x32_bf16 v[104:107], a[144:147], v[48:51], v[104:107]
  v_cvt_pk_bf16_f32 v34, v36, v37
  v_mfma_f32_16x16x32_bf16 v[212:215], a[148:151], v[48:51], v[212:215]
  v_exp_f32 v38, v38
  v_mfma_f32_16x16x32_bf16 v[108:111], a[152:155], v[48:51], v[108:111]
  v_mfma_f32_16x16x32_bf16 v[220:223], a[156:159], v[48:51], v[220:223]
  v_exp_f32 v39, v39
  v_mfma_f32_16x16x32_bf16 a[168:171], a[224:227], v[48:51], a[168:171]
  v_cvt_pk_bf16_f32 v35, v38, v39
  v_mfma_f32_16x16x32_bf16 v[112:115], a[128:131], v[56:59], v[112:115]
  v_exp_f32 v40, v40
  v_mfma_f32_16x16x32_bf16 v[228:231], a[132:135], v[56:59], v[228:231]
  v_mfma_f32_16x16x32_bf16 v[116:119], a[136:139], v[56:59], v[116:119]
  v_exp_f32 v41, v41
  v_mfma_f32_16x16x32_bf16 v[236:239], a[140:143], v[56:59], v[236:239]
  v_cvt_pk_bf16_f32 v40, v40, v41
  v_mfma_f32_16x16x32_bf16 v[120:123], a[144:147], v[56:59], v[120:123]
  v_exp_f32 v42, v42
  v_mfma_f32_16x16x32_bf16 v[244:247], a[148:151], v[56:59], v[244:247]
  buffer_load_dwordx4 v28, s[16:19], s78 offen offset:3072 sc1 lds
  v_mfma_f32_16x16x32_bf16 v[124:127], a[152:155], v[56:59], v[124:127]
  v_exp_f32 v43, v43
  v_mfma_f32_16x16x32_bf16 v[252:255], a[156:159], v[56:59], v[252:255]
  v_cvt_pk_bf16_f32 v41, v42, v43
  v_mfma_f32_16x16x32_bf16 a[172:175], a[224:227], v[56:59], a[172:175]
  s_waitcnt lgkmcnt(0)
  v_exp_f32 v44, v44
  v_mfma_f32_16x16x32_bf16 v[48:51], a[64:67], v[192:195], 0
  s_add_u32 s78, s78, 16384
  v_mfma_f32_16x16x32_bf16 v[48:51], a[68:71], v[200:203], v[48:51]
  s_cmp_eq_u32 s78, s62
  v_exp_f32 v45, v45
  v_mfma_f32_16x16x32_bf16 v[48:51], a[72:75], v[208:211], v[48:51]
  s_cmov_b32 s78, s79
  v_cvt_pk_bf16_f32 v42, v44, v45
  v_mfma_f32_16x16x32_bf16 v[48:51], a[76:79], v[216:219], v[48:51]
  s_cmp_eq_u32 s78, s63
  v_exp_f32 v46, v46
  v_mfma_f32_16x16x32_bf16 v[52:55], a[80:83], v[192:195], 0
  s_cmov_b32 s78, s94
  v_mfma_f32_16x16x32_bf16 v[52:55], a[84:87], v[200:203], v[52:55]
  s_mov_b32 m0, s65
  v_exp_f32 v47, v47
  v_mfma_f32_16x16x32_bf16 v[52:55], a[88:91], v[208:211], v[52:55]
  s_add_u32 s65, s65, 16384
  v_cvt_pk_bf16_f32 v43, v46, v47
  v_mfma_f32_16x16x32_bf16 v[52:55], a[92:95], v[216:219], v[52:55]
  buffer_load_dwordx4 v28, s[16:19], s78 offen offset:0 sc1 lds
  v_mfma_f32_16x16x32_bf16 v[56:59], a[64:67], v[224:227], 0
  v_mfma_f32_16x16x32_bf16 v[56:59], a[68:71], v[232:235], v[56:59]
  v_exp_f32 v48, v48
  v_mfma_f32_16x16x32_bf16 v[56:59], a[72:75], v[240:243], v[56:59]
  buffer_load_dwordx4 v28, s[16:19], s78 offen offset:1024 sc1 lds
  v_mfma_f32_16x16x32_bf16 v[56:59], a[76:79], v[248:251], v[56:59]
  v_exp_f32 v49, v49
  v_mfma_f32_16x16x32_bf16 v[60:63], a[80:83], v[224:227], 0
  v_cvt_pk_bf16_f32 v48, v48, v49
  v_mfma_f32_16x16x32_bf16 v[60:63], a[84:87], v[232:235], v[60:63]
  s_sub_u32 s25, s65, 163840
  v_exp_f32 v50, v50
  v_mfma_f32_16x16x32_bf16 v[60:63], a[88:91], v[240:243], v[60:63]
  buffer_load_dwordx4 v28, s[16:19], s78 offen offset:2048 sc1 lds
  v_mfma_f32_16x16x32_bf16 v[60:63], a[92:95], v[248:251], v[60:63]
  s_min_u32 s65, s65, s25
  v_exp_f32 v51, v51
  v_mfma_f32_16x16x32_bf16 v[64:67], a[96:99], v[32:35], v[64:67]
  s_waitcnt lgkmcnt(0)
  s_barrier
  v_cvt_pk_bf16_f32 v49, v50, v51
  v_mfma_f32_16x16x32_bf16 v[132:135], a[100:103], v[32:35], v[132:135]
  v_exp_f32 v52, v52
  v_mfma_f32_16x16x32_bf16 v[68:71], a[104:107], v[32:35], v[68:71]
  ds_read_b128 a[64:67], v12 offset:0
  ds_read_b128 a[68:71], v12 offset:1024
  v_mfma_f32_16x16x32_bf16 v[140:143], a[108:111], v[32:35], v[140:143]
  v_exp_f32 v53, v53
  v_mfma_f32_16x16x32_bf16 v[72:75], a[112:115], v[32:35], v[72:75]
  ds_read_b128 a[72:75], v12 offset:2048
  v_cvt_pk_bf16_f32 v50, v52, v53
  v_mfma_f32_16x16x32_bf16 v[148:151], a[116:119], v[32:35], v[148:151]
  v_exp_f32 v54, v54
  v_mfma_f32_16x16x32_bf16 v[76:79], a[120:123], v[32:35], v[76:79]
  ds_read_b128 a[76:79], v12 offset:3072
  ds_read_b128 a[80:83], v12 offset:4096
  v_mfma_f32_16x16x32_bf16 v[156:159], a[124:127], v[32:35], v[156:159]
  v_exp_f32 v55, v55
  v_mfma_f32_16x16x32_bf16 a[160:163], a[224:227], v[32:35], a[160:163]
  ds_read_b128 a[84:87], v12 offset:5120
  v_cvt_pk_bf16_f32 v51, v54, v55
  v_mfma_f32_16x16x32_bf16 v[80:83], a[96:99], v[40:43], v[80:83]
  v_exp_f32 v56, v56
  v_mfma_f32_16x16x32_bf16 v[164:167], a[100:103], v[40:43], v[164:167]
  ds_read_b128 a[88:91], v12 offset:6144
  ds_read_b128 a[92:95], v12 offset:7168
  v_mfma_f32_16x16x32_bf16 v[84:87], a[104:107], v[40:43], v[84:87]
  v_exp_f32 v57, v57
  v_mfma_f32_16x16x32_bf16 v[172:175], a[108:111], v[40:43], v[172:175]
  v_cvt_pk_bf16_f32 v56, v56, v57
  v_mfma_f32_16x16x32_bf16 v[88:91], a[112:115], v[40:43], v[88:91]
  v_exp_f32 v58, v58
  v_mfma_f32_16x16x32_bf16 v[180:183], a[116:119], v[40:43], v[180:183]
  buffer_load_dwordx4 v28, s[16:19], s78 offen offset:3072 sc1 lds
  v_mfma_f32_16x16x32_bf16 v[92:95], a[120:123], v[40:43], v[92:95]
  v_exp_f32 v59, v59
  v_mfma_f32_16x16x32_bf16 v[188:191], a[124:127], v[40:43], v[188:191]
  v_cvt_pk_bf16_f32 v57, v58, v59
  v_mfma_f32_16x16x32_bf16 a[164:167], a[224:227], v[40:43], a[164:167]
  s_waitcnt lgkmcnt(0)
  v_exp_f32 v60, v60
  v_mfma_f32_16x16x32_bf16 v[32:35], a[64:67], v[128:131], v[16:19]
  s_add_u32 s78, s78, 16384
  ds_read_b128 a[128:131], v12 offset:8192
  ds_read_b128 a[132:135], v12 offset:9216
  v_mfma_f32_16x16x32_bf16 v[32:35], a[68:71], v[136:139], v[32:35]
  s_cmp_eq_u32 s78, s62
  v_exp_f32 v61, v61
  v_mfma_f32_16x16x32_bf16 v[32:35], a[72:75], v[144:147], v[32:35]
  s_cmov_b32 s78, s79
  ds_read_b128 a[136:139], v12 offset:10240
  v_cvt_pk_bf16_f32 v58, v60, v61
  v_mfma_f32_16x16x32_bf16 v[32:35], a[76:79], v[152:155], v[32:35]
  s_cmp_eq_u32 s78, s63
  v_exp_f32 v62, v62
  v_mfma_f32_16x16x32_bf16 v[36:39], a[80:83], v[128:131], v[20:23]
  s_cmov_b32 s78, s94
  ds_read_b128 a[140:143], v12 offset:11264
  ds_read_b128 a[144:147], v12 offset:12288
  v_mfma_f32_16x16x32_bf16 v[36:39], a[84:87], v[136:139], v[36:39]
  s_mov_b32 m0, s65
  v_exp_f32 v63, v63
  v_mfma_f32_16x16x32_bf16 v[36:39], a[88:91], v[144:147], v[36:39]
  s_add_u32 s65, s65, 16384
  ds_read_b128 a[148:151], v12 offset:13312
  v_cvt_pk_bf16_f32 v59, v62, v63
  v_mfma_f32_16x16x32_bf16 v[36:39], a[92:95], v[152:155], v[36:39]
  buffer_load_dwordx4 v28, s[16:19], s78 offen offset:0 sc1 lds
  v_mfma_f32_16x16x32_bf16 v[40:43], a[64:67], v[160:163], 0
  ds_read_b128 a[152:155], v12 offset:14336
  ds_read_b128 a[156:159], v12 offset:15360
  v_mfma_f32_16x16x32_bf16 v[40:43], a[68:71], v[168:171], v[40:43]
  v_exp_f32 v32, v32
  v_mfma_f32_16x16x32_bf16 v[40:43], a[72:75], v[176:179], v[40:43]
  buffer_load_dwordx4 v28, s[16:19], s78 offen offset:1024 sc1 lds
  v_mfma_f32_16x16x32_bf16 v[40:43], a[76:79], v[184:187], v[40:43]
  v_exp_f32 v33, v33
  v_mfma_f32_16x16x32_bf16 v[44:47], a[80:83], v[160:163], v[16:19]
  v_cvt_pk_bf16_f32 v32, v32, v33
  v_mfma_f32_16x16x32_bf16 v[44:47], a[84:87], v[168:171], v[44:47]
  s_sub_u32 s25, s65, 163840
  v_exp_f32 v34, v34
  v_mfma_f32_16x16x32_bf16 v[44:47], a[88:91], v[176:179], v[44:47]
  buffer_load_dwordx4 v28, s[16:19], s78 offen offset:2048 sc1 lds
  v_mfma_f32_16x16x32_bf16 v[44:47], a[92:95], v[184:187], v[44:47]
  s_min_u32 s65, s65, s25
  v_exp_f32 v35, v35
  v_mfma_f32_16x16x32_bf16 v[96:99], a[96:99], v[48:51], v[96:99]
  v_cvt_pk_bf16_f32 v33, v34, v35
  v_mfma_f32_16x16x32_bf16 v[196:199], a[100:103], v[48:51], v[196:199]
  v_exp_f32 v36, v36
  v_mfma_f32_16x16x32_bf16 v[100:103], a[104:107], v[48:51], v[100:103]
  v_mfma_f32_16x16x32_bf16 v[204:207], a[108:111], v[48:51], v[204:207]
  v_exp_f32 v37, v37
  v_mfma_f32_16x16x32_bf16 v[104:107], a[112:115], v[48:51], v[104:107]
  v_cvt_pk_bf16_f32 v34, v36, v37
  v_mfma_f32_16x16x32_bf16 v[212:215], a[116:119], v[48:51], v[212:215]
  v_exp_f32 v38, v38
  v_mfma_f32_16x16x32_bf16 v[108:111], a[120:123], v[48:51], v[108:111]
  v_mfma_f32_16x16x32_bf16 v[220:223], a[124:127], v[48:51], v[220:223]
  v_exp_f32 v39, v39
  v_mfma_f32_16x16x32_bf16 a[168:171], a[224:227], v[48:51], a[168:171]
  v_cvt_pk_bf16_f32 v35, v38, v39
  v_mfma_f32_16x16x32_bf16 v[112:115], a[96:99], v[56:59], v[112:115]
  v_exp_f32 v40, v40
  v_mfma_f32_16x16x32_bf16 v[228:231], a[100:103], v[56:59], v[228:231]
  v_mfma_f32_16x16x32_bf16 v[116:119], a[104:107], v[56:59], v[116:119]
  v_exp_f32 v41, v41
  v_mfma_f32_16x16x32_bf16 v[236:239], a[108:111], v[56:59], v[236:239]
  v_cvt_pk_bf16_f32 v40, v40, v41
  v_mfma_f32_16x16x32_bf16 v[120:123], a[112:115], v[56:59], v[120:123]
  v_exp_f32 v42, v42
  v_mfma_f32_16x16x32_bf16 v[244:247], a[116:119], v[56:59], v[244:247]
  buffer_load_dwordx4 v28, s[16:19], s78 offen offset:3072 sc1 lds
  v_mfma_f32_16x16x32_bf16 v[124:127], a[120:123], v[56:59], v[124:127]
  v_exp_f32 v43, v43
  v_mfma_f32_16x16x32_bf16 v[252:255], a[124:127], v[56:59], v[252:255]
  v_cvt_pk_bf16_f32 v41, v42, v43
  v_mfma_f32_16x16x32_bf16 a[172:175], a[224:227], v[56:59], a[172:175]
  s_waitcnt lgkmcnt(0)
  v_exp_f32 v44, v44
  v_mfma_f32_16x16x32_bf16 v[48:51], a[64:67], v[192:195], 0
  s_add_u32 s78, s78, 16384
  v_mfma_f32_16x16x32_bf16 v[48:51], a[68:71], v[200:203], v[48:51]
  s_cmp_eq_u32 s78, s62
  v_exp_f32 v45, v45
  v_mfma_f32_16x16x32_bf16 v[48:51], a[72:75], v[208:211], v[48:51]
  s_cmov_b32 s78, s79
  v_cvt_pk_bf16_f32 v42, v44, v45
  v_mfma_f32_16x16x32_bf16 v[48:51], a[76:79], v[216:219], v[48:51]
  s_cmp_eq_u32 s78, s63
  v_exp_f32 v46, v46
  v_mfma_f32_16x16x32_bf16 v[52:55], a[80:83], v[192:195], 0
  s_cmov_b32 s78, s94
  v_mfma_f32_16x16x32_bf16 v[52:55], a[84:87], v[200:203], v[52:55]
  s_mov_b32 m0, s65
  v_exp_f32 v47, v47
  v_mfma_f32_16x16x32_bf16 v[52:55], a[88:91], v[208:211], v[52:55]
  s_add_u32 s65, s65, 16384
  v_cvt_pk_bf16_f32 v43, v46, v47
  v_mfma_f32_16x16x32_bf16 v[52:55], a[92:95], v[216:219], v[52:55]
  buffer_load_dwordx4 v28, s[16:19], s78 offen offset:0 sc1 lds
  v_mfma_f32_16x16x32_bf16 v[56:59], a[64:67], v[224:227], 0
  v_mfma_f32_16x16x32_bf16 v[56:59], a[68:71], v[232:235], v[56:59]
  v_exp_f32 v48, v48
  v_mfma_f32_16x16x32_bf16 v[56:59], a[72:75], v[240:243], v[56:59]
  buffer_load_dwordx4 v28, s[16:19], s78 offen offset:1024 sc1 lds
  v_mfma_f32_16x16x32_bf16 v[56:59], a[76:79], v[248:251], v[56:59]
  v_exp_f32 v49, v49
  v_mfma_f32_16x16x32_bf16 v[60:63], a[80:83], v[224:227], 0
  v_cvt_pk_bf16_f32 v48, v48, v49
  v_mfma_f32_16x16x32_bf16 v[60:63], a[84:87], v[232:235], v[60:63]
  s_sub_u32 s25, s65, 163840
  v_exp_f32 v50, v50
  v_mfma_f32_16x16x32_bf16 v[60:63], a[88:91], v[240:243], v[60:63]
  buffer_load_dwordx4 v28, s[16:19], s78 offen offset:2048 sc1 lds
  v_mfma_f32_16x16x32_bf16 v[60:63], a[92:95], v[248:251], v[60:63]
  s_min_u32 s65, s65, s25
  v_exp_f32 v51, v51
  v_mfma_f32_16x16x32_bf16 v[64:67], a[128:131], v[32:35], v[64:67]
  v_cvt_pk_bf16_f32 v49, v50, v51
  v_mfma_f32_16x16x32_bf16 v[132:135], a[132:135], v[32:35], v[132:135]
  s_mov_b32 s26, 60293120
  v_exp_f32 v52, v52
  v_mfma_f32_16x16x32_bf16 v[68:71], a[136:139], v[32:35], v[68:71]
  ds_read_b128 a[64:67], v5 offset:16384
  ds_read_b128 a[68:71], v5 offset:17408
  v_mfma_f32_16x16x32_bf16 v[140:143], a[140:143], v[32:35], v[140:143]
  v_exp_f32 v53, v53
  v_mfma_f32_16x16x32_bf16 v[72:75], a[144:147], v[32:35], v[72:75]
  ds_read_b128 a[72:75], v5 offset:18432
  v_cvt_pk_bf16_f32 v50, v52, v53
  v_mfma_f32_16x16x32_bf16 v[148:151], a[148:151], v[32:35], v[148:151]
  v_exp_f32 v54, v54
  v_mfma_f32_16x16x32_bf16 v[76:79], a[152:155], v[32:35], v[76:79]
  ds_read_b128 a[76:79], v5 offset:19456
  ds_read_b128 a[80:83], v5 offset:20480
  v_mfma_f32_16x16x32_bf16 v[156:159], a[156:159], v[32:35], v[156:159]
  v_exp_f32 v55, v55
  v_mfma_f32_16x16x32_bf16 a[160:163], a[224:227], v[32:35], a[160:163]
  ds_read_b128 a[84:87], v5 offset:21504
  v_cvt_pk_bf16_f32 v51, v54, v55
  v_mfma_f32_16x16x32_bf16 v[80:83], a[128:131], v[40:43], v[80:83]
  v_exp_f32 v56, v56
  v_mfma_f32_16x16x32_bf16 v[164:167], a[132:135], v[40:43], v[164:167]
  ds_read_b128 a[88:91], v5 offset:22528
  ds_read_b128 a[92:95], v5 offset:23552
  v_mfma_f32_16x16x32_bf16 v[84:87], a[136:139], v[40:43], v[84:87]
  v_exp_f32 v57, v57
  v_mfma_f32_16x16x32_bf16 v[172:175], a[140:143], v[40:43], v[172:175]
  buffer_load_dword v6, v14, s[20:23], s26 offen sc1
  v_cvt_pk_bf16_f32 v56, v56, v57
  v_mfma_f32_16x16x32_bf16 v[88:91], a[144:147], v[40:43], v[88:91]
  v_exp_f32 v58, v58
  v_mfma_f32_16x16x32_bf16 v[180:183], a[148:151], v[40:43], v[180:183]
  buffer_load_dwordx4 v28, s[16:19], s78 offen offset:3072 sc1 lds
  v_mfma_f32_16x16x32_bf16 v[92:95], a[152:155], v[40:43], v[92:95]
  v_exp_f32 v59, v59
  v_mfma_f32_16x16x32_bf16 v[188:191], a[156:159], v[40:43], v[188:191]
  v_cvt_pk_bf16_f32 v57, v58, v59
  v_mfma_f32_16x16x32_bf16 a[164:167], a[224:227], v[40:43], a[164:167]
  s_waitcnt lgkmcnt(0)
  v_exp_f32 v60, v60
  v_mfma_f32_16x16x32_bf16 v[32:35], a[64:67], v[192:195], v[16:19]
  s_add_u32 s78, s78, 16384
  ds_read_b128 a[96:99], v5 offset:24576
  ds_read_b128 a[100:103], v5 offset:25600
  v_mfma_f32_16x16x32_bf16 v[32:35], a[68:71], v[200:203], v[32:35]
  s_cmp_eq_u32 s78, s62
  v_exp_f32 v61, v61
  v_mfma_f32_16x16x32_bf16 v[32:35], a[72:75], v[208:211], v[32:35]
  s_cmov_b32 s78, s79
  ds_read_b128 a[104:107], v5 offset:26624
  v_cvt_pk_bf16_f32 v58, v60, v61
  v_mfma_f32_16x16x32_bf16 v[32:35], a[76:79], v[216:219], v[32:35]
  s_cmp_eq_u32 s78, s63
  v_exp_f32 v62, v62
  v_mfma_f32_16x16x32_bf16 v[36:39], a[80:83], v[192:195], v[20:23]
  s_cmov_b32 s78, s94
  ds_read_b128 a[108:111], v5 offset:27648
  ds_read_b128 a[112:115], v5 offset:28672
  v_mfma_f32_16x16x32_bf16 v[36:39], a[84:87], v[200:203], v[36:39]
  s_mov_b32 m0, s65
  v_exp_f32 v63, v63
  v_mfma_f32_16x16x32_bf16 v[36:39], a[88:91], v[208:211], v[36:39]
  s_add_u32 s65, s65, 16384
  ds_read_b128 a[116:119], v5 offset:29696
  v_cvt_pk_bf16_f32 v59, v62, v63
  v_mfma_f32_16x16x32_bf16 v[36:39], a[92:95], v[216:219], v[36:39]
  buffer_load_dwordx4 v28, s[16:19], s78 offen offset:0 sc1 lds
  v_mfma_f32_16x16x32_bf16 v[40:43], a[64:67], v[224:227], 0
  ds_read_b128 a[120:123], v5 offset:30720
  ds_read_b128 a[124:127], v5 offset:31744
  v_mfma_f32_16x16x32_bf16 v[40:43], a[68:71], v[232:235], v[40:43]
  v_exp_f32 v32, v32
  v_mfma_f32_16x16x32_bf16 v[40:43], a[72:75], v[240:243], v[40:43]
  buffer_load_dwordx4 v28, s[16:19], s78 offen offset:1024 sc1 lds
  v_mfma_f32_16x16x32_bf16 v[40:43], a[76:79], v[248:251], v[40:43]
  v_exp_f32 v33, v33
  v_mfma_f32_16x16x32_bf16 v[44:47], a[80:83], v[224:227], v[16:19]
  v_cvt_pk_bf16_f32 v32, v32, v33
  v_mfma_f32_16x16x32_bf16 v[44:47], a[84:87], v[232:235], v[44:47]
  s_sub_u32 s25, s65, 163840
  v_exp_f32 v34, v34
  v_mfma_f32_16x16x32_bf16 v[44:47], a[88:91], v[240:243], v[44:47]
  buffer_load_dwordx4 v28, s[16:19], s78 offen offset:2048 sc1 lds
  v_mfma_f32_16x16x32_bf16 v[44:47], a[92:95], v[248:251], v[44:47]
  s_min_u32 s65, s65, s25
  v_exp_f32 v35, v35
  v_mfma_f32_16x16x32_bf16 v[96:99], a[128:131], v[48:51], v[96:99]
  v_cvt_pk_bf16_f32 v33, v34, v35
  v_mfma_f32_16x16x32_bf16 v[196:199], a[132:135], v[48:51], v[196:199]
  v_exp_f32 v36, v36
  v_mfma_f32_16x16x32_bf16 v[100:103], a[136:139], v[48:51], v[100:103]
  ds_read_b128 a[64:67], v12 offset:16384
  ds_read_b128 a[68:71], v12 offset:17408
  v_mfma_f32_16x16x32_bf16 v[204:207], a[140:143], v[48:51], v[204:207]
  v_exp_f32 v37, v37
  v_mfma_f32_16x16x32_bf16 v[104:107], a[144:147], v[48:51], v[104:107]
  ds_read_b128 a[72:75], v12 offset:18432
  v_cvt_pk_bf16_f32 v34, v36, v37
  v_mfma_f32_16x16x32_bf16 v[212:215], a[148:151], v[48:51], v[212:215]
  v_exp_f32 v38, v38
  v_mfma_f32_16x16x32_bf16 v[108:111], a[152:155], v[48:51], v[108:111]
  ds_read_b128 a[76:79], v12 offset:19456
  ds_read_b128 a[80:83], v12 offset:20480
  v_mfma_f32_16x16x32_bf16 v[220:223], a[156:159], v[48:51], v[220:223]
  v_exp_f32 v39, v39
  v_mfma_f32_16x16x32_bf16 a[168:171], a[224:227], v[48:51], a[168:171]
  ds_read_b128 a[84:87], v12 offset:21504
  v_cvt_pk_bf16_f32 v35, v38, v39
  v_mfma_f32_16x16x32_bf16 v[112:115], a[128:131], v[56:59], v[112:115]
  v_exp_f32 v40, v40
  v_mfma_f32_16x16x32_bf16 v[228:231], a[132:135], v[56:59], v[228:231]
  ds_read_b128 a[88:91], v12 offset:22528
  ds_read_b128 a[92:95], v12 offset:23552
  v_mfma_f32_16x16x32_bf16 v[116:119], a[136:139], v[56:59], v[116:119]
  v_exp_f32 v41, v41
  v_mfma_f32_16x16x32_bf16 v[236:239], a[140:143], v[56:59], v[236:239]
  v_cvt_pk_bf16_f32 v40, v40, v41
  v_mfma_f32_16x16x32_bf16 v[120:123], a[144:147], v[56:59], v[120:123]
  v_exp_f32 v42, v42
  v_mfma_f32_16x16x32_bf16 v[244:247], a[148:151], v[56:59], v[244:247]
  buffer_load_dwordx4 v28, s[16:19], s78 offen offset:3072 sc1 lds
  v_mfma_f32_16x16x32_bf16 v[124:127], a[152:155], v[56:59], v[124:127]
  v_exp_f32 v43, v43
  v_mfma_f32_16x16x32_bf16 v[252:255], a[156:159], v[56:59], v[252:255]
  v_cvt_pk_bf16_f32 v41, v42, v43
  v_mfma_f32_16x16x32_bf16 a[172:175], a[224:227], v[56:59], a[172:175]
  s_waitcnt lgkmcnt(0)
  v_exp_f32 v44, v44
  v_mfma_f32_16x16x32_bf16 v[48:51], a[64:67], v[192:195], 0
  s_add_u32 s78, s78, 16384
  ds_read_b128 a[128:131], v12 offset:24576
  ds_read_b128 a[132:135], v12 offset:25600
  v_mfma_f32_16x16x32_bf16 v[48:51], a[68:71], v[200:203], v[48:51]
  s_cmp_eq_u32 s78, s62
  v_exp_f32 v45, v45
  v_mfma_f32_16x16x32_bf16 v[48:51], a[72:75], v[208:211], v[48:51]
  s_cmov_b32 s78, s79
  ds_read_b128 a[136:139], v12 offset:26624
  v_cvt_pk_bf16_f32 v42, v44, v45
  v_mfma_f32_16x16x32_bf16 v[48:51], a[76:79], v[216:219], v[48:51]
  s_cmp_eq_u32 s78, s63
  v_exp_f32 v46, v46
  v_mfma_f32_16x16x32_bf16 v[52:55], a[80:83], v[192:195], 0
  s_cmov_b32 s78, s94
  ds_read_b128 a[140:143], v12 offset:27648
  ds_read_b128 a[144:147], v12 offset:28672
  v_mfma_f32_16x16x32_bf16 v[52:55], a[84:87], v[200:203], v[52:55]
  s_mov_b32 m0, s65
  v_exp_f32 v47, v47
  v_mfma_f32_16x16x32_bf16 v[52:55], a[88:91], v[208:211], v[52:55]
  s_add_u32 s65, s65, 16384
  ds_read_b128 a[148:151], v12 offset:29696
  v_cvt_pk_bf16_f32 v43, v46, v47
  v_mfma_f32_16x16x32_bf16 v[52:55], a[92:95], v[216:219], v[52:55]
  buffer_load_dwordx4 v28, s[16:19], s78 offen offset:0 sc1 lds
  v_mfma_f32_16x16x32_bf16 v[56:59], a[64:67], v[224:227], 0
  s_add_u32 s64, s64, 16384
  ds_read_b128 a[152:155], v12 offset:30720
  ds_read_b128 a[156:159], v12 offset:31744
  v_mfma_f32_16x16x32_bf16 v[56:59], a[68:71], v[232:235], v[56:59]
  s_sub_u32 s24, s64, 163840
  v_exp_f32 v48, v48
  v_mfma_f32_16x16x32_bf16 v[56:59], a[72:75], v[240:243], v[56:59]
  buffer_load_dwordx4 v28, s[16:19], s78 offen offset:1024 sc1 lds
  v_mfma_f32_16x16x32_bf16 v[56:59], a[76:79], v[248:251], v[56:59]
  s_min_u32 s64, s64, s24
  v_exp_f32 v49, v49
  v_mfma_f32_16x16x32_bf16 v[60:63], a[80:83], v[224:227], 0
  v_add_u32 v3, s64, v12
  v_cvt_pk_bf16_f32 v48, v48, v49
  v_mfma_f32_16x16x32_bf16 v[60:63], a[84:87], v[232:235], v[60:63]
  s_sub_u32 s25, s65, 163840
  v_exp_f32 v50, v50
  v_mfma_f32_16x16x32_bf16 v[60:63], a[88:91], v[240:243], v[60:63]
  buffer_load_dwordx4 v28, s[16:19], s78 offen offset:2048 sc1 lds
  v_mfma_f32_16x16x32_bf16 v[60:63], a[92:95], v[248:251], v[60:63]
  s_min_u32 s65, s65, s25
  v_exp_f32 v51, v51
  v_mfma_f32_16x16x32_bf16 v[96:99], a[96:99], v[32:35], v[96:99]
  s_waitcnt vmcnt(7) lgkmcnt(0)
  s_barrier
  v_cvt_pk_bf16_f32 v49, v50, v51
  v_mfma_f32_16x16x32_bf16 v[196:199], a[100:103], v[32:35], v[196:199]
  s_add_u32 s26, s93, 65536
  v_exp_f32 v52, v52
  v_mfma_f32_16x16x32_bf16 v[100:103], a[104:107], v[32:35], v[100:103]
  ds_read_b128 a[64:67], v3 offset:0
  ds_read_b128 a[68:71], v3 offset:1024
  v_mfma_f32_16x16x32_bf16 v[204:207], a[108:111], v[32:35], v[204:207]
  v_exp_f32 v53, v53
  v_mfma_f32_16x16x32_bf16 v[104:107], a[112:115], v[32:35], v[104:107]
  ds_read_b128 a[72:75], v3 offset:2048
  v_cvt_pk_bf16_f32 v50, v52, v53
  v_mfma_f32_16x16x32_bf16 v[212:215], a[116:119], v[32:35], v[212:215]
  v_exp_f32 v54, v54
  v_mfma_f32_16x16x32_bf16 v[108:111], a[120:123], v[32:35], v[108:111]
  ds_read_b128 a[76:79], v3 offset:3072
  ds_read_b128 a[80:83], v3 offset:4096
  v_mfma_f32_16x16x32_bf16 v[220:223], a[124:127], v[32:35], v[220:223]
  v_exp_f32 v55, v55
  v_mfma_f32_16x16x32_bf16 a[168:171], a[224:227], v[32:35], a[168:171]
  ds_read_b128 a[84:87], v3 offset:5120
  v_cvt_pk_bf16_f32 v51, v54, v55
  v_mfma_f32_16x16x32_bf16 v[112:115], a[96:99], v[40:43], v[112:115]
  v_exp_f32 v56, v56
  v_mfma_f32_16x16x32_bf16 v[228:231], a[100:103], v[40:43], v[228:231]
  ds_read_b128 a[88:91], v3 offset:6144
  ds_read_b128 a[92:95], v3 offset:7168
  v_mfma_f32_16x16x32_bf16 v[116:119], a[104:107], v[40:43], v[116:119]
  v_exp_f32 v57, v57
  v_mfma_f32_16x16x32_bf16 v[236:239], a[108:111], v[40:43], v[236:239]
  buffer_store_dword v30, v29, s[20:23], s26 offen sc1
  v_cvt_pk_bf16_f32 v56, v56, v57
  v_mfma_f32_16x16x32_bf16 v[120:123], a[112:115], v[40:43], v[120:123]
  v_exp_f32 v58, v58
  v_mfma_f32_16x16x32_bf16 v[244:247], a[116:119], v[40:43], v[244:247]
  buffer_load_dwordx4 v28, s[16:19], s78 offen offset:3072 sc1 lds
  v_mfma_f32_16x16x32_bf16 v[124:127], a[120:123], v[40:43], v[124:127]
  v_exp_f32 v59, v59
  v_mfma_f32_16x16x32_bf16 v[252:255], a[124:127], v[40:43], v[252:255]
  v_cvt_pk_bf16_f32 v57, v58, v59
  v_mfma_f32_16x16x32_bf16 a[172:175], a[224:227], v[40:43], a[172:175]
  s_waitcnt lgkmcnt(0)
  v_exp_f32 v60, v60
  s_branch diag_done
diag3:
  s_waitcnt lgkmcnt(15)
  v_mfma_f32_16x16x32_bf16 v[48:51], a[64:67], v[128:131], 0
  ds_read_b128 a[128:131], v4 offset:8192
  ds_read_b128 a[132:135], v4 offset:9216
  s_waitcnt lgkmcnt(15)
  v_mfma_f32_16x16x32_bf16 v[48:51], a[68:71], v[136:139], v[48:51]
  buffer_store_dwordx4 a[0:3], v12, s[16:19], s101 offen offset:0 sc1
  s_waitcnt lgkmcnt(14)
  v_mfma_f32_16x16x32_bf16 v[48:51], a[72:75], v[144:147], v[48:51]
  ds_read_b128 a[136:139], v4 offset:10240
  s_waitcnt lgkmcnt(14)
  v_mfma_f32_16x16x32_bf16 v[48:51], a[76:79], v[152:155], v[48:51]
  s_waitcnt lgkmcnt(11)
  v_mfma_f32_16x16x32_bf16 v[52:55], a[80:83], v[128:131], 0
  ds_read_b128 a[140:143], v4 offset:11264
  ds_read_b128 a[144:147], v4 offset:12288
  s_waitcnt lgkmcnt(12)
  v_mfma_f32_16x16x32_bf16 v[52:55], a[84:87], v[136:139], v[52:55]
  s_waitcnt lgkmcnt(11)
  v_mfma_f32_16x16x32_bf16 v[52:55], a[88:91], v[144:147], v[52:55]
  ds_read_b128 a[148:151], v4 offset:13312
  s_waitcnt lgkmcnt(11)
  v_mfma_f32_16x16x32_bf16 v[52:55], a[92:95], v[152:155], v[52:55]
  buffer_store_dwordx4 a[8:11], v12, s[16:19], s101 offen offset:1024 sc1
  v_mfma_f32_16x16x32_bf16 v[56:59], a[64:67], v[160:163], 0
  s_add_u32 s29, s101, 4096
  ds_read_b128 a[152:155], v4 offset:14336
  ds_read_b128 a[156:159], v4 offset:15360
  v_mfma_f32_16x16x32_bf16 v[56:59], a[68:71], v[168:171], v[56:59]
  v_exp_f32 v48, v48
  v_mfma_f32_16x16x32_bf16 v[56:59], a[72:75], v[176:179], v[56:59]
  v_mfma_f32_16x16x32_bf16 v[56:59], a[76:79], v[184:187], v[56:59]
  v_exp_f32 v49, v49
  v_mfma_f32_16x16x32_bf16 v[60:63], a[80:83], v[160:163], 0
  v_cvt_pk_bf16_f32 v48, v48, v49
  v_mfma_f32_16x16x32_bf16 v[60:63], a[84:87], v[168:171], v[60:63]
  v_exp_f32 v50, v50
  v_mfma_f32_16x16x32_bf16 v[60:63], a[88:91], v[176:179], v[60:63]
  v_mfma_f32_16x16x32_bf16 v[60:63], a[92:95], v[184:187], v[60:63]
  s_waitcnt lgkmcnt(0)
  v_exp_f32 v51, v51
  s_nop 0
  v_cvt_pk_bf16_f32 v49, v50, v51
  v_exp_f32 v52, v52
  v_exp_f32 v53, v53
  s_nop 0
  v_cvt_pk_bf16_f32 v50, v52, v53
  v_exp_f32 v54, v54
  v_exp_f32 v55, v55
  s_nop 0
  v_cvt_pk_bf16_f32 v51, v54, v55
  v_exp_f32 v56, v56
  v_exp_f32 v57, v57
  s_nop 0
  v_cvt_pk_bf16_f32 v56, v56, v57
  v_exp_f32 v58, v58
  v_exp_f32 v59, v59
  s_nop 0
  v_cvt_pk_bf16_f32 v57, v58, v59
  v_exp_f32 v60, v60
  v_mfma_f32_16x16x32_bf16 v[32:35], a[64:67], v[192:195], 0
  v_mfma_f32_16x16x32_bf16 v[32:35], a[68:71], v[200:203], v[32:35]
  v_exp_f32 v61, v61
  v_mfma_f32_16x16x32_bf16 v[32:35], a[72:75], v[208:211], v[32:35]
  v_cvt_pk_bf16_f32 v58, v60, v61
  v_mfma_f32_16x16x32_bf16 v[32:35], a[76:79], v[216:219], v[32:35]
  v_exp_f32 v62, v62
  v_mfma_f32_16x16x32_bf16 v[36:39], a[80:83], v[192:195], 0
  buffer_store_dwordx4 a[32:35], v12, s[16:19], s29 offen offset:0 sc1
  v_mfma_f32_16x16x32_bf16 v[36:39], a[84:87], v[200:203], v[36:39]
  v_exp_f32 v63, v63
  v_mfma_f32_16x16x32_bf16 v[36:39], a[88:91], v[208:211], v[36:39]
  v_cvt_pk_bf16_f32 v59, v62, v63
  v_mfma_f32_16x16x32_bf16 v[36:39], a[92:95], v[216:219], v[36:39]
  v_mfma_f32_16x16x32_bf16 v[40:43], a[64:67], v[224:227], 0
  v_and_b32 v6, 7, v0
  v_lshlrev_b32 v6, 9, v6
  v_mfma_f32_16x16x32_bf16 v[40:43], a[68:71], v[232:235], v[40:43]
  s_andn2_b32 s26, s93, 0xe00
  v_exp_f32 v32, v32
  v_mfma_f32_16x16x32_bf16 v[40:43], a[72:75], v[240:243], v[40:43]
  v_mfma_f32_16x16x32_bf16 v[40:43], a[76:79], v[248:251], v[40:43]
  s_add_u32 s26, s26, 32768
  v_exp_f32 v33, v33
  v_mfma_f32_16x16x32_bf16 v[44:47], a[80:83], v[224:227], 0
  v_cvt_pk_bf16_f32 v32, v32, v33
  v_mfma_f32_16x16x32_bf16 v[44:47], a[84:87], v[232:235], v[44:47]
  v_exp_f32 v34, v34
  v_mfma_f32_16x16x32_bf16 v[44:47], a[88:91], v[240:243], v[44:47]
  buffer_load_dword v6, v6, s[20:23], s26 offen sc1
  v_mfma_f32_16x16x32_bf16 v[44:47], a[92:95], v[248:251], v[44:47]
  v_exp_f32 v35, v35
  v_mfma_f32_16x16x32_bf16 v[64:67], a[128:131], v[48:51], 0
  v_cvt_pk_bf16_f32 v33, v34, v35
  v_mfma_f32_16x16x32_bf16 v[132:135], a[132:135], v[48:51], 0
  v_exp_f32 v36, v36
  v_mfma_f32_16x16x32_bf16 v[68:71], a[136:139], v[48:51], 0
  ds_read_b128 a[64:67], v4 offset:16384
  ds_read_b128 a[68:71], v4 offset:17408
  v_mfma_f32_16x16x32_bf16 v[140:143], a[140:143], v[48:51], 0
  v_exp_f32 v37, v37
  v_mfma_f32_16x16x32_bf16 v[72:75], a[144:147], v[48:51], 0
  ds_read_b128 a[72:75], v4 offset:18432
  v_cvt_pk_bf16_f32 v34, v36, v37
  v_mfma_f32_16x16x32_bf16 v[148:151], a[148:151], v[48:51], 0
  v_exp_f32 v38, v38
  v_mfma_f32_16x16x32_bf16 v[76:79], a[152:155], v[48:51], 0
  ds_read_b128 a[76:79], v4 offset:19456
  ds_read_b128 a[80:83], v4 offset:20480
  v_mfma_f32_16x16x32_bf16 v[156:159], a[156:159], v[48:51], 0
  buffer_store_dwordx4 a[40:43], v12, s[16:19], s29 offen offset:1024 sc1
  v_exp_f32 v39, v39
  v_mfma_f32_16x16x32_bf16 a[160:163], a[224:227], v[48:51], 0
  s_add_u32 s28, s101, s82
  ds_read_b128 a[84:87], v4 offset:21504
  v_cvt_pk_bf16_f32 v35, v38, v39
  v_mfma_f32_16x16x32_bf16 v[80:83], a[128:131], v[56:59], 0
  v_exp_f32 v40, v40
  v_mfma_f32_16x16x32_bf16 v[164:167], a[132:135], v[56:59], 0
  ds_read_b128 a[88:91], v4 offset:22528
  ds_read_b128 a[92:95], v4 offset:23552
  v_mfma_f32_16x16x32_bf16 v[84:87], a[136:139], v[56:59], 0
  v_exp_f32 v41, v41
  v_mfma_f32_16x16x32_bf16 v[172:175], a[140:143], v[56:59], 0
  v_cvt_pk_bf16_f32 v40, v40, v41
  v_mfma_f32_16x16x32_bf16 v[88:91], a[144:147], v[56:59], 0
  v_exp_f32 v42, v42
  v_mfma_f32_16x16x32_bf16 v[180:183], a[148:151], v[56:59], 0
  buffer_store_dwordx4 a[16:19], v12, s[16:19], s28 offen offset:0 sc1
  v_mfma_f32_16x16x32_bf16 v[92:95], a[152:155], v[56:59], 0
  v_exp_f32 v43, v43
  v_mfma_f32_16x16x32_bf16 v[188:191], a[156:159], v[56:59], 0
  v_cvt_pk_bf16_f32 v41, v42, v43
  v_mfma_f32_16x16x32_bf16 a[164:167], a[224:227], v[56:59], 0
  s_waitcnt lgkmcnt(0)
  v_exp_f32 v44, v44
  v_mfma_f32_16x16x32_bf16 v[48:51], a[64:67], v[192:195], v[16:19]
  ds_read_b128 a[96:99], v4 offset:24576
  ds_read_b128 a[100:103], v4 offset:25600
  v_mfma_f32_16x16x32_bf16 v[48:51], a[68:71], v[200:203], v[48:51]
  v_exp_f32 v45, v45
  v_mfma_f32_16x16x32_bf16 v[48:51], a[72:75], v[208:211], v[48:51]
  ds_read_b128 a[104:107], v4 offset:26624
  v_cvt_pk_bf16_f32 v42, v44, v45
  v_mfma_f32_16x16x32_bf16 v[48:51], a[76:79], v[216:219], v[48:51]
  v_exp_f32 v46, v46
  v_mfma_f32_16x16x32_bf16 v[52:55], a[80:83], v[192:195], v[20:23]
  ds_read_b128 a[108:111], v4 offset:27648
  ds_read_b128 a[112:115], v4 offset:28672
  v_mfma_f32_16x16x32_bf16 v[52:55], a[84:87], v[200:203], v[52:55]
  v_exp_f32 v47, v47
  v_mfma_f32_16x16x32_bf16 v[52:55], a[88:91], v[208:211], v[52:55]
  ds_read_b128 a[116:119], v4 offset:29696
  v_cvt_pk_bf16_f32 v43, v46, v47
  v_mfma_f32_16x16x32_bf16 v[52:55], a[92:95], v[216:219], v[52:55]
  buffer_store_dwordx4 a[20:23], v12, s[16:19], s28 offen offset:1024 sc1
  v_mfma_f32_16x16x32_bf16 v[56:59], a[64:67], v[224:227], 0
  ds_read_b128 a[120:123], v4 offset:30720
  ds_read_b128 a[124:127], v4 offset:31744
  v_mfma_f32_16x16x32_bf16 v[56:59], a[68:71], v[232:235], v[56:59]
  v_exp_f32 v48, v48
  v_mfma_f32_16x16x32_bf16 v[56:59], a[72:75], v[240:243], v[56:59]
  v_mfma_f32_16x16x32_bf16 v[56:59], a[76:79], v[248:251], v[56:59]
  v_exp_f32 v49, v49
  v_mfma_f32_16x16x32_bf16 v[60:63], a[80:83], v[224:227], v[16:19]
  v_cvt_pk_bf16_f32 v48, v48, v49
  v_mfma_f32_16x16x32_bf16 v[60:63], a[84:87], v[232:235], v[60:63]
  v_exp_f32 v50, v50
  v_mfma_f32_16x16x32_bf16 v[60:63], a[88:91], v[240:243], v[60:63]
  v_mfma_f32_16x16x32_bf16 v[60:63], a[92:95], v[248:251], v[60:63]
  v_exp_f32 v51, v51
  v_mfma_f32_16x16x32_bf16 v[96:99], a[128:131], v[32:35], 0
  v_cvt_pk_bf16_f32 v49, v50, v51
  v_mfma_f32_16x16x32_bf16 v[196:199], a[132:135], v[32:35], 0
  v_exp_f32 v52, v52
  v_mfma_f32_16x16x32_bf16 v[100:103], a[136:139], v[32:35], 0
  ds_read_b128 a[64:67], v4 offset:32768
  ds_read_b128 a[68:71], v4 offset:33792
  v_mfma_f32_16x16x32_bf16 v[204:207], a[140:143], v[32:35], 0
  v_exp_f32 v53, v53
  v_mfma_f32_16x16x32_bf16 v[104:107], a[144:147], v[32:35], 0
  ds_read_b128 a[72:75], v4 offset:34816
  v_cvt_pk_bf16_f32 v50, v52, v53
  v_mfma_f32_16x16x32_bf16 v[212:215], a[148:151], v[32:35], 0
  v_exp_f32 v54, v54
  v_mfma_f32_16x16x32_bf16 v[108:111], a[152:155], v[32:35], 0
  ds_read_b128 a[76:79], v4 offset:35840
  ds_read_b128 a[80:83], v4 offset:36864
  v_mfma_f32_16x16x32_bf16 v[220:223], a[156:159], v[32:35], 0
  v_exp_f32 v55, v55
  v_mfma_f32_16x16x32_bf16 a[168:171], a[224:227], v[32:35], 0
  ds_read_b128 a[84:87], v4 offset:37888
  v_cvt_pk_bf16_f32 v51, v54, v55
  v_mfma_f32_16x16x32_bf16 v[112:115], a[128:131], v[40:43], 0
  v_exp_f32 v56, v56
  v_mfma_f32_16x16x32_bf16 v[228:231], a[132:135], v[40:43], 0
  ds_read_b128 a[88:91], v4 offset:38912
  ds_read_b128 a[92:95], v4 offset:39936
  v_mfma_f32_16x16x32_bf16 v[116:119], a[136:139], v[40:43], 0
  buffer_store_dwordx4 a[24:27], v12, s[16:19], s28 offen offset:2048 sc1
  v_exp_f32 v57, v57
  v_mfma_f32_16x16x32_bf16 v[236:239], a[140:143], v[40:43], 0
  v_cvt_pk_bf16_f32 v56, v56, v57
  v_mfma_f32_16x16x32_bf16 v[120:123], a[144:147], v[40:43], 0
  v_exp_f32 v58, v58
  v_mfma_f32_16x16x32_bf16 v[244:247], a[148:151], v[40:43], 0
  s_waitcnt vmcnt(4)
  v_xor_b32 v6, s92, v6
  v_cmp_lt_u32 vcc, 15, v6
  v_mfma_f32_16x16x32_bf16 v[124:127], a[152:155], v[40:43], 0
  v_exp_f32 v59, v59
  v_mfma_f32_16x16x32_bf16 v[252:255], a[156:159], v[40:43], 0
  v_cvt_pk_bf16_f32 v57, v58, v59
  v_mfma_f32_16x16x32_bf16 a[172:175], a[224:227], v[40:43], 0
  s_cbranch_vccnz spin3
spun3:
  s_waitcnt lgkmcnt(0)
  v_exp_f32 v60, v60
  v_mfma_f32_16x16x32_bf16 v[32:35], a[64:67], v[128:131], 0
  s_mov_b32 s78, 0
  ds_read_b128 a[128:131], v4 offset:40960
  ds_read_b128 a[132:135], v4 offset:41984
  v_mfma_f32_16x16x32_bf16 v[32:35], a[68:71], v[136:139], v[32:35]
  s_cmp_eq_u32 s78, s62
  v_exp_f32 v61, v61
  v_mfma_f32_16x16x32_bf16 v[32:35], a[72:75], v[144:147], v[32:35]
  s_cmov_b32 s78, s79
  ds_read_b128 a[136:139], v4 offset:43008
  v_cvt_pk_bf16_f32 v58, v60, v61
  v_mfma_f32_16x16x32_bf16 v[32:35], a[76:79], v[152:155], v[32:35]
  s_cmp_eq_u32 s78, s63
  v_exp_f32 v62, v62
  v_mfma_f32_16x16x32_bf16 v[36:39], a[80:83], v[128:131], 0
  s_cmov_b32 s78, s94
  ds_read_b128 a[140:143], v4 offset:44032
  ds_read_b128 a[144:147], v4 offset:45056
  v_mfma_f32_16x16x32_bf16 v[36:39], a[84:87], v[136:139], v[36:39]
  s_mov_b32 m0, s65
  buffer_store_dwordx4 a[28:31], v12, s[16:19], s28 offen offset:3072 sc1
  v_exp_f32 v63, v63
  v_mfma_f32_16x16x32_bf16 v[36:39], a[88:91], v[144:147], v[36:39]
  s_add_u32 s65, s65, 16384
  ds_read_b128 a[148:151], v4 offset:46080
  v_cvt_pk_bf16_f32 v59, v62, v63
  v_mfma_f32_16x16x32_bf16 v[36:39], a[92:95], v[152:155], v[36:39]
  buffer_load_dwordx4 v28, s[16:19], s78 offen offset:0 sc1 lds
  v_mfma_f32_16x16x32_bf16 v[40:43], a[64:67], v[160:163], 0
  ds_read_b128 a[152:155], v4 offset:47104
  ds_read_b128 a[156:159], v4 offset:48128
  v_mfma_f32_16x16x32_bf16 v[40:43], a[68:71], v[168:171], v[40:43]
  v_exp_f32 v32, v32
  v_mfma_f32_16x16x32_bf16 v[40:43], a[72:75], v[176:179], v[40:43]
  buffer_load_dwordx4 v28, s[16:19], s78 offen offset:1024 sc1 lds
  v_mfma_f32_16x16x32_bf16 v[40:43], a[76:79], v[184:187], v[40:43]
  v_exp_f32 v33, v33
  v_mfma_f32_16x16x32_bf16 v[44:47], a[80:83], v[160:163], 0
  v_cvt_pk_bf16_f32 v32, v32, v33
  v_mfma_f32_16x16x32_bf16 v[44:47], a[84:87], v[168:171], v[44:47]
  s_sub_u32 s25, s65, 163840
  v_exp_f32 v34, v34
  v_mfma_f32_16x16x32_bf16 v[44:47], a[88:91], v[176:179], v[44:47]
  buffer_load_dwordx4 v28, s[16:19], s78 offen offset:2048 sc1 lds
  v_mfma_f32_16x16x32_bf16 v[44:47], a[92:95], v[184:187], v[44:47]
  s_min_u32 s65, s65, s25
  v_exp_f32 v35, v35
  v_mfma_f32_16x16x32_bf16 v[96:99], a[96:99], v[48:51], v[96:99]
  v_cvt_pk_bf16_f32 v33, v34, v35
  v_mfma_f32_16x16x32_bf16 v[196:199], a[100:103], v[48:51], v[196:199]
  v_exp_f32 v36, v36
  v_mfma_f32_16x16x32_bf16 v[100:103], a[104:107], v[48:51], v[100:103]
  v_mfma_f32_16x16x32_bf16 v[204:207], a[108:111], v[48:51], v[204:207]
  v_exp_f32 v37, v37
  v_mfma_f32_16x16x32_bf16 v[104:107], a[112:115], v[48:51], v[104:107]
  v_cvt_pk_bf16_f32 v34, v36, v37
  v_mfma_f32_16x16x32_bf16 v[212:215], a[116:119], v[48:51], v[212:215]
  v_exp_f32 v38, v38
  v_mfma_f32_16x16x32_bf16 v[108:111], a[120:123], v[48:51], v[108:111]
  v_mfma_f32_16x16x32_bf16 v[220:223], a[124:127], v[48:51], v[220:223]
  v_exp_f32 v39, v39
  v_mfma_f32_16x16x32_bf16 a[168:171], a[224:227], v[48:51], a[168:171]
  v_cvt_pk_bf16_f32 v35, v38, v39
  v_mfma_f32_16x16x32_bf16 v[112:115], a[96:99], v[56:59], v[112:115]
  v_exp_f32 v40, v40
  v_mfma_f32_16x16x32_bf16 v[228:231], a[100:103], v[56:59], v[228:231]
  v_mfma_f32_16x16x32_bf16 v[116:119], a[104:107], v[56:59], v[116:119]
  v_exp_f32 v41, v41
  v_mfma_f32_16x16x32_bf16 v[236:239], a[108:111], v[56:59], v[236:239]
  v_cvt_pk_bf16_f32 v40, v40, v41
  v_mfma_f32_16x16x32_bf16 v[120:123], a[112:115], v[56:59], v[120:123]
  v_exp_f32 v42, v42
  v_mfma_f32_16x16x32_bf16 v[244:247], a[116:119], v[56:59], v[244:247]
  buffer_load_dwordx4 v28, s[16:19], s78 offen offset:3072 sc1 lds
  v_mfma_f32_16x16x32_bf16 v[124:127], a[120:123], v[56:59], v[124:127]
  v_exp_f32 v43, v43
  v_mfma_f32_16x16x32_bf16 v[252:255], a[124:127], v[56:59], v[252:255]
  v_cvt_pk_bf16_f32 v41, v42, v43
  v_mfma_f32_16x16x32_bf16 a[172:175], a[224:227], v[56:59], a[172:175]
  s_waitcnt lgkmcnt(0)
  v_exp_f32 v44, v44
  v_mfma_f32_16x16x32_bf16 v[48:51], a[64:67], v[192:195], 0
  s_add_u32 s78, s78, 16384
  v_mfma_f32_16x16x32_bf16 v[48:51], a[68:71], v[200:203], v[48:51]
  s_cmp_eq_u32 s78, s62
  v_exp_f32 v45, v45
  v_mfma_f32_16x16x32_bf16 v[48:51], a[72:75], v[208:211], v[48:51]
  s_cmov_b32 s78, s79
  v_cvt_pk_bf16_f32 v42, v44, v45
  v_mfma_f32_16x16x32_bf16 v[48:51], a[76:79], v[216:219], v[48:51]
  s_cmp_eq_u32 s78, s63
  v_exp_f32 v46, v46
  v_mfma_f32_16x16x32_bf16 v[52:55], a[80:83], v[192:195], 0
  s_cmov_b32 s78, s94
  v_mfma_f32_16x16x32_bf16 v[52:55], a[84:87], v[200:203], v[52:55]
  s_mov_b32 m0, s65
  v_exp_f32 v47, v47
  v_mfma_f32_16x16x32_bf16 v[52:55], a[88:91], v[208:211], v[52:55]
  s_add_u32 s65, s65, 16384
  v_cvt_pk_bf16_f32 v43, v46, v47
  v_mfma_f32_16x16x32_bf16 v[52:55], a[92:95], v[216:219], v[52:55]
  buffer_load_dwordx4 v28, s[16:19], s78 offen offset:0 sc1 lds
  v_mfma_f32_16x16x32_bf16 v[56:59], a[64:67], v[224:227], 0
  v_mfma_f32_16x16x32_bf16 v[56:59], a[68:71], v[232:235], v[56:59]
  v_exp_f32 v48, v48
  v_mfma_f32_16x16x32_bf16 v[56:59], a[72:75], v[240:243], v[56:59]
  buffer_load_dwordx4 v28, s[16:19], s78 offen offset:1024 sc1 lds
  v_mfma_f32_16x16x32_bf16 v[56:59], a[76:79], v[248:251], v[56:59]
  v_exp_f32 v49, v49
  v_mfma_f32_16x16x32_bf16 v[60:63], a[80:83], v[224:227], 0
  v_cvt_pk_bf16_f32 v48, v48, v49
  v_mfma_f32_16x16x32_bf16 v[60:63], a[84:87], v[232:235], v[60:63]
  s_sub_u32 s25, s65, 163840
  v_exp_f32 v50, v50
  v_mfma_f32_16x16x32_bf16 v[60:63], a[88:91], v[240:243], v[60:63]
  buffer_load_dwordx4 v28, s[16:19], s78 offen offset:2048 sc1 lds
  v_mfma_f32_16x16x32_bf16 v[60:63], a[92:95], v[248:251], v[60:63]
  s_min_u32 s65, s65, s25
  v_exp_f32 v51, v51
  v_mfma_f32_16x16x32_bf16 v[64:67], a[128:131], v[32:35], v[64:67]
  s_waitcnt lgkmcnt(0)
  s_barrier
  v_cvt_pk_bf16_f32 v49, v50, v51
  v_mfma_f32_16x16x32_bf16 v[132:135], a[132:135], v[32:35], v[132:135]
  v_exp_f32 v52, v52
  v_mfma_f32_16x16x32_bf16 v[68:71], a[136:139], v[32:35], v[68:71]
  ds_read_b128 a[64:67], v12 offset:0
  ds_read_b128 a[68:71], v12 offset:1024
  v_mfma_f32_16x16x32_bf16 v[140:143], a[140:143], v[32:35], v[140:143]
  v_exp_f32 v53, v53
  v_mfma_f32_16x16x32_bf16 v[72:75], a[144:147], v[32:35], v[72:75]
  ds_read_b128 a[72:75], v12 offset:2048
  v_cvt_pk_bf16_f32 v50, v52, v53
  v_mfma_f32_16x16x32_bf16 v[148:151], a[148:151], v[32:35], v[148:151]
  v_exp_f32 v54, v54
  v_mfma_f32_16x16x32_bf16 v[76:79], a[152:155], v[32:35], v[76:79]
  ds_read_b128 a[76:79], v12 offset:3072
  ds_read_b128 a[80:83], v12 offset:4096
  v_mfma_f32_16x16x32_bf16 v[156:159], a[156:159], v[32:35], v[156:159]
  v_exp_f32 v55, v55
  v_mfma_f32_16x16x32_bf16 a[160:163], a[224:227], v[32:35], a[160:163]
  ds_read_b128 a[84:87], v12 offset:5120
  v_cvt_pk_bf16_f32 v51, v54, v55
  v_mfma_f32_16x16x32_bf16 v[80:83], a[128:131], v[40:43], v[80:83]
  v_exp_f32 v56, v56
  v_mfma_f32_16x16x32_bf16 v[164:167], a[132:135], v[40:43], v[164:167]
  ds_read_b128 a[88:91], v12 offset:6144
  ds_read_b128 a[92:95], v12 offset:7168
  v_mfma_f32_16x16x32_bf16 v[84:87], a[136:139], v[40:43], v[84:87]
  v_exp_f32 v57, v57
  v_mfma_f32_16x16x32_bf16 v[172:175], a[140:143], v[40:43], v[172:175]
  v_cvt_pk_bf16_f32 v56, v56, v57
  v_mfma_f32_16x16x32_bf16 v[88:91], a[144:147], v[40:43], v[88:91]
  v_exp_f32 v58, v58
  v_mfma_f32_16x16x32_bf16 v[180:183], a[148:151], v[40:43], v[180:183]
  buffer_load_dwordx4 v28, s[16:19], s78 offen offset:3072 sc1 lds
  v_mfma_f32_16x16x32_bf16 v[92:95], a[152:155], v[40:43], v[92:95]
  v_exp_f32 v59, v59
  v_mfma_f32_16x16x32_bf16 v[188:191], a[156:159], v[40:43], v[188:191]
  v_cvt_pk_bf16_f32 v57, v58, v59
  v_mfma_f32_16x16x32_bf16 a[164:167], a[224:227], v[40:43], a[164:167]
  s_waitcnt lgkmcnt(0)
  v_exp_f32 v60, v60
  v_mfma_f32_16x16x32_bf16 v[32:35], a[64:67], v[128:131], 0
  s_add_u32 s78, s78, 16384
  ds_read_b128 a[96:99], v12 offset:8192
  ds_read_b128 a[100:103], v12 offset:9216
  v_mfma_f32_16x16x32_bf16 v[32:35], a[68:71], v[136:139], v[32:35]
  s_cmp_eq_u32 s78, s62
  v_exp_f32 v61, v61
  v_mfma_f32_16x16x32_bf16 v[32:35], a[72:75], v[144:147], v[32:35]
  s_cmov_b32 s78, s79
  ds_read_b128 a[104:107], v12 offset:10240
  v_cvt_pk_bf16_f32 v58, v60, v61
  v_mfma_f32_16x16x32_bf16 v[32:35], a[76:79], v[152:155], v[32:35]
  s_cmp_eq_u32 s78, s63
  v_exp_f32 v62, v62
  v_mfma_f32_16x16x32_bf16 v[36:39], a[80:83], v[128:131], 0
  s_cmov_b32 s78, s94
  ds_read_b128 a[108:111], v12 offset:11264
  ds_read_b128 a[112:115], v12 offset:12288
  v_mfma_f32_16x16x32_bf16 v[36:39], a[84:87], v[136:139], v[36:39]
  s_mov_b32 m0, s65
  v_exp_f32 v63, v63
  v_mfma_f32_16x16x32_bf16 v[36:39], a[88:91], v[144:147], v[36:39]
  s_add_u32 s65, s65, 16384
  ds_read_b128 a[116:119], v12 offset:13312
  v_cvt_pk_bf16_f32 v59, v62, v63
  v_mfma_f32_16x16x32_bf16 v[36:39], a[92:95], v[152:155], v[36:39]
  buffer_load_dwordx4 v28, s[16:19], s78 offen offset:0 sc1 lds
  v_mfma_f32_16x16x32_bf16 v[40:43], a[64:67], v[160:163], 0
  ds_read_b128 a[120:123], v12 offset:14336
  ds_read_b128 a[124:127], v12 offset:15360
  v_mfma_f32_16x16x32_bf16 v[40:43], a[68:71], v[168:171], v[40:43]
  v_exp_f32 v32, v32
  v_mfma_f32_16x16x32_bf16 v[40:43], a[72:75], v[176:179], v[40:43]
  buffer_load_dwordx4 v28, s[16:19], s78 offen offset:1024 sc1 lds
  v_mfma_f32_16x16x32_bf16 v[40:43], a[76:79], v[184:187], v[40:43]
  v_exp_f32 v33, v33
  v_mfma_f32_16x16x32_bf16 v[44:47], a[80:83], v[160:163], 0
  v_cvt_pk_bf16_f32 v32, v32, v33
  v_mfma_f32_16x16x32_bf16 v[44:47], a[84:87], v[168:171], v[44:47]
  s_sub_u32 s25, s65, 163840
  v_exp_f32 v34, v34
  v_mfma_f32_16x16x32_bf16 v[44:47], a[88:91], v[176:179], v[44:47]
  buffer_load_dwordx4 v28, s[16:19], s78 offen offset:2048 sc1 lds
  v_mfma_f32_16x16x32_bf16 v[44:47], a[92:95], v[184:187], v[44:47]
  s_min_u32 s65, s65, s25
  v_exp_f32 v35, v35
  v_mfma_f32_16x16x32_bf16 v[96:99], a[128:131], v[48:51], v[96:99]
  v_cvt_pk_bf16_f32 v33, v34, v35
  v_mfma_f32_16x16x32_bf16 v[196:199], a[132:135], v[48:51], v[196:199]
  v_exp_f32 v36, v36
  v_mfma_f32_16x16x32_bf16 v[100:103], a[136:139], v[48:51], v[100:103]
  v_mfma_f32_16x16x32_bf16 v[204:207], a[140:143], v[48:51], v[204:207]
  v_exp_f32 v37, v37
  v_mfma_f32_16x16x32_bf16 v[104:107], a[144:147], v[48:51], v[104:107]
  v_cvt_pk_bf16_f32 v34, v36, v37
  v_mfma_f32_16x16x32_bf16 v[212:215], a[148:151], v[48:51], v[212:215]
  v_exp_f32 v38, v38
  v_mfma_f32_16x16x32_bf16 v[108:111], a[152:155], v[48:51], v[108:111]
  v_mfma_f32_16x16x32_bf16 v[220:223], a[156:159], v[48:51], v[220:223]
  v_exp_f32 v39, v39
  v_mfma_f32_16x16x32_bf16 a[168:171], a[224:227], v[48:51], a[168:171]
  v_cvt_pk_bf16_f32 v35, v38, v39
  v_mfma_f32_16x16x32_bf16 v[112:115], a[128:131], v[56:59], v[112:115]
  v_exp_f32 v40, v40
  v_mfma_f32_16x16x32_bf16 v[228:231], a[132:135], v[56:59], v[228:231]
  v_mfma_f32_16x16x32_bf16 v[116:119], a[136:139], v[56:59], v[116:119]
  v_exp_f32 v41, v41
  v_mfma_f32_16x16x32_bf16 v[236:239], a[140:143], v[56:59], v[236:239]
  v_cvt_pk_bf16_f32 v40, v40, v41
  v_mfma_f32_16x16x32_bf16 v[120:123], a[144:147], v[56:59], v[120:123]
  v_exp_f32 v42, v42
  v_mfma_f32_16x16x32_bf16 v[244:247], a[148:151], v[56:59], v[244:247]
  buffer_load_dwordx4 v28, s[16:19], s78 offen offset:3072 sc1 lds
  v_mfma_f32_16x16x32_bf16 v[124:127], a[152:155], v[56:59], v[124:127]
  v_exp_f32 v43, v43
  v_mfma_f32_16x16x32_bf16 v[252:255], a[156:159], v[56:59], v[252:255]
  v_cvt_pk_bf16_f32 v41, v42, v43
  v_mfma_f32_16x16x32_bf16 a[172:175], a[224:227], v[56:59], a[172:175]
  s_waitcnt lgkmcnt(0)
  v_exp_f32 v44, v44
  v_mfma_f32_16x16x32_bf16 v[48:51], a[64:67], v[192:195], 0
  s_add_u32 s78, s78, 16384
  v_mfma_f32_16x16x32_bf16 v[48:51], a[68:71], v[200:203], v[48:51]
  s_cmp_eq_u32 s78, s62
  v_exp_f32 v45, v45
  v_mfma_f32_16x16x32_bf16 v[48:51], a[72:75], v[208:211], v[48:51]
  s_cmov_b32 s78, s79
  v_cvt_pk_bf16_f32 v42, v44, v45
  v_mfma_f32_16x16x32_bf16 v[48:51], a[76:79], v[216:219], v[48:51]
  s_cmp_eq_u32 s78, s63
  v_exp_f32 v46, v46
  v_mfma_f32_16x16x32_bf16 v[52:55], a[80:83], v[192:195], 0
  s_cmov_b32 s78, s94
  v_mfma_f32_16x16x32_bf16 v[52:55], a[84:87], v[200:203], v[52:55]
  s_mov_b32 m0, s65
  v_exp_f32 v47, v47
  v_mfma_f32_16x16x32_bf16 v[52:55], a[88:91], v[208:211], v[52:55]
  s_add_u32 s65, s65, 16384
  v_cvt_pk_bf16_f32 v43, v46, v47
  v_mfma_f32_16x16x32_bf16 v[52:55], a[92:95], v[216:219], v[52:55]
  buffer_load_dwordx4 v28, s[16:19], s78 offen offset:0 sc1 lds
  v_mfma_f32_16x16x32_bf16 v[56:59], a[64:67], v[224:227], 0
  v_mfma_f32_16x16x32_bf16 v[56:59], a[68:71], v[232:235], v[56:59]
  v_exp_f32 v48, v48
  v_mfma_f32_16x16x32_bf16 v[56:59], a[72:75], v[240:243], v[56:59]
  buffer_load_dwordx4 v28, s[16:19], s78 offen offset:1024 sc1 lds
  v_mfma_f32_16x16x32_bf16 v[56:59], a[76:79], v[248:251], v[56:59]
  v_exp_f32 v49, v49
  v_mfma_f32_16x16x32_bf16 v[60:63], a[80:83], v[224:227], 0
  v_cvt_pk_bf16_f32 v48, v48, v49
  v_mfma_f32_16x16x32_bf16 v[60:63], a[84:87], v[232:235], v[60:63]
  s_sub_u32 s25, s65, 163840
  v_exp_f32 v50, v50
  v_mfma_f32_16x16x32_bf16 v[60:63], a[88:91], v[240:243], v[60:63]
  buffer_load_dwordx4 v28, s[16:19], s78 offen offset:2048 sc1 lds
  v_mfma_f32_16x16x32_bf16 v[60:63], a[92:95], v[248:251], v[60:63]
  s_min_u32 s65, s65, s25
  v_exp_f32 v51, v51
  v_mfma_f32_16x16x32_bf16 v[64:67], a[96:99], v[32:35], v[64:67]
  v_cvt_pk_bf16_f32 v49, v50, v51
  v_mfma_f32_16x16x32_bf16 v[132:135], a[100:103], v[32:35], v[132:135]
  s_mov_b32 s26, 60293120
  v_exp_f32 v52, v52
  v_mfma_f32_16x16x32_bf16 v[68:71], a[104:107], v[32:35], v[68:71]
  ds_read_b128 a[64:67], v12 offset:16384
  ds_read_b128 a[68:71], v12 offset:17408
  v_mfma_f32_16x16x32_bf16 v[140:143], a[108:111], v[32:35], v[140:143]
  v_exp_f32 v53, v53
  v_mfma_f32_16x16x32_bf16 v[72:75], a[112:115], v[32:35], v[72:75]
  ds_read_b128 a[72:75], v12 offset:18432
  v_cvt_pk_bf16_f32 v50, v52, v53
  v_mfma_f32_16x16x32_bf16 v[148:151], a[116:119], v[32:35], v[148:151]
  v_exp_f32 v54, v54
  v_mfma_f32_16x16x32_bf16 v[76:79], a[120:123], v[32:35], v[76:79]
  ds_read_b128 a[76:79], v12 offset:19456
  ds_read_b128 a[80:83], v12 offset:20480
  v_mfma_f32_16x16x32_bf16 v[156:159], a[124:127], v[32:35], v[156:159]
  v_exp_f32 v55, v55
  v_mfma_f32_16x16x32_bf16 a[160:163], a[224:227], v[32:35], a[160:163]
  ds_read_b128 a[84:87], v12 offset:21504
  v_cvt_pk_bf16_f32 v51, v54, v55
  v_mfma_f32_16x16x32_bf16 v[80:83], a[96:99], v[40:43], v[80:83]
  v_exp_f32 v56, v56
  v_mfma_f32_16x16x32_bf16 v[164:167], a[100:103], v[40:43], v[164:167]
  ds_read_b128 a[88:91], v12 offset:22528
  ds_read_b128 a[92:95], v12 offset:23552
  v_mfma_f32_16x16x32_bf16 v[84:87], a[104:107], v[40:43], v[84:87]
  v_exp_f32 v57, v57
  v_mfma_f32_16x16x32_bf16 v[172:175], a[108:111], v[40:43], v[172:175]
  buffer_load_dword v6, v14, s[20:23], s26 offen sc1
  v_cvt_pk_bf16_f32 v56, v56, v57
  v_mfma_f32_16x16x32_bf16 v[88:91], a[112:115], v[40:43], v[88:91]
  v_exp_f32 v58, v58
  v_mfma_f32_16x16x32_bf16 v[180:183], a[116:119], v[40:43], v[180:183]
  buffer_load_dwordx4 v28, s[16:19], s78 offen offset:3072 sc1 lds
  v_mfma_f32_16x16x32_bf16 v[92:95], a[120:123], v[40:43], v[92:95]
  v_exp_f32 v59, v59
  v_mfma_f32_16x16x32_bf16 v[188:191], a[124:127], v[40:43], v[188:191]
  v_cvt_pk_bf16_f32 v57, v58, v59
  v_mfma_f32_16x16x32_bf16 a[164:167], a[224:227], v[40:43], a[164:167]
  s_waitcnt lgkmcnt(0)
  v_exp_f32 v60, v60
  v_mfma_f32_16x16x32_bf16 v[32:35], a[64:67], v[128:131], v[16:19]
  s_add_u32 s78, s78, 16384
  ds_read_b128 a[128:131], v12 offset:24576
  ds_read_b128 a[132:135], v12 offset:25600
  v_mfma_f32_16x16x32_bf16 v[32:35], a[68:71], v[136:139], v[32:35]
  s_cmp_eq_u32 s78, s62
  v_exp_f32 v61, v61
  v_mfma_f32_16x16x32_bf16 v[32:35], a[72:75], v[144:147], v[32:35]
  s_cmov_b32 s78, s79
  ds_read_b128 a[136:139], v12 offset:26624
  v_cvt_pk_bf16_f32 v58, v60, v61
  v_mfma_f32_16x16x32_bf16 v[32:35], a[76:79], v[152:155], v[32:35]
  s_cmp_eq_u32 s78, s63
  v_exp_f32 v62, v62
  v_mfma_f32_16x16x32_bf16 v[36:39], a[80:83], v[128:131], v[20:23]
  s_cmov_b32 s78, s94
  ds_read_b128 a[140:143], v12 offset:27648
  ds_read_b128 a[144:147], v12 offset:28672
  v_mfma_f32_16x16x32_bf16 v[36:39], a[84:87], v[136:139], v[36:39]
  s_mov_b32 m0, s65
  v_exp_f32 v63, v63
  v_mfma_f32_16x16x32_bf16 v[36:39], a[88:91], v[144:147], v[36:39]
  s_add_u32 s65, s65, 16384
  ds_read_b128 a[148:151], v12 offset:29696
  v_cvt_pk_bf16_f32 v59, v62, v63
  v_mfma_f32_16x16x32_bf16 v[36:39], a[92:95], v[152:155], v[36:39]
  buffer_load_dwordx4 v28, s[16:19], s78 offen offset:0 sc1 lds
  v_mfma_f32_16x16x32_bf16 v[40:43], a[64:67], v[160:163], 0
  ds_read_b128 a[152:155], v12 offset:30720
  ds_read_b128 a[156:159], v12 offset:31744
  v_mfma_f32_16x16x32_bf16 v[40:43], a[68:71], v[168:171], v[40:43]
  v_exp_f32 v32, v32
  v_mfma_f32_16x16x32_bf16 v[40:43], a[72:75], v[176:179], v[40:43]
  buffer_load_dwordx4 v28, s[16:19], s78 offen offset:1024 sc1 lds
  v_mfma_f32_16x16x32_bf16 v[40:43], a[76:79], v[184:187], v[40:43]
  v_exp_f32 v33, v33
  v_mfma_f32_16x16x32_bf16 v[44:47], a[80:83], v[160:163], v[16:19]
  v_cvt_pk_bf16_f32 v32, v32, v33
  v_mfma_f32_16x16x32_bf16 v[44:47], a[84:87], v[168:171], v[44:47]
  s_sub_u32 s25, s65, 163840
  v_exp_f32 v34, v34
  v_mfma_f32_16x16x32_bf16 v[44:47], a[88:91], v[176:179], v[44:47]
  buffer_load_dwordx4 v28, s[16:19], s78 offen offset:2048 sc1 lds
  v_mfma_f32_16x16x32_bf16 v[44:47], a[92:95], v[184:187], v[44:47]
  s_min_u32 s65, s65, s25
  v_exp_f32 v35, v35
  v_mfma_f32_16x16x32_bf16 v[96:99], a[96:99], v[48:51], v[96:99]
  v_cvt_pk_bf16_f32 v33, v34, v35
  v_mfma_f32_16x16x32_bf16 v[196:199], a[100:103], v[48:51], v[196:199]
  v_exp_f32 v36, v36
  v_mfma_f32_16x16x32_bf16 v[100:103], a[104:107], v[48:51], v[100:103]
  v_mfma_f32_16x16x32_bf16 v[204:207], a[108:111], v[48:51], v[204:207]
  v_exp_f32 v37, v37
  v_mfma_f32_16x16x32_bf16 v[104:107], a[112:115], v[48:51], v[104:107]
  v_cvt_pk_bf16_f32 v34, v36, v37
  v_mfma_f32_16x16x32_bf16 v[212:215], a[116:119], v[48:51], v[212:215]
  v_exp_f32 v38, v38
  v_mfma_f32_16x16x32_bf16 v[108:111], a[120:123], v[48:51], v[108:111]
  v_mfma_f32_16x16x32_bf16 v[220:223], a[124:127], v[48:51], v[220:223]
  v_exp_f32 v39, v39
  v_mfma_f32_16x16x32_bf16 a[168:171], a[224:227], v[48:51], a[168:171]
  v_cvt_pk_bf16_f32 v35, v38, v39
  v_mfma_f32_16x16x32_bf16 v[112:115], a[96:99], v[56:59], v[112:115]
  v_exp_f32 v40, v40
  v_mfma_f32_16x16x32_bf16 v[228:231], a[100:103], v[56:59], v[228:231]
  v_mfma_f32_16x16x32_bf16 v[116:119], a[104:107], v[56:59], v[116:119]
  v_exp_f32 v41, v41
  v_mfma_f32_16x16x32_bf16 v[236:239], a[108:111], v[56:59], v[236:239]
  v_cvt_pk_bf16_f32 v40, v40, v41
  v_mfma_f32_16x16x32_bf16 v[120:123], a[112:115], v[56:59], v[120:123]
  v_exp_f32 v42, v42
  v_mfma_f32_16x16x32_bf16 v[244:247], a[116:119], v[56:59], v[244:247]
  buffer_load_dwordx4 v28, s[16:19], s78 offen offset:3072 sc1 lds
  v_mfma_f32_16x16x32_bf16 v[124:127], a[120:123], v[56:59], v[124:127]
  v_exp_f32 v43, v43
  v_mfma_f32_16x16x32_bf16 v[252:255], a[124:127], v[56:59], v[252:255]
  v_cvt_pk_bf16_f32 v41, v42, v43
  v_mfma_f32_16x16x32_bf16 a[172:175], a[224:227], v[56:59], a[172:175]
  s_waitcnt lgkmcnt(0)
  v_exp_f32 v44, v44
  v_mfma_f32_16x16x32_bf16 v[48:51], a[64:67], v[192:195], 0
  s_add_u32 s78, s78, 16384
  v_mfma_f32_16x16x32_bf16 v[48:51], a[68:71], v[200:203], v[48:51]
  s_cmp_eq_u32 s78, s62
  v_exp_f32 v45, v45
  v_mfma_f32_16x16x32_bf16 v[48:51], a[72:75], v[208:211], v[48:51]
  s_cmov_b32 s78, s79
  v_cvt_pk_bf16_f32 v42, v44, v45
  v_mfma_f32_16x16x32_bf16 v[48:51], a[76:79], v[216:219], v[48:51]
  s_cmp_eq_u32 s78, s63
  v_exp_f32 v46, v46
  v_mfma_f32_16x16x32_bf16 v[52:55], a[80:83], v[192:195], 0
  s_cmov_b32 s78, s94
  v_mfma_f32_16x16x32_bf16 v[52:55], a[84:87], v[200:203], v[52:55]
  s_mov_b32 m0, s65
  v_exp_f32 v47, v47
  v_mfma_f32_16x16x32_bf16 v[52:55], a[88:91], v[208:211], v[52:55]
  s_add_u32 s65, s65, 16384
  v_cvt_pk_bf16_f32 v43, v46, v47
  v_mfma_f32_16x16x32_bf16 v[52:55], a[92:95], v[216:219], v[52:55]
  buffer_load_dwordx4 v28, s[16:19], s78 offen offset:0 sc1 lds
  v_mfma_f32_16x16x32_bf16 v[56:59], a[64:67], v[224:227], 0
  s_add_u32 s64, s64, 16384
  v_mfma_f32_16x16x32_bf16 v[56:59], a[68:71], v[232:235], v[56:59]
  s_sub_u32 s24, s64, 163840
  v_exp_f32 v48, v48
  v_mfma_f32_16x16x32_bf16 v[56:59], a[72:75], v[240:243], v[56:59]
  buffer_load_dwordx4 v28, s[16:19], s78 offen offset:1024 sc1 lds
  v_mfma_f32_16x16x32_bf16 v[56:59], a[76:79], v[248:251], v[56:59]
  s_min_u32 s64, s64, s24
  v_exp_f32 v49, v49
  v_mfma_f32_16x16x32_bf16 v[60:63], a[80:83], v[224:227], 0
  v_add_u32 v3, s64, v12
  v_cvt_pk_bf16_f32 v48, v48, v49
  v_mfma_f32_16x16x32_bf16 v[60:63], a[84:87], v[232:235], v[60:63]
  s_sub_u32 s25, s65, 163840
  v_exp_f32 v50, v50
  v_mfma_f32_16x16x32_bf16 v[60:63], a[88:91], v[240:243], v[60:63]
  buffer_load_dwordx4 v28, s[16:19], s78 offen offset:2048 sc1 lds
  v_mfma_f32_16x16x32_bf16 v[60:63], a[92:95], v[248:251], v[60:63]
  s_min_u32 s65, s65, s25
  v_exp_f32 v51, v51
  v_mfma_f32_16x16x32_bf16 v[64:67], a[128:131], v[32:35], v[64:67]
  s_waitcnt vmcnt(7) lgkmcnt(0)
  s_barrier
  v_cvt_pk_bf16_f32 v49, v50, v51
  v_mfma_f32_16x16x32_bf16 v[132:135], a[132:135], v[32:35], v[132:135]
  s_add_u32 s26, s93, 65536
  v_exp_f32 v52, v52
  v_mfma_f32_16x16x32_bf16 v[68:71], a[136:139], v[32:35], v[68:71]
  ds_read_b128 a[64:67], v3 offset:0
  ds_read_b128 a[68:71], v3 offset:1024
  v_mfma_f32_16x16x32_bf16 v[140:143], a[140:143], v[32:35], v[140:143]
  v_exp_f32 v53, v53
  v_mfma_f32_16x16x32_bf16 v[72:75], a[144:147], v[32:35], v[72:75]
  ds_read_b128 a[72:75], v3 offset:2048
  v_cvt_pk_bf16_f32 v50, v52, v53
  v_mfma_f32_16x16x32_bf16 v[148:151], a[148:151], v[32:35], v[148:151]
  v_exp_f32 v54, v54
  v_mfma_f32_16x16x32_bf16 v[76:79], a[152:155], v[32:35], v[76:79]
  ds_read_b128 a[76:79], v3 offset:3072
  ds_read_b128 a[80:83], v3 offset:4096
  v_mfma_f32_16x16x32_bf16 v[156:159], a[156:159], v[32:35], v[156:159]
  v_exp_f32 v55, v55
  v_mfma_f32_16x16x32_bf16 a[160:163], a[224:227], v[32:35], a[160:163]
  ds_read_b128 a[84:87], v3 offset:5120
  v_cvt_pk_bf16_f32 v51, v54, v55
  v_mfma_f32_16x16x32_bf16 v[80:83], a[128:131], v[40:43], v[80:83]
  v_exp_f32 v56, v56
  v_mfma_f32_16x16x32_bf16 v[164:167], a[132:135], v[40:43], v[164:167]
  ds_read_b128 a[88:91], v3 offset:6144
  ds_read_b128 a[92:95], v3 offset:7168
  v_mfma_f32_16x16x32_bf16 v[84:87], a[136:139], v[40:43], v[84:87]
  v_exp_f32 v57, v57
  v_mfma_f32_16x16x32_bf16 v[172:175], a[140:143], v[40:43], v[172:175]
  buffer_store_dword v30, v29, s[20:23], s26 offen sc1
  v_cvt_pk_bf16_f32 v56, v56, v57
  v_mfma_f32_16x16x32_bf16 v[88:91], a[144:147], v[40:43], v[88:91]
  v_exp_f32 v58, v58
  v_mfma_f32_16x16x32_bf16 v[180:183], a[148:151], v[40:43], v[180:183]
  buffer_load_dwordx4 v28, s[16:19], s78 offen offset:3072 sc1 lds
  v_mfma_f32_16x16x32_bf16 v[92:95], a[152:155], v[40:43], v[92:95]
  v_exp_f32 v59, v59
  v_mfma_f32_16x16x32_bf16 v[188:191], a[156:159], v[40:43], v[188:191]
  v_cvt_pk_bf16_f32 v57, v58, v59
  v_mfma_f32_16x16x32_bf16 a[164:167], a[224:227], v[40:43], a[164:167]
  s_waitcnt lgkmcnt(0)
  v_exp_f32 v60, v60
diag_done:
  v_xor_b32 v6, s92, v6
  v_cmp_lt_u32 vcc, 15, v6
  s_cmp_lt_u32 s6, 4
  s_cbranch_vccnz wspin
wspin_ok:
  s_cbranch_scc1 low_i
m64_first:
  v_mfma_f32_16x16x32_bf16 v[32:35], a[64:67], v[128:131], 0
  s_add_u32 s78, s78, 16384
  ds_read_b128 a[96:99], v3 offset:8192
  ds_read_b128 a[100:103], v3 offset:9216
  v_mfma_f32_16x16x32_bf16 v[32:35], a[68:71], v[136:139], v[32:35]
  s_cmp_eq_u32 s78, s62
  buffer_load_dwordx4 a[176:179], v28, s[20:23], s67 offen offset:0 sc1
  v_exp_f32 v61, v61
  v_mfma_f32_16x16x32_bf16 v[32:35], a[72:75], v[144:147], v[32:35]
  s_cmov_b32 s78, s79
  ds_read_b128 a[104:107], v3 offset:10240
  v_cvt_pk_bf16_f32 v58, v60, v61
  v_mfma_f32_16x16x32_bf16 v[32:35], a[76:79], v[152:155], v[32:35]
  s_cmp_eq_u32 s78, s63
  v_exp_f32 v62, v62
  v_mfma_f32_16x16x32_bf16 v[36:39], a[80:83], v[128:131], 0
  s_cmov_b32 s78, s94
  ds_read_b128 a[108:111], v3 offset:11264
  ds_read_b128 a[112:115], v3 offset:12288
  v_mfma_f32_16x16x32_bf16 v[36:39], a[84:87], v[136:139], v[36:39]
  s_mov_b32 m0, s65
  v_exp_f32 v63, v63
  v_mfma_f32_16x16x32_bf16 v[36:39], a[88:91], v[144:147], v[36:39]
  s_add_u32 s65, s65, 16384
  ds_read_b128 a[116:119], v3 offset:13312
  v_cvt_pk_bf16_f32 v59, v62, v63
  v_mfma_f32_16x16x32_bf16 v[36:39], a[92:95], v[152:155], v[36:39]
  buffer_load_dwordx4 v28, s[16:19], s78 offen offset:0 sc1 lds
  v_mfma_f32_16x16x32_bf16 v[40:43], a[64:67], v[160:163], 0
  ds_read_b128 a[120:123], v3 offset:14336
  ds_read_b128 a[124:127], v3 offset:15360
  v_mfma_f32_16x16x32_bf16 v[40:43], a[68:71], v[168:171], v[40:43]
  v_exp_f32 v32, v32
  v_mfma_f32_16x16x32_bf16 v[40:43], a[72:75], v[176:179], v[40:43]
  buffer_load_dwordx4 v28, s[16:19], s78 offen offset:1024 sc1 lds
  v_mfma_f32_16x16x32_bf16 v[40:43], a[76:79], v[184:187], v[40:43]
  v_exp_f32 v33, v33
  v_mfma_f32_16x16x32_bf16 v[44:47], a[80:83], v[160:163], 0
  v_cvt_pk_bf16_f32 v32, v32, v33
  v_mfma_f32_16x16x32_bf16 v[44:47], a[84:87], v[168:171], v[44:47]
  s_sub_u32 s25, s65, 163840
  v_exp_f32 v34, v34
  v_mfma_f32_16x16x32_bf16 v[44:47], a[88:91], v[176:179], v[44:47]
  buffer_load_dwordx4 a[180:183], v28, s[20:23], s67 offen offset:1024 sc1
  v_mfma_f32_16x16x32_bf16 v[44:47], a[92:95], v[184:187], v[44:47]
  s_min_u32 s65, s65, s25
  v_exp_f32 v35, v35
  v_mfma_f32_16x16x32_bf16 v[96:99], a[128:131], v[48:51], v[96:99]
  v_cvt_pk_bf16_f32 v33, v34, v35
  v_mfma_f32_16x16x32_bf16 v[196:199], a[132:135], v[48:51], v[196:199]
  v_exp_f32 v36, v36
  v_mfma_f32_16x16x32_bf16 v[100:103], a[136:139], v[48:51], v[100:103]
  buffer_load_dwordx4 a[184:187], v28, s[20:23], s67 offen offset:2048 sc1
  v_mfma_f32_16x16x32_bf16 v[204:207], a[140:143], v[48:51], v[204:207]
  v_exp_f32 v37, v37
  v_mfma_f32_16x16x32_bf16 v[104:107], a[144:147], v[48:51], v[104:107]
  v_cvt_pk_bf16_f32 v34, v36, v37
  v_mfma_f32_16x16x32_bf16 v[212:215], a[148:151], v[48:51], v[212:215]
  v_exp_f32 v38, v38
  v_mfma_f32_16x16x32_bf16 v[108:111], a[152:155], v[48:51], v[108:111]
  buffer_load_dwordx4 a[188:191], v28, s[20:23], s67 offen offset:3072 sc1
  v_mfma_f32_16x16x32_bf16 v[220:223], a[156:159], v[48:51], v[220:223]
  s_add_u32 s67, s67, 16384
  v_exp_f32 v39, v39
  v_mfma_f32_16x16x32_bf16 a[168:171], a[224:227], v[48:51], a[168:171]
  v_cvt_pk_bf16_f32 v35, v38, v39
  v_mfma_f32_16x16x32_bf16 v[112:115], a[128:131], v[56:59], v[112:115]
  v_exp_f32 v40, v40
  v_mfma_f32_16x16x32_bf16 v[228:231], a[132:135], v[56:59], v[228:231]
  v_mfma_f32_16x16x32_bf16 v[116:119], a[136:139], v[56:59], v[116:119]
  v_exp_f32 v41, v41
  v_mfma_f32_16x16x32_bf16 v[236:239], a[140:143], v[56:59], v[236:239]
  v_cvt_pk_bf16_f32 v40, v40, v41
  v_mfma_f32_16x16x32_bf16 v[120:123], a[144:147], v[56:59], v[120:123]
  v_exp_f32 v42, v42
  v_mfma_f32_16x16x32_bf16 v[244:247], a[148:151], v[56:59], v[244:247]
  buffer_load_dwordx4 a[192:195], v28, s[20:23], s67 offen offset:0 sc1
  v_mfma_f32_16x16x32_bf16 v[124:127], a[152:155], v[56:59], v[124:127]
  v_exp_f32 v43, v43
  v_mfma_f32_16x16x32_bf16 v[252:255], a[156:159], v[56:59], v[252:255]
  v_cvt_pk_bf16_f32 v41, v42, v43
  v_mfma_f32_16x16x32_bf16 a[172:175], a[224:227], v[56:59], a[172:175]
  s_waitcnt lgkmcnt(0)
  v_exp_f32 v44, v44
  v_mfma_f32_16x16x32_bf16 v[48:51], a[64:67], v[192:195], 0
  v_mfma_f32_16x16x32_bf16 v[48:51], a[68:71], v[200:203], v[48:51]
  v_exp_f32 v45, v45
  v_mfma_f32_16x16x32_bf16 v[48:51], a[72:75], v[208:211], v[48:51]
  v_cvt_pk_bf16_f32 v42, v44, v45
  v_mfma_f32_16x16x32_bf16 v[48:51], a[76:79], v[216:219], v[48:51]
  v_exp_f32 v46, v46
  v_mfma_f32_16x16x32_bf16 v[52:55], a[80:83], v[192:195], 0
  buffer_load_dwordx4 a[196:199], v28, s[20:23], s67 offen offset:1024 sc1
  v_mfma_f32_16x16x32_bf16 v[52:55], a[84:87], v[200:203], v[52:55]
  v_exp_f32 v47, v47
  v_mfma_f32_16x16x32_bf16 v[52:55], a[88:91], v[208:211], v[52:55]
  v_cvt_pk_bf16_f32 v43, v46, v47
  v_mfma_f32_16x16x32_bf16 v[52:55], a[92:95], v[216:219], v[52:55]
  buffer_load_dwordx4 v28, s[16:19], s78 offen offset:2048 sc1 lds
  v_mfma_f32_16x16x32_bf16 v[56:59], a[64:67], v[224:227], 0
  s_add_u32 s64, s64, 16384
  v_mfma_f32_16x16x32_bf16 v[56:59], a[68:71], v[232:235], v[56:59]
  s_sub_u32 s24, s64, 163840
  v_exp_f32 v48, v48
  v_mfma_f32_16x16x32_bf16 v[56:59], a[72:75], v[240:243], v[56:59]
  buffer_load_dwordx4 v28, s[16:19], s78 offen offset:3072 sc1 lds
  v_mfma_f32_16x16x32_bf16 v[56:59], a[76:79], v[248:251], v[56:59]
  s_min_u32 s64, s64, s24
  v_exp_f32 v49, v49
  v_mfma_f32_16x16x32_bf16 v[60:63], a[80:83], v[224:227], 0
  v_add_u32 v3, s64, v12
  v_cvt_pk_bf16_f32 v48, v48, v49
  v_mfma_f32_16x16x32_bf16 v[60:63], a[84:87], v[232:235], v[60:63]
  v_exp_f32 v50, v50
  v_mfma_f32_16x16x32_bf16 v[60:63], a[88:91], v[240:243], v[60:63]
  buffer_load_dwordx4 a[200:203], v28, s[20:23], s67 offen offset:2048 sc1
  v_mfma_f32_16x16x32_bf16 v[60:63], a[92:95], v[248:251], v[60:63]
  v_exp_f32 v51, v51
  v_mfma_f32_16x16x32_bf16 v[64:67], a[96:99], v[32:35], v[64:67]
  v_cvt_pk_bf16_f32 v49, v50, v51
  v_mfma_f32_16x16x32_bf16 v[132:135], a[100:103], v[32:35], v[132:135]
  v_exp_f32 v52, v52
  v_mfma_f32_16x16x32_bf16 v[68:71], a[104:107], v[32:35], v[68:71]
  ds_read_b128 a[64:67], v3 offset:0
  ds_read_b128 a[68:71], v3 offset:1024
  v_mfma_f32_16x16x32_bf16 v[140:143], a[108:111], v[32:35], v[140:143]
  v_exp_f32 v53, v53
  v_mfma_f32_16x16x32_bf16 v[72:75], a[112:115], v[32:35], v[72:75]
  ds_read_b128 a[72:75], v3 offset:2048
  v_cvt_pk_bf16_f32 v50, v52, v53
  v_mfma_f32_16x16x32_bf16 v[148:151], a[116:119], v[32:35], v[148:151]
  v_exp_f32 v54, v54
  v_mfma_f32_16x16x32_bf16 v[76:79], a[120:123], v[32:35], v[76:79]
  ds_read_b128 a[76:79], v3 offset:3072
  ds_read_b128 a[80:83], v3 offset:4096
  v_mfma_f32_16x16x32_bf16 v[156:159], a[124:127], v[32:35], v[156:159]
  buffer_load_dwordx4 a[204:207], v28, s[20:23], s67 offen offset:3072 sc1
  v_exp_f32 v55, v55
  v_mfma_f32_16x16x32_bf16 a[160:163], a[224:227], v[32:35], a[160:163]
  s_add_u32 s67, s67, 16384
  ds_read_b128 a[84:87], v3 offset:5120
  v_cvt_pk_bf16_f32 v51, v54, v55
  v_mfma_f32_16x16x32_bf16 v[80:83], a[96:99], v[40:43], v[80:83]
  v_exp_f32 v56, v56
  v_mfma_f32_16x16x32_bf16 v[164:167], a[100:103], v[40:43], v[164:167]
  ds_read_b128 a[88:91], v3 offset:6144
  ds_read_b128 a[92:95], v3 offset:7168
  v_mfma_f32_16x16x32_bf16 v[84:87], a[104:107], v[40:43], v[84:87]
  v_exp_f32 v57, v57
  v_mfma_f32_16x16x32_bf16 v[172:175], a[108:111], v[40:43], v[172:175]
  v_cvt_pk_bf16_f32 v56, v56, v57
  v_mfma_f32_16x16x32_bf16 v[88:91], a[112:115], v[40:43], v[88:91]
  v_exp_f32 v58, v58
  v_mfma_f32_16x16x32_bf16 v[180:183], a[116:119], v[40:43], v[180:183]
  buffer_load_dwordx4 a[208:211], v28, s[20:23], s67 offen offset:0 sc1
  v_mfma_f32_16x16x32_bf16 v[92:95], a[120:123], v[40:43], v[92:95]
  v_exp_f32 v59, v59
  v_mfma_f32_16x16x32_bf16 v[188:191], a[124:127], v[40:43], v[188:191]
  v_cvt_pk_bf16_f32 v57, v58, v59
  v_mfma_f32_16x16x32_bf16 a[164:167], a[224:227], v[40:43], a[164:167]
  s_waitcnt lgkmcnt(0)
  v_exp_f32 v60, v60
  v_mfma_f32_16x16x32_bf16 v[32:35], a[64:67], v[128:131], 0
  s_add_u32 s78, s78, 16384
  ds_read_b128 a[128:131], v3 offset:8192
  ds_read_b128 a[132:135], v3 offset:9216
  v_mfma_f32_16x16x32_bf16 v[32:35], a[68:71], v[136:139], v[32:35]
  s_cmp_eq_u32 s78, s62
  v_exp_f32 v61, v61
  v_mfma_f32_16x16x32_bf16 v[32:35], a[72:75], v[144:147], v[32:35]
  s_cmov_b32 s78, s79
  ds_read_b128 a[136:139], v3 offset:10240
  v_cvt_pk_bf16_f32 v58, v60, v61
  v_mfma_f32_16x16x32_bf16 v[32:35], a[76:79], v[152:155], v[32:35]
  s_cmp_eq_u32 s78, s63
  v_exp_f32 v62, v62
  v_mfma_f32_16x16x32_bf16 v[36:39], a[80:83], v[128:131], 0
  s_cmov_b32 s78, s94
  ds_read_b128 a[140:143], v3 offset:11264
  ds_read_b128 a[144:147], v3 offset:12288
  v_mfma_f32_16x16x32_bf16 v[36:39], a[84:87], v[136:139], v[36:39]
  s_mov_b32 m0, s65
  v_exp_f32 v63, v63
  v_mfma_f32_16x16x32_bf16 v[36:39], a[88:91], v[144:147], v[36:39]
  s_add_u32 s65, s65, 16384
  ds_read_b128 a[148:151], v3 offset:13312
  v_cvt_pk_bf16_f32 v59, v62, v63
  v_mfma_f32_16x16x32_bf16 v[36:39], a[92:95], v[152:155], v[36:39]
  buffer_load_dwordx4 v28, s[16:19], s78 offen offset:0 sc1 lds
  v_mfma_f32_16x16x32_bf16 v[40:43], a[64:67], v[160:163], 0
  ds_read_b128 a[152:155], v3 offset:14336
  ds_read_b128 a[156:159], v3 offset:15360
  v_mfma_f32_16x16x32_bf16 v[40:43], a[68:71], v[168:171], v[40:43]
  buffer_load_dwordx4 a[212:215], v28, s[20:23], s67 offen offset:1024 sc1
  v_exp_f32 v32, v32
  v_mfma_f32_16x16x32_bf16 v[40:43], a[72:75], v[176:179], v[40:43]
  buffer_load_dwordx4 v28, s[16:19], s78 offen offset:1024 sc1 lds
  v_mfma_f32_16x16x32_bf16 v[40:43], a[76:79], v[184:187], v[40:43]
  v_exp_f32 v33, v33
  v_mfma_f32_16x16x32_bf16 v[44:47], a[80:83], v[160:163], 0
  v_cvt_pk_bf16_f32 v32, v32, v33
  v_mfma_f32_16x16x32_bf16 v[44:47], a[84:87], v[168:171], v[44:47]
  s_sub_u32 s25, s65, 163840
  v_exp_f32 v34, v34
  v_mfma_f32_16x16x32_bf16 v[44:47], a[88:91], v[176:179], v[44:47]
  buffer_load_dwordx4 a[216:219], v28, s[20:23], s67 offen offset:2048 sc1
  v_mfma_f32_16x16x32_bf16 v[44:47], a[92:95], v[184:187], v[44:47]
  s_min_u32 s65, s65, s25
  v_exp_f32 v35, v35
  v_mfma_f32_16x16x32_bf16 v[96:99], a[96:99], v[48:51], v[96:99]
  v_cvt_pk_bf16_f32 v33, v34, v35
  v_mfma_f32_16x16x32_bf16 v[196:199], a[100:103], v[48:51], v[196:199]
  v_exp_f32 v36, v36
  v_mfma_f32_16x16x32_bf16 v[100:103], a[104:107], v[48:51], v[100:103]
  buffer_load_dwordx4 a[220:223], v28, s[20:23], s67 offen offset:3072 sc1
  v_mfma_f32_16x16x32_bf16 v[204:207], a[108:111], v[48:51], v[204:207]
  s_add_u32 s67, s67, 16384
  v_exp_f32 v37, v37
  v_mfma_f32_16x16x32_bf16 v[104:107], a[112:115], v[48:51], v[104:107]
  v_cvt_pk_bf16_f32 v34, v36, v37
  v_mfma_f32_16x16x32_bf16 v[212:215], a[116:119], v[48:51], v[212:215]
  v_exp_f32 v38, v38
  v_mfma_f32_16x16x32_bf16 v[108:111], a[120:123], v[48:51], v[108:111]
  v_mfma_f32_16x16x32_bf16 v[220:223], a[124:127], v[48:51], v[220:223]
  v_exp_f32 v39, v39
  v_mfma_f32_16x16x32_bf16 a[168:171], a[224:227], v[48:51], a[168:171]
  v_cvt_pk_bf16_f32 v35, v38, v39
  v_mfma_f32_16x16x32_bf16 v[112:115], a[96:99], v[56:59], v[112:115]
  v_exp_f32 v40, v40
  v_mfma_f32_16x16x32_bf16 v[228:231], a[100:103], v[56:59], v[228:231]
  buffer_load_dwordx4 a[240:243], v28, s[20:23], s67 offen offset:0 sc1
  v_mfma_f32_16x16x32_bf16 v[116:119], a[104:107], v[56:59], v[116:119]
  v_exp_f32 v41, v41
  v_mfma_f32_16x16x32_bf16 v[236:239], a[108:111], v[56:59], v[236:239]
  v_cvt_pk_bf16_f32 v40, v40, v41
  v_mfma_f32_16x16x32_bf16 v[120:123], a[112:115], v[56:59], v[120:123]
  v_exp_f32 v42, v42
  v_mfma_f32_16x16x32_bf16 v[244:247], a[116:119], v[56:59], v[244:247]
  v_mfma_f32_16x16x32_bf16 v[124:127], a[120:123], v[56:59], v[124:127]
  v_exp_f32 v43, v43
  v_mfma_f32_16x16x32_bf16 v[252:255], a[124:127], v[56:59], v[252:255]
  v_cvt_pk_bf16_f32 v41, v42, v43
  v_mfma_f32_16x16x32_bf16 a[172:175], a[224:227], v[56:59], a[172:175]
  s_waitcnt lgkmcnt(0)
  v_exp_f32 v44, v44
  v_mfma_f32_16x16x32_bf16 v[48:51], a[64:67], v[192:195], 0
  buffer_load_dwordx4 a[244:247], v28, s[20:23], s67 offen offset:1024 sc1
  v_mfma_f32_16x16x32_bf16 v[48:51], a[68:71], v[200:203], v[48:51]
  v_exp_f32 v45, v45
  v_mfma_f32_16x16x32_bf16 v[48:51], a[72:75], v[208:211], v[48:51]
  v_cvt_pk_bf16_f32 v42, v44, v45
  v_mfma_f32_16x16x32_bf16 v[48:51], a[76:79], v[216:219], v[48:51]
  v_exp_f32 v46, v46
  v_mfma_f32_16x16x32_bf16 v[52:55], a[80:83], v[192:195], 0
  v_mfma_f32_16x16x32_bf16 v[52:55], a[84:87], v[200:203], v[52:55]
  v_exp_f32 v47, v47
  v_mfma_f32_16x16x32_bf16 v[52:55], a[88:91], v[208:211], v[52:55]
  v_cvt_pk_bf16_f32 v43, v46, v47
  v_mfma_f32_16x16x32_bf16 v[52:55], a[92:95], v[216:219], v[52:55]
  buffer_load_dwordx4 v28, s[16:19], s78 offen offset:2048 sc1 lds
  v_mfma_f32_16x16x32_bf16 v[56:59], a[64:67], v[224:227], 0
  s_add_u32 s64, s64, 16384
  v_mfma_f32_16x16x32_bf16 v[56:59], a[68:71], v[232:235], v[56:59]
  s_sub_u32 s24, s64, 163840
  v_exp_f32 v48, v48
  v_mfma_f32_16x16x32_bf16 v[56:59], a[72:75], v[240:243], v[56:59]
  buffer_load_dwordx4 v28, s[16:19], s78 offen offset:3072 sc1 lds
  v_mfma_f32_16x16x32_bf16 v[56:59], a[76:79], v[248:251], v[56:59]
  s_min_u32 s64, s64, s24
  v_exp_f32 v49, v49
  v_mfma_f32_16x16x32_bf16 v[60:63], a[80:83], v[224:227], 0
  v_add_u32 v3, s64, v12
  v_cvt_pk_bf16_f32 v48, v48, v49
  v_mfma_f32_16x16x32_bf16 v[60:63], a[84:87], v[232:235], v[60:63]
  v_exp_f32 v50, v50
  v_mfma_f32_16x16x32_bf16 v[60:63], a[88:91], v[240:243], v[60:63]
  buffer_load_dwordx4 a[248:251], v28, s[20:23], s67 offen offset:2048 sc1
  v_mfma_f32_16x16x32_bf16 v[60:63], a[92:95], v[248:251], v[60:63]
  v_exp_f32 v51, v51
  v_mfma_f32_16x16x32_bf16 v[64:67], a[128:131], v[32:35], v[64:67]
  v_cvt_pk_bf16_f32 v49, v50, v51
  v_mfma_f32_16x16x32_bf16 v[132:135], a[132:135], v[32:35], v[132:135]
  v_exp_f32 v52, v52
  v_mfma_f32_16x16x32_bf16 v[68:71], a[136:139], v[32:35], v[68:71]
  ds_read_b128 a[64:67], v3 offset:0
  ds_read_b128 a[68:71], v3 offset:1024
  v_mfma_f32_16x16x32_bf16 v[140:143], a[140:143], v[32:35], v[140:143]
  v_exp_f32 v53, v53
  v_mfma_f32_16x16x32_bf16 v[72:75], a[144:147], v[32:35], v[72:75]
  ds_read_b128 a[72:75], v3 offset:2048
  v_cvt_pk_bf16_f32 v50, v52, v53
  v_mfma_f32_16x16x32_bf16 v[148:151], a[148:151], v[32:35], v[148:151]
  buffer_load_dwordx4 a[252:255], v28, s[20:23], s67 offen offset:3072 sc1
  v_exp_f32 v54, v54
  v_mfma_f32_16x16x32_bf16 v[76:79], a[152:155], v[32:35], v[76:79]
  s_add_u32 s67, s67, 16384
  ds_read_b128 a[76:79], v3 offset:3072
  ds_read_b128 a[80:83], v3 offset:4096
  v_mfma_f32_16x16x32_bf16 v[156:159], a[156:159], v[32:35], v[156:159]
  v_exp_f32 v55, v55
  v_mfma_f32_16x16x32_bf16 a[160:163], a[224:227], v[32:35], a[160:163]
  ds_read_b128 a[84:87], v3 offset:5120
  v_cvt_pk_bf16_f32 v51, v54, v55
  v_mfma_f32_16x16x32_bf16 v[80:83], a[128:131], v[40:43], v[80:83]
  v_exp_f32 v56, v56
  v_mfma_f32_16x16x32_bf16 v[164:167], a[132:135], v[40:43], v[164:167]
  ds_read_b128 a[88:91], v3 offset:6144
  ds_read_b128 a[92:95], v3 offset:7168
  v_mfma_f32_16x16x32_bf16 v[84:87], a[136:139], v[40:43], v[84:87]
  v_exp_f32 v57, v57
  v_mfma_f32_16x16x32_bf16 v[172:175], a[140:143], v[40:43], v[172:175]
  v_cvt_pk_bf16_f32 v56, v56, v57
  v_mfma_f32_16x16x32_bf16 v[88:91], a[144:147], v[40:43], v[88:91]
  v_exp_f32 v58, v58
  v_mfma_f32_16x16x32_bf16 v[180:183], a[148:151], v[40:43], v[180:183]
  buffer_load_dwordx4 a[0:3], v28, s[20:23], s67 offen offset:0 sc1
  v_mfma_f32_16x16x32_bf16 v[92:95], a[152:155], v[40:43], v[92:95]
  v_exp_f32 v59, v59
  v_mfma_f32_16x16x32_bf16 v[188:191], a[156:159], v[40:43], v[188:191]
  v_cvt_pk_bf16_f32 v57, v58, v59
  v_mfma_f32_16x16x32_bf16 a[164:167], a[224:227], v[40:43], a[164:167]
  s_waitcnt lgkmcnt(0)
  v_exp_f32 v60, v60
  v_mfma_f32_16x16x32_bf16 v[32:35], a[64:67], v[128:131], 0
  s_add_u32 s78, s78, 16384
  ds_read_b128 a[96:99], v3 offset:8192
  ds_read_b128 a[100:103], v3 offset:9216
  v_mfma_f32_16x16x32_bf16 v[32:35], a[68:71], v[136:139], v[32:35]
  s_cmp_eq_u32 s78, s62
  v_exp_f32 v61, v61
  v_mfma_f32_16x16x32_bf16 v[32:35], a[72:75], v[144:147], v[32:35]
  s_cmov_b32 s78, s79
  ds_read_b128 a[104:107], v3 offset:10240
  v_cvt_pk_bf16_f32 v58, v60, v61
  v_mfma_f32_16x16x32_bf16 v[32:35], a[76:79], v[152:155], v[32:35]
  s_cmp_eq_u32 s78, s63
  buffer_load_dwordx4 a[4:7], v28, s[20:23], s67 offen offset:1024 sc1
  v_exp_f32 v62, v62
  v_mfma_f32_16x16x32_bf16 v[36:39], a[80:83], v[128:131], 0
  s_cmov_b32 s78, s94
  ds_read_b128 a[108:111], v3 offset:11264
  ds_read_b128 a[112:115], v3 offset:12288
  v_mfma_f32_16x16x32_bf16 v[36:39], a[84:87], v[136:139], v[36:39]
  s_mov_b32 m0, s65
  v_exp_f32 v63, v63
  v_mfma_f32_16x16x32_bf16 v[36:39], a[88:91], v[144:147], v[36:39]
  s_add_u32 s65, s65, 16384
  ds_read_b128 a[116:119], v3 offset:13312
  v_cvt_pk_bf16_f32 v59, v62, v63
  v_mfma_f32_16x16x32_bf16 v[36:39], a[92:95], v[152:155], v[36:39]
  buffer_load_dwordx4 v28, s[16:19], s78 offen offset:0 sc1 lds
  v_mfma_f32_16x16x32_bf16 v[40:43], a[64:67], v[160:163], 0
  ds_read_b128 a[120:123], v3 offset:14336
  ds_read_b128 a[124:127], v3 offset:15360
  v_mfma_f32_16x16x32_bf16 v[40:43], a[68:71], v[168:171], v[40:43]
  v_exp_f32 v32, v32
  v_mfma_f32_16x16x32_bf16 v[40:43], a[72:75], v[176:179], v[40:43]
  buffer_load_dwordx4 v28, s[16:19], s78 offen offset:1024 sc1 lds
  v_mfma_f32_16x16x32_bf16 v[40:43], a[76:79], v[184:187], v[40:43]
  v_exp_f32 v33, v33
  v_mfma_f32_16x16x32_bf16 v[44:47], a[80:83], v[160:163], 0
  v_cvt_pk_bf16_f32 v32, v32, v33
  v_mfma_f32_16x16x32_bf16 v[44:47], a[84:87], v[168:171], v[44:47]
  s_sub_u32 s25, s65, 163840
  v_exp_f32 v34, v34
  v_mfma_f32_16x16x32_bf16 v[44:47], a[88:91], v[176:179], v[44:47]
  buffer_load_dwordx4 a[8:11], v28, s[20:23], s67 offen offset:2048 sc1
  v_mfma_f32_16x16x32_bf16 v[44:47], a[92:95], v[184:187], v[44:47]
  s_min_u32 s65, s65, s25
  v_exp_f32 v35, v35
  v_mfma_f32_16x16x32_bf16 v[96:99], a[128:131], v[48:51], v[96:99]
  v_cvt_pk_bf16_f32 v33, v34, v35
  v_mfma_f32_16x16x32_bf16 v[196:199], a[132:135], v[48:51], v[196:199]
  v_exp_f32 v36, v36
  v_mfma_f32_16x16x32_bf16 v[100:103], a[136:139], v[48:51], v[100:103]
  buffer_load_dwordx4 a[12:15], v28, s[20:23], s67 offen offset:3072 sc1
  v_mfma_f32_16x16x32_bf16 v[204:207], a[140:143], v[48:51], v[204:207]
  s_add_u32 s67, s67, 16384
  v_exp_f32 v37, v37
  v_mfma_f32_16x16x32_bf16 v[104:107], a[144:147], v[48:51], v[104:107]
  v_cvt_pk_bf16_f32 v34, v36, v37
  v_mfma_f32_16x16x32_bf16 v[212:215], a[148:151], v[48:51], v[212:215]
  v_exp_f32 v38, v38
  v_mfma_f32_16x16x32_bf16 v[108:111], a[152:155], v[48:51], v[108:111]
  buffer_load_dwordx4 a[16:19], v28, s[20:23], s67 offen offset:0 sc1
  v_mfma_f32_16x16x32_bf16 v[220:223], a[156:159], v[48:51], v[220:223]
  v_exp_f32 v39, v39
  v_mfma_f32_16x16x32_bf16 a[168:171], a[224:227], v[48:51], a[168:171]
  v_cvt_pk_bf16_f32 v35, v38, v39
  v_mfma_f32_16x16x32_bf16 v[112:115], a[128:131], v[56:59], v[112:115]
  v_exp_f32 v40, v40
  v_mfma_f32_16x16x32_bf16 v[228:231], a[132:135], v[56:59], v[228:231]
  v_mfma_f32_16x16x32_bf16 v[116:119], a[136:139], v[56:59], v[116:119]
  v_exp_f32 v41, v41
  v_mfma_f32_16x16x32_bf16 v[236:239], a[140:143], v[56:59], v[236:239]
  v_cvt_pk_bf16_f32 v40, v40, v41
  v_mfma_f32_16x16x32_bf16 v[120:123], a[144:147], v[56:59], v[120:123]
  v_exp_f32 v42, v42
  v_mfma_f32_16x16x32_bf16 v[244:247], a[148:151], v[56:59], v[244:247]
  buffer_load_dwordx4 a[20:23], v28, s[20:23], s67 offen offset:1024 sc1
  v_mfma_f32_16x16x32_bf16 v[124:127], a[152:155], v[56:59], v[124:127]
  v_exp_f32 v43, v43
  v_mfma_f32_16x16x32_bf16 v[252:255], a[156:159], v[56:59], v[252:255]
  v_cvt_pk_bf16_f32 v41, v42, v43
  v_mfma_f32_16x16x32_bf16 a[172:175], a[224:227], v[56:59], a[172:175]
  s_waitcnt lgkmcnt(0)
  v_exp_f32 v44, v44
  v_mfma_f32_16x16x32_bf16 v[48:51], a[64:67], v[192:195], 0
  v_mfma_f32_16x16x32_bf16 v[48:51], a[68:71], v[200:203], v[48:51]
  v_exp_f32 v45, v45
  v_mfma_f32_16x16x32_bf16 v[48:51], a[72:75], v[208:211], v[48:51]
  v_cvt_pk_bf16_f32 v42, v44, v45
  v_mfma_f32_16x16x32_bf16 v[48:51], a[76:79], v[216:219], v[48:51]
  v_exp_f32 v46, v46
  v_mfma_f32_16x16x32_bf16 v[52:55], a[80:83], v[192:195], 0
  buffer_load_dwordx4 a[24:27], v28, s[20:23], s67 offen offset:2048 sc1
  v_mfma_f32_16x16x32_bf16 v[52:55], a[84:87], v[200:203], v[52:55]
  v_exp_f32 v47, v47
  v_mfma_f32_16x16x32_bf16 v[52:55], a[88:91], v[208:211], v[52:55]
  v_cvt_pk_bf16_f32 v43, v46, v47
  v_mfma_f32_16x16x32_bf16 v[52:55], a[92:95], v[216:219], v[52:55]
  buffer_load_dwordx4 v28, s[16:19], s78 offen offset:2048 sc1 lds
  v_mfma_f32_16x16x32_bf16 v[56:59], a[64:67], v[224:227], 0
  s_add_u32 s64, s64, 16384
  v_mfma_f32_16x16x32_bf16 v[56:59], a[68:71], v[232:235], v[56:59]
  s_sub_u32 s24, s64, 163840
  v_exp_f32 v48, v48
  v_mfma_f32_16x16x32_bf16 v[56:59], a[72:75], v[240:243], v[56:59]
  buffer_load_dwordx4 v28, s[16:19], s78 offen offset:3072 sc1 lds
  v_mfma_f32_16x16x32_bf16 v[56:59], a[76:79], v[248:251], v[56:59]
  s_min_u32 s64, s64, s24
  v_exp_f32 v49, v49
  v_mfma_f32_16x16x32_bf16 v[60:63], a[80:83], v[224:227], 0
  v_add_u32 v3, s64, v12
  v_cvt_pk_bf16_f32 v48, v48, v49
  v_mfma_f32_16x16x32_bf16 v[60:63], a[84:87], v[232:235], v[60:63]
  v_exp_f32 v50, v50
  v_mfma_f32_16x16x32_bf16 v[60:63], a[88:91], v[240:243], v[60:63]
  buffer_load_dwordx4 a[28:31], v28, s[20:23], s67 offen offset:3072 sc1
  v_mfma_f32_16x16x32_bf16 v[60:63], a[92:95], v[248:251], v[60:63]
  s_add_u32 s67, s67, 16384
  v_exp_f32 v51, v51
  v_mfma_f32_16x16x32_bf16 v[64:67], a[96:99], v[32:35], v[64:67]
  v_cvt_pk_bf16_f32 v49, v50, v51
  v_mfma_f32_16x16x32_bf16 v[132:135], a[100:103], v[32:35], v[132:135]
  v_exp_f32 v52, v52
  v_mfma_f32_16x16x32_bf16 v[68:71], a[104:107], v[32:35], v[68:71]
  ds_read_b128 a[64:67], v3 offset:0
  ds_read_b128 a[68:71], v3 offset:1024
  v_mfma_f32_16x16x32_bf16 v[140:143], a[108:111], v[32:35], v[140:143]
  v_exp_f32 v53, v53
  v_mfma_f32_16x16x32_bf16 v[72:75], a[112:115], v[32:35], v[72:75]
  ds_read_b128 a[72:75], v3 offset:2048
  v_cvt_pk_bf16_f32 v50, v52, v53
  v_mfma_f32_16x16x32_bf16 v[148:151], a[116:119], v[32:35], v[148:151]
  v_exp_f32 v54, v54
  v_mfma_f32_16x16x32_bf16 v[76:79], a[120:123], v[32:35], v[76:79]
  ds_read_b128 a[76:79], v3 offset:3072
  ds_read_b128 a[80:83], v3 offset:4096
  v_mfma_f32_16x16x32_bf16 v[156:159], a[124:127], v[32:35], v[156:159]
  v_exp_f32 v55, v55
  v_mfma_f32_16x16x32_bf16 a[160:163], a[224:227], v[32:35], a[160:163]
  ds_read_b128 a[84:87], v3 offset:5120
  v_cvt_pk_bf16_f32 v51, v54, v55
  v_mfma_f32_16x16x32_bf16 v[80:83], a[96:99], v[40:43], v[80:83]
  v_exp_f32 v56, v56
  v_mfma_f32_16x16x32_bf16 v[164:167], a[100:103], v[40:43], v[164:167]
  ds_read_b128 a[88:91], v3 offset:6144
  ds_read_b128 a[92:95], v3 offset:7168
  v_mfma_f32_16x16x32_bf16 v[84:87], a[104:107], v[40:43], v[84:87]
  v_exp_f32 v57, v57
  v_mfma_f32_16x16x32_bf16 v[172:175], a[108:111], v[40:43], v[172:175]
  v_cvt_pk_bf16_f32 v56, v56, v57
  v_mfma_f32_16x16x32_bf16 v[88:91], a[112:115], v[40:43], v[88:91]
  v_exp_f32 v58, v58
  v_mfma_f32_16x16x32_bf16 v[180:183], a[116:119], v[40:43], v[180:183]
  buffer_load_dwordx4 a[32:35], v28, s[20:23], s67 offen offset:0 sc1
  v_mfma_f32_16x16x32_bf16 v[92:95], a[120:123], v[40:43], v[92:95]
  v_exp_f32 v59, v59
  v_mfma_f32_16x16x32_bf16 v[188:191], a[124:127], v[40:43], v[188:191]
  v_cvt_pk_bf16_f32 v57, v58, v59
  v_mfma_f32_16x16x32_bf16 a[164:167], a[224:227], v[40:43], a[164:167]
  s_waitcnt lgkmcnt(0)
  v_exp_f32 v60, v60
  v_mfma_f32_16x16x32_bf16 v[32:35], a[64:67], v[128:131], 0
  s_add_u32 s78, s78, 16384
  ds_read_b128 a[128:131], v3 offset:8192
  ds_read_b128 a[132:135], v3 offset:9216
  v_mfma_f32_16x16x32_bf16 v[32:35], a[68:71], v[136:139], v[32:35]
  s_cmp_eq_u32 s78, s62
  buffer_load_dwordx4 a[36:39], v28, s[20:23], s67 offen offset:1024 sc1
  v_exp_f32 v61, v61
  v_mfma_f32_16x16x32_bf16 v[32:35], a[72:75], v[144:147], v[32:35]
  s_cmov_b32 s78, s79
  ds_read_b128 a[136:139], v3 offset:10240
  v_cvt_pk_bf16_f32 v58, v60, v61
  v_mfma_f32_16x16x32_bf16 v[32:35], a[76:79], v[152:155], v[32:35]
  s_cmp_eq_u32 s78, s63
  v_exp_f32 v62, v62
  v_mfma_f32_16x16x32_bf16 v[36:39], a[80:83], v[128:131], 0
  s_cmov_b32 s78, s94
  ds_read_b128 a[140:143], v3 offset:11264
  ds_read_b128 a[144:147], v3 offset:12288
  v_mfma_f32_16x16x32_bf16 v[36:39], a[84:87], v[136:139], v[36:39]
  s_mov_b32 m0, s65
  v_exp_f32 v63, v63
  v_mfma_f32_16x16x32_bf16 v[36:39], a[88:91], v[144:147], v[36:39]
  s_add_u32 s65, s65, 16384
  ds_read_b128 a[148:151], v3 offset:13312
  v_cvt_pk_bf16_f32 v59, v62, v63
  v_mfma_f32_16x16x32_bf16 v[36:39], a[92:95], v[152:155], v[36:39]
  buffer_load_dwordx4 v28, s[16:19], s78 offen offset:0 sc1 lds
  v_mfma_f32_16x16x32_bf16 v[40:43], a[64:67], v[160:163], 0
  ds_read_b128 a[152:155], v3 offset:14336
  ds_read_b128 a[156:159], v3 offset:15360
  v_mfma_f32_16x16x32_bf16 v[40:43], a[68:71], v[168:171], v[40:43]
  v_exp_f32 v32, v32
  v_mfma_f32_16x16x32_bf16 v[40:43], a[72:75], v[176:179], v[40:43]
  buffer_load_dwordx4 v28, s[16:19], s78 offen offset:1024 sc1 lds
  v_mfma_f32_16x16x32_bf16 v[40:43], a[76:79], v[184:187], v[40:43]
  v_exp_f32 v33, v33
  v_mfma_f32_16x16x32_bf16 v[44:47], a[80:83], v[160:163], 0
  v_cvt_pk_bf16_f32 v32, v32, v33
  v_mfma_f32_16x16x32_bf16 v[44:47], a[84:87], v[168:171], v[44:47]
  s_sub_u32 s25, s65, 163840
  v_exp_f32 v34, v34
  v_mfma_f32_16x16x32_bf16 v[44:47], a[88:91], v[176:179], v[44:47]
  buffer_load_dwordx4 a[40:43], v28, s[20:23], s67 offen offset:2048 sc1
  v_mfma_f32_16x16x32_bf16 v[44:47], a[92:95], v[184:187], v[44:47]
  s_min_u32 s65, s65, s25
  v_exp_f32 v35, v35
  v_mfma_f32_16x16x32_bf16 v[96:99], a[96:99], v[48:51], v[96:99]
  v_cvt_pk_bf16_f32 v33, v34, v35
  v_mfma_f32_16x16x32_bf16 v[196:199], a[100:103], v[48:51], v[196:199]
  v_exp_f32 v36, v36
  v_mfma_f32_16x16x32_bf16 v[100:103], a[104:107], v[48:51], v[100:103]
  buffer_load_dwordx4 a[44:47], v28, s[20:23], s67 offen offset:3072 sc1
  v_mfma_f32_16x16x32_bf16 v[204:207], a[108:111], v[48:51], v[204:207]
  s_add_u32 s67, s67, 16384
  v_exp_f32 v37, v37
  v_mfma_f32_16x16x32_bf16 v[104:107], a[112:115], v[48:51], v[104:107]
  v_cvt_pk_bf16_f32 v34, v36, v37
  v_mfma_f32_16x16x32_bf16 v[212:215], a[116:119], v[48:51], v[212:215]
  v_exp_f32 v38, v38
  v_mfma_f32_16x16x32_bf16 v[108:111], a[120:123], v[48:51], v[108:111]
  buffer_load_dwordx4 a[48:51], v28, s[20:23], s67 offen offset:0 sc1
  v_mfma_f32_16x16x32_bf16 v[220:223], a[124:127], v[48:51], v[220:223]
  v_exp_f32 v39, v39
  v_mfma_f32_16x16x32_bf16 a[168:171], a[224:227], v[48:51], a[168:171]
  v_cvt_pk_bf16_f32 v35, v38, v39
  v_mfma_f32_16x16x32_bf16 v[112:115], a[96:99], v[56:59], v[112:115]
  v_exp_f32 v40, v40
  v_mfma_f32_16x16x32_bf16 v[228:231], a[100:103], v[56:59], v[228:231]
  buffer_load_dwordx4 a[52:55], v28, s[20:23], s67 offen offset:1024 sc1
  v_mfma_f32_16x16x32_bf16 v[116:119], a[104:107], v[56:59], v[116:119]
  v_exp_f32 v41, v41
  v_mfma_f32_16x16x32_bf16 v[236:239], a[108:111], v[56:59], v[236:239]
  v_cvt_pk_bf16_f32 v40, v40, v41
  v_mfma_f32_16x16x32_bf16 v[120:123], a[112:115], v[56:59], v[120:123]
  v_exp_f32 v42, v42
  v_mfma_f32_16x16x32_bf16 v[244:247], a[116:119], v[56:59], v[244:247]
  v_mfma_f32_16x16x32_bf16 v[124:127], a[120:123], v[56:59], v[124:127]
  v_exp_f32 v43, v43
  v_mfma_f32_16x16x32_bf16 v[252:255], a[124:127], v[56:59], v[252:255]
  v_cvt_pk_bf16_f32 v41, v42, v43
  v_mfma_f32_16x16x32_bf16 a[172:175], a[224:227], v[56:59], a[172:175]
  s_waitcnt lgkmcnt(0)
  v_exp_f32 v44, v44
  v_mfma_f32_16x16x32_bf16 v[48:51], a[64:67], v[192:195], 0
  buffer_load_dwordx4 a[56:59], v28, s[20:23], s67 offen offset:2048 sc1
  v_mfma_f32_16x16x32_bf16 v[48:51], a[68:71], v[200:203], v[48:51]
  v_exp_f32 v45, v45
  v_mfma_f32_16x16x32_bf16 v[48:51], a[72:75], v[208:211], v[48:51]
  v_cvt_pk_bf16_f32 v42, v44, v45
  v_mfma_f32_16x16x32_bf16 v[48:51], a[76:79], v[216:219], v[48:51]
  v_exp_f32 v46, v46
  v_mfma_f32_16x16x32_bf16 v[52:55], a[80:83], v[192:195], 0
  v_mfma_f32_16x16x32_bf16 v[52:55], a[84:87], v[200:203], v[52:55]
  v_exp_f32 v47, v47
  v_mfma_f32_16x16x32_bf16 v[52:55], a[88:91], v[208:211], v[52:55]
  v_cvt_pk_bf16_f32 v43, v46, v47
  v_mfma_f32_16x16x32_bf16 v[52:55], a[92:95], v[216:219], v[52:55]
  buffer_load_dwordx4 v28, s[16:19], s78 offen offset:2048 sc1 lds
  v_mfma_f32_16x16x32_bf16 v[56:59], a[64:67], v[224:227], 0
  s_add_u32 s64, s64, 16384
  v_mfma_f32_16x16x32_bf16 v[56:59], a[68:71], v[232:235], v[56:59]
  s_sub_u32 s24, s64, 163840
  v_exp_f32 v48, v48
  v_mfma_f32_16x16x32_bf16 v[56:59], a[72:75], v[240:243], v[56:59]
  buffer_load_dwordx4 v28, s[16:19], s78 offen offset:3072 sc1 lds
  v_mfma_f32_16x16x32_bf16 v[56:59], a[76:79], v[248:251], v[56:59]
  s_min_u32 s64, s64, s24
  v_exp_f32 v49, v49
  v_mfma_f32_16x16x32_bf16 v[60:63], a[80:83], v[224:227], 0
  v_add_u32 v3, s64, v12
  v_cvt_pk_bf16_f32 v48, v48, v49
  v_mfma_f32_16x16x32_bf16 v[60:63], a[84:87], v[232:235], v[60:63]
  v_exp_f32 v50, v50
  v_mfma_f32_16x16x32_bf16 v[60:63], a[88:91], v[240:243], v[60:63]
  buffer_load_dwordx4 a[60:63], v28, s[20:23], s67 offen offset:3072 sc1
  v_mfma_f32_16x16x32_bf16 v[60:63], a[92:95], v[248:251], v[60:63]
  s_add_u32 s67, s67, 16384
  v_exp_f32 v51, v51
  v_mfma_f32_16x16x32_bf16 v[64:67], a[128:131], v[32:35], v[64:67]
  s_waitcnt vmcnt(26) lgkmcnt(0)
  s_barrier
  v_cvt_pk_bf16_f32 v49, v50, v51
  v_mfma_f32_16x16x32_bf16 v[132:135], a[132:135], v[32:35], v[132:135]
  v_exp_f32 v52, v52
  v_mfma_f32_16x16x32_bf16 v[68:71], a[136:139], v[32:35], v[68:71]
  ds_read_b128 a[64:67], v3 offset:0
  ds_read_b128 a[68:71], v3 offset:1024
  v_mfma_f32_16x16x32_bf16 v[140:143], a[140:143], v[32:35], v[140:143]
  v_exp_f32 v53, v53
  v_mfma_f32_16x16x32_bf16 v[72:75], a[144:147], v[32:35], v[72:75]
  ds_read_b128 a[72:75], v3 offset:2048
  v_cvt_pk_bf16_f32 v50, v52, v53
  v_mfma_f32_16x16x32_bf16 v[148:151], a[148:151], v[32:35], v[148:151]
  v_exp_f32 v54, v54
  v_mfma_f32_16x16x32_bf16 v[76:79], a[152:155], v[32:35], v[76:79]
  ds_read_b128 a[76:79], v3 offset:3072
  ds_read_b128 a[80:83], v3 offset:4096
  v_mfma_f32_16x16x32_bf16 v[156:159], a[156:159], v[32:35], v[156:159]
  v_exp_f32 v55, v55
  v_mfma_f32_16x16x32_bf16 a[160:163], a[224:227], v[32:35], a[160:163]
  ds_read_b128 a[84:87], v3 offset:5120
  v_cvt_pk_bf16_f32 v51, v54, v55
  v_mfma_f32_16x16x32_bf16 v[80:83], a[128:131], v[40:43], v[80:83]
  v_exp_f32 v56, v56
  v_mfma_f32_16x16x32_bf16 v[164:167], a[132:135], v[40:43], v[164:167]
  ds_read_b128 a[88:91], v3 offset:6144
  ds_read_b128 a[92:95], v3 offset:7168
  v_mfma_f32_16x16x32_bf16 v[84:87], a[136:139], v[40:43], v[84:87]
  v_exp_f32 v57, v57
  v_mfma_f32_16x16x32_bf16 v[172:175], a[140:143], v[40:43], v[172:175]
  v_cvt_pk_bf16_f32 v56, v56, v57
  v_mfma_f32_16x16x32_bf16 v[88:91], a[144:147], v[40:43], v[88:91]
  v_exp_f32 v58, v58
  v_mfma_f32_16x16x32_bf16 v[180:183], a[148:151], v[40:43], v[180:183]
  v_mfma_f32_16x16x32_bf16 v[92:95], a[152:155], v[40:43], v[92:95]
  v_exp_f32 v59, v59
  v_mfma_f32_16x16x32_bf16 v[188:191], a[156:159], v[40:43], v[188:191]
  v_cvt_pk_bf16_f32 v57, v58, v59
  v_mfma_f32_16x16x32_bf16 a[164:167], a[224:227], v[40:43], a[164:167]
  s_waitcnt lgkmcnt(0)
  v_exp_f32 v60, v60
  s_mov_b32 s81, 1
  s_sub_u32 s66, s6, 1
  s_cmp_lt_u32 s6, 4
  s_cbranch_scc1 low_i2
m64:
  v_mfma_f32_16x16x32_bf16 v[32:35], a[64:67], v[128:131], 0
  s_add_u32 s78, s78, 16384
  ds_read_b128 a[96:99], v3 offset:8192
  ds_read_b128 a[100:103], v3 offset:9216
  v_mfma_f32_16x16x32_bf16 v[32:35], a[68:71], v[136:139], v[32:35]
  s_cmp_eq_u32 s78, s62
  v_exp_f32 v61, v61
  v_mfma_f32_16x16x32_bf16 v[32:35], a[72:75], v[144:147], v[32:35]
  s_cmov_b32 s78, s79
  ds_read_b128 a[104:107], v3 offset:10240
  v_cvt_pk_bf16_f32 v58, v60, v61
  v_mfma_f32_16x16x32_bf16 v[32:35], a[76:79], v[152:155], v[32:35]
  s_cmp_eq_u32 s78, s63
  v_exp_f32 v62, v62
  v_mfma_f32_16x16x32_bf16 v[36:39], a[80:83], v[128:131], 0
  s_cmov_b32 s78, s94
  ds_read_b128 a[108:111], v3 offset:11264
  ds_read_b128 a[112:115], v3 offset:12288
  v_mfma_f32_16x16x32_bf16 v[36:39], a[84:87], v[136:139], v[36:39]
  s_mov_b32 m0, s65
  v_exp_f32 v63, v63
  v_mfma_f32_16x16x32_bf16 v[36:39], a[88:91], v[144:147], v[36:39]
  s_add_u32 s65, s65, 16384
  ds_read_b128 a[116:119], v3 offset:13312
  v_cvt_pk_bf16_f32 v59, v62, v63
  v_mfma_f32_16x16x32_bf16 v[36:39], a[92:95], v[152:155], v[36:39]
  buffer_load_dwordx4 v28, s[16:19], s78 offen offset:0 sc1 lds
  v_mfma_f32_16x16x32_bf16 v[40:43], a[64:67], v[160:163], 0
  ds_read_b128 a[120:123], v3 offset:14336
  ds_read_b128 a[124:127], v3 offset:15360
  v_mfma_f32_16x16x32_bf16 v[40:43], a[68:71], v[168:171], v[40:43]
  v_exp_f32 v32, v32
  v_mfma_f32_16x16x32_bf16 v[40:43], a[72:75], v[176:179], v[40:43]
  buffer_load_dwordx4 v28, s[16:19], s78 offen offset:1024 sc1 lds
  v_mfma_f32_16x16x32_bf16 v[40:43], a[76:79], v[184:187], v[40:43]
  v_exp_f32 v33, v33
  v_mfma_f32_16x16x32_bf16 v[44:47], a[80:83], v[160:163], 0
  v_cvt_pk_bf16_f32 v32, v32, v33
  v_mfma_f32_16x16x32_bf16 v[44:47], a[84:87], v[168:171], v[44:47]
  s_sub_u32 s25, s65, 163840
  v_exp_f32 v34, v34
  v_mfma_f32_16x16x32_bf16 v[44:47], a[88:91], v[176:179], v[44:47]
  v_mfma_f32_16x16x32_bf16 v[44:47], a[92:95], v[184:187], v[44:47]
  s_min_u32 s65, s65, s25
  v_exp_f32 v35, v35
  v_mfma_f32_16x16x32_bf16 v[96:99], a[128:131], v[48:51], v[96:99]
  v_cvt_pk_bf16_f32 v33, v34, v35
  v_mfma_f32_16x16x32_bf16 v[196:199], a[132:135], v[48:51], v[196:199]
  v_exp_f32 v36, v36
  v_mfma_f32_16x16x32_bf16 v[100:103], a[136:139], v[48:51], v[100:103]
  v_mfma_f32_16x16x32_bf16 v[204:207], a[140:143], v[48:51], v[204:207]
  v_exp_f32 v37, v37
  v_mfma_f32_16x16x32_bf16 v[104:107], a[144:147], v[48:51], v[104:107]
  v_cvt_pk_bf16_f32 v34, v36, v37
  v_mfma_f32_16x16x32_bf16 v[212:215], a[148:151], v[48:51], v[212:215]
  v_exp_f32 v38, v38
  v_mfma_f32_16x16x32_bf16 v[108:111], a[152:155], v[48:51], v[108:111]
  v_mfma_f32_16x16x32_bf16 v[220:223], a[156:159], v[48:51], v[220:223]
  v_exp_f32 v39, v39
  v_mfma_f32_16x16x32_bf16 a[168:171], a[224:227], v[48:51], a[168:171]
  v_cvt_pk_bf16_f32 v35, v38, v39
  v_mfma_f32_16x16x32_bf16 v[112:115], a[128:131], v[56:59], v[112:115]
  v_exp_f32 v40, v40
  v_mfma_f32_16x16x32_bf16 v[228:231], a[132:135], v[56:59], v[228:231]
  v_mfma_f32_16x16x32_bf16 v[116:119], a[136:139], v[56:59], v[116:119]
  v_exp_f32 v41, v41
  v_mfma_f32_16x16x32_bf16 v[236:239], a[140:143], v[56:59], v[236:239]
  v_cvt_pk_bf16_f32 v40, v40, v41
  v_mfma_f32_16x16x32_bf16 v[120:123], a[144:147], v[56:59], v[120:123]
  v_exp_f32 v42, v42
  v_mfma_f32_16x16x32_bf16 v[244:247], a[148:151], v[56:59], v[244:247]
  v_mfma_f32_16x16x32_bf16 v[124:127], a[152:155], v[56:59], v[124:127]
  v_exp_f32 v43, v43
  v_mfma_f32_16x16x32_bf16 v[252:255], a[156:159], v[56:59], v[252:255]
  v_cvt_pk_bf16_f32 v41, v42, v43
  v_mfma_f32_16x16x32_bf16 a[172:175], a[224:227], v[56:59], a[172:175]
  s_waitcnt lgkmcnt(0)
  v_exp_f32 v44, v44
  v_mfma_f32_16x16x32_bf16 v[48:51], a[64:67], v[192:195], 0
  v_mfma_f32_16x16x32_bf16 v[48:51], a[68:71], v[200:203], v[48:51]
  v_exp_f32 v45, v45
  v_mfma_f32_16x16x32_bf16 v[48:51], a[72:75], v[208:211], v[48:51]
  v_cvt_pk_bf16_f32 v42, v44, v45
  v_mfma_f32_16x16x32_bf16 v[48:51], a[76:79], v[216:219], v[48:51]
  v_exp_f32 v46, v46
  v_mfma_f32_16x16x32_bf16 v[52:55], a[80:83], v[192:195], 0
  v_mfma_f32_16x16x32_bf16 v[52:55], a[84:87], v[200:203], v[52:55]
  v_exp_f32 v47, v47
  v_mfma_f32_16x16x32_bf16 v[52:55], a[88:91], v[208:211], v[52:55]
  v_cvt_pk_bf16_f32 v43, v46, v47
  v_mfma_f32_16x16x32_bf16 v[52:55], a[92:95], v[216:219], v[52:55]
  buffer_load_dwordx4 v28, s[16:19], s78 offen offset:2048 sc1 lds
  v_mfma_f32_16x16x32_bf16 v[56:59], a[64:67], v[224:227], 0
  s_add_u32 s64, s64, 16384
  v_mfma_f32_16x16x32_bf16 v[56:59], a[68:71], v[232:235], v[56:59]
  s_sub_u32 s24, s64, 163840
  v_exp_f32 v48, v48
  v_mfma_f32_16x16x32_bf16 v[56:59], a[72:75], v[240:243], v[56:59]
  buffer_load_dwordx4 v28, s[16:19], s78 offen offset:3072 sc1 lds
  v_mfma_f32_16x16x32_bf16 v[56:59], a[76:79], v[248:251], v[56:59]
  s_min_u32 s64, s64, s24
  v_exp_f32 v49, v49
  v_mfma_f32_16x16x32_bf16 v[60:63], a[80:83], v[224:227], 0
  v_add_u32 v3, s64, v12
  v_cvt_pk_bf16_f32 v48, v48, v49
  v_mfma_f32_16x16x32_bf16 v[60:63], a[84:87], v[232:235], v[60:63]
  v_exp_f32 v50, v50
  v_mfma_f32_16x16x32_bf16 v[60:63], a[88:91], v[240:243], v[60:63]
  v_mfma_f32_16x16x32_bf16 v[60:63], a[92:95], v[248:251], v[60:63]
  v_exp_f32 v51, v51
  v_mfma_f32_16x16x32_bf16 v[64:67], a[96:99], v[32:35], v[64:67]
  v_cvt_pk_bf16_f32 v49, v50, v51
  v_mfma_f32_16x16x32_bf16 v[132:135], a[100:103], v[32:35], v[132:135]
  v_exp_f32 v52, v52
  v_mfma_f32_16x16x32_bf16 v[68:71], a[104:107], v[32:35], v[68:71]
  ds_read_b128 a[64:67], v3 offset:0
  ds_read_b128 a[68:71], v3 offset:1024
  v_mfma_f32_16x16x32_bf16 v[140:143], a[108:111], v[32:35], v[140:143]
  v_exp_f32 v53, v53
  v_mfma_f32_16x16x32_bf16 v[72:75], a[112:115], v[32:35], v[72:75]
  ds_read_b128 a[72:75], v3 offset:2048
  v_cvt_pk_bf16_f32 v50, v52, v53
  v_mfma_f32_16x16x32_bf16 v[148:151], a[116:119], v[32:35], v[148:151]
  v_exp_f32 v54, v54
  v_mfma_f32_16x16x32_bf16 v[76:79], a[120:123], v[32:35], v[76:79]
  ds_read_b128 a[76:79], v3 offset:3072
  ds_read_b128 a[80:83], v3 offset:4096
  v_mfma_f32_16x16x32_bf16 v[156:159], a[124:127], v[32:35], v[156:159]
  v_exp_f32 v55, v55
  v_mfma_f32_16x16x32_bf16 a[160:163], a[224:227], v[32:35], a[160:163]
  ds_read_b128 a[84:87], v3 offset:5120
  v_cvt_pk_bf16_f32 v51, v54, v55
  v_mfma_f32_16x16x32_bf16 v[80:83], a[96:99], v[40:43], v[80:83]
  v_exp_f32 v56, v56
  v_mfma_f32_16x16x32_bf16 v[164:167], a[100:103], v[40:43], v[164:167]
  ds_read_b128 a[88:91], v3 offset:6144
  ds_read_b128 a[92:95], v3 offset:7168
  v_mfma_f32_16x16x32_bf16 v[84:87], a[104:107], v[40:43], v[84:87]
  v_exp_f32 v57, v57
  v_mfma_f32_16x16x32_bf16 v[172:175], a[108:111], v[40:43], v[172:175]
  v_cvt_pk_bf16_f32 v56, v56, v57
  v_mfma_f32_16x16x32_bf16 v[88:91], a[112:115], v[40:43], v[88:91]
  v_exp_f32 v58, v58
  v_mfma_f32_16x16x32_bf16 v[180:183], a[116:119], v[40:43], v[180:183]
  v_mfma_f32_16x16x32_bf16 v[92:95], a[120:123], v[40:43], v[92:95]
  v_exp_f32 v59, v59
  v_mfma_f32_16x16x32_bf16 v[188:191], a[124:127], v[40:43], v[188:191]
  v_cvt_pk_bf16_f32 v57, v58, v59
  v_mfma_f32_16x16x32_bf16 a[164:167], a[224:227], v[40:43], a[164:167]
  s_waitcnt lgkmcnt(0)
  v_exp_f32 v60, v60
  v_mfma_f32_16x16x32_bf16 v[32:35], a[64:67], v[128:131], 0
  s_add_u32 s78, s78, 16384
  ds_read_b128 a[128:131], v3 offset:8192
  ds_read_b128 a[132:135], v3 offset:9216
  v_mfma_f32_16x16x32_bf16 v[32:35], a[68:71], v[136:139], v[32:35]
  s_cmp_eq_u32 s78, s62
  v_exp_f32 v61, v61
  v_mfma_f32_16x16x32_bf16 v[32:35], a[72:75], v[144:147], v[32:35]
  s_cmov_b32 s78, s79
  ds_read_b128 a[136:139], v3 offset:10240
  v_cvt_pk_bf16_f32 v58, v60, v61
  v_mfma_f32_16x16x32_bf16 v[32:35], a[76:79], v[152:155], v[32:35]
  s_cmp_eq_u32 s78, s63
  v_exp_f32 v62, v62
  v_mfma_f32_16x16x32_bf16 v[36:39], a[80:83], v[128:131], 0
  s_cmov_b32 s78, s94
  ds_read_b128 a[140:143], v3 offset:11264
  ds_read_b128 a[144:147], v3 offset:12288
  v_mfma_f32_16x16x32_bf16 v[36:39], a[84:87], v[136:139], v[36:39]
  s_mov_b32 m0, s65
  v_exp_f32 v63, v63
  v_mfma_f32_16x16x32_bf16 v[36:39], a[88:91], v[144:147], v[36:39]
  s_add_u32 s65, s65, 16384
  ds_read_b128 a[148:151], v3 offset:13312
  v_cvt_pk_bf16_f32 v59, v62, v63
  v_mfma_f32_16x16x32_bf16 v[36:39], a[92:95], v[152:155], v[36:39]
  buffer_load_dwordx4 v28, s[16:19], s78 offen offset:0 sc1 lds
  v_mfma_f32_16x16x32_bf16 v[40:43], a[64:67], v[160:163], 0
  ds_read_b128 a[152:155], v3 offset:14336
  ds_read_b128 a[156:159], v3 offset:15360
  v_mfma_f32_16x16x32_bf16 v[40:43], a[68:71], v[168:171], v[40:43]
  v_exp_f32 v32, v32
  v_mfma_f32_16x16x32_bf16 v[40:43], a[72:75], v[176:179], v[40:43]
  buffer_load_dwordx4 v28, s[16:19], s78 offen offset:1024 sc1 lds
  v_mfma_f32_16x16x32_bf16 v[40:43], a[76:79], v[184:187], v[40:43]
  v_exp_f32 v33, v33
  v_mfma_f32_16x16x32_bf16 v[44:47], a[80:83], v[160:163], 0
  v_cvt_pk_bf16_f32 v32, v32, v33
  v_mfma_f32_16x16x32_bf16 v[44:47], a[84:87], v[168:171], v[44:47]
  s_sub_u32 s25, s65, 163840
  v_exp_f32 v34, v34
  v_mfma_f32_16x16x32_bf16 v[44:47], a[88:91], v[176:179], v[44:47]
  v_mfma_f32_16x16x32_bf16 v[44:47], a[92:95], v[184:187], v[44:47]
  s_min_u32 s65, s65, s25
  v_exp_f32 v35, v35
  v_mfma_f32_16x16x32_bf16 v[96:99], a[96:99], v[48:51], v[96:99]
  v_cvt_pk_bf16_f32 v33, v34, v35
  v_mfma_f32_16x16x32_bf16 v[196:199], a[100:103], v[48:51], v[196:199]
  v_exp_f32 v36, v36
  v_mfma_f32_16x16x32_bf16 v[100:103], a[104:107], v[48:51], v[100:103]
  v_mfma_f32_16x16x32_bf16 v[204:207], a[108:111], v[48:51], v[204:207]
  v_exp_f32 v37, v37
  v_mfma_f32_16x16x32_bf16 v[104:107], a[112:115], v[48:51], v[104:107]
  v_cvt_pk_bf16_f32 v34, v36, v37
  v_mfma_f32_16x16x32_bf16 v[212:215], a[116:119], v[48:51], v[212:215]
  v_exp_f32 v38, v38
  v_mfma_f32_16x16x32_bf16 v[108:111], a[120:123], v[48:51], v[108:111]
  v_mfma_f32_16x16x32_bf16 v[220:223], a[124:127], v[48:51], v[220:223]
  v_exp_f32 v39, v39
  v_mfma_f32_16x16x32_bf16 a[168:171], a[224:227], v[48:51], a[168:171]
  v_cvt_pk_bf16_f32 v35, v38, v39
  v_mfma_f32_16x16x32_bf16 v[112:115], a[96:99], v[56:59], v[112:115]
  v_exp_f32 v40, v40
  v_mfma_f32_16x16x32_bf16 v[228:231], a[100:103], v[56:59], v[228:231]
  v_mfma_f32_16x16x32_bf16 v[116:119], a[104:107], v[56:59], v[116:119]
  v_exp_f32 v41, v41
  v_mfma_f32_16x16x32_bf16 v[236:239], a[108:111], v[56:59], v[236:239]
  v_cvt_pk_bf16_f32 v40, v40, v41
  v_mfma_f32_16x16x32_bf16 v[120:123], a[112:115], v[56:59], v[120:123]
  v_exp_f32 v42, v42
  v_mfma_f32_16x16x32_bf16 v[244:247], a[116:119], v[56:59], v[244:247]
  v_mfma_f32_16x16x32_bf16 v[124:127], a[120:123], v[56:59], v[124:127]
  v_exp_f32 v43, v43
  v_mfma_f32_16x16x32_bf16 v[252:255], a[124:127], v[56:59], v[252:255]
  v_cvt_pk_bf16_f32 v41, v42, v43
  v_mfma_f32_16x16x32_bf16 a[172:175], a[224:227], v[56:59], a[172:175]
  s_waitcnt lgkmcnt(0)
  v_exp_f32 v44, v44
  v_mfma_f32_16x16x32_bf16 v[48:51], a[64:67], v[192:195], 0
  v_mfma_f32_16x16x32_bf16 v[48:51], a[68:71], v[200:203], v[48:51]
  v_exp_f32 v45, v45
  v_mfma_f32_16x16x32_bf16 v[48:51], a[72:75], v[208:211], v[48:51]
  v_cvt_pk_bf16_f32 v42, v44, v45
  v_mfma_f32_16x16x32_bf16 v[48:51], a[76:79], v[216:219], v[48:51]
  v_exp_f32 v46, v46
  v_mfma_f32_16x16x32_bf16 v[52:55], a[80:83], v[192:195], 0
  v_mfma_f32_16x16x32_bf16 v[52:55], a[84:87], v[200:203], v[52:55]
  v_exp_f32 v47, v47
  v_mfma_f32_16x16x32_bf16 v[52:55], a[88:91], v[208:211], v[52:55]
  v_cvt_pk_bf16_f32 v43, v46, v47
  v_mfma_f32_16x16x32_bf16 v[52:55], a[92:95], v[216:219], v[52:55]
  buffer_load_dwordx4 v28, s[16:19], s78 offen offset:2048 sc1 lds
  v_mfma_f32_16x16x32_bf16 v[56:59], a[64:67], v[224:227], 0
  s_add_u32 s64, s64, 16384
  v_mfma_f32_16x16x32_bf16 v[56:59], a[68:71], v[232:235], v[56:59]
  s_sub_u32 s24, s64, 163840
  v_exp_f32 v48, v48
  v_mfma_f32_16x16x32_bf16 v[56:59], a[72:75], v[240:243], v[56:59]
  buffer_load_dwordx4 v28, s[16:19], s78 offen offset:3072 sc1 lds
  v_mfma_f32_16x16x32_bf16 v[56:59], a[76:79], v[248:251], v[56:59]
  s_min_u32 s64, s64, s24
  v_exp_f32 v49, v49
  v_mfma_f32_16x16x32_bf16 v[60:63], a[80:83], v[224:227], 0
  v_add_u32 v3, s64, v12
  v_cvt_pk_bf16_f32 v48, v48, v49
  v_mfma_f32_16x16x32_bf16 v[60:63], a[84:87], v[232:235], v[60:63]
  v_exp_f32 v50, v50
  v_mfma_f32_16x16x32_bf16 v[60:63], a[88:91], v[240:243], v[60:63]
  v_mfma_f32_16x16x32_bf16 v[60:63], a[92:95], v[248:251], v[60:63]
  v_exp_f32 v51, v51
  v_mfma_f32_16x16x32_bf16 v[64:67], a[128:131], v[32:35], v[64:67]
  v_cvt_pk_bf16_f32 v49, v50, v51
  v_mfma_f32_16x16x32_bf16 v[132:135], a[132:135], v[32:35], v[132:135]
  v_exp_f32 v52, v52
  v_mfma_f32_16x16x32_bf16 v[68:71], a[136:139], v[32:35], v[68:71]
  ds_read_b128 a[64:67], v3 offset:0
  ds_read_b128 a[68:71], v3 offset:1024
  v_mfma_f32_16x16x32_bf16 v[140:143], a[140:143], v[32:35], v[140:143]
  v_exp_f32 v53, v53
  v_mfma_f32_16x16x32_bf16 v[72:75], a[144:147], v[32:35], v[72:75]
  ds_read_b128 a[72:75], v3 offset:2048
  v_cvt_pk_bf16_f32 v50, v52, v53
  v_mfma_f32_16x16x32_bf16 v[148:151], a[148:151], v[32:35], v[148:151]
  v_exp_f32 v54, v54
  v_mfma_f32_16x16x32_bf16 v[76:79], a[152:155], v[32:35], v[76:79]
  ds_read_b128 a[76:79], v3 offset:3072
  ds_read_b128 a[80:83], v3 offset:4096
  v_mfma_f32_16x16x32_bf16 v[156:159], a[156:159], v[32:35], v[156:159]
  v_exp_f32 v55, v55
  v_mfma_f32_16x16x32_bf16 a[160:163], a[224:227], v[32:35], a[160:163]
  ds_read_b128 a[84:87], v3 offset:5120
  v_cvt_pk_bf16_f32 v51, v54, v55
  v_mfma_f32_16x16x32_bf16 v[80:83], a[128:131], v[40:43], v[80:83]
  v_exp_f32 v56, v56
  v_mfma_f32_16x16x32_bf16 v[164:167], a[132:135], v[40:43], v[164:167]
  ds_read_b128 a[88:91], v3 offset:6144
  ds_read_b128 a[92:95], v3 offset:7168
  v_mfma_f32_16x16x32_bf16 v[84:87], a[136:139], v[40:43], v[84:87]
  v_exp_f32 v57, v57
  v_mfma_f32_16x16x32_bf16 v[172:175], a[140:143], v[40:43], v[172:175]
  v_cvt_pk_bf16_f32 v56, v56, v57
  v_mfma_f32_16x16x32_bf16 v[88:91], a[144:147], v[40:43], v[88:91]
  v_exp_f32 v58, v58
  v_mfma_f32_16x16x32_bf16 v[180:183], a[148:151], v[40:43], v[180:183]
  v_mfma_f32_16x16x32_bf16 v[92:95], a[152:155], v[40:43], v[92:95]
  v_exp_f32 v59, v59
  v_mfma_f32_16x16x32_bf16 v[188:191], a[156:159], v[40:43], v[188:191]
  v_cvt_pk_bf16_f32 v57, v58, v59
  v_mfma_f32_16x16x32_bf16 a[164:167], a[224:227], v[40:43], a[164:167]
  s_waitcnt lgkmcnt(0)
  v_exp_f32 v60, v60
  v_mfma_f32_16x16x32_bf16 v[32:35], a[64:67], v[128:131], 0
  s_add_u32 s78, s78, 16384
  ds_read_b128 a[96:99], v3 offset:8192
  ds_read_b128 a[100:103], v3 offset:9216
  v_mfma_f32_16x16x32_bf16 v[32:35], a[68:71], v[136:139], v[32:35]
  s_cmp_eq_u32 s78, s62
  v_exp_f32 v61, v61
  v_mfma_f32_16x16x32_bf16 v[32:35], a[72:75], v[144:147], v[32:35]
  s_cmov_b32 s78, s79
  ds_read_b128 a[104:107], v3 offset:10240
  v_cvt_pk_bf16_f32 v58, v60, v61
  v_mfma_f32_16x16x32_bf16 v[32:35], a[76:79], v[152:155], v[32:35]
  s_cmp_eq_u32 s78, s63
  v_exp_f32 v62, v62
  v_mfma_f32_16x16x32_bf16 v[36:39], a[80:83], v[128:131], 0
  s_cmov_b32 s78, s94
  ds_read_b128 a[108:111], v3 offset:11264
  ds_read_b128 a[112:115], v3 offset:12288
  v_mfma_f32_16x16x32_bf16 v[36:39], a[84:87], v[136:139], v[36:39]
  s_mov_b32 m0, s65
  v_exp_f32 v63, v63
  v_mfma_f32_16x16x32_bf16 v[36:39], a[88:91], v[144:147], v[36:39]
  s_add_u32 s65, s65, 16384
  ds_read_b128 a[116:119], v3 offset:13312
  v_cvt_pk_bf16_f32 v59, v62, v63
  v_mfma_f32_16x16x32_bf16 v[36:39], a[92:95], v[152:155], v[36:39]
  buffer_load_dwordx4 v28, s[16:19], s78 offen offset:0 sc1 lds
  v_mfma_f32_16x16x32_bf16 v[40:43], a[64:67], v[160:163], 0
  ds_read_b128 a[120:123], v3 offset:14336
  ds_read_b128 a[124:127], v3 offset:15360
  v_mfma_f32_16x16x32_bf16 v[40:43], a[68:71], v[168:171], v[40:43]
  v_exp_f32 v32, v32
  v_mfma_f32_16x16x32_bf16 v[40:43], a[72:75], v[176:179], v[40:43]
  buffer_load_dwordx4 v28, s[16:19], s78 offen offset:1024 sc1 lds
  v_mfma_f32_16x16x32_bf16 v[40:43], a[76:79], v[184:187], v[40:43]
  v_exp_f32 v33, v33
  v_mfma_f32_16x16x32_bf16 v[44:47], a[80:83], v[160:163], 0
  v_cvt_pk_bf16_f32 v32, v32, v33
  v_mfma_f32_16x16x32_bf16 v[44:47], a[84:87], v[168:171], v[44:47]
  s_sub_u32 s25, s65, 163840
  v_exp_f32 v34, v34
  v_mfma_f32_16x16x32_bf16 v[44:47], a[88:91], v[176:179], v[44:47]
  v_mfma_f32_16x16x32_bf16 v[44:47], a[92:95], v[184:187], v[44:47]
  s_min_u32 s65, s65, s25
  v_exp_f32 v35, v35
  v_mfma_f32_16x16x32_bf16 v[96:99], a[128:131], v[48:51], v[96:99]
  v_cvt_pk_bf16_f32 v33, v34, v35
  v_mfma_f32_16x16x32_bf16 v[196:199], a[132:135], v[48:51], v[196:199]
  v_exp_f32 v36, v36
  v_mfma_f32_16x16x32_bf16 v[100:103], a[136:139], v[48:51], v[100:103]
  v_mfma_f32_16x16x32_bf16 v[204:207], a[140:143], v[48:51], v[204:207]
  v_exp_f32 v37, v37
  v_mfma_f32_16x16x32_bf16 v[104:107], a[144:147], v[48:51], v[104:107]
  v_cvt_pk_bf16_f32 v34, v36, v37
  v_mfma_f32_16x16x32_bf16 v[212:215], a[148:151], v[48:51], v[212:215]
  v_exp_f32 v38, v38
  v_mfma_f32_16x16x32_bf16 v[108:111], a[152:155], v[48:51], v[108:111]
  v_mfma_f32_16x16x32_bf16 v[220:223], a[156:159], v[48:51], v[220:223]
  v_exp_f32 v39, v39
  v_mfma_f32_16x16x32_bf16 a[168:171], a[224:227], v[48:51], a[168:171]
  v_cvt_pk_bf16_f32 v35, v38, v39
  v_mfma_f32_16x16x32_bf16 v[112:115], a[128:131], v[56:59], v[112:115]
  v_exp_f32 v40, v40
  v_mfma_f32_16x16x32_bf16 v[228:231], a[132:135], v[56:59], v[228:231]
  v_mfma_f32_16x16x32_bf16 v[116:119], a[136:139], v[56:59], v[116:119]
  v_exp_f32 v41, v41
  v_mfma_f32_16x16x32_bf16 v[236:239], a[140:143], v[56:59], v[236:239]
  v_cvt_pk_bf16_f32 v40, v40, v41
  v_mfma_f32_16x16x32_bf16 v[120:123], a[144:147], v[56:59], v[120:123]
  v_exp_f32 v42, v42
  v_mfma_f32_16x16x32_bf16 v[244:247], a[148:151], v[56:59], v[244:247]
  v_mfma_f32_16x16x32_bf16 v[124:127], a[152:155], v[56:59], v[124:127]
  v_exp_f32 v43, v43
  v_mfma_f32_16x16x32_bf16 v[252:255], a[156:159], v[56:59], v[252:255]
  v_cvt_pk_bf16_f32 v41, v42, v43
  v_mfma_f32_16x16x32_bf16 a[172:175], a[224:227], v[56:59], a[172:175]
  s_waitcnt lgkmcnt(0)
  v_exp_f32 v44, v44
  v_mfma_f32_16x16x32_bf16 v[48:51], a[64:67], v[192:195], 0
  v_mfma_f32_16x16x32_bf16 v[48:51], a[68:71], v[200:203], v[48:51]
  v_exp_f32 v45, v45
  v_mfma_f32_16x16x32_bf16 v[48:51], a[72:75], v[208:211], v[48:51]
  v_cvt_pk_bf16_f32 v42, v44, v45
  v_mfma_f32_16x16x32_bf16 v[48:51], a[76:79], v[216:219], v[48:51]
  v_exp_f32 v46, v46
  v_mfma_f32_16x16x32_bf16 v[52:55], a[80:83], v[192:195], 0
  v_mfma_f32_16x16x32_bf16 v[52:55], a[84:87], v[200:203], v[52:55]
  v_exp_f32 v47, v47
  v_mfma_f32_16x16x32_bf16 v[52:55], a[88:91], v[208:211], v[52:55]
  v_cvt_pk_bf16_f32 v43, v46, v47
  v_mfma_f32_16x16x32_bf16 v[52:55], a[92:95], v[216:219], v[52:55]
  buffer_load_dwordx4 v28, s[16:19], s78 offen offset:2048 sc1 lds
  v_mfma_f32_16x16x32_bf16 v[56:59], a[64:67], v[224:227], 0
  s_add_u32 s64, s64, 16384
  v_mfma_f32_16x16x32_bf16 v[56:59], a[68:71], v[232:235], v[56:59]
  s_sub_u32 s24, s64, 163840
  v_exp_f32 v48, v48
  v_mfma_f32_16x16x32_bf16 v[56:59], a[72:75], v[240:243], v[56:59]
  buffer_load_dwordx4 v28, s[16:19], s78 offen offset:3072 sc1 lds
  v_mfma_f32_16x16x32_bf16 v[56:59], a[76:79], v[248:251], v[56:59]
  s_min_u32 s64, s64, s24
  v_exp_f32 v49, v49
  v_mfma_f32_16x16x32_bf16 v[60:63], a[80:83], v[224:227], 0
  v_add_u32 v3, s64, v12
  v_cvt_pk_bf16_f32 v48, v48, v49
  v_mfma_f32_16x16x32_bf16 v[60:63], a[84:87], v[232:235], v[60:63]
  v_exp_f32 v50, v50
  v_mfma_f32_16x16x32_bf16 v[60:63], a[88:91], v[240:243], v[60:63]
  v_mfma_f32_16x16x32_bf16 v[60:63], a[92:95], v[248:251], v[60:63]
  v_exp_f32 v51, v51
  v_mfma_f32_16x16x32_bf16 v[64:67], a[96:99], v[32:35], v[64:67]
  v_cvt_pk_bf16_f32 v49, v50, v51
  v_mfma_f32_16x16x32_bf16 v[132:135], a[100:103], v[32:35], v[132:135]
  v_exp_f32 v52, v52
  v_mfma_f32_16x16x32_bf16 v[68:71], a[104:107], v[32:35], v[68:71]
  ds_read_b128 a[64:67], v3 offset:0
  ds_read_b128 a[68:71], v3 offset:1024
  v_mfma_f32_16x16x32_bf16 v[140:143], a[108:111], v[32:35], v[140:143]
  v_exp_f32 v53, v53
  v_mfma_f32_16x16x32_bf16 v[72:75], a[112:115], v[32:35], v[72:75]
  ds_read_b128 a[72:75], v3 offset:2048
  v_cvt_pk_bf16_f32 v50, v52, v53
  v_mfma_f32_16x16x32_bf16 v[148:151], a[116:119], v[32:35], v[148:151]
  v_exp_f32 v54, v54
  v_mfma_f32_16x16x32_bf16 v[76:79], a[120:123], v[32:35], v[76:79]
  ds_read_b128 a[76:79], v3 offset:3072
  ds_read_b128 a[80:83], v3 offset:4096
  v_mfma_f32_16x16x32_bf16 v[156:159], a[124:127], v[32:35], v[156:159]
  v_exp_f32 v55, v55
  v_mfma_f32_16x16x32_bf16 a[160:163], a[224:227], v[32:35], a[160:163]
  ds_read_b128 a[84:87], v3 offset:5120
  v_cvt_pk_bf16_f32 v51, v54, v55
  v_mfma_f32_16x16x32_bf16 v[80:83], a[96:99], v[40:43], v[80:83]
  v_exp_f32 v56, v56
  v_mfma_f32_16x16x32_bf16 v[164:167], a[100:103], v[40:43], v[164:167]
  ds_read_b128 a[88:91], v3 offset:6144
  ds_read_b128 a[92:95], v3 offset:7168
  v_mfma_f32_16x16x32_bf16 v[84:87], a[104:107], v[40:43], v[84:87]
  v_exp_f32 v57, v57
  v_mfma_f32_16x16x32_bf16 v[172:175], a[108:111], v[40:43], v[172:175]
  v_cvt_pk_bf16_f32 v56, v56, v57
  v_mfma_f32_16x16x32_bf16 v[88:91], a[112:115], v[40:43], v[88:91]
  v_exp_f32 v58, v58
  v_mfma_f32_16x16x32_bf16 v[180:183], a[116:119], v[40:43], v[180:183]
  v_mfma_f32_16x16x32_bf16 v[92:95], a[120:123], v[40:43], v[92:95]
  v_exp_f32 v59, v59
  v_mfma_f32_16x16x32_bf16 v[188:191], a[124:127], v[40:43], v[188:191]
  v_cvt_pk_bf16_f32 v57, v58, v59
  v_mfma_f32_16x16x32_bf16 a[164:167], a[224:227], v[40:43], a[164:167]
  s_waitcnt lgkmcnt(0)
  v_exp_f32 v60, v60
  v_mfma_f32_16x16x32_bf16 v[32:35], a[64:67], v[128:131], 0
  s_add_u32 s78, s78, 16384
  ds_read_b128 a[128:131], v3 offset:8192
  ds_read_b128 a[132:135], v3 offset:9216
  v_mfma_f32_16x16x32_bf16 v[32:35], a[68:71], v[136:139], v[32:35]
  s_cmp_eq_u32 s78, s62
  v_exp_f32 v61, v61
  v_mfma_f32_16x16x32_bf16 v[32:35], a[72:75], v[144:147], v[32:35]
  s_cmov_b32 s78, s79
  ds_read_b128 a[136:139], v3 offset:10240
  v_cvt_pk_bf16_f32 v58, v60, v61
  v_mfma_f32_16x16x32_bf16 v[32:35], a[76:79], v[152:155], v[32:35]
  s_cmp_eq_u32 s78, s63
  v_exp_f32 v62, v62
  v_mfma_f32_16x16x32_bf16 v[36:39], a[80:83], v[128:131], 0
  s_cmov_b32 s78, s94
  ds_read_b128 a[140:143], v3 offset:11264
  ds_read_b128 a[144:147], v3 offset:12288
  v_mfma_f32_16x16x32_bf16 v[36:39], a[84:87], v[136:139], v[36:39]
  s_mov_b32 m0, s65
  v_exp_f32 v63, v63
  v_mfma_f32_16x16x32_bf16 v[36:39], a[88:91], v[144:147], v[36:39]
  s_add_u32 s65, s65, 16384
  ds_read_b128 a[148:151], v3 offset:13312
  v_cvt_pk_bf16_f32 v59, v62, v63
  v_mfma_f32_16x16x32_bf16 v[36:39], a[92:95], v[152:155], v[36:39]
  buffer_load_dwordx4 v28, s[16:19], s78 offen offset:0 sc1 lds
  v_mfma_f32_16x16x32_bf16 v[40:43], a[64:67], v[160:163], 0
  ds_read_b128 a[152:155], v3 offset:14336
  ds_read_b128 a[156:159], v3 offset:15360
  v_mfma_f32_16x16x32_bf16 v[40:43], a[68:71], v[168:171], v[40:43]
  v_exp_f32 v32, v32
  v_mfma_f32_16x16x32_bf16 v[40:43], a[72:75], v[176:179], v[40:43]
  buffer_load_dwordx4 v28, s[16:19], s78 offen offset:1024 sc1 lds
  v_mfma_f32_16x16x32_bf16 v[40:43], a[76:79], v[184:187], v[40:43]
  v_exp_f32 v33, v33
  v_mfma_f32_16x16x32_bf16 v[44:47], a[80:83], v[160:163], 0
  v_cvt_pk_bf16_f32 v32, v32, v33
  v_mfma_f32_16x16x32_bf16 v[44:47], a[84:87], v[168:171], v[44:47]
  s_sub_u32 s25, s65, 163840
  v_exp_f32 v34, v34
  v_mfma_f32_16x16x32_bf16 v[44:47], a[88:91], v[176:179], v[44:47]
  v_mfma_f32_16x16x32_bf16 v[44:47], a[92:95], v[184:187], v[44:47]
  s_min_u32 s65, s65, s25
  v_exp_f32 v35, v35
  v_mfma_f32_16x16x32_bf16 v[96:99], a[96:99], v[48:51], v[96:99]
  v_cvt_pk_bf16_f32 v33, v34, v35
  v_mfma_f32_16x16x32_bf16 v[196:199], a[100:103], v[48:51], v[196:199]
  v_exp_f32 v36, v36
  v_mfma_f32_16x16x32_bf16 v[100:103], a[104:107], v[48:51], v[100:103]
  v_mfma_f32_16x16x32_bf16 v[204:207], a[108:111], v[48:51], v[204:207]
  v_exp_f32 v37, v37
  v_mfma_f32_16x16x32_bf16 v[104:107], a[112:115], v[48:51], v[104:107]
  v_cvt_pk_bf16_f32 v34, v36, v37
  v_mfma_f32_16x16x32_bf16 v[212:215], a[116:119], v[48:51], v[212:215]
  v_exp_f32 v38, v38
  v_mfma_f32_16x16x32_bf16 v[108:111], a[120:123], v[48:51], v[108:111]
  v_mfma_f32_16x16x32_bf16 v[220:223], a[124:127], v[48:51], v[220:223]
  v_exp_f32 v39, v39
  v_mfma_f32_16x16x32_bf16 a[168:171], a[224:227], v[48:51], a[168:171]
  v_cvt_pk_bf16_f32 v35, v38, v39
  v_mfma_f32_16x16x32_bf16 v[112:115], a[96:99], v[56:59], v[112:115]
  v_exp_f32 v40, v40
  v_mfma_f32_16x16x32_bf16 v[228:231], a[100:103], v[56:59], v[228:231]
  v_mfma_f32_16x16x32_bf16 v[116:119], a[104:107], v[56:59], v[116:119]
  v_exp_f32 v41, v41
  v_mfma_f32_16x16x32_bf16 v[236:239], a[108:111], v[56:59], v[236:239]
  v_cvt_pk_bf16_f32 v40, v40, v41
  v_mfma_f32_16x16x32_bf16 v[120:123], a[112:115], v[56:59], v[120:123]
  v_exp_f32 v42, v42
  v_mfma_f32_16x16x32_bf16 v[244:247], a[116:119], v[56:59], v[244:247]
  v_mfma_f32_16x16x32_bf16 v[124:127], a[120:123], v[56:59], v[124:127]
  v_exp_f32 v43, v43
  v_mfma_f32_16x16x32_bf16 v[252:255], a[124:127], v[56:59], v[252:255]
  v_cvt_pk_bf16_f32 v41, v42, v43
  v_mfma_f32_16x16x32_bf16 a[172:175], a[224:227], v[56:59], a[172:175]
  s_waitcnt lgkmcnt(0)
  v_exp_f32 v44, v44
  v_mfma_f32_16x16x32_bf16 v[48:51], a[64:67], v[192:195], 0
  v_mfma_f32_16x16x32_bf16 v[48:51], a[68:71], v[200:203], v[48:51]
  v_exp_f32 v45, v45
  v_mfma_f32_16x16x32_bf16 v[48:51], a[72:75], v[208:211], v[48:51]
  v_cvt_pk_bf16_f32 v42, v44, v45
  v_mfma_f32_16x16x32_bf16 v[48:51], a[76:79], v[216:219], v[48:51]
  v_exp_f32 v46, v46
  v_mfma_f32_16x16x32_bf16 v[52:55], a[80:83], v[192:195], 0
  v_mfma_f32_16x16x32_bf16 v[52:55], a[84:87], v[200:203], v[52:55]
  v_exp_f32 v47, v47
  v_mfma_f32_16x16x32_bf16 v[52:55], a[88:91], v[208:211], v[52:55]
  v_cvt_pk_bf16_f32 v43, v46, v47
  v_mfma_f32_16x16x32_bf16 v[52:55], a[92:95], v[216:219], v[52:55]
  buffer_load_dwordx4 v28, s[16:19], s78 offen offset:2048 sc1 lds
  v_mfma_f32_16x16x32_bf16 v[56:59], a[64:67], v[224:227], 0
  s_add_u32 s64, s64, 16384
  v_mfma_f32_16x16x32_bf16 v[56:59], a[68:71], v[232:235], v[56:59]
  s_sub_u32 s24, s64, 163840
  v_exp_f32 v48, v48
  v_mfma_f32_16x16x32_bf16 v[56:59], a[72:75], v[240:243], v[56:59]
  buffer_load_dwordx4 v28, s[16:19], s78 offen offset:3072 sc1 lds
  v_mfma_f32_16x16x32_bf16 v[56:59], a[76:79], v[248:251], v[56:59]
  s_min_u32 s64, s64, s24
  v_exp_f32 v49, v49
  v_mfma_f32_16x16x32_bf16 v[60:63], a[80:83], v[224:227], 0
  v_add_u32 v3, s64, v12
  v_cvt_pk_bf16_f32 v48, v48, v49
  v_mfma_f32_16x16x32_bf16 v[60:63], a[84:87], v[232:235], v[60:63]
  v_exp_f32 v50, v50
  v_mfma_f32_16x16x32_bf16 v[60:63], a[88:91], v[240:243], v[60:63]
  v_mfma_f32_16x16x32_bf16 v[60:63], a[92:95], v[248:251], v[60:63]
  v_exp_f32 v51, v51
  v_mfma_f32_16x16x32_bf16 v[64:67], a[128:131], v[32:35], v[64:67]
  s_waitcnt vmcnt(8) lgkmcnt(0)
  s_barrier
  v_cvt_pk_bf16_f32 v49, v50, v51
  v_mfma_f32_16x16x32_bf16 v[132:135], a[132:135], v[32:35], v[132:135]
  v_exp_f32 v52, v52
  v_mfma_f32_16x16x32_bf16 v[68:71], a[136:139], v[32:35], v[68:71]
  ds_read_b128 a[64:67], v3 offset:0
  ds_read_b128 a[68:71], v3 offset:1024
  v_mfma_f32_16x16x32_bf16 v[140:143], a[140:143], v[32:35], v[140:143]
  v_exp_f32 v53, v53
  v_mfma_f32_16x16x32_bf16 v[72:75], a[144:147], v[32:35], v[72:75]
  ds_read_b128 a[72:75], v3 offset:2048
  v_cvt_pk_bf16_f32 v50, v52, v53
  v_mfma_f32_16x16x32_bf16 v[148:151], a[148:151], v[32:35], v[148:151]
  v_exp_f32 v54, v54
  v_mfma_f32_16x16x32_bf16 v[76:79], a[152:155], v[32:35], v[76:79]
  ds_read_b128 a[76:79], v3 offset:3072
  ds_read_b128 a[80:83], v3 offset:4096
  v_mfma_f32_16x16x32_bf16 v[156:159], a[156:159], v[32:35], v[156:159]
  v_exp_f32 v55, v55
  v_mfma_f32_16x16x32_bf16 a[160:163], a[224:227], v[32:35], a[160:163]
  ds_read_b128 a[84:87], v3 offset:5120
  v_cvt_pk_bf16_f32 v51, v54, v55
  v_mfma_f32_16x16x32_bf16 v[80:83], a[128:131], v[40:43], v[80:83]
  s_add_u32 s81, s81, 1
  v_exp_f32 v56, v56
  v_mfma_f32_16x16x32_bf16 v[164:167], a[132:135], v[40:43], v[164:167]
  ds_read_b128 a[88:91], v3 offset:6144
  ds_read_b128 a[92:95], v3 offset:7168
  v_mfma_f32_16x16x32_bf16 v[84:87], a[136:139], v[40:43], v[84:87]
  s_bitcmp1_b32 s68, s81
  v_exp_f32 v57, v57
  v_mfma_f32_16x16x32_bf16 v[172:175], a[140:143], v[40:43], v[172:175]
  s_cbranch_scc1 m64_hook
m64_back:
  v_cvt_pk_bf16_f32 v56, v56, v57
  v_mfma_f32_16x16x32_bf16 v[88:91], a[144:147], v[40:43], v[88:91]
  v_exp_f32 v58, v58
  v_mfma_f32_16x16x32_bf16 v[180:183], a[148:151], v[40:43], v[180:183]
  v_mfma_f32_16x16x32_bf16 v[92:95], a[152:155], v[40:43], v[92:95]
  s_sub_u32 s66, s66, 1
  v_exp_f32 v59, v59
  v_mfma_f32_16x16x32_bf16 v[188:191], a[156:159], v[40:43], v[188:191]
  s_cmp_lg_u32 s66, 0
  v_cvt_pk_bf16_f32 v57, v58, v59
  v_mfma_f32_16x16x32_bf16 a[164:167], a[224:227], v[40:43], a[164:167]
  s_waitcnt lgkmcnt(0)
  v_exp_f32 v60, v60
  s_cbranch_scc1 m64
m64_done:
  v_accvgpr_read_b32 v24, a160
  s_nop 4
  v_accvgpr_read_b32 v25, a164
  s_mov_b32 s26, 0x4e800000
  v_min_f32 v30, v24, v25
  v_add_f32 v31, v24, v25
  v_cmp_nle_f32 vcc, 0x30800000, v30
  v_cmp_nge_f32 s[24:25], s26, v31
  s_nop 0
  s_or_b64 vcc, vcc, s[24:25]
  s_mov_b64 s[98:99], vcc
  s_cbranch_vccnz a_skip
  v_rcp_f32 v26, v25
  v_rcp_f32 v24, v24
  s_add_u32 s24, s52, 131072
  v_mov_b32 v25, v24
  v_mov_b32 v27, v26
  v_pk_mul_f32 v[64:65], v[64:65], v[24:25]
  v_pk_mul_f32 v[66:67], v[66:67], v[24:25]
  v_pk_mul_f32 v[132:133], v[132:133], v[24:25]
  v_pk_mul_f32 v[134:135], v[134:135], v[24:25]
  v_cvt_pk_bf16_f32 v64, v64, v65
  v_cvt_pk_bf16_f32 v65, v66, v67
  v_cvt_pk_bf16_f32 v66, v132, v133
  v_cvt_pk_bf16_f32 v67, v134, v135
  buffer_store_dwordx4 v[64:67], v12, s[20:23], s52 offen offset:0 sc1
  v_pk_mul_f32 v[68:69], v[68:69], v[24:25]
  v_pk_mul_f32 v[70:71], v[70:71], v[24:25]
  v_pk_mul_f32 v[140:141], v[140:141], v[24:25]
  v_pk_mul_f32 v[142:143], v[142:143], v[24:25]
  v_cvt_pk_bf16_f32 v68, v68, v69
  v_cvt_pk_bf16_f32 v69, v70, v71
  v_cvt_pk_bf16_f32 v70, v140, v141
  v_cvt_pk_bf16_f32 v71, v142, v143
  buffer_store_dwordx4 v[68:71], v12, s[20:23], s52 offen offset:1024 sc1
  v_pk_mul_f32 v[72:73], v[72:73], v[24:25]
  v_pk_mul_f32 v[74:75], v[74:75], v[24:25]
  v_pk_mul_f32 v[148:149], v[148:149], v[24:25]
  v_pk_mul_f32 v[150:151], v[150:151], v[24:25]
  v_cvt_pk_bf16_f32 v72, v72, v73
  v_cvt_pk_bf16_f32 v73, v74, v75
  v_cvt_pk_bf16_f32 v74, v148, v149
  v_cvt_pk_bf16_f32 v75, v150, v151
  buffer_store_dwordx4 v[72:75], v12, s[20:23], s52 offen offset:2048 sc1
  v_pk_mul_f32 v[76:77], v[76:77], v[24:25]
  v_pk_mul_f32 v[78:79], v[78:79], v[24:25]
  v_pk_mul_f32 v[156:157], v[156:157], v[24:25]
  v_pk_mul_f32 v[158:159], v[158:159], v[24:25]
  v_cvt_pk_bf16_f32 v76, v76, v77
  v_cvt_pk_bf16_f32 v77, v78, v79
  v_cvt_pk_bf16_f32 v78, v156, v157
  v_cvt_pk_bf16_f32 v79, v158, v159
  buffer_store_dwordx4 v[76:79], v12, s[20:23], s52 offen offset:3072 sc1
  v_pk_mul_f32 v[80:81], v[80:81], v[26:27]
  v_pk_mul_f32 v[82:83], v[82:83], v[26:27]
  v_pk_mul_f32 v[164:165], v[164:165], v[26:27]
  v_pk_mul_f32 v[166:167], v[166:167], v[26:27]
  v_cvt_pk_bf16_f32 v80, v80, v81
  v_cvt_pk_bf16_f32 v81, v82, v83
  v_cvt_pk_bf16_f32 v82, v164, v165
  v_cvt_pk_bf16_f32 v83, v166, v167
  buffer_store_dwordx4 v[80:83], v12, s[20:23], s24 offen offset:0 sc1
  v_pk_mul_f32 v[84:85], v[84:85], v[26:27]
  v_pk_mul_f32 v[86:87], v[86:87], v[26:27]
  v_pk_mul_f32 v[172:173], v[172:173], v[26:27]
  v_pk_mul_f32 v[174:175], v[174:175], v[26:27]
  v_cvt_pk_bf16_f32 v84, v84, v85
  v_cvt_pk_bf16_f32 v85, v86, v87
  v_cvt_pk_bf16_f32 v86, v172, v173
  v_cvt_pk_bf16_f32 v87, v174, v175
  buffer_store_dwordx4 v[84:87], v12, s[20:23], s24 offen offset:1024 sc1
  v_pk_mul_f32 v[88:89], v[88:89], v[26:27]
  v_pk_mul_f32 v[90:91], v[90:91], v[26:27]
  v_pk_mul_f32 v[180:181], v[180:181], v[26:27]
  v_pk_mul_f32 v[182:183], v[182:183], v[26:27]
  v_cvt_pk_bf16_f32 v88, v88, v89
  v_cvt_pk_bf16_f32 v89, v90, v91
  v_cvt_pk_bf16_f32 v90, v180, v181
  v_cvt_pk_bf16_f32 v91, v182, v183
  buffer_store_dwordx4 v[88:91], v12, s[20:23], s24 offen offset:2048 sc1
  v_pk_mul_f32 v[92:93], v[92:93], v[26:27]
  v_pk_mul_f32 v[94:95], v[94:95], v[26:27]
  v_pk_mul_f32 v[188:189], v[188:189], v[26:27]
  v_pk_mul_f32 v[190:191], v[190:191], v[26:27]
  v_cvt_pk_bf16_f32 v92, v92, v93
  v_cvt_pk_bf16_f32 v93, v94, v95
  v_cvt_pk_bf16_f32 v94, v188, v189
  v_cvt_pk_bf16_f32 v95, v190, v191
  buffer_store_dwordx4 v[92:95], v12, s[20:23], s24 offen offset:3072 sc1
  s_getpc_b64 s[26:27]
L_pc2:
  s_lshl_b32 s24, s3, 2
  s_add_u32 s24, s24, s4
  s_add_u32 s24, s24, 32
  s_and_b32 s24, s24, 127
  s_lshl_b32 s24, s24, 10
  s_add_u32 s24, s24, tail-L_pc2
  v_and_b32 v11, 7, v0
  v_lshlrev_b32 v11, 7, v11
  v_add_u32 v11, s24, v11
  v_min_u32 v11, low_i-L_pc2-4, v11
  global_load_dword v4, v11, s[26:27]
a_skip:
  s_mov_b32 s8, s40
  s_mov_b32 s9, s41
  s_mov_b32 s66, s70
  s_cmp_eq_u32 s66, 0
  s_cbranch_scc1 tail
m32:
  v_mfma_f32_16x16x32_bf16 v[32:35], a[64:67], v[192:195], 0
  s_add_u32 s78, s78, 16384
  ds_read_b128 a[96:99], v3 offset:8192
  ds_read_b128 a[100:103], v3 offset:9216
  v_mfma_f32_16x16x32_bf16 v[32:35], a[68:71], v[200:203], v[32:35]
  s_cmp_eq_u32 s78, s62
  v_exp_f32 v61, v61
  v_mfma_f32_16x16x32_bf16 v[32:35], a[72:75], v[208:211], v[32:35]
  s_cmov_b32 s78, s79
  ds_read_b128 a[104:107], v3 offset:10240
  v_cvt_pk_bf16_f32 v58, v60, v61
  v_mfma_f32_16x16x32_bf16 v[32:35], a[76:79], v[216:219], v[32:35]
  s_cmp_eq_u32 s78, s63
  v_exp_f32 v62, v62
  v_mfma_f32_16x16x32_bf16 v[36:39], a[80:83], v[192:195], 0
  s_cmov_b32 s78, s94
  ds_read_b128 a[108:111], v3 offset:11264
  ds_read_b128 a[112:115], v3 offset:12288
  v_mfma_f32_16x16x32_bf16 v[36:39], a[84:87], v[200:203], v[36:39]
  s_mov_b32 m0, s65
  v_exp_f32 v63, v63
  v_mfma_f32_16x16x32_bf16 v[36:39], a[88:91], v[208:211], v[36:39]
  s_add_u32 s65, s65, 16384
  ds_read_b128 a[116:119], v3 offset:13312
  v_cvt_pk_bf16_f32 v59, v62, v63
  v_mfma_f32_16x16x32_bf16 v[36:39], a[92:95], v[216:219], v[36:39]
  buffer_load_dwordx4 v28, s[16:19], s78 offen offset:0 sc1 lds
  v_mfma_f32_16x16x32_bf16 v[40:43], a[64:67], v[224:227], 0
  s_add_u32 s64, s64, 16384
  ds_read_b128 a[120:123], v3 offset:14336
  ds_read_b128 a[124:127], v3 offset:15360
  v_mfma_f32_16x16x32_bf16 v[40:43], a[68:71], v[232:235], v[40:43]
  s_sub_u32 s24, s64, 163840
  v_exp_f32 v32, v32
  v_mfma_f32_16x16x32_bf16 v[40:43], a[72:75], v[240:243], v[40:43]
  buffer_load_dwordx4 v28, s[16:19], s78 offen offset:1024 sc1 lds
  v_mfma_f32_16x16x32_bf16 v[40:43], a[76:79], v[248:251], v[40:43]
  s_min_u32 s64, s64, s24
  v_exp_f32 v33, v33
  v_mfma_f32_16x16x32_bf16 v[44:47], a[80:83], v[224:227], 0
  v_add_u32 v3, s64, v12
  v_cvt_pk_bf16_f32 v32, v32, v33
  v_mfma_f32_16x16x32_bf16 v[44:47], a[84:87], v[232:235], v[44:47]
  s_sub_u32 s25, s65, 163840
  v_exp_f32 v34, v34
  v_mfma_f32_16x16x32_bf16 v[44:47], a[88:91], v[240:243], v[44:47]
  buffer_load_dwordx4 v28, s[16:19], s78 offen offset:2048 sc1 lds
  v_mfma_f32_16x16x32_bf16 v[44:47], a[92:95], v[248:251], v[44:47]
  s_min_u32 s65, s65, s25
  v_exp_f32 v35, v35
  v_mfma_f32_16x16x32_bf16 v[96:99], a[128:131], v[48:51], v[96:99]
  v_cvt_pk_bf16_f32 v33, v34, v35
  v_mfma_f32_16x16x32_bf16 v[196:199], a[132:135], v[48:51], v[196:199]
  v_exp_f32 v36, v36
  v_mfma_f32_16x16x32_bf16 v[100:103], a[136:139], v[48:51], v[100:103]
  ds_read_b128 a[64:67], v3 offset:0
  ds_read_b128 a[68:71], v3 offset:1024
  v_mfma_f32_16x16x32_bf16 v[204:207], a[140:143], v[48:51], v[204:207]
  v_exp_f32 v37, v37
  v_mfma_f32_16x16x32_bf16 v[104:107], a[144:147], v[48:51], v[104:107]
  ds_read_b128 a[72:75], v3 offset:2048
  v_cvt_pk_bf16_f32 v34, v36, v37
  v_mfma_f32_16x16x32_bf16 v[212:215], a[148:151], v[48:51], v[212:215]
  v_exp_f32 v38, v38
  v_mfma_f32_16x16x32_bf16 v[108:111], a[152:155], v[48:51], v[108:111]
  ds_read_b128 a[76:79], v3 offset:3072
  ds_read_b128 a[80:83], v3 offset:4096
  v_mfma_f32_16x16x32_bf16 v[220:223], a[156:159], v[48:51], v[220:223]
  v_exp_f32 v39, v39
  v_mfma_f32_16x16x32_bf16 a[168:171], a[224:227], v[48:51], a[168:171]
  ds_read_b128 a[84:87], v3 offset:5120
  v_cvt_pk_bf16_f32 v35, v38, v39
  v_mfma_f32_16x16x32_bf16 v[112:115], a[128:131], v[56:59], v[112:115]
  v_exp_f32 v40, v40
  v_mfma_f32_16x16x32_bf16 v[228:231], a[132:135], v[56:59], v[228:231]
  ds_read_b128 a[88:91], v3 offset:6144
  ds_read_b128 a[92:95], v3 offset:7168
  v_mfma_f32_16x16x32_bf16 v[116:119], a[136:139], v[56:59], v[116:119]
  v_exp_f32 v41, v41
  v_mfma_f32_16x16x32_bf16 v[236:239], a[140:143], v[56:59], v[236:239]
  v_cvt_pk_bf16_f32 v40, v40, v41
  v_mfma_f32_16x16x32_bf16 v[120:123], a[144:147], v[56:59], v[120:123]
  v_exp_f32 v42, v42
  v_mfma_f32_16x16x32_bf16 v[244:247], a[148:151], v[56:59], v[244:247]
  buffer_load_dwordx4 v28, s[16:19], s78 offen offset:3072 sc1 lds
  v_mfma_f32_16x16x32_bf16 v[124:127], a[152:155], v[56:59], v[124:127]
  v_exp_f32 v43, v43
  v_mfma_f32_16x16x32_bf16 v[252:255], a[156:159], v[56:59], v[252:255]
  v_cvt_pk_bf16_f32 v41, v42, v43
  v_mfma_f32_16x16x32_bf16 a[172:175], a[224:227], v[56:59], a[172:175]
  s_waitcnt lgkmcnt(0)
  v_exp_f32 v44, v44
  v_mfma_f32_16x16x32_bf16 v[48:51], a[64:67], v[192:195], 0
  s_add_u32 s78, s78, 16384
  ds_read_b128 a[128:131], v3 offset:8192
  ds_read_b128 a[132:135], v3 offset:9216
  v_mfma_f32_16x16x32_bf16 v[48:51], a[68:71], v[200:203], v[48:51]
  s_cmp_eq_u32 s78, s62
  v_exp_f32 v45, v45
  v_mfma_f32_16x16x32_bf16 v[48:51], a[72:75], v[208:211], v[48:51]
  s_cmov_b32 s78, s79
  ds_read_b128 a[136:139], v3 offset:10240
  v_cvt_pk_bf16_f32 v42, v44, v45
  v_mfma_f32_16x16x32_bf16 v[48:51], a[76:79], v[216:219], v[48:51]
  s_cmp_eq_u32 s78, s63
  v_exp_f32 v46, v46
  v_mfma_f32_16x16x32_bf16 v[52:55], a[80:83], v[192:195], 0
  s_cmov_b32 s78, s94
  ds_read_b128 a[140:143], v3 offset:11264
  ds_read_b128 a[144:147], v3 offset:12288
  v_mfma_f32_16x16x32_bf16 v[52:55], a[84:87], v[200:203], v[52:55]
  s_mov_b32 m0, s65
  v_exp_f32 v47, v47
  v_mfma_f32_16x16x32_bf16 v[52:55], a[88:91], v[208:211], v[52:55]
  s_add_u32 s65, s65, 16384
  ds_read_b128 a[148:151], v3 offset:13312
  v_cvt_pk_bf16_f32 v43, v46, v47
  v_mfma_f32_16x16x32_bf16 v[52:55], a[92:95], v[216:219], v[52:55]
  buffer_load_dwordx4 v28, s[16:19], s78 offen offset:0 sc1 lds
  v_mfma_f32_16x16x32_bf16 v[56:59], a[64:67], v[224:227], 0
  s_add_u32 s64, s64, 16384
  ds_read_b128 a[152:155], v3 offset:14336
  ds_read_b128 a[156:159], v3 offset:15360
  v_mfma_f32_16x16x32_bf16 v[56:59], a[68:71], v[232:235], v[56:59]
  s_sub_u32 s24, s64, 163840
  v_exp_f32 v48, v48
  v_mfma_f32_16x16x32_bf16 v[56:59], a[72:75], v[240:243], v[56:59]
  buffer_load_dwordx4 v28, s[16:19], s78 offen offset:1024 sc1 lds
  v_mfma_f32_16x16x32_bf16 v[56:59], a[76:79], v[248:251], v[56:59]
  s_min_u32 s64, s64, s24
  v_exp_f32 v49, v49
  v_mfma_f32_16x16x32_bf16 v[60:63], a[80:83], v[224:227], 0
  v_add_u32 v3, s64, v12
  v_cvt_pk_bf16_f32 v48, v48, v49
  v_mfma_f32_16x16x32_bf16 v[60:63], a[84:87], v[232:235], v[60:63]
  s_sub_u32 s25, s65, 163840
  v_exp_f32 v50, v50
  v_mfma_f32_16x16x32_bf16 v[60:63], a[88:91], v[240:243], v[60:63]
  buffer_load_dwordx4 v28, s[16:19], s78 offen offset:2048 sc1 lds
  v_mfma_f32_16x16x32_bf16 v[60:63], a[92:95], v[248:251], v[60:63]
  s_min_u32 s65, s65, s25
  v_exp_f32 v51, v51
  v_mfma_f32_16x16x32_bf16 v[96:99], a[96:99], v[32:35], v[96:99]
  v_cvt_pk_bf16_f32 v49, v50, v51
  v_mfma_f32_16x16x32_bf16 v[196:199], a[100:103], v[32:35], v[196:199]
  v_exp_f32 v52, v52
  v_mfma_f32_16x16x32_bf16 v[100:103], a[104:107], v[32:35], v[100:103]
  ds_read_b128 a[64:67], v3 offset:0
  ds_read_b128 a[68:71], v3 offset:1024
  v_mfma_f32_16x16x32_bf16 v[204:207], a[108:111], v[32:35], v[204:207]
  v_exp_f32 v53, v53
  v_mfma_f32_16x16x32_bf16 v[104:107], a[112:115], v[32:35], v[104:107]
  ds_read_b128 a[72:75], v3 offset:2048
  v_cvt_pk_bf16_f32 v50, v52, v53
  v_mfma_f32_16x16x32_bf16 v[212:215], a[116:119], v[32:35], v[212:215]
  v_exp_f32 v54, v54
  v_mfma_f32_16x16x32_bf16 v[108:111], a[120:123], v[32:35], v[108:111]
  ds_read_b128 a[76:79], v3 offset:3072
  ds_read_b128 a[80:83], v3 offset:4096
  v_mfma_f32_16x16x32_bf16 v[220:223], a[124:127], v[32:35], v[220:223]
  v_exp_f32 v55, v55
  v_mfma_f32_16x16x32_bf16 a[168:171], a[224:227], v[32:35], a[168:171]
  ds_read_b128 a[84:87], v3 offset:5120
  v_cvt_pk_bf16_f32 v51, v54, v55
  v_mfma_f32_16x16x32_bf16 v[112:115], a[96:99], v[40:43], v[112:115]
  v_exp_f32 v56, v56
  v_mfma_f32_16x16x32_bf16 v[228:231], a[100:103], v[40:43], v[228:231]
  ds_read_b128 a[88:91], v3 offset:6144
  ds_read_b128 a[92:95], v3 offset:7168
  v_mfma_f32_16x16x32_bf16 v[116:119], a[104:107], v[40:43], v[116:119]
  v_exp_f32 v57, v57
  v_mfma_f32_16x16x32_bf16 v[236:239], a[108:111], v[40:43], v[236:239]
  v_cvt_pk_bf16_f32 v56, v56, v57
  v_mfma_f32_16x16x32_bf16 v[120:123], a[112:115], v[40:43], v[120:123]
  v_exp_f32 v58, v58
  v_mfma_f32_16x16x32_bf16 v[244:247], a[116:119], v[40:43], v[244:247]
  buffer_load_dwordx4 v28, s[16:19], s78 offen offset:3072 sc1 lds
  v_mfma_f32_16x16x32_bf16 v[124:127], a[120:123], v[40:43], v[124:127]
  v_exp_f32 v59, v59
  v_mfma_f32_16x16x32_bf16 v[252:255], a[124:127], v[40:43], v[252:255]
  v_cvt_pk_bf16_f32 v57, v58, v59
  v_mfma_f32_16x16x32_bf16 a[172:175], a[224:227], v[40:43], a[172:175]
  s_waitcnt lgkmcnt(0)
  v_exp_f32 v60, v60
  v_mfma_f32_16x16x32_bf16 v[32:35], a[64:67], v[192:195], 0
  s_add_u32 s78, s78, 16384
  ds_read_b128 a[96:99], v3 offset:8192
  ds_read_b128 a[100:103], v3 offset:9216
  v_mfma_f32_16x16x32_bf16 v[32:35], a[68:71], v[200:203], v[32:35]
  s_cmp_eq_u32 s78, s62
  v_exp_f32 v61, v61
  v_mfma_f32_16x16x32_bf16 v[32:35], a[72:75], v[208:211], v[32:35]
  s_cmov_b32 s78, s79
  ds_read_b128 a[104:107], v3 offset:10240
  v_cvt_pk_bf16_f32 v58, v60, v61
  v_mfma_f32_16x16x32_bf16 v[32:35], a[76:79], v[216:219], v[32:35]
  s_cmp_eq_u32 s78, s63
  v_exp_f32 v62, v62
  v_mfma_f32_16x16x32_bf16 v[36:39], a[80:83], v[192:195], 0
  s_cmov_b32 s78, s94
  ds_read_b128 a[108:111], v3 offset:11264
  ds_read_b128 a[112:115], v3 offset:12288
  v_mfma_f32_16x16x32_bf16 v[36:39], a[84:87], v[200:203], v[36:39]
  s_mov_b32 m0, s65
  v_exp_f32 v63, v63
  v_mfma_f32_16x16x32_bf16 v[36:39], a[88:91], v[208:211], v[36:39]
  s_add_u32 s65, s65, 16384
  ds_read_b128 a[116:119], v3 offset:13312
  v_cvt_pk_bf16_f32 v59, v62, v63
  v_mfma_f32_16x16x32_bf16 v[36:39], a[92:95], v[216:219], v[36:39]
  buffer_load_dwordx4 v28, s[16:19], s78 offen offset:0 sc1 lds
  v_mfma_f32_16x16x32_bf16 v[40:43], a[64:67], v[224:227], 0
  s_add_u32 s64, s64, 16384
  ds_read_b128 a[120:123], v3 offset:14336
  ds_read_b128 a[124:127], v3 offset:15360
  v_mfma_f32_16x16x32_bf16 v[40:43], a[68:71], v[232:235], v[40:43]
  s_sub_u32 s24, s64, 163840
  v_exp_f32 v32, v32
  v_mfma_f32_16x16x32_bf16 v[40:43], a[72:75], v[240:243], v[40:43]
  buffer_load_dwordx4 v28, s[16:19], s78 offen offset:1024 sc1 lds
  v_mfma_f32_16x16x32_bf16 v[40:43], a[76:79], v[248:251], v[40:43]
  s_min_u32 s64, s64, s24
  v_exp_f32 v33, v33
  v_mfma_f32_16x16x32_bf16 v[44:47], a[80:83], v[224:227], 0
  v_add_u32 v3, s64, v12
  v_cvt_pk_bf16_f32 v32, v32, v33
  v_mfma_f32_16x16x32_bf16 v[44:47], a[84:87], v[232:235], v[44:47]
  s_sub_u32 s25, s65, 163840
  v_exp_f32 v34, v34
  v_mfma_f32_16x16x32_bf16 v[44:47], a[88:91], v[240:243], v[44:47]
  buffer_load_dwordx4 v28, s[16:19], s78 offen offset:2048 sc1 lds
  v_mfma_f32_16x16x32_bf16 v[44:47], a[92:95], v[248:251], v[44:47]
  s_min_u32 s65, s65, s25
  v_exp_f32 v35, v35
  v_mfma_f32_16x16x32_bf16 v[96:99], a[128:131], v[48:51], v[96:99]
  v_cvt_pk_bf16_f32 v33, v34, v35
  v_mfma_f32_16x16x32_bf16 v[196:199], a[132:135], v[48:51], v[196:199]
  v_exp_f32 v36, v36
  v_mfma_f32_16x16x32_bf16 v[100:103], a[136:139], v[48:51], v[100:103]
  ds_read_b128 a[64:67], v3 offset:0
  ds_read_b128 a[68:71], v3 offset:1024
  v_mfma_f32_16x16x32_bf16 v[204:207], a[140:143], v[48:51], v[204:207]
  v_exp_f32 v37, v37
  v_mfma_f32_16x16x32_bf16 v[104:107], a[144:147], v[48:51], v[104:107]
  ds_read_b128 a[72:75], v3 offset:2048
  v_cvt_pk_bf16_f32 v34, v36, v37
  v_mfma_f32_16x16x32_bf16 v[212:215], a[148:151], v[48:51], v[212:215]
  v_exp_f32 v38, v38
  v_mfma_f32_16x16x32_bf16 v[108:111], a[152:155], v[48:51], v[108:111]
  ds_read_b128 a[76:79], v3 offset:3072
  ds_read_b128 a[80:83], v3 offset:4096
  v_mfma_f32_16x16x32_bf16 v[220:223], a[156:159], v[48:51], v[220:223]
  v_exp_f32 v39, v39
  v_mfma_f32_16x16x32_bf16 a[168:171], a[224:227], v[48:51], a[168:171]
  ds_read_b128 a[84:87], v3 offset:5120
  v_cvt_pk_bf16_f32 v35, v38, v39
  v_mfma_f32_16x16x32_bf16 v[112:115], a[128:131], v[56:59], v[112:115]
  v_exp_f32 v40, v40
  v_mfma_f32_16x16x32_bf16 v[228:231], a[132:135], v[56:59], v[228:231]
  ds_read_b128 a[88:91], v3 offset:6144
  ds_read_b128 a[92:95], v3 offset:7168
  v_mfma_f32_16x16x32_bf16 v[116:119], a[136:139], v[56:59], v[116:119]
  v_exp_f32 v41, v41
  v_mfma_f32_16x16x32_bf16 v[236:239], a[140:143], v[56:59], v[236:239]
  v_cvt_pk_bf16_f32 v40, v40, v41
  v_mfma_f32_16x16x32_bf16 v[120:123], a[144:147], v[56:59], v[120:123]
  v_exp_f32 v42, v42
  v_mfma_f32_16x16x32_bf16 v[244:247], a[148:151], v[56:59], v[244:247]
  buffer_load_dwordx4 v28, s[16:19], s78 offen offset:3072 sc1 lds
  v_mfma_f32_16x16x32_bf16 v[124:127], a[152:155], v[56:59], v[124:127]
  v_exp_f32 v43, v43
  v_mfma_f32_16x16x32_bf16 v[252:255], a[156:159], v[56:59], v[252:255]
  v_cvt_pk_bf16_f32 v41, v42, v43
  v_mfma_f32_16x16x32_bf16 a[172:175], a[224:227], v[56:59], a[172:175]
  s_waitcnt lgkmcnt(0)
  v_exp_f32 v44, v44
  v_mfma_f32_16x16x32_bf16 v[48:51], a[64:67], v[192:195], 0
  s_add_u32 s78, s78, 16384
  ds_read_b128 a[128:131], v3 offset:8192
  ds_read_b128 a[132:135], v3 offset:9216
  v_mfma_f32_16x16x32_bf16 v[48:51], a[68:71], v[200:203], v[48:51]
  s_cmp_eq_u32 s78, s62
  v_exp_f32 v45, v45
  v_mfma_f32_16x16x32_bf16 v[48:51], a[72:75], v[208:211], v[48:51]
  s_cmov_b32 s78, s79
  ds_read_b128 a[136:139], v3 offset:10240
  v_cvt_pk_bf16_f32 v42, v44, v45
  v_mfma_f32_16x16x32_bf16 v[48:51], a[76:79], v[216:219], v[48:51]
  s_cmp_eq_u32 s78, s63
  v_exp_f32 v46, v46
  v_mfma_f32_16x16x32_bf16 v[52:55], a[80:83], v[192:195], 0
  s_cmov_b32 s78, s94
  ds_read_b128 a[140:143], v3 offset:11264
  ds_read_b128 a[144:147], v3 offset:12288
  v_mfma_f32_16x16x32_bf16 v[52:55], a[84:87], v[200:203], v[52:55]
  s_mov_b32 m0, s65
  v_exp_f32 v47, v47
  v_mfma_f32_16x16x32_bf16 v[52:55], a[88:91], v[208:211], v[52:55]
  s_add_u32 s65, s65, 16384
  ds_read_b128 a[148:151], v3 offset:13312
  v_cvt_pk_bf16_f32 v43, v46, v47
  v_mfma_f32_16x16x32_bf16 v[52:55], a[92:95], v[216:219], v[52:55]
  buffer_load_dwordx4 v28, s[16:19], s78 offen offset:0 sc1 lds
  v_mfma_f32_16x16x32_bf16 v[56:59], a[64:67], v[224:227], 0
  s_add_u32 s64, s64, 16384
  ds_read_b128 a[152:155], v3 offset:14336
  ds_read_b128 a[156:159], v3 offset:15360
  v_mfma_f32_16x16x32_bf16 v[56:59], a[68:71], v[232:235], v[56:59]
  s_sub_u32 s24, s64, 163840
  v_exp_f32 v48, v48
  v_mfma_f32_16x16x32_bf16 v[56:59], a[72:75], v[240:243], v[56:59]
  buffer_load_dwordx4 v28, s[16:19], s78 offen offset:1024 sc1 lds
  v_mfma_f32_16x16x32_bf16 v[56:59], a[76:79], v[248:251], v[56:59]
  s_min_u32 s64, s64, s24
  v_exp_f32 v49, v49
  v_mfma_f32_16x16x32_bf16 v[60:63], a[80:83], v[224:227], 0
  v_add_u32 v3, s64, v12
  v_cvt_pk_bf16_f32 v48, v48, v49
  v_mfma_f32_16x16x32_bf16 v[60:63], a[84:87], v[232:235], v[60:63]
  s_sub_u32 s25, s65, 163840
  v_exp_f32 v50, v50
  v_mfma_f32_16x16x32_bf16 v[60:63], a[88:91], v[240:243], v[60:63]
  buffer_load_dwordx4 v28, s[16:19], s78 offen offset:2048 sc1 lds
  v_mfma_f32_16x16x32_bf16 v[60:63], a[92:95], v[248:251], v[60:63]
  s_min_u32 s65, s65, s25
  v_exp_f32 v51, v51
  v_mfma_f32_16x16x32_bf16 v[96:99], a[96:99], v[32:35], v[96:99]
  s_waitcnt vmcnt(7) lgkmcnt(0)
  s_barrier
  v_cvt_pk_bf16_f32 v49, v50, v51
  v_mfma_f32_16x16x32_bf16 v[196:199], a[100:103], v[32:35], v[196:199]
  v_exp_f32 v52, v52
  v_mfma_f32_16x16x32_bf16 v[100:103], a[104:107], v[32:35], v[100:103]
  ds_read_b128 a[64:67], v3 offset:0
  ds_read_b128 a[68:71], v3 offset:1024
  v_mfma_f32_16x16x32_bf16 v[204:207], a[108:111], v[32:35], v[204:207]
  v_exp_f32 v53, v53
  v_mfma_f32_16x16x32_bf16 v[104:107], a[112:115], v[32:35], v[104:107]
  ds_read_b128 a[72:75], v3 offset:2048
  v_cvt_pk_bf16_f32 v50, v52, v53
  v_mfma_f32_16x16x32_bf16 v[212:215], a[116:119], v[32:35], v[212:215]
  v_exp_f32 v54, v54
  v_mfma_f32_16x16x32_bf16 v[108:111], a[120:123], v[32:35], v[108:111]
  ds_read_b128 a[76:79], v3 offset:3072
  ds_read_b128 a[80:83], v3 offset:4096
  v_mfma_f32_16x16x32_bf16 v[220:223], a[124:127], v[32:35], v[220:223]
  v_exp_f32 v55, v55
  v_mfma_f32_16x16x32_bf16 a[168:171], a[224:227], v[32:35], a[168:171]
  ds_read_b128 a[84:87], v3 offset:5120
  v_cvt_pk_bf16_f32 v51, v54, v55
  v_mfma_f32_16x16x32_bf16 v[112:115], a[96:99], v[40:43], v[112:115]
  s_add_u32 s81, s81, 1
  v_exp_f32 v56, v56
  v_mfma_f32_16x16x32_bf16 v[228:231], a[100:103], v[40:43], v[228:231]
  ds_read_b128 a[88:91], v3 offset:6144
  ds_read_b128 a[92:95], v3 offset:7168
  v_mfma_f32_16x16x32_bf16 v[116:119], a[104:107], v[40:43], v[116:119]
  s_bitcmp1_b32 s68, s81
  v_exp_f32 v57, v57
  v_mfma_f32_16x16x32_bf16 v[236:239], a[108:111], v[40:43], v[236:239]
  s_cbranch_scc1 m32_hook
m32_back:
  v_cvt_pk_bf16_f32 v56, v56, v57
  v_mfma_f32_16x16x32_bf16 v[120:123], a[112:115], v[40:43], v[120:123]
  v_exp_f32 v58, v58
  v_mfma_f32_16x16x32_bf16 v[244:247], a[116:119], v[40:43], v[244:247]
  buffer_load_dwordx4 v28, s[16:19], s78 offen offset:3072 sc1 lds
  v_mfma_f32_16x16x32_bf16 v[124:127], a[120:123], v[40:43], v[124:127]
  s_sub_u32 s66, s66, 1
  v_exp_f32 v59, v59
  v_mfma_f32_16x16x32_bf16 v[252:255], a[124:127], v[40:43], v[252:255]
  s_cmp_lg_u32 s66, 0
  v_cvt_pk_bf16_f32 v57, v58, v59
  v_mfma_f32_16x16x32_bf16 a[172:175], a[224:227], v[40:43], a[172:175]
  s_waitcnt lgkmcnt(0)
  v_exp_f32 v60, v60
  s_cbranch_scc1 m32
  s_cmp_eq_u64 s[98:99], 0
  s_cbranch_scc0 tail
  s_waitcnt vmcnt(63)
  v_mov_b32 v1, s92
  buffer_store_dword v1, v29, s[20:23], s34 offen sc1
tail:
  v_exp_f32 v61, v61
  s_nop 0
  v_cvt_pk_bf16_f32 v58, v60, v61
  v_exp_f32 v62, v62
  v_exp_f32 v63, v63
  s_nop 0
  v_cvt_pk_bf16_f32 v59, v62, v63
  v_mfma_f32_16x16x32_bf16 v[96:99], a[128:131], v[48:51], v[96:99]
  s_mov_b32 m0, s47
  s_lshr_b32 s24, s7, 1
  s_lshl_b32 s24, s24, 2
  v_mfma_f32_16x16x32_bf16 v[196:199], a[132:135], v[48:51], v[196:199]
  buffer_load_dwordx4 v12, s[20:23], s50 offen offset:0 sc1 lds
  v_mfma_f32_16x16x32_bf16 v[100:103], a[136:139], v[48:51], v[100:103]
  s_and_b32 s25, s3, 3
  s_add_u32 s24, s24, s25
  s_and_b32 s25, s7, 1
  v_mfma_f32_16x16x32_bf16 v[204:207], a[140:143], v[48:51], v[204:207]
  buffer_load_dwordx4 v12, s[20:23], s50 offen offset:1024 sc1 lds
  v_mfma_f32_16x16x32_bf16 v[104:107], a[144:147], v[48:51], v[104:107]
  s_lshl_b32 s26, s25, 4
  s_add_u32 s82, s24, s26
  s_xor_b32 s73, s82, 16
  v_mfma_f32_16x16x32_bf16 v[212:215], a[148:151], v[48:51], v[212:215]
  buffer_load_dwordx4 v12, s[20:23], s50 offen offset:2048 sc1 lds
  v_mfma_f32_16x16x32_bf16 v[108:111], a[152:155], v[48:51], v[108:111]
  s_sub_u32 s83, s73, s82
  s_lshl_b32 s83, s83, 19
  s_lshl_b32 s25, s25, 2
  v_mfma_f32_16x16x32_bf16 v[220:223], a[156:159], v[48:51], v[220:223]
  buffer_load_dwordx4 v12, s[20:23], s50 offen offset:3072 sc1 lds
  v_mfma_f32_16x16x32_bf16 a[168:171], a[224:227], v[48:51], a[168:171]
  s_add_u32 m0, s49, 64
  s_add_u32 s25, s25, s4
  s_lshl_b32 s91, s25, 9
  v_mfma_f32_16x16x32_bf16 v[112:115], a[128:131], v[56:59], v[112:115]
  buffer_load_dwordx4 v12, s[8:11], s48 offen offset:0 lds
  v_mfma_f32_16x16x32_bf16 v[228:231], a[132:135], v[56:59], v[228:231]
  s_add_u32 s91, s91, 60030976
  s_lshl_b32 s25, s25, 14
  s_lshl_b32 s24, s82, 19
  v_mfma_f32_16x16x32_bf16 v[116:119], a[136:139], v[56:59], v[116:119]
  buffer_load_dwordx4 v12, s[8:11], s48 offen offset:1024 lds
  v_mfma_f32_16x16x32_bf16 v[236:239], a[140:143], v[56:59], v[236:239]
  s_add_u32 s24, s24, s25
  s_add_u32 s24, s24, 33554432
  v_mov_b32 v2, v12
  v_mfma_f32_16x16x32_bf16 v[120:123], a[144:147], v[56:59], v[120:123]
  buffer_load_dwordx4 v12, s[8:11], s48 offen offset:2048 lds
  v_mfma_f32_16x16x32_bf16 v[244:247], a[148:151], v[56:59], v[244:247]
  v_and_b32 v5, 3, v0
  v_lshlrev_b32 v5, 7, v5
  v_mfma_f32_16x16x32_bf16 v[124:127], a[152:155], v[56:59], v[124:127]
  buffer_load_dwordx4 v12, s[8:11], s48 offen offset:3072 lds
  v_mfma_f32_16x16x32_bf16 v[252:255], a[156:159], v[56:59], v[252:255]
  s_add_u32 s48, s48, 4
  s_add_u32 m0, s49, 4224
  v_bfe_u32 v6, v0, 2, 1
  v_mfma_f32_16x16x32_bf16 a[172:175], a[224:227], v[56:59], a[172:175]
  buffer_load_dwordx4 v12, s[8:11], s48 offen offset:0 lds
  v_lshl_add_u32 v5, v6, 12, v5
  s_add_u32 s25, s4, 1
  s_and_b32 s25, s25, 3
  s_lshl_b32 s25, s25, 17
  s_add_u32 s74, s24, s25
  s_add_u32 s25, s4, 2
  buffer_load_dwordx4 v12, s[8:11], s48 offen offset:1024 lds
  s_and_b32 s25, s25, 3
  s_lshl_b32 s25, s25, 17
  s_add_u32 s75, s24, s25
  s_add_u32 s25, s4, 3
  s_and_b32 s25, s25, 3
  s_lshl_b32 s25, s25, 17
  buffer_load_dwordx4 v12, s[8:11], s48 offen offset:2048 lds
  s_add_u32 s76, s24, s25
  s_add_u32 s25, s4, 4
  s_and_b32 s25, s25, 3
  s_lshl_b32 s25, s25, 17
  s_add_u32 s77, s24, s25
  s_lshl_b32 s29, s51, 12
  buffer_load_dwordx4 v12, s[8:11], s48 offen offset:3072 lds
  v_and_b32 v9, 15, v0
  v_lshrrev_b32 v10, 4, v0
  v_add_u32 v11, v9, v10
  v_subrev_u32 v11, 15, v11
  v_lshlrev_b32 v11, 2, v11
  v_add_u32 v13, s29, v11
  v_cmp_gt_i32 vcc, 0, v11
  s_nop 1
  v_cndmask_b32 v13, v13, v11, vcc
  buffer_load_dword v7, v13, s[8:11], 0 offen
  s_lshl_b32 s30, s51, 1
  buffer_load_ushort v8, off, s[12:15], s30
  v_bfe_u32 v14, v0, 1, 3
  v_accvgpr_read_b32 v24, a168
  v_accvgpr_read_b32 v25, a172
  s_mov_b32 s26, 0x4e800000
  v_min_f32 v30, v24, v25
  v_add_f32 v31, v24, v25
  v_cmp_nle_f32 vcc, 0x30800000, v30
  v_cmp_nge_f32 s[24:25], s26, v31
  s_nop 0
  s_or_b64 vcc, vcc, s[24:25]
  s_or_b64 vcc, vcc, s[98:99]
  s_cbranch_vccnz slow
epi:
  v_add_u32 v16, s84, v28
  v_add_u32 v17, s85, v28
  v_add_u32 v18, s86, v28
  s_add_u32 s67, s67, 98304
  v_rcp_f32 v26, v25
  v_rcp_f32 v24, v24
  s_add_u32 s24, s53, 131072
  v_mov_b32 v25, v24
  v_mov_b32 v27, v26
  v_pk_mul_f32 v[96:97], v[96:97], v[24:25]
  v_pk_mul_f32 v[98:99], v[98:99], v[24:25]
  v_pk_mul_f32 v[196:197], v[196:197], v[24:25]
  v_pk_mul_f32 v[198:199], v[198:199], v[24:25]
  v_cvt_pk_bf16_f32 v96, v96, v97
  v_cvt_pk_bf16_f32 v97, v98, v99
  v_cvt_pk_bf16_f32 v98, v196, v197
  v_cvt_pk_bf16_f32 v99, v198, v199
  buffer_store_dwordx4 v[96:99], v12, s[20:23], s53 offen offset:0 sc1
  ds_read_b128 a[64:67], v16 offset:0
  ds_read_b128 a[68:71], v16 offset:1024
  ds_read_b128 a[72:75], v16 offset:2048
  v_pk_mul_f32 v[100:101], v[100:101], v[24:25]
  v_pk_mul_f32 v[102:103], v[102:103], v[24:25]
  v_pk_mul_f32 v[204:205], v[204:205], v[24:25]
  v_pk_mul_f32 v[206:207], v[206:207], v[24:25]
  v_cvt_pk_bf16_f32 v100, v100, v101
  v_cvt_pk_bf16_f32 v101, v102, v103
  v_cvt_pk_bf16_f32 v102, v204, v205
  v_cvt_pk_bf16_f32 v103, v206, v207
  buffer_store_dwordx4 v[100:103], v12, s[20:23], s53 offen offset:1024 sc1
  ds_read_b128 a[76:79], v16 offset:3072
  ds_read_b128 a[80:83], v16 offset:16384
  ds_read_b128 a[84:87], v16 offset:17408
  v_pk_mul_f32 v[104:105], v[104:105], v[24:25]
  v_pk_mul_f32 v[106:107], v[106:107], v[24:25]
  v_pk_mul_f32 v[212:213], v[212:213], v[24:25]
  v_pk_mul_f32 v[214:215], v[214:215], v[24:25]
  v_cvt_pk_bf16_f32 v104, v104, v105
  v_cvt_pk_bf16_f32 v105, v106, v107
  v_cvt_pk_bf16_f32 v106, v212, v213
  v_cvt_pk_bf16_f32 v107, v214, v215
  buffer_store_dwordx4 v[104:107], v12, s[20:23], s53 offen offset:2048 sc1
  ds_read_b128 a[88:91], v16 offset:18432
  ds_read_b128 a[92:95], v16 offset:19456
  ds_read_b128 a[96:99], v17 offset:0
  v_pk_mul_f32 v[108:109], v[108:109], v[24:25]
  v_pk_mul_f32 v[110:111], v[110:111], v[24:25]
  v_pk_mul_f32 v[220:221], v[220:221], v[24:25]
  v_pk_mul_f32 v[222:223], v[222:223], v[24:25]
  v_cvt_pk_bf16_f32 v108, v108, v109
  v_cvt_pk_bf16_f32 v109, v110, v111
  v_cvt_pk_bf16_f32 v110, v220, v221
  v_cvt_pk_bf16_f32 v111, v222, v223
  buffer_store_dwordx4 v[108:111], v12, s[20:23], s53 offen offset:3072 sc1
  ds_read_b128 a[100:103], v17 offset:1024
  ds_read_b128 a[104:107], v17 offset:2048
  ds_read_b128 a[108:111], v17 offset:3072
  v_pk_mul_f32 v[112:113], v[112:113], v[26:27]
  v_pk_mul_f32 v[114:115], v[114:115], v[26:27]
  v_pk_mul_f32 v[228:229], v[228:229], v[26:27]
  v_pk_mul_f32 v[230:231], v[230:231], v[26:27]
  v_cvt_pk_bf16_f32 v112, v112, v113
  v_cvt_pk_bf16_f32 v113, v114, v115
  v_cvt_pk_bf16_f32 v114, v228, v229
  v_cvt_pk_bf16_f32 v115, v230, v231
  buffer_store_dwordx4 v[112:115], v12, s[20:23], s24 offen offset:0 sc1
  ds_read_b128 a[112:115], v17 offset:16384
  ds_read_b128 a[116:119], v17 offset:17408
  ds_read_b128 a[120:123], v17 offset:18432
  v_pk_mul_f32 v[116:117], v[116:117], v[26:27]
  v_pk_mul_f32 v[118:119], v[118:119], v[26:27]
  v_pk_mul_f32 v[236:237], v[236:237], v[26:27]
  v_pk_mul_f32 v[238:239], v[238:239], v[26:27]
  v_cvt_pk_bf16_f32 v116, v116, v117
  v_cvt_pk_bf16_f32 v117, v118, v119
  v_cvt_pk_bf16_f32 v118, v236, v237
  v_cvt_pk_bf16_f32 v119, v238, v239
  buffer_store_dwordx4 v[116:119], v12, s[20:23], s24 offen offset:1024 sc1
  ds_read_b128 a[124:127], v17 offset:19456
  s_waitcnt vmcnt(21)
  ds_read_b128 a[128:131], v18 offset:0
  v_pk_mul_f32 v[120:121], v[120:121], v[26:27]
  v_pk_mul_f32 v[122:123], v[122:123], v[26:27]
  v_pk_mul_f32 v[244:245], v[244:245], v[26:27]
  v_pk_mul_f32 v[246:247], v[246:247], v[26:27]
  v_cvt_pk_bf16_f32 v120, v120, v121
  v_cvt_pk_bf16_f32 v121, v122, v123
  v_cvt_pk_bf16_f32 v122, v244, v245
  v_cvt_pk_bf16_f32 v123, v246, v247
  buffer_store_dwordx4 v[120:123], v12, s[20:23], s24 offen offset:2048 sc1
  ds_read_b128 a[132:135], v18 offset:1024
  ds_read_b128 a[136:139], v18 offset:2048
  ds_read_b128 a[140:143], v18 offset:3072
  v_pk_mul_f32 v[124:125], v[124:125], v[26:27]
  v_pk_mul_f32 v[126:127], v[126:127], v[26:27]
  v_pk_mul_f32 v[252:253], v[252:253], v[26:27]
  v_pk_mul_f32 v[254:255], v[254:255], v[26:27]
  v_cvt_pk_bf16_f32 v124, v124, v125
  v_cvt_pk_bf16_f32 v125, v126, v127
  v_cvt_pk_bf16_f32 v126, v252, v253
  v_cvt_pk_bf16_f32 v127, v254, v255
  buffer_store_dwordx4 v[124:127], v12, s[20:23], s24 offen offset:3072 sc1
  ds_read_b128 a[144:147], v18 offset:16384
  ds_read_b128 a[148:151], v18 offset:17408
  ds_read_b128 a[152:155], v18 offset:18432
  ds_read_b128 a[156:159], v18 offset:19456
  v_mov_b32 v22, 0
  v_mov_b32 v23, 0
  v_lshlrev_b32 v11, 3, v0
  v_add_u32 v11, s47, v11
  ds_write_b64 v11, v[22:23] offset:4096
  v_mul_u32_u24 v11, 4160, v10
  v_lshl_add_u32 v11, v9, 2, v11
  v_add_u32 v11, s46, v11
  buffer_load_dwordx4 a[160:163], v28, s[20:23], s67 offen offset:0 sc1
  s_waitcnt vmcnt(10)
  ds_write_b32 v11, v7
  v_and_b32 v11, 3, v0
  v_mul_u32_u24 v11, 4160, v11
  v_bfe_u32 v13, v0, 2, 2
  v_add_u32 v13, v13, v10
  v_lshl_add_u32 v11, v13, 4, v11
  s_lshl_b32 s30, s45, 8
  s_add_u32 s30, s30, s46
  buffer_load_dwordx4 a[164:167], v28, s[20:23], s67 offen offset:1024 sc1
  v_add_u32 v3, s30, v11
  v_and_b32 v11, 1, v0
  v_mul_u32_u24 v11, 4640, v11
  v_lshl_add_u32 v11, v10, 4, v11
  v_lshlrev_b32 v13, 6, v14
  v_sub_u32 v11, v11, v13
  s_add_u32 s30, s30, 17088
  v_add_u32 v4, s30, v11
  buffer_load_dwordx4 a[168:171], v28, s[20:23], s67 offen offset:2048 sc1
  v_lshl_add_u32 v11, v10, 2, v9
  v_sub_u32 v11, 15, v11
  s_cmp_eq_u32 s45, 0
  s_cselect_b32 s30, 0xffff, 0
  s_waitcnt vmcnt(11)
  v_and_b32 v8, s30, v8
  v_cmp_eq_u32 vcc, 0, v11
  s_nop 1
  v_cndmask_b32 v24, 0, v8, vcc
  v_cmp_eq_u32 vcc, 1, v11
  buffer_load_dwordx4 a[172:175], v28, s[20:23], s67 offen offset:3072 sc1
  s_nop 0
  v_cndmask_b32 v25, 0, v8, vcc
  v_cmp_eq_u32 vcc, 2, v11
  s_nop 1
  v_cndmask_b32 v26, 0, v8, vcc
  v_cmp_eq_u32 vcc, 3, v11
  s_nop 1
  v_cndmask_b32 v27, 0, v8, vcc
  s_add_u32 s67, s67, 16384
  s_waitcnt lgkmcnt(0)
  s_barrier
  ds_read_b128 v[96:99], v4 offset:3584
  ds_read_b128 v[64:67], v3 offset:0
  ds_read_b128 v[100:103], v4 offset:3072
  ds_read_b128 v[68:71], v3 offset:512
  ds_read_b128 v[104:107], v4 offset:2560
  ds_read_b128 v[72:75], v3 offset:1024
  ds_read_b128 v[108:111], v4 offset:2048
  ds_read_b128 v[76:79], v3 offset:1536
  ds_read_b128 v[112:115], v4 offset:1536
  ds_read_b128 v[80:83], v3 offset:2048
  ds_read_b128 v[116:119], v4 offset:1024
  ds_read_b128 v[84:87], v3 offset:2560
  ds_read_b128 v[120:123], v4 offset:512
  ds_read_b128 v[88:91], v3 offset:3072
  ds_read_b128 v[124:127], v4 offset:0
  ds_read_b128 v[92:95], v3 offset:3584
  s_waitcnt lgkmcnt(15)
  v_mfma_f32_16x16x32_bf16 v[32:35], v[24:27], v[96:99], 0
  buffer_load_dwordx4 a[224:227], v28, s[20:23], s67 offen offset:0 sc1
  s_waitcnt lgkmcnt(14)
  v_mfma_f32_16x16x32_bf16 v[32:35], v[64:67], v[96:99], v[32:35]
  s_waitcnt lgkmcnt(13)
  v_mfma_f32_16x16x32_bf16 v[36:39], v[24:27], v[100:103], 0
  v_mfma_f32_16x16x32_bf16 v[36:39], v[64:67], v[100:103], v[36:39]
  s_waitcnt lgkmcnt(12)
  v_mfma_f32_16x16x32_bf16 v[36:39], v[68:71], v[96:99], v[36:39]
  buffer_load_dwordx4 a[228:231], v28, s[20:23], s67 offen offset:1024 sc1
  s_waitcnt lgkmcnt(11)
  v_mfma_f32_16x16x32_bf16 v[40:43], v[24:27], v[104:107], 0
  v_mfma_f32_16x16x32_bf16 v[40:43], v[64:67], v[104:107], v[40:43]
  v_mfma_f32_16x16x32_bf16 v[40:43], v[68:71], v[100:103], v[40:43]
  s_waitcnt lgkmcnt(10)
  v_mfma_f32_16x16x32_bf16 v[40:43], v[72:75], v[96:99], v[40:43]
  buffer_load_dwordx4 a[232:235], v28, s[20:23], s67 offen offset:2048 sc1
  s_waitcnt lgkmcnt(9)
  v_mfma_f32_16x16x32_bf16 v[44:47], v[24:27], v[108:111], 0
  v_mfma_f32_16x16x32_bf16 v[44:47], v[64:67], v[108:111], v[44:47]
  v_mfma_f32_16x16x32_bf16 v[44:47], v[68:71], v[104:107], v[44:47]
  v_mfma_f32_16x16x32_bf16 v[44:47], v[72:75], v[100:103], v[44:47]
  buffer_load_dwordx4 a[236:239], v28, s[20:23], s67 offen offset:3072 sc1
  s_waitcnt lgkmcnt(8)
  v_mfma_f32_16x16x32_bf16 v[44:47], v[76:79], v[96:99], v[44:47]
  s_add_u32 s67, s67, 16384
  ds_read_b128 v[160:163], v4 offset:3648
  ds_read_b128 v[128:131], v3 offset:64
  s_waitcnt lgkmcnt(9)
  v_mfma_f32_16x16x32_bf16 v[48:51], v[24:27], v[112:115], 0
  v_mfma_f32_16x16x32_bf16 v[48:51], v[64:67], v[112:115], v[48:51]
  v_mfma_f32_16x16x32_bf16 v[48:51], v[68:71], v[108:111], v[48:51]
  ds_read_b128 v[164:167], v4 offset:3136
  ds_read_b128 v[132:135], v3 offset:576
  v_mfma_f32_16x16x32_bf16 v[48:51], v[72:75], v[104:107], v[48:51]
  v_mfma_f32_16x16x32_bf16 v[48:51], v[76:79], v[100:103], v[48:51]
  s_waitcnt lgkmcnt(10)
  v_mfma_f32_16x16x32_bf16 v[48:51], v[80:83], v[96:99], v[48:51]
  ds_read_b128 v[168:171], v4 offset:2624
  ds_read_b128 v[136:139], v3 offset:1088
  s_waitcnt lgkmcnt(11)
  v_mfma_f32_16x16x32_bf16 v[52:55], v[24:27], v[116:119], 0
  v_mfma_f32_16x16x32_bf16 v[52:55], v[64:67], v[116:119], v[52:55]
  v_mfma_f32_16x16x32_bf16 v[52:55], v[68:71], v[112:115], v[52:55]
  ds_read_b128 v[172:175], v4 offset:2112
  ds_read_b128 v[140:143], v3 offset:1600
  v_mfma_f32_16x16x32_bf16 v[52:55], v[72:75], v[108:111], v[52:55]
  v_mfma_f32_16x16x32_bf16 v[52:55], v[76:79], v[104:107], v[52:55]
  v_mfma_f32_16x16x32_bf16 v[52:55], v[80:83], v[100:103], v[52:55]
  ds_read_b128 v[176:179], v4 offset:1600
  ds_read_b128 v[144:147], v3 offset:2112
  s_waitcnt lgkmcnt(14)
  v_mfma_f32_16x16x32_bf16 v[52:55], v[84:87], v[96:99], v[52:55]
  s_waitcnt lgkmcnt(13)
  v_mfma_f32_16x16x32_bf16 v[56:59], v[24:27], v[120:123], 0
  v_mfma_f32_16x16x32_bf16 v[56:59], v[64:67], v[120:123], v[56:59]
  ds_read_b128 v[180:183], v4 offset:1088
  ds_read_b128 v[148:151], v3 offset:2624
  v_mfma_f32_16x16x32_bf16 v[56:59], v[68:71], v[116:119], v[56:59]
  v_mfma_f32_16x16x32_bf16 v[56:59], v[72:75], v[112:115], v[56:59]
  v_mfma_f32_16x16x32_bf16 v[56:59], v[76:79], v[108:111], v[56:59]
  ds_read_b128 v[184:187], v4 offset:576
  ds_read_b128 v[152:155], v3 offset:3136
  v_mfma_f32_16x16x32_bf16 v[56:59], v[80:83], v[104:107], v[56:59]
  v_mfma_f32_16x16x32_bf16 v[56:59], v[84:87], v[100:103], v[56:59]
  s_waitcnt lgkmcnt(15)
  v_mfma_f32_16x16x32_bf16 v[56:59], v[88:91], v[96:99], v[56:59]
  ds_read_b128 v[188:191], v4 offset:64
  ds_read_b128 v[156:159], v3 offset:3648
  v_mfma_f32_16x16x32_bf16 v[60:63], v[24:27], v[124:127], 0
  v_mfma_f32_16x16x32_bf16 v[60:63], v[64:67], v[124:127], v[60:63]
  v_mfma_f32_16x16x32_bf16 v[60:63], v[68:71], v[120:123], v[60:63]
  v_mfma_f32_16x16x32_bf16 v[60:63], v[72:75], v[116:119], v[60:63]
  v_mfma_f32_16x16x32_bf16 v[60:63], v[76:79], v[112:115], v[60:63]
  v_mfma_f32_16x16x32_bf16 v[60:63], v[80:83], v[108:111], v[60:63]
  v_mfma_f32_16x16x32_bf16 v[60:63], v[84:87], v[104:107], v[60:63]
  v_mfma_f32_16x16x32_bf16 v[60:63], v[88:91], v[100:103], v[60:63]
  s_waitcnt lgkmcnt(15)
  v_mfma_f32_16x16x32_bf16 v[60:63], v[92:95], v[96:99], v[60:63]
  s_waitcnt lgkmcnt(0)
  v_mfma_f32_16x16x32_bf16 v[32:35], v[128:131], v[160:163], v[32:35]
  v_mfma_f32_16x16x32_bf16 v[36:39], v[128:131], v[164:167], v[36:39]
  s_waitcnt vmcnt(8)
  ds_read_b128 v[96:99], v4 offset:3712
  ds_read_b128 v[64:67], v3 offset:128
  v_mfma_f32_16x16x32_bf16 v[36:39], v[132:135], v[160:163], v[36:39]
  v_mov_b32 v1, s92
  v_mfma_f32_16x16x32_bf16 v[40:43], v[128:131], v[168:171], v[40:43]
  buffer_store_dword v1, v29, s[20:23], s35 offen sc1
  v_mfma_f32_16x16x32_bf16 v[40:43], v[132:135], v[164:167], v[40:43]
  ds_read_b128 v[100:103], v4 offset:3200
  ds_read_b128 v[68:71], v3 offset:640
  v_mfma_f32_16x16x32_bf16 v[40:43], v[136:139], v[160:163], v[40:43]
  buffer_store_dword v1, v29, s[20:23], s34 offen sc1
  v_mfma_f32_16x16x32_bf16 v[44:47], v[128:131], v[172:175], v[44:47]
  v_mfma_f32_16x16x32_bf16 v[44:47], v[132:135], v[168:171], v[44:47]
  ds_read_b128 v[104:107], v4 offset:2688
  ds_read_b128 v[72:75], v3 offset:1152
  v_mfma_f32_16x16x32_bf16 v[44:47], v[136:139], v[164:167], v[44:47]
  v_mfma_f32_16x16x32_bf16 v[44:47], v[140:143], v[160:163], v[44:47]
  v_mfma_f32_16x16x32_bf16 v[48:51], v[128:131], v[176:179], v[48:51]
  ds_read_b128 v[108:111], v4 offset:2176
  ds_read_b128 v[76:79], v3 offset:1664
  v_mfma_f32_16x16x32_bf16 v[48:51], v[132:135], v[172:175], v[48:51]
  v_mfma_f32_16x16x32_bf16 v[48:51], v[136:139], v[168:171], v[48:51]
  v_mfma_f32_16x16x32_bf16 v[48:51], v[140:143], v[164:167], v[48:51]
  ds_read_b128 v[112:115], v4 offset:1664
  ds_read_b128 v[80:83], v3 offset:2176
  v_mfma_f32_16x16x32_bf16 v[48:51], v[144:147], v[160:163], v[48:51]
  v_mfma_f32_16x16x32_bf16 v[52:55], v[128:131], v[180:183], v[52:55]
  v_mfma_f32_16x16x32_bf16 v[52:55], v[132:135], v[176:179], v[52:55]
  ds_read_b128 v[116:119], v4 offset:1152
  ds_read_b128 v[84:87], v3 offset:2688
  v_mfma_f32_16x16x32_bf16 v[52:55], v[136:139], v[172:175], v[52:55]
  v_mfma_f32_16x16x32_bf16 v[52:55], v[140:143], v[168:171], v[52:55]
  v_mfma_f32_16x16x32_bf16 v[52:55], v[144:147], v[164:167], v[52:55]
  ds_read_b128 v[120:123], v4 offset:640
  ds_read_b128 v[88:91], v3 offset:3200
  v_mfma_f32_16x16x32_bf16 v[52:55], v[148:151], v[160:163], v[52:55]
  v_mfma_f32_16x16x32_bf16 v[56:59], v[128:131], v[184:187], v[56:59]
  v_mfma_f32_16x16x32_bf16 v[56:59], v[132:135], v[180:183], v[56:59]
  ds_read_b128 v[124:127], v4 offset:128
  ds_read_b128 v[92:95], v3 offset:3712
  v_mfma_f32_16x16x32_bf16 v[56:59], v[136:139], v[176:179], v[56:59]
  v_mfma_f32_16x16x32_bf16 v[56:59], v[140:143], v[172:175], v[56:59]
  v_mfma_f32_16x16x32_bf16 v[56:59], v[144:147], v[168:171], v[56:59]
  v_mfma_f32_16x16x32_bf16 v[56:59], v[148:151], v[164:167], v[56:59]
  v_mfma_f32_16x16x32_bf16 v[56:59], v[152:155], v[160:163], v[56:59]
  v_mfma_f32_16x16x32_bf16 v[60:63], v[128:131], v[188:191], v[60:63]
  v_mfma_f32_16x16x32_bf16 v[60:63], v[132:135], v[184:187], v[60:63]
  v_mfma_f32_16x16x32_bf16 v[60:63], v[136:139], v[180:183], v[60:63]
  v_mfma_f32_16x16x32_bf16 v[60:63], v[140:143], v[176:179], v[60:63]
  v_mfma_f32_16x16x32_bf16 v[60:63], v[144:147], v[172:175], v[60:63]
  v_mfma_f32_16x16x32_bf16 v[60:63], v[148:151], v[168:171], v[60:63]
  v_mfma_f32_16x16x32_bf16 v[60:63], v[152:155], v[164:167], v[60:63]
  s_lshl_b32 s26, s82, 13
  s_add_u32 s26, s26, s91
  v_mfma_f32_16x16x32_bf16 v[60:63], v[156:159], v[160:163], v[60:63]
  s_waitcnt lgkmcnt(0)
  v_mfma_f32_16x16x32_bf16 v[32:35], v[64:67], v[96:99], v[32:35]
  buffer_load_dword v6, v5, s[20:23], s26 offen sc1
  v_mfma_f32_16x16x32_bf16 v[36:39], v[64:67], v[100:103], v[36:39]
  ds_read_b128 v[160:163], v4 offset:3776
  ds_read_b128 v[128:131], v3 offset:192
  v_mfma_f32_16x16x32_bf16 v[36:39], v[68:71], v[96:99], v[36:39]
  v_mfma_f32_16x16x32_bf16 v[40:43], v[64:67], v[104:107], v[40:43]
  v_mfma_f32_16x16x32_bf16 v[40:43], v[68:71], v[100:103], v[40:43]
  ds_read_b128 v[164:167], v4 offset:3264
  ds_read_b128 v[132:135], v3 offset:704
  v_mfma_f32_16x16x32_bf16 v[40:43], v[72:75], v[96:99], v[40:43]
  v_mfma_f32_16x16x32_bf16 v[44:47], v[64:67], v[108:111], v[44:47]
  v_mfma_f32_16x16x32_bf16 v[44:47], v[68:71], v[104:107], v[44:47]
  ds_read_b128 v[168:171], v4 offset:2752
  ds_read_b128 v[136:139], v3 offset:1216
  v_mfma_f32_16x16x32_bf16 v[44:47], v[72:75], v[100:103], v[44:47]
  v_mfma_f32_16x16x32_bf16 v[44:47], v[76:79], v[96:99], v[44:47]
  v_mfma_f32_16x16x32_bf16 v[48:51], v[64:67], v[112:115], v[48:51]
  ds_read_b128 v[172:175], v4 offset:2240
  ds_read_b128 v[140:143], v3 offset:1728
  v_mfma_f32_16x16x32_bf16 v[48:51], v[68:71], v[108:111], v[48:51]
  v_mfma_f32_16x16x32_bf16 v[48:51], v[72:75], v[104:107], v[48:51]
  v_mfma_f32_16x16x32_bf16 v[48:51], v[76:79], v[100:103], v[48:51]
  ds_read_b128 v[176:179], v4 offset:1728
  ds_read_b128 v[144:147], v3 offset:2240
  v_mfma_f32_16x16x32_bf16 v[48:51], v[80:83], v[96:99], v[48:51]
  v_mfma_f32_16x16x32_bf16 v[52:55], v[64:67], v[116:119], v[52:55]
  v_mfma_f32_16x16x32_bf16 v[52:55], v[68:71], v[112:115], v[52:55]
  ds_read_b128 v[180:183], v4 offset:1216
  ds_read_b128 v[148:151], v3 offset:2752
  v_mfma_f32_16x16x32_bf16 v[52:55], v[72:75], v[108:111], v[52:55]
  v_mfma_f32_16x16x32_bf16 v[52:55], v[76:79], v[104:107], v[52:55]
  v_mfma_f32_16x16x32_bf16 v[52:55], v[80:83], v[100:103], v[52:55]
  ds_read_b128 v[184:187], v4 offset:704
  ds_read_b128 v[152:155], v3 offset:3264
  v_mfma_f32_16x16x32_bf16 v[52:55], v[84:87], v[96:99], v[52:55]
  v_mfma_f32_16x16x32_bf16 v[56:59], v[64:67], v[120:123], v[56:59]
  v_mfma_f32_16x16x32_bf16 v[56:59], v[68:71], v[116:119], v[56:59]
  ds_read_b128 v[188:191], v4 offset:192
  ds_read_b128 v[156:159], v3 offset:3776
  v_mfma_f32_16x16x32_bf16 v[56:59], v[72:75], v[112:115], v[56:59]
  v_mfma_f32_16x16x32_bf16 v[56:59], v[76:79], v[108:111], v[56:59]
  v_mfma_f32_16x16x32_bf16 v[56:59], v[80:83], v[104:107], v[56:59]
  v_mfma_f32_16x16x32_bf16 v[56:59], v[84:87], v[100:103], v[56:59]
  v_mfma_f32_16x16x32_bf16 v[56:59], v[88:91], v[96:99], v[56:59]
  v_mfma_f32_16x16x32_bf16 v[60:63], v[64:67], v[124:127], v[60:63]
  v_mfma_f32_16x16x32_bf16 v[60:63], v[68:71], v[120:123], v[60:63]
  v_mfma_f32_16x16x32_bf16 v[60:63], v[72:75], v[116:119], v[60:63]
  v_mfma_f32_16x16x32_bf16 v[60:63], v[76:79], v[112:115], v[60:63]
  v_mfma_f32_16x16x32_bf16 v[60:63], v[80:83], v[108:111], v[60:63]
  v_mfma_f32_16x16x32_bf16 v[60:63], v[84:87], v[104:107], v[60:63]
  v_mfma_f32_16x16x32_bf16 v[60:63], v[88:91], v[100:103], v[60:63]
  v_mfma_f32_16x16x32_bf16 v[60:63], v[92:95], v[96:99], v[60:63]
  s_waitcnt lgkmcnt(0)
  v_mfma_f32_16x16x32_bf16 v[32:35], v[128:131], v[160:163], v[32:35]
  s_waitcnt vmcnt(0)
  v_xor_b32 v6, s92, v6
  v_cmp_lt_u32 vcc, 15, v6
  v_mfma_f32_16x16x32_bf16 v[36:39], v[128:131], v[164:167], v[36:39]
  v_mfma_f32_16x16x32_bf16 v[36:39], v[132:135], v[160:163], v[36:39]
  s_cbranch_vccnz cspin
cspin_ok:
  v_mfma_f32_16x16x32_bf16 v[40:43], v[128:131], v[168:171], v[40:43]
  buffer_load_dwordx4 v[192:195], v2, s[20:23], s74 offen offset:0 sc1
  v_mfma_f32_16x16x32_bf16 v[40:43], v[132:135], v[164:167], v[40:43]
  v_mfma_f32_16x16x32_bf16 v[40:43], v[136:139], v[160:163], v[40:43]
  v_mfma_f32_16x16x32_bf16 v[44:47], v[128:131], v[172:175], v[44:47]
  buffer_load_dwordx4 v[196:199], v2, s[20:23], s74 offen offset:1024 sc1
  v_mfma_f32_16x16x32_bf16 v[44:47], v[132:135], v[168:171], v[44:47]
  v_mfma_f32_16x16x32_bf16 v[44:47], v[136:139], v[164:167], v[44:47]
  v_mfma_f32_16x16x32_bf16 v[44:47], v[140:143], v[160:163], v[44:47]
  buffer_load_dwordx4 v[200:203], v2, s[20:23], s74 offen offset:2048 sc1
  v_mfma_f32_16x16x32_bf16 v[48:51], v[128:131], v[176:179], v[48:51]
  v_mfma_f32_16x16x32_bf16 v[48:51], v[132:135], v[172:175], v[48:51]
  v_mfma_f32_16x16x32_bf16 v[48:51], v[136:139], v[168:171], v[48:51]
  buffer_load_dwordx4 v[204:207], v2, s[20:23], s74 offen offset:3072 sc1
  v_mfma_f32_16x16x32_bf16 v[48:51], v[140:143], v[164:167], v[48:51]
  v_mfma_f32_16x16x32_bf16 v[48:51], v[144:147], v[160:163], v[48:51]
  v_mfma_f32_16x16x32_bf16 v[52:55], v[128:131], v[180:183], v[52:55]
  buffer_load_dwordx4 v[208:211], v2, s[20:23], s75 offen offset:0 sc1
  v_mfma_f32_16x16x32_bf16 v[52:55], v[132:135], v[176:179], v[52:55]
  v_mfma_f32_16x16x32_bf16 v[52:55], v[136:139], v[172:175], v[52:55]
  v_mfma_f32_16x16x32_bf16 v[52:55], v[140:143], v[168:171], v[52:55]
  buffer_load_dwordx4 v[212:215], v2, s[20:23], s75 offen offset:1024 sc1
  v_mfma_f32_16x16x32_bf16 v[52:55], v[144:147], v[164:167], v[52:55]
  v_mfma_f32_16x16x32_bf16 v[52:55], v[148:151], v[160:163], v[52:55]
  v_mfma_f32_16x16x32_bf16 v[56:59], v[128:131], v[184:187], v[56:59]
  buffer_load_dwordx4 v[216:219], v2, s[20:23], s75 offen offset:2048 sc1
  v_mfma_f32_16x16x32_bf16 v[56:59], v[132:135], v[180:183], v[56:59]
  v_mfma_f32_16x16x32_bf16 v[56:59], v[136:139], v[176:179], v[56:59]
  v_mfma_f32_16x16x32_bf16 v[56:59], v[140:143], v[172:175], v[56:59]
  buffer_load_dwordx4 v[220:223], v2, s[20:23], s75 offen offset:3072 sc1
  v_mfma_f32_16x16x32_bf16 v[56:59], v[144:147], v[168:171], v[56:59]
  v_mfma_f32_16x16x32_bf16 v[56:59], v[148:151], v[164:167], v[56:59]
  v_mfma_f32_16x16x32_bf16 v[56:59], v[152:155], v[160:163], v[56:59]
  buffer_load_dwordx4 v[224:227], v2, s[20:23], s76 offen offset:0 sc1
  v_mfma_f32_16x16x32_bf16 v[60:63], v[128:131], v[188:191], v[60:63]
  v_mfma_f32_16x16x32_bf16 v[60:63], v[132:135], v[184:187], v[60:63]
  v_mfma_f32_16x16x32_bf16 v[60:63], v[136:139], v[180:183], v[60:63]
  buffer_load_dwordx4 v[228:231], v2, s[20:23], s76 offen offset:1024 sc1
  v_mfma_f32_16x16x32_bf16 v[60:63], v[140:143], v[176:179], v[60:63]
  v_mfma_f32_16x16x32_bf16 v[60:63], v[144:147], v[172:175], v[60:63]
  v_mfma_f32_16x16x32_bf16 v[60:63], v[148:151], v[168:171], v[60:63]
  buffer_load_dwordx4 v[232:235], v2, s[20:23], s76 offen offset:2048 sc1
  v_mfma_f32_16x16x32_bf16 v[60:63], v[152:155], v[164:167], v[60:63]
  v_mfma_f32_16x16x32_bf16 v[60:63], v[156:159], v[160:163], v[60:63]
  buffer_load_dwordx4 v[236:239], v2, s[20:23], s76 offen offset:3072 sc1
  buffer_load_dwordx4 v[240:243], v2, s[20:23], s77 offen offset:0 sc1
  buffer_load_dwordx4 v[244:247], v2, s[20:23], s77 offen offset:1024 sc1
  buffer_load_dwordx4 v[248:251], v2, s[20:23], s77 offen offset:2048 sc1
  buffer_load_dwordx4 v[252:255], v2, s[20:23], s77 offen offset:3072 sc1
  v_add_u32 v2, 4096, v2
  v_and_b32 v2, 0x3fff, v2
  ds_write_b128 v16, v[32:35] offset:0
  ds_write_b128 v16, v[36:39] offset:1024
  ds_write_b128 v16, v[40:43] offset:2048
  buffer_load_dwordx4 v[128:131], v2, s[20:23], s74 offen offset:0 sc1
  ds_write_b128 v16, v[44:47] offset:3072
  ds_write_b128 v16, v[48:51] offset:16384
  ds_write_b128 v16, v[52:55] offset:17408
  buffer_load_dwordx4 v[132:135], v2, s[20:23], s74 offen offset:1024 sc1
  ds_write_b128 v16, v[56:59] offset:18432
  ds_write_b128 v16, v[60:63] offset:19456
  s_lshr_b32 s30, s4, 1
  buffer_load_dwordx4 v[136:139], v2, s[20:23], s74 offen offset:2048 sc1
  s_lshl_b32 s30, s30, 14
  s_lshl_b32 s31, s45, 11
  s_add_u32 s30, s30, s31
  buffer_load_dwordx4 v[140:143], v2, s[20:23], s74 offen offset:3072 sc1
  s_add_u32 s30, s30, s84
  v_add_u32 v9, s30, v12
  s_mov_b32 s8, s56
  s_mov_b32 s9, s57
  s_mov_b32 s10, 4194304
  s_mov_b32 s11, 0x20000
  s_waitcnt lgkmcnt(0)
  s_barrier
  ds_read_b128 v[64:67], v9 offset:0
  ds_read_b128 v[68:71], v9 offset:4096
  ds_read_b128 v[72:75], v9 offset:8192
  ds_read_b128 v[76:79], v9 offset:12288
  ds_read_b128 v[80:83], v9 offset:1024
  ds_read_b128 v[84:87], v9 offset:5120
  ds_read_b128 v[88:91], v9 offset:9216
  buffer_load_dwordx4 v[144:147], v2, s[20:23], s75 offen offset:0 sc1
  ds_read_b128 v[92:95], v9 offset:13312
  s_lshl_b32 s30, s44, 13
  s_lshl_b32 s31, s4, 11
  s_add_u32 s30, s30, s31
  s_add_u32 s30, s30, 54525952
  v_lshlrev_b32 v11, 7, v14
  v_lshl_add_u32 v11, v10, 5, v11
  buffer_load_dwordx4 v[148:151], v2, s[20:23], s75 offen offset:1024 sc1
  v_and_b32 v13, 1, v0
  v_lshl_add_u32 v11, v13, 4, v11
  s_waitcnt lgkmcnt(6)
  v_add_f32 v64, v64, v68
  s_waitcnt lgkmcnt(4)
  v_add_f32 v72, v72, v76
  v_cvt_pk_bf16_f32 v40, v64, v72
  v_add_f32 v65, v65, v69
  v_add_f32 v73, v73, v77
  buffer_load_dwordx4 v[152:155], v2, s[20:23], s75 offen offset:2048 sc1
  v_cvt_pk_bf16_f32 v41, v65, v73
  v_add_f32 v66, v66, v70
  v_add_f32 v74, v74, v78
  v_cvt_pk_bf16_f32 v42, v66, v74
  v_add_f32 v67, v67, v71
  v_add_f32 v75, v75, v79
  v_cvt_pk_bf16_f32 v43, v67, v75
  buffer_load_dwordx4 v[156:159], v2, s[20:23], s75 offen offset:3072 sc1
  buffer_store_dwordx4 v[40:43], v11, s[20:23], s30 offen offset:0 sc1
  s_waitcnt lgkmcnt(2)
  v_add_f32 v80, v80, v84
  s_waitcnt lgkmcnt(0)
  v_add_f32 v88, v88, v92
  v_cvt_pk_bf16_f32 v44, v80, v88
  v_add_f32 v81, v81, v85
  v_add_f32 v89, v89, v93
  v_cvt_pk_bf16_f32 v45, v81, v89
  buffer_load_dwordx4 v[160:163], v2, s[20:23], s76 offen offset:0 sc1
  v_add_f32 v82, v82, v86
  v_add_f32 v90, v90, v94
  v_cvt_pk_bf16_f32 v46, v82, v90
  v_add_f32 v83, v83, v87
  v_add_f32 v91, v91, v95
  v_cvt_pk_bf16_f32 v47, v83, v91
  buffer_store_dwordx4 v[44:47], v11, s[20:23], s30 offen offset:1024 sc1
  buffer_load_dwordx4 v[164:167], v2, s[20:23], s76 offen offset:1024 sc1
  s_mov_b32 s12, s32
  s_mov_b32 s13, s33
  s_mov_b32 s14, 2097152
  s_mov_b32 s15, 0x20000
  v_lshrrev_b32 v24, 5, v0
  s_lshl_b32 s24, s3, 3
  s_lshl_b32 s25, s4, 1
  buffer_load_dwordx4 v[168:171], v2, s[20:23], s76 offen offset:2048 sc1
  s_add_u32 s24, s24, s25
  v_add_u32 v24, s24, v24
  v_and_b32 v26, 31, v0
  s_lshl_b32 s24, s7, 5
  v_add_u32 v26, s24, v26
  v_and_b32 v25, 7, v24
  v_lshlrev_b32 v25, 5, v25
  buffer_load_dwordx4 v[172:175], v2, s[20:23], s76 offen offset:3072 sc1
  v_lshl_add_u32 v25, v29, 6, v25
  v_add_u32 v25, s84, v25
  v_and_b32 v21, 15, v0
  v_lshlrev_b32 v21, 4, v21
  v_lshrrev_b32 v22, 4, v0
  v_lshl_add_u32 v21, v22, 13, v21
  s_lshl_b32 s24, s7, 2
  s_add_u32 s24, s24, s4
  s_lshl_b32 s24, s24, 16
  s_lshl_b32 s25, s3, 8
  s_add_u32 s24, s24, s25
  s_add_u32 s71, s24, 54525952
  s_add_u32 s72, s71, 31744
  v_lshlrev_b32 v26, 2, v26
  v_lshl_add_u32 v22, v24, 13, v26
  v_add_u32 v23, 4096, v22
  v_lshl_add_u32 v24, v24, 14, v26
  buffer_load_dword v56, v22, s[12:15], 0 offen offset:0
  buffer_load_dword v57, v22, s[12:15], 0 offen offset:1024
  buffer_load_dword v58, v22, s[12:15], 0 offen offset:2048
  buffer_load_dword v59, v22, s[12:15], 0 offen offset:3072
  buffer_load_dword v60, v23, s[12:15], 0 offen offset:0
  buffer_load_dword v61, v23, s[12:15], 0 offen offset:1024
  buffer_load_dword v62, v23, s[12:15], 0 offen offset:2048
  buffer_load_dword v63, v23, s[12:15], 0 offen offset:3072
  s_waitcnt vmcnt(37)
  v_mfma_f32_16x16x32_bf16 v[64:67], a[176:179], v[192:195], 0
  s_waitcnt vmcnt(36)
  v_mfma_f32_16x16x32_bf16 v[64:67], a[192:195], v[196:199], v[64:67]
  buffer_load_dwordx4 v[176:179], v2, s[20:23], s77 offen offset:0 sc1
  s_waitcnt vmcnt(36)
  v_mfma_f32_16x16x32_bf16 v[64:67], a[208:211], v[200:203], v[64:67]
  s_waitcnt vmcnt(35)
  v_mfma_f32_16x16x32_bf16 v[64:67], a[240:243], v[204:207], v[64:67]
  v_mfma_f32_16x16x32_bf16 v[80:83], a[180:183], v[192:195], 0
  v_mfma_f32_16x16x32_bf16 v[80:83], a[196:199], v[196:199], v[80:83]
  buffer_load_dwordx4 v[180:183], v2, s[20:23], s77 offen offset:1024 sc1
  v_mfma_f32_16x16x32_bf16 v[80:83], a[212:215], v[200:203], v[80:83]
  v_mfma_f32_16x16x32_bf16 v[80:83], a[244:247], v[204:207], v[80:83]
  v_mfma_f32_16x16x32_bf16 v[96:99], a[184:187], v[192:195], 0
  v_mfma_f32_16x16x32_bf16 v[96:99], a[200:203], v[196:199], v[96:99]
  buffer_load_dwordx4 v[184:187], v2, s[20:23], s77 offen offset:2048 sc1
  v_mfma_f32_16x16x32_bf16 v[96:99], a[216:219], v[200:203], v[96:99]
  v_mfma_f32_16x16x32_bf16 v[96:99], a[248:251], v[204:207], v[96:99]
  v_mfma_f32_16x16x32_bf16 v[112:115], a[188:191], v[192:195], 0
  v_mfma_f32_16x16x32_bf16 v[112:115], a[204:207], v[196:199], v[112:115]
  buffer_load_dwordx4 v[188:191], v2, s[20:23], s77 offen offset:3072 sc1
  v_mfma_f32_16x16x32_bf16 v[112:115], a[220:223], v[200:203], v[112:115]
  v_add_u32 v2, 4096, v2
  v_and_b32 v2, 0x3fff, v2
  v_mfma_f32_16x16x32_bf16 v[112:115], a[252:255], v[204:207], v[112:115]
  s_waitcnt vmcnt(34)
  v_mfma_f32_16x16x32_bf16 v[68:71], a[176:179], v[208:211], 0
  v_mfma_f32_16x16x32_bf16 v[68:71], a[192:195], v[212:215], v[68:71]
  buffer_load_dwordx4 v[192:195], v2, s[20:23], s74 offen offset:0 sc1
  v_mfma_f32_16x16x32_bf16 v[68:71], a[208:211], v[216:219], v[68:71]
  v_mfma_f32_16x16x32_bf16 v[68:71], a[240:243], v[220:223], v[68:71]
  v_mfma_f32_16x16x32_bf16 v[84:87], a[180:183], v[208:211], 0
  v_mfma_f32_16x16x32_bf16 v[84:87], a[196:199], v[212:215], v[84:87]
  buffer_load_dwordx4 v[196:199], v2, s[20:23], s74 offen offset:1024 sc1
  v_mfma_f32_16x16x32_bf16 v[84:87], a[212:215], v[216:219], v[84:87]
  v_mfma_f32_16x16x32_bf16 v[84:87], a[244:247], v[220:223], v[84:87]
  v_mfma_f32_16x16x32_bf16 v[100:103], a[184:187], v[208:211], 0
  v_mfma_f32_16x16x32_bf16 v[100:103], a[200:203], v[212:215], v[100:103]
  buffer_load_dwordx4 v[200:203], v2, s[20:23], s74 offen offset:2048 sc1
  v_mfma_f32_16x16x32_bf16 v[100:103], a[216:219], v[216:219], v[100:103]
  v_mfma_f32_16x16x32_bf16 v[100:103], a[248:251], v[220:223], v[100:103]
  v_mfma_f32_16x16x32_bf16 v[116:119], a[188:191], v[208:211], 0
  v_mfma_f32_16x16x32_bf16 v[116:119], a[204:207], v[212:215], v[116:119]
  buffer_load_dwordx4 v[204:207], v2, s[20:23], s74 offen offset:3072 sc1
  v_mfma_f32_16x16x32_bf16 v[116:119], a[220:223], v[216:219], v[116:119]
  v_mfma_f32_16x16x32_bf16 v[116:119], a[252:255], v[220:223], v[116:119]
  s_waitcnt vmcnt(34)
  v_mfma_f32_16x16x32_bf16 v[72:75], a[176:179], v[224:227], 0
  v_mfma_f32_16x16x32_bf16 v[72:75], a[192:195], v[228:231], v[72:75]
  buffer_load_dwordx4 v[208:211], v2, s[20:23], s75 offen offset:0 sc1
  v_mfma_f32_16x16x32_bf16 v[72:75], a[208:211], v[232:235], v[72:75]
  v_mfma_f32_16x16x32_bf16 v[72:75], a[240:243], v[236:239], v[72:75]
  v_mfma_f32_16x16x32_bf16 v[88:91], a[180:183], v[224:227], 0
  v_mfma_f32_16x16x32_bf16 v[88:91], a[196:199], v[228:231], v[88:91]
  buffer_load_dwordx4 v[212:215], v2, s[20:23], s75 offen offset:1024 sc1
  v_mfma_f32_16x16x32_bf16 v[88:91], a[212:215], v[232:235], v[88:91]
  v_mfma_f32_16x16x32_bf16 v[88:91], a[244:247], v[236:239], v[88:91]
  v_mfma_f32_16x16x32_bf16 v[104:107], a[184:187], v[224:227], 0
  v_mfma_f32_16x16x32_bf16 v[104:107], a[200:203], v[228:231], v[104:107]
  buffer_load_dwordx4 v[216:219], v2, s[20:23], s75 offen offset:2048 sc1
  v_mfma_f32_16x16x32_bf16 v[104:107], a[216:219], v[232:235], v[104:107]
  v_mfma_f32_16x16x32_bf16 v[104:107], a[248:251], v[236:239], v[104:107]
  v_mfma_f32_16x16x32_bf16 v[120:123], a[188:191], v[224:227], 0
  v_mfma_f32_16x16x32_bf16 v[120:123], a[204:207], v[228:231], v[120:123]
  buffer_load_dwordx4 v[220:223], v2, s[20:23], s75 offen offset:3072 sc1
  v_mfma_f32_16x16x32_bf16 v[120:123], a[220:223], v[232:235], v[120:123]
  v_mfma_f32_16x16x32_bf16 v[120:123], a[252:255], v[236:239], v[120:123]
  s_waitcnt vmcnt(34)
  v_mfma_f32_16x16x32_bf16 v[76:79], a[176:179], v[240:243], 0
  v_mov_b32 v1, s92
  v_mfma_f32_16x16x32_bf16 v[76:79], a[192:195], v[244:247], v[76:79]
  buffer_load_dwordx4 v[224:227], v2, s[20:23], s76 offen offset:0 sc1
  v_mfma_f32_16x16x32_bf16 v[76:79], a[208:211], v[248:251], v[76:79]
  s_add_u32 s27, s93, 98304
  v_mfma_f32_16x16x32_bf16 v[76:79], a[240:243], v[252:255], v[76:79]
  v_mfma_f32_16x16x32_bf16 v[92:95], a[180:183], v[240:243], 0
  v_mfma_f32_16x16x32_bf16 v[92:95], a[196:199], v[244:247], v[92:95]
  buffer_load_dwordx4 v[228:231], v2, s[20:23], s76 offen offset:1024 sc1
  v_mfma_f32_16x16x32_bf16 v[92:95], a[212:215], v[248:251], v[92:95]
  v_mfma_f32_16x16x32_bf16 v[92:95], a[244:247], v[252:255], v[92:95]
  v_mfma_f32_16x16x32_bf16 v[108:111], a[184:187], v[240:243], 0
  v_mfma_f32_16x16x32_bf16 v[108:111], a[200:203], v[244:247], v[108:111]
  buffer_load_dwordx4 v[232:235], v2, s[20:23], s76 offen offset:2048 sc1
  v_mfma_f32_16x16x32_bf16 v[108:111], a[216:219], v[248:251], v[108:111]
  v_mfma_f32_16x16x32_bf16 v[108:111], a[248:251], v[252:255], v[108:111]
  v_mfma_f32_16x16x32_bf16 v[124:127], a[188:191], v[240:243], 0
  v_mfma_f32_16x16x32_bf16 v[124:127], a[204:207], v[244:247], v[124:127]
  buffer_load_dwordx4 v[236:239], v2, s[20:23], s76 offen offset:3072 sc1
  v_mfma_f32_16x16x32_bf16 v[124:127], a[220:223], v[248:251], v[124:127]
  v_mfma_f32_16x16x32_bf16 v[124:127], a[252:255], v[252:255], v[124:127]
  s_waitcnt vmcnt(34)
  v_mfma_f32_16x16x32_bf16 v[64:67], a[0:3], v[128:131], v[64:67]
  v_mfma_f32_16x16x32_bf16 v[64:67], a[16:19], v[132:135], v[64:67]
  buffer_load_dwordx4 v[240:243], v2, s[20:23], s77 offen offset:0 sc1
  v_mfma_f32_16x16x32_bf16 v[64:67], a[32:35], v[136:139], v[64:67]
  v_mfma_f32_16x16x32_bf16 v[64:67], a[48:51], v[140:143], v[64:67]
  v_mfma_f32_16x16x32_bf16 v[80:83], a[4:7], v[128:131], v[80:83]
  v_mfma_f32_16x16x32_bf16 v[80:83], a[20:23], v[132:135], v[80:83]
  s_waitcnt vmcnt(28)
  s_barrier
  v_mfma_f32_16x16x32_bf16 v[80:83], a[36:39], v[136:139], v[80:83]
  buffer_load_dwordx4 v[244:247], v2, s[20:23], s77 offen offset:1024 sc1
  v_mfma_f32_16x16x32_bf16 v[80:83], a[52:55], v[140:143], v[80:83]
  buffer_store_dword v1, v29, s[20:23], s27 offen sc1
  v_mfma_f32_16x16x32_bf16 v[96:99], a[8:11], v[128:131], v[96:99]
  v_mfma_f32_16x16x32_bf16 v[96:99], a[24:27], v[132:135], v[96:99]
  v_mfma_f32_16x16x32_bf16 v[96:99], a[40:43], v[136:139], v[96:99]
  buffer_load_dwordx4 v[248:251], v2, s[20:23], s77 offen offset:2048 sc1
  v_mfma_f32_16x16x32_bf16 v[96:99], a[56:59], v[140:143], v[96:99]
  s_lshl_b32 s26, s73, 13
  s_add_u32 s26, s26, s91
  v_mfma_f32_16x16x32_bf16 v[112:115], a[12:15], v[128:131], v[112:115]
  buffer_load_dword v6, v5, s[20:23], s26 offen sc1
  v_mfma_f32_16x16x32_bf16 v[112:115], a[28:31], v[132:135], v[112:115]
  v_mfma_f32_16x16x32_bf16 v[112:115], a[44:47], v[136:139], v[112:115]
  buffer_load_dwordx4 v[252:255], v2, s[20:23], s77 offen offset:3072 sc1
  v_mfma_f32_16x16x32_bf16 v[112:115], a[60:63], v[140:143], v[112:115]
  v_add_u32 v2, 4096, v2
  v_and_b32 v2, 0x3fff, v2
  v_mfma_f32_16x16x32_bf16 v[68:71], a[0:3], v[144:147], v[68:71]
  v_mfma_f32_16x16x32_bf16 v[68:71], a[16:19], v[148:151], v[68:71]
  v_mfma_f32_16x16x32_bf16 v[68:71], a[32:35], v[152:155], v[68:71]
  buffer_load_dwordx4 v[128:131], v2, s[20:23], s74 offen offset:0 sc1
  v_mfma_f32_16x16x32_bf16 v[68:71], a[48:51], v[156:159], v[68:71]
  v_mfma_f32_16x16x32_bf16 v[84:87], a[4:7], v[144:147], v[84:87]
  v_mfma_f32_16x16x32_bf16 v[84:87], a[20:23], v[148:151], v[84:87]
  v_mfma_f32_16x16x32_bf16 v[84:87], a[36:39], v[152:155], v[84:87]
  buffer_load_dwordx4 v[132:135], v2, s[20:23], s74 offen offset:1024 sc1
  v_mfma_f32_16x16x32_bf16 v[84:87], a[52:55], v[156:159], v[84:87]
  v_mfma_f32_16x16x32_bf16 v[100:103], a[8:11], v[144:147], v[100:103]
  v_mfma_f32_16x16x32_bf16 v[100:103], a[24:27], v[148:151], v[100:103]
  v_mfma_f32_16x16x32_bf16 v[100:103], a[40:43], v[152:155], v[100:103]
  buffer_load_dwordx4 v[136:139], v2, s[20:23], s74 offen offset:2048 sc1
  v_mfma_f32_16x16x32_bf16 v[100:103], a[56:59], v[156:159], v[100:103]
  v_mfma_f32_16x16x32_bf16 v[116:119], a[12:15], v[144:147], v[116:119]
  v_mfma_f32_16x16x32_bf16 v[116:119], a[28:31], v[148:151], v[116:119]
  v_mfma_f32_16x16x32_bf16 v[116:119], a[44:47], v[152:155], v[116:119]
  buffer_load_dwordx4 v[140:143], v2, s[20:23], s74 offen offset:3072 sc1
  v_mfma_f32_16x16x32_bf16 v[116:119], a[60:63], v[156:159], v[116:119]
  s_waitcnt vmcnt(34)
  v_mfma_f32_16x16x32_bf16 v[72:75], a[0:3], v[160:163], v[72:75]
  s_sub_u32 s24, s4, 1
  s_and_b32 s24, s24, 3
  s_lshl_b32 s24, s24, 12
  v_mfma_f32_16x16x32_bf16 v[72:75], a[16:19], v[164:167], v[72:75]
  s_add_u32 s24, s24, s85
  v_add_u32 v7, s24, v12
  v_mfma_f32_16x16x32_bf16 v[72:75], a[32:35], v[168:171], v[72:75]
  buffer_load_dwordx4 v[144:147], v2, s[20:23], s75 offen offset:0 sc1
  v_mfma_f32_16x16x32_bf16 v[72:75], a[48:51], v[172:175], v[72:75]
  s_sub_u32 s24, s4, 2
  s_and_b32 s24, s24, 3
  s_lshl_b32 s24, s24, 12
  v_mfma_f32_16x16x32_bf16 v[88:91], a[4:7], v[160:163], v[88:91]
  s_add_u32 s24, s24, s85
  v_add_u32 v8, s24, v12
  v_mfma_f32_16x16x32_bf16 v[88:91], a[20:23], v[164:167], v[88:91]
  s_sub_u32 s24, s4, 3
  s_and_b32 s24, s24, 3
  s_lshl_b32 s24, s24, 12
  v_mfma_f32_16x16x32_bf16 v[88:91], a[36:39], v[168:171], v[88:91]
  buffer_load_dwordx4 v[148:151], v2, s[20:23], s75 offen offset:1024 sc1
  v_mfma_f32_16x16x32_bf16 v[88:91], a[52:55], v[172:175], v[88:91]
  s_add_u32 s24, s24, s86
  v_add_u32 v9, s24, v12
  v_and_b32 v10, 15, v0
  v_mfma_f32_16x16x32_bf16 v[104:107], a[8:11], v[160:163], v[104:107]
  v_lshlrev_b32 v10, 11, v10
  v_bfe_u32 v11, v0, 4, 1
  v_mfma_f32_16x16x32_bf16 v[104:107], a[24:27], v[164:167], v[104:107]
  v_lshl_add_u32 v10, v11, 5, v10
  v_lshrrev_b32 v11, 5, v0
  v_mfma_f32_16x16x32_bf16 v[104:107], a[40:43], v[168:171], v[104:107]
  buffer_load_dwordx4 v[152:155], v2, s[20:23], s75 offen offset:2048 sc1
  v_mfma_f32_16x16x32_bf16 v[104:107], a[56:59], v[172:175], v[104:107]
  v_lshl_add_u32 v10, v11, 4, v10
  v_mfma_f32_16x16x32_bf16 v[120:123], a[12:15], v[160:163], v[120:123]
  s_lshl_b32 s24, s73, 17
  s_lshl_b32 s25, s4, 15
  s_add_u32 s24, s24, s25
  v_mfma_f32_16x16x32_bf16 v[120:123], a[28:31], v[164:167], v[120:123]
  s_lshl_b32 s25, s6, 7
  s_add_u32 s24, s24, s25
  s_add_u32 s89, s24, 1024
  v_mfma_f32_16x16x32_bf16 v[120:123], a[44:47], v[168:171], v[120:123]
  buffer_load_dwordx4 v[156:159], v2, s[20:23], s75 offen offset:3072 sc1
  v_mfma_f32_16x16x32_bf16 v[120:123], a[60:63], v[172:175], v[120:123]
  s_waitcnt vmcnt(26)
  s_sub_u32 s24, s93, 59768832
  s_lshr_b32 s24, s24, 5
  v_mfma_f32_16x16x32_bf16 v[76:79], a[0:3], v[176:179], v[76:79]
  s_add_u32 s24, s24, s4
  s_lshl_b32 s88, s24, 7
  s_add_u32 s88, s88, 59899904
  v_mfma_f32_16x16x32_bf16 v[76:79], a[16:19], v[180:183], v[76:79]
  s_lshl_b32 s24, s24, 12
  s_add_u32 s90, s24, 67108864
  s_xor_b32 s24, s24, 524288
  v_mfma_f32_16x16x32_bf16 v[76:79], a[32:35], v[184:187], v[76:79]
  buffer_load_dwordx4 v[160:163], v2, s[20:23], s76 offen offset:0 sc1
  v_mfma_f32_16x16x32_bf16 v[76:79], a[48:51], v[188:191], v[76:79]
  s_add_u32 s82, s24, 67108864
  v_mfma_f32_16x16x32_bf16 v[92:95], a[4:7], v[176:179], v[92:95]
  v_mfma_f32_16x16x32_bf16 v[92:95], a[20:23], v[180:183], v[92:95]
  v_mfma_f32_16x16x32_bf16 v[92:95], a[36:39], v[184:187], v[92:95]
  buffer_load_dwordx4 v[164:167], v2, s[20:23], s76 offen offset:1024 sc1
  v_mfma_f32_16x16x32_bf16 v[92:95], a[52:55], v[188:191], v[92:95]
  v_mfma_f32_16x16x32_bf16 v[108:111], a[8:11], v[176:179], v[108:111]
  v_mfma_f32_16x16x32_bf16 v[108:111], a[24:27], v[180:183], v[108:111]
  v_mfma_f32_16x16x32_bf16 v[108:111], a[40:43], v[184:187], v[108:111]
  buffer_load_dwordx4 v[168:171], v2, s[20:23], s76 offen offset:2048 sc1
  v_mfma_f32_16x16x32_bf16 v[108:111], a[56:59], v[188:191], v[108:111]
  v_mfma_f32_16x16x32_bf16 v[124:127], a[12:15], v[176:179], v[124:127]
  v_mfma_f32_16x16x32_bf16 v[124:127], a[28:31], v[180:183], v[124:127]
  v_mfma_f32_16x16x32_bf16 v[124:127], a[44:47], v[184:187], v[124:127]
  buffer_load_dwordx4 v[172:175], v2, s[20:23], s76 offen offset:3072 sc1
  v_mfma_f32_16x16x32_bf16 v[124:127], a[60:63], v[188:191], v[124:127]
  s_waitcnt vmcnt(26)
  v_mfma_f32_16x16x32_bf16 v[64:67], a[64:67], v[192:195], v[64:67]
  v_mfma_f32_16x16x32_bf16 v[64:67], a[80:83], v[196:199], v[64:67]
  v_mfma_f32_16x16x32_bf16 v[64:67], a[96:99], v[200:203], v[64:67]
  buffer_load_dwordx4 v[176:179], v2, s[20:23], s77 offen offset:0 sc1
  v_mfma_f32_16x16x32_bf16 v[64:67], a[112:115], v[204:207], v[64:67]
  s_waitcnt vmcnt(14)
  v_xor_b32 v6, s92, v6
  v_cmp_lt_u32 vcc, 15, v6
  v_mfma_f32_16x16x32_bf16 v[80:83], a[68:71], v[192:195], v[80:83]
  v_mfma_f32_16x16x32_bf16 v[80:83], a[84:87], v[196:199], v[80:83]
  s_cbranch_vccnz cspin2
cspin2_ok:
  v_mfma_f32_16x16x32_bf16 v[80:83], a[100:103], v[200:203], v[80:83]
  buffer_load_dwordx4 v[180:183], v2, s[20:23], s77 offen offset:1024 sc1
  v_mfma_f32_16x16x32_bf16 v[80:83], a[116:119], v[204:207], v[80:83]
  v_mfma_f32_16x16x32_bf16 v[96:99], a[72:75], v[192:195], v[96:99]
  v_mfma_f32_16x16x32_bf16 v[96:99], a[88:91], v[196:199], v[96:99]
  v_mfma_f32_16x16x32_bf16 v[96:99], a[104:107], v[200:203], v[96:99]
  buffer_load_dwordx4 v[184:187], v2, s[20:23], s77 offen offset:2048 sc1
  v_mfma_f32_16x16x32_bf16 v[96:99], a[120:123], v[204:207], v[96:99]
  v_mfma_f32_16x16x32_bf16 v[112:115], a[76:79], v[192:195], v[112:115]
  v_mfma_f32_16x16x32_bf16 v[112:115], a[92:95], v[196:199], v[112:115]
  v_mfma_f32_16x16x32_bf16 v[112:115], a[108:111], v[200:203], v[112:115]
  buffer_load_dwordx4 v[188:191], v2, s[20:23], s77 offen offset:3072 sc1
  v_mfma_f32_16x16x32_bf16 v[112:115], a[124:127], v[204:207], v[112:115]
  v_add_u32 v2, 4096, v2
  v_and_b32 v2, 0x3fff, v2
  v_mfma_f32_16x16x32_bf16 v[68:71], a[64:67], v[208:211], v[68:71]
  s_add_u32 s74, s74, s83
  s_add_u32 s75, s75, s83
  s_add_u32 s76, s76, s83
  v_mfma_f32_16x16x32_bf16 v[68:71], a[80:83], v[212:215], v[68:71]
  s_add_u32 s77, s77, s83
  v_mfma_f32_16x16x32_bf16 v[68:71], a[96:99], v[216:219], v[68:71]
  buffer_load_dwordx4 v[192:195], v2, s[20:23], s74 offen offset:0 sc1
  v_mfma_f32_16x16x32_bf16 v[68:71], a[112:115], v[220:223], v[68:71]
  v_mfma_f32_16x16x32_bf16 v[84:87], a[68:71], v[208:211], v[84:87]
  v_mfma_f32_16x16x32_bf16 v[84:87], a[84:87], v[212:215], v[84:87]
  v_mfma_f32_16x16x32_bf16 v[84:87], a[100:103], v[216:219], v[84:87]
  buffer_load_dwordx4 v[196:199], v2, s[20:23], s74 offen offset:1024 sc1
  v_mfma_f32_16x16x32_bf16 v[84:87], a[116:119], v[220:223], v[84:87]
  v_mfma_f32_16x16x32_bf16 v[100:103], a[72:75], v[208:211], v[100:103]
  v_mfma_f32_16x16x32_bf16 v[100:103], a[88:91], v[212:215], v[100:103]
  v_mfma_f32_16x16x32_bf16 v[100:103], a[104:107], v[216:219], v[100:103]
  buffer_load_dwordx4 v[200:203], v2, s[20:23], s74 offen offset:2048 sc1
  v_mfma_f32_16x16x32_bf16 v[100:103], a[120:123], v[220:223], v[100:103]
  v_mfma_f32_16x16x32_bf16 v[116:119], a[76:79], v[208:211], v[116:119]
  v_mfma_f32_16x16x32_bf16 v[116:119], a[92:95], v[212:215], v[116:119]
  v_mfma_f32_16x16x32_bf16 v[116:119], a[108:111], v[216:219], v[116:119]
  buffer_load_dwordx4 v[204:207], v2, s[20:23], s74 offen offset:3072 sc1
  v_mfma_f32_16x16x32_bf16 v[116:119], a[124:127], v[220:223], v[116:119]
  v_mfma_f32_16x16x32_bf16 v[72:75], a[64:67], v[224:227], v[72:75]
  v_mfma_f32_16x16x32_bf16 v[72:75], a[80:83], v[228:231], v[72:75]
  v_mfma_f32_16x16x32_bf16 v[72:75], a[96:99], v[232:235], v[72:75]
  buffer_load_dwordx4 v[208:211], v2, s[20:23], s75 offen offset:0 sc1
  v_mfma_f32_16x16x32_bf16 v[72:75], a[112:115], v[236:239], v[72:75]
  v_mfma_f32_16x16x32_bf16 v[88:91], a[68:71], v[224:227], v[88:91]
  v_mfma_f32_16x16x32_bf16 v[88:91], a[84:87], v[228:231], v[88:91]
  v_mfma_f32_16x16x32_bf16 v[88:91], a[100:103], v[232:235], v[88:91]
  buffer_load_dwordx4 v[212:215], v2, s[20:23], s75 offen offset:1024 sc1
  v_mfma_f32_16x16x32_bf16 v[88:91], a[116:119], v[236:239], v[88:91]
  v_mfma_f32_16x16x32_bf16 v[104:107], a[72:75], v[224:227], v[104:107]
  v_mfma_f32_16x16x32_bf16 v[104:107], a[88:91], v[228:231], v[104:107]
  v_mfma_f32_16x16x32_bf16 v[104:107], a[104:107], v[232:235], v[104:107]
  buffer_load_dwordx4 v[216:219], v2, s[20:23], s75 offen offset:2048 sc1
  v_mfma_f32_16x16x32_bf16 v[104:107], a[120:123], v[236:239], v[104:107]
  v_mfma_f32_16x16x32_bf16 v[120:123], a[76:79], v[224:227], v[120:123]
  v_mfma_f32_16x16x32_bf16 v[120:123], a[92:95], v[228:231], v[120:123]
  v_mfma_f32_16x16x32_bf16 v[120:123], a[108:111], v[232:235], v[120:123]
  buffer_load_dwordx4 v[220:223], v2, s[20:23], s75 offen offset:3072 sc1
  v_mfma_f32_16x16x32_bf16 v[120:123], a[124:127], v[236:239], v[120:123]
  s_waitcnt vmcnt(24)
  v_mfma_f32_16x16x32_bf16 v[76:79], a[64:67], v[240:243], v[76:79]
  v_mfma_f32_16x16x32_bf16 v[76:79], a[80:83], v[244:247], v[76:79]
  v_mfma_f32_16x16x32_bf16 v[76:79], a[96:99], v[248:251], v[76:79]
  buffer_load_dwordx4 v[224:227], v2, s[20:23], s76 offen offset:0 sc1
  v_mfma_f32_16x16x32_bf16 v[76:79], a[112:115], v[252:255], v[76:79]
  v_mfma_f32_16x16x32_bf16 v[92:95], a[68:71], v[240:243], v[92:95]
  v_mfma_f32_16x16x32_bf16 v[92:95], a[84:87], v[244:247], v[92:95]
  v_mfma_f32_16x16x32_bf16 v[92:95], a[100:103], v[248:251], v[92:95]
  buffer_load_dwordx4 v[228:231], v2, s[20:23], s76 offen offset:1024 sc1
  v_mfma_f32_16x16x32_bf16 v[92:95], a[116:119], v[252:255], v[92:95]
  v_mfma_f32_16x16x32_bf16 v[108:111], a[72:75], v[240:243], v[108:111]
  v_mfma_f32_16x16x32_bf16 v[108:111], a[88:91], v[244:247], v[108:111]
  v_mfma_f32_16x16x32_bf16 v[108:111], a[104:107], v[248:251], v[108:111]
  buffer_load_dwordx4 v[232:235], v2, s[20:23], s76 offen offset:2048 sc1
  v_mfma_f32_16x16x32_bf16 v[108:111], a[120:123], v[252:255], v[108:111]
  v_mfma_f32_16x16x32_bf16 v[124:127], a[76:79], v[240:243], v[124:127]
  v_mfma_f32_16x16x32_bf16 v[124:127], a[92:95], v[244:247], v[124:127]
  v_mfma_f32_16x16x32_bf16 v[124:127], a[108:111], v[248:251], v[124:127]
  buffer_load_dwordx4 v[236:239], v2, s[20:23], s76 offen offset:3072 sc1
  v_mfma_f32_16x16x32_bf16 v[124:127], a[124:127], v[252:255], v[124:127]
  s_waitcnt vmcnt(24)
  v_and_b32 v26, 7, v0
  v_lshlrev_b32 v26, 7, v26
  v_mfma_f32_16x16x32_bf16 v[64:67], a[128:131], v[128:131], v[64:67]
  s_lshl_b32 s28, s7, 2
  s_add_u32 s28, s28, s4
  s_lshl_b32 s28, s28, 10
  v_mfma_f32_16x16x32_bf16 v[64:67], a[144:147], v[132:135], v[64:67]
  s_add_u32 s28, s28, 59867136
  v_mfma_f32_16x16x32_bf16 v[64:67], a[160:163], v[136:139], v[64:67]
  buffer_load_dword v26, v26, s[20:23], s28 offen sc1
  v_mfma_f32_16x16x32_bf16 v[64:67], a[224:227], v[140:143], v[64:67]
  v_mfma_f32_16x16x32_bf16 v[80:83], a[132:135], v[128:131], v[80:83]
  v_mfma_f32_16x16x32_bf16 v[80:83], a[148:151], v[132:135], v[80:83]
  v_mfma_f32_16x16x32_bf16 v[80:83], a[164:167], v[136:139], v[80:83]
  v_mfma_f32_16x16x32_bf16 v[80:83], a[228:231], v[140:143], v[80:83]
  v_mfma_f32_16x16x32_bf16 v[96:99], a[136:139], v[128:131], v[96:99]
  v_mfma_f32_16x16x32_bf16 v[96:99], a[152:155], v[132:135], v[96:99]
  v_mfma_f32_16x16x32_bf16 v[96:99], a[168:171], v[136:139], v[96:99]
  v_mfma_f32_16x16x32_bf16 v[96:99], a[232:235], v[140:143], v[96:99]
  v_mfma_f32_16x16x32_bf16 v[112:115], a[140:143], v[128:131], v[112:115]
  ds_write_b128 v17, v[64:67] offset:0
  v_mfma_f32_16x16x32_bf16 v[112:115], a[156:159], v[132:135], v[112:115]
  v_mfma_f32_16x16x32_bf16 v[112:115], a[172:175], v[136:139], v[112:115]
  v_mfma_f32_16x16x32_bf16 v[112:115], a[236:239], v[140:143], v[112:115]
  s_waitcnt vmcnt(21)
  v_mfma_f32_16x16x32_bf16 v[68:71], a[128:131], v[144:147], v[68:71]
  ds_write_b128 v17, v[80:83] offset:1024
  v_mfma_f32_16x16x32_bf16 v[68:71], a[144:147], v[148:151], v[68:71]
  buffer_load_dwordx4 v[128:131], v2, s[20:23], s77 offen offset:0 sc1
  v_mfma_f32_16x16x32_bf16 v[68:71], a[160:163], v[152:155], v[68:71]
  v_mfma_f32_16x16x32_bf16 v[68:71], a[224:227], v[156:159], v[68:71]
  v_mfma_f32_16x16x32_bf16 v[84:87], a[132:135], v[144:147], v[84:87]
  ds_write_b128 v17, v[96:99] offset:2048
  v_mfma_f32_16x16x32_bf16 v[84:87], a[148:151], v[148:151], v[84:87]
  buffer_load_dwordx4 v[132:135], v2, s[20:23], s77 offen offset:1024 sc1
  v_mfma_f32_16x16x32_bf16 v[84:87], a[164:167], v[152:155], v[84:87]
  v_mfma_f32_16x16x32_bf16 v[84:87], a[228:231], v[156:159], v[84:87]
  v_mfma_f32_16x16x32_bf16 v[100:103], a[136:139], v[144:147], v[100:103]
  ds_write_b128 v17, v[112:115] offset:3072
  v_mfma_f32_16x16x32_bf16 v[100:103], a[152:155], v[148:151], v[100:103]
  buffer_load_dwordx4 v[136:139], v2, s[20:23], s77 offen offset:2048 sc1
  v_mfma_f32_16x16x32_bf16 v[100:103], a[168:171], v[152:155], v[100:103]
  v_mfma_f32_16x16x32_bf16 v[100:103], a[232:235], v[156:159], v[100:103]
  v_mfma_f32_16x16x32_bf16 v[116:119], a[140:143], v[144:147], v[116:119]
  ds_write_b128 v17, v[68:71] offset:16384
  v_mfma_f32_16x16x32_bf16 v[116:119], a[156:159], v[148:151], v[116:119]
  buffer_load_dwordx4 v[140:143], v2, s[20:23], s77 offen offset:3072 sc1
  v_mfma_f32_16x16x32_bf16 v[116:119], a[172:175], v[152:155], v[116:119]
  v_add_u32 v2, 4096, v2
  v_and_b32 v2, 0x3fff, v2
  v_mfma_f32_16x16x32_bf16 v[116:119], a[236:239], v[156:159], v[116:119]
  s_waitcnt vmcnt(21)
  v_mfma_f32_16x16x32_bf16 v[72:75], a[128:131], v[160:163], v[72:75]
  ds_write_b128 v17, v[84:87] offset:17408
  v_mfma_f32_16x16x32_bf16 v[72:75], a[144:147], v[164:167], v[72:75]
  buffer_load_dwordx4 v[144:147], v2, s[20:23], s74 offen offset:0 sc1
  v_mfma_f32_16x16x32_bf16 v[72:75], a[160:163], v[168:171], v[72:75]
  v_mfma_f32_16x16x32_bf16 v[72:75], a[224:227], v[172:175], v[72:75]
  v_mfma_f32_16x16x32_bf16 v[88:91], a[132:135], v[160:163], v[88:91]
  ds_write_b128 v17, v[100:103] offset:18432
  v_mfma_f32_16x16x32_bf16 v[88:91], a[148:151], v[164:167], v[88:91]
  buffer_load_dwordx4 v[148:151], v2, s[20:23], s74 offen offset:1024 sc1
  v_mfma_f32_16x16x32_bf16 v[88:91], a[164:167], v[168:171], v[88:91]
  v_mfma_f32_16x16x32_bf16 v[88:91], a[228:231], v[172:175], v[88:91]
  v_mfma_f32_16x16x32_bf16 v[104:107], a[136:139], v[160:163], v[104:107]
  ds_write_b128 v17, v[116:119] offset:19456
  v_mfma_f32_16x16x32_bf16 v[104:107], a[152:155], v[164:167], v[104:107]
  buffer_load_dwordx4 v[152:155], v2, s[20:23], s74 offen offset:2048 sc1
  v_mfma_f32_16x16x32_bf16 v[104:107], a[168:171], v[168:171], v[104:107]
  v_mfma_f32_16x16x32_bf16 v[104:107], a[232:235], v[172:175], v[104:107]
  v_mfma_f32_16x16x32_bf16 v[120:123], a[140:143], v[160:163], v[120:123]
  ds_write_b128 v18, v[72:75] offset:0
  v_mfma_f32_16x16x32_bf16 v[120:123], a[156:159], v[164:167], v[120:123]
  buffer_load_dwordx4 v[156:159], v2, s[20:23], s74 offen offset:3072 sc1
  v_mfma_f32_16x16x32_bf16 v[120:123], a[172:175], v[168:171], v[120:123]
  v_mfma_f32_16x16x32_bf16 v[120:123], a[236:239], v[172:175], v[120:123]
  s_waitcnt vmcnt(21)
  v_mfma_f32_16x16x32_bf16 v[76:79], a[128:131], v[176:179], v[76:79]
  ds_write_b128 v18, v[88:91] offset:1024
  v_mfma_f32_16x16x32_bf16 v[76:79], a[144:147], v[180:183], v[76:79]
  buffer_load_dwordx4 v[160:163], v2, s[20:23], s75 offen offset:0 sc1
  v_mfma_f32_16x16x32_bf16 v[76:79], a[160:163], v[184:187], v[76:79]
  v_mfma_f32_16x16x32_bf16 v[76:79], a[224:227], v[188:191], v[76:79]
  v_mfma_f32_16x16x32_bf16 v[92:95], a[132:135], v[176:179], v[92:95]
  ds_write_b128 v18, v[104:107] offset:2048
  v_mfma_f32_16x16x32_bf16 v[92:95], a[148:151], v[180:183], v[92:95]
  buffer_load_dwordx4 v[164:167], v2, s[20:23], s75 offen offset:1024 sc1
  v_mfma_f32_16x16x32_bf16 v[92:95], a[164:167], v[184:187], v[92:95]
  v_mfma_f32_16x16x32_bf16 v[92:95], a[228:231], v[188:191], v[92:95]
  v_mfma_f32_16x16x32_bf16 v[108:111], a[136:139], v[176:179], v[108:111]
  ds_write_b128 v18, v[120:123] offset:3072
  v_mfma_f32_16x16x32_bf16 v[108:111], a[152:155], v[180:183], v[108:111]
  buffer_load_dwordx4 v[168:171], v2, s[20:23], s75 offen offset:2048 sc1
  v_mfma_f32_16x16x32_bf16 v[108:111], a[168:171], v[184:187], v[108:111]
  s_waitcnt vmcnt(11)
  v_xor_b32 v26, s92, v26
  v_cmp_lt_u32 vcc, 15, v26
  v_mfma_f32_16x16x32_bf16 v[108:111], a[232:235], v[188:191], v[108:111]
  v_mfma_f32_16x16x32_bf16 v[124:127], a[140:143], v[176:179], v[124:127]
  s_cbranch_vccnz zspin
zspun:
  v_mfma_f32_16x16x32_bf16 v[124:127], a[156:159], v[180:183], v[124:127]
  buffer_load_dwordx4 v[172:175], v2, s[20:23], s75 offen offset:3072 sc1
  v_mfma_f32_16x16x32_bf16 v[124:127], a[172:175], v[184:187], v[124:127]
  v_mfma_f32_16x16x32_bf16 v[124:127], a[236:239], v[188:191], v[124:127]
  v_mfma_f32_16x16x32_bf16 v[64:67], a[176:179], v[192:195], 0
  v_mfma_f32_16x16x32_bf16 v[64:67], a[192:195], v[196:199], v[64:67]
  buffer_load_dwordx4 v[176:179], v2, s[20:23], s76 offen offset:0 sc1
  v_mfma_f32_16x16x32_bf16 v[64:67], a[208:211], v[200:203], v[64:67]
  v_mfma_f32_16x16x32_bf16 v[64:67], a[240:243], v[204:207], v[64:67]
  v_mfma_f32_16x16x32_bf16 v[80:83], a[180:183], v[192:195], 0
  v_mfma_f32_16x16x32_bf16 v[80:83], a[196:199], v[196:199], v[80:83]
  s_waitcnt lgkmcnt(0)
  s_barrier
  v_mfma_f32_16x16x32_bf16 v[80:83], a[212:215], v[200:203], v[80:83]
  buffer_load_dwordx4 v[180:183], v2, s[20:23], s76 offen offset:1024 sc1
  v_mfma_f32_16x16x32_bf16 v[80:83], a[244:247], v[204:207], v[80:83]
  s_lshl_b32 s28, s4, 11
  ds_read_b128 v[240:243], v7 offset:0
  ds_read_b128 v[244:247], v8 offset:16384
  v_mfma_f32_16x16x32_bf16 v[96:99], a[184:187], v[192:195], 0
  s_add_u32 m0, s28, s84
  ds_read_b128 v[248:251], v9 offset:0
  ds_read_b128 v[252:255], v7 offset:1024
  v_mfma_f32_16x16x32_bf16 v[96:99], a[200:203], v[196:199], v[96:99]
  ds_read_b128 v[48:51], v8 offset:17408
  ds_read_b128 v[52:55], v9 offset:1024
  v_mfma_f32_16x16x32_bf16 v[96:99], a[216:219], v[200:203], v[96:99]
  buffer_load_dwordx4 v[184:187], v2, s[20:23], s76 offen offset:2048 sc1
  v_mfma_f32_16x16x32_bf16 v[96:99], a[248:251], v[204:207], v[96:99]
  buffer_load_dwordx4 v21, s[20:23], s71 offen sc1 lds
  v_mfma_f32_16x16x32_bf16 v[112:115], a[188:191], v[192:195], 0
  buffer_load_dwordx4 v21, s[20:23], s72 offen offset:1024 sc1 lds
  v_mfma_f32_16x16x32_bf16 v[112:115], a[204:207], v[196:199], v[112:115]
  v_mfma_f32_16x16x32_bf16 v[112:115], a[220:223], v[200:203], v[112:115]
  buffer_load_dwordx4 v[188:191], v2, s[20:23], s76 offen offset:3072 sc1
  v_mfma_f32_16x16x32_bf16 v[112:115], a[252:255], v[204:207], v[112:115]
  s_waitcnt lgkmcnt(3)
  v_add_f32 v76, v76, v240
  v_mfma_f32_16x16x32_bf16 v[68:71], a[176:179], v[208:211], 0
  v_add_f32 v77, v77, v241
  v_add_f32 v78, v78, v242
  v_mfma_f32_16x16x32_bf16 v[68:71], a[192:195], v[212:215], v[68:71]
  v_add_f32 v79, v79, v243
  v_add_f32 v244, v244, v248
  v_mfma_f32_16x16x32_bf16 v[68:71], a[208:211], v[216:219], v[68:71]
  buffer_load_dwordx4 v[192:195], v2, s[20:23], s77 offen offset:0 sc1
  v_mfma_f32_16x16x32_bf16 v[68:71], a[240:243], v[220:223], v[68:71]
  v_add_f32 v245, v245, v249
  v_add_f32 v246, v246, v250
  v_mfma_f32_16x16x32_bf16 v[84:87], a[180:183], v[208:211], 0
  v_add_f32 v247, v247, v251
  v_add_f32 v76, v76, v244
  v_mfma_f32_16x16x32_bf16 v[84:87], a[196:199], v[212:215], v[84:87]
  v_add_f32 v77, v77, v245
  v_add_f32 v78, v78, v246
  v_mfma_f32_16x16x32_bf16 v[84:87], a[212:215], v[216:219], v[84:87]
  buffer_load_dwordx4 v[196:199], v2, s[20:23], s77 offen offset:1024 sc1
  v_mfma_f32_16x16x32_bf16 v[84:87], a[244:247], v[220:223], v[84:87]
  v_add_f32 v79, v79, v247
  v_mfma_f32_16x16x32_bf16 v[100:103], a[184:187], v[208:211], 0
  ds_read_b128 v[240:243], v7 offset:2048
  ds_read_b128 v[244:247], v8 offset:18432
  v_mfma_f32_16x16x32_bf16 v[100:103], a[200:203], v[212:215], v[100:103]
  ds_read_b128 v[248:251], v9 offset:2048
  v_mfma_f32_16x16x32_bf16 v[100:103], a[216:219], v[216:219], v[100:103]
  buffer_load_dwordx4 v[200:203], v2, s[20:23], s77 offen offset:2048 sc1
  v_mfma_f32_16x16x32_bf16 v[100:103], a[248:251], v[220:223], v[100:103]
  buffer_store_dwordx4 v[76:79], v12, s[20:23], s90 offen offset:0 sc1
  v_mfma_f32_16x16x32_bf16 v[116:119], a[188:191], v[208:211], 0
  s_waitcnt lgkmcnt(3)
  v_add_f32 v92, v92, v252
  v_add_f32 v93, v93, v253
  v_mfma_f32_16x16x32_bf16 v[116:119], a[204:207], v[212:215], v[116:119]
  v_add_f32 v94, v94, v254
  v_add_f32 v95, v95, v255
  v_mfma_f32_16x16x32_bf16 v[116:119], a[220:223], v[216:219], v[116:119]
  buffer_load_dwordx4 v[204:207], v2, s[20:23], s77 offen offset:3072 sc1
  v_mfma_f32_16x16x32_bf16 v[116:119], a[252:255], v[220:223], v[116:119]
  v_add_u32 v2, 4096, v2
  v_and_b32 v2, 0x3fff, v2
  v_mfma_f32_16x16x32_bf16 v[72:75], a[176:179], v[224:227], 0
  v_add_f32 v48, v48, v52
  v_add_f32 v49, v49, v53
  v_mfma_f32_16x16x32_bf16 v[72:75], a[192:195], v[228:231], v[72:75]
  v_add_f32 v50, v50, v54
  v_add_f32 v51, v51, v55
  v_mfma_f32_16x16x32_bf16 v[72:75], a[208:211], v[232:235], v[72:75]
  buffer_load_dwordx4 v[208:211], v2, s[20:23], s74 offen offset:0 sc1
  v_mfma_f32_16x16x32_bf16 v[72:75], a[240:243], v[236:239], v[72:75]
  v_add_f32 v92, v92, v48
  v_add_f32 v93, v93, v49
  v_mfma_f32_16x16x32_bf16 v[88:91], a[180:183], v[224:227], 0
  v_add_f32 v94, v94, v50
  v_add_f32 v95, v95, v51
  v_mfma_f32_16x16x32_bf16 v[88:91], a[196:199], v[228:231], v[88:91]
  ds_read_b128 v[252:255], v7 offset:3072
  ds_read_b128 v[48:51], v8 offset:19456
  v_mfma_f32_16x16x32_bf16 v[88:91], a[212:215], v[232:235], v[88:91]
  buffer_load_dwordx4 v[212:215], v2, s[20:23], s74 offen offset:1024 sc1
  v_mfma_f32_16x16x32_bf16 v[88:91], a[244:247], v[236:239], v[88:91]
  ds_read_b128 v[52:55], v9 offset:3072
  v_mfma_f32_16x16x32_bf16 v[104:107], a[184:187], v[224:227], 0
  buffer_store_dwordx4 v[92:95], v12, s[20:23], s90 offen offset:1024 sc1
  v_mfma_f32_16x16x32_bf16 v[104:107], a[200:203], v[228:231], v[104:107]
  s_waitcnt lgkmcnt(3)
  v_add_f32 v108, v108, v240
  v_add_f32 v109, v109, v241
  v_mfma_f32_16x16x32_bf16 v[104:107], a[216:219], v[232:235], v[104:107]
  buffer_load_dwordx4 v[216:219], v2, s[20:23], s74 offen offset:2048 sc1
  v_mfma_f32_16x16x32_bf16 v[104:107], a[248:251], v[236:239], v[104:107]
  v_add_f32 v110, v110, v242
  v_add_f32 v111, v111, v243
  v_mfma_f32_16x16x32_bf16 v[120:123], a[188:191], v[224:227], 0
  v_add_f32 v244, v244, v248
  v_add_f32 v245, v245, v249
  v_mfma_f32_16x16x32_bf16 v[120:123], a[204:207], v[228:231], v[120:123]
  v_add_f32 v246, v246, v250
  v_add_f32 v247, v247, v251
  v_mfma_f32_16x16x32_bf16 v[120:123], a[220:223], v[232:235], v[120:123]
  buffer_load_dwordx4 v[220:223], v2, s[20:23], s74 offen offset:3072 sc1
  v_mfma_f32_16x16x32_bf16 v[120:123], a[252:255], v[236:239], v[120:123]
  s_waitcnt vmcnt(24)
  v_add_f32 v108, v108, v244
  v_add_f32 v109, v109, v245
  v_mfma_f32_16x16x32_bf16 v[32:35], a[176:179], v[128:131], 0
  v_add_f32 v110, v110, v246
  v_add_f32 v111, v111, v247
  v_mfma_f32_16x16x32_bf16 v[32:35], a[192:195], v[132:135], v[32:35]
  buffer_store_dwordx4 v[108:111], v12, s[20:23], s90 offen offset:2048 sc1
  v_mfma_f32_16x16x32_bf16 v[32:35], a[208:211], v[136:139], v[32:35]
  buffer_load_dwordx4 v[224:227], v2, s[20:23], s75 offen offset:0 sc1
  v_mfma_f32_16x16x32_bf16 v[32:35], a[240:243], v[140:143], v[32:35]
  s_waitcnt lgkmcnt(0)
  v_add_f32 v124, v124, v252
  v_add_f32 v125, v125, v253
  v_mfma_f32_16x16x32_bf16 v[36:39], a[180:183], v[128:131], 0
  v_add_f32 v126, v126, v254
  v_add_f32 v127, v127, v255
  v_mfma_f32_16x16x32_bf16 v[36:39], a[196:199], v[132:135], v[36:39]
  v_add_f32 v48, v48, v52
  v_add_f32 v49, v49, v53
  v_mfma_f32_16x16x32_bf16 v[36:39], a[212:215], v[136:139], v[36:39]
  buffer_load_dwordx4 v[228:231], v2, s[20:23], s75 offen offset:1024 sc1
  v_mfma_f32_16x16x32_bf16 v[36:39], a[244:247], v[140:143], v[36:39]
  v_add_f32 v50, v50, v54
  v_add_f32 v51, v51, v55
  v_mfma_f32_16x16x32_bf16 v[40:43], a[184:187], v[128:131], 0
  v_add_f32 v124, v124, v48
  v_add_f32 v125, v125, v49
  v_mfma_f32_16x16x32_bf16 v[40:43], a[200:203], v[132:135], v[40:43]
  v_add_f32 v126, v126, v50
  v_add_f32 v127, v127, v51
  v_mfma_f32_16x16x32_bf16 v[40:43], a[216:219], v[136:139], v[40:43]
  buffer_load_dwordx4 v[232:235], v2, s[20:23], s75 offen offset:2048 sc1
  v_mfma_f32_16x16x32_bf16 v[40:43], a[248:251], v[140:143], v[40:43]
  buffer_store_dwordx4 v[124:127], v12, s[20:23], s90 offen offset:3072 sc1
  v_mfma_f32_16x16x32_bf16 v[44:47], a[188:191], v[128:131], 0
  v_mfma_f32_16x16x32_bf16 v[44:47], a[204:207], v[132:135], v[44:47]
  v_mfma_f32_16x16x32_bf16 v[44:47], a[220:223], v[136:139], v[44:47]
  buffer_load_dwordx4 v[236:239], v2, s[20:23], s75 offen offset:3072 sc1
  v_mfma_f32_16x16x32_bf16 v[44:47], a[252:255], v[140:143], v[44:47]
  s_waitcnt vmcnt(26)
  v_mfma_f32_16x16x32_bf16 v[64:67], a[0:3], v[144:147], v[64:67]
  v_mfma_f32_16x16x32_bf16 v[64:67], a[16:19], v[148:151], v[64:67]
  v_mfma_f32_16x16x32_bf16 v[64:67], a[32:35], v[152:155], v[64:67]
  buffer_load_dwordx4 v[128:131], v2, s[20:23], s76 offen offset:0 sc1
  v_mfma_f32_16x16x32_bf16 v[64:67], a[48:51], v[156:159], v[64:67]
  v_mfma_f32_16x16x32_bf16 v[80:83], a[4:7], v[144:147], v[80:83]
  v_mfma_f32_16x16x32_bf16 v[80:83], a[20:23], v[148:151], v[80:83]
  v_mfma_f32_16x16x32_bf16 v[80:83], a[36:39], v[152:155], v[80:83]
  buffer_load_dwordx4 v[132:135], v2, s[20:23], s76 offen offset:1024 sc1
  v_mfma_f32_16x16x32_bf16 v[80:83], a[52:55], v[156:159], v[80:83]
  v_mfma_f32_16x16x32_bf16 v[96:99], a[8:11], v[144:147], v[96:99]
  v_mfma_f32_16x16x32_bf16 v[96:99], a[24:27], v[148:151], v[96:99]
  v_mfma_f32_16x16x32_bf16 v[96:99], a[40:43], v[152:155], v[96:99]
  buffer_load_dwordx4 v[136:139], v2, s[20:23], s76 offen offset:2048 sc1
  v_mfma_f32_16x16x32_bf16 v[96:99], a[56:59], v[156:159], v[96:99]
  v_mfma_f32_16x16x32_bf16 v[112:115], a[12:15], v[144:147], v[112:115]
  v_mfma_f32_16x16x32_bf16 v[112:115], a[28:31], v[148:151], v[112:115]
  v_mfma_f32_16x16x32_bf16 v[112:115], a[44:47], v[152:155], v[112:115]
  buffer_load_dwordx4 v[140:143], v2, s[20:23], s76 offen offset:3072 sc1
  v_mfma_f32_16x16x32_bf16 v[112:115], a[60:63], v[156:159], v[112:115]
  s_waitcnt vmcnt(26)
  v_mfma_f32_16x16x32_bf16 v[68:71], a[0:3], v[160:163], v[68:71]
  v_mfma_f32_16x16x32_bf16 v[68:71], a[16:19], v[164:167], v[68:71]
  v_mfma_f32_16x16x32_bf16 v[68:71], a[32:35], v[168:171], v[68:71]
  buffer_load_dwordx4 v[144:147], v2, s[20:23], s77 offen offset:0 sc1
  v_mfma_f32_16x16x32_bf16 v[68:71], a[48:51], v[172:175], v[68:71]
  v_mfma_f32_16x16x32_bf16 v[84:87], a[4:7], v[160:163], v[84:87]
  v_mfma_f32_16x16x32_bf16 v[84:87], a[20:23], v[164:167], v[84:87]
  v_mfma_f32_16x16x32_bf16 v[84:87], a[36:39], v[168:171], v[84:87]
  buffer_load_dwordx4 v[148:151], v2, s[20:23], s77 offen offset:1024 sc1
  v_mfma_f32_16x16x32_bf16 v[84:87], a[52:55], v[172:175], v[84:87]
  v_mfma_f32_16x16x32_bf16 v[100:103], a[8:11], v[160:163], v[100:103]
  v_mfma_f32_16x16x32_bf16 v[100:103], a[24:27], v[164:167], v[100:103]
  v_mfma_f32_16x16x32_bf16 v[100:103], a[40:43], v[168:171], v[100:103]
  buffer_load_dwordx4 v[152:155], v2, s[20:23], s77 offen offset:2048 sc1
  v_mfma_f32_16x16x32_bf16 v[100:103], a[56:59], v[172:175], v[100:103]
  v_mfma_f32_16x16x32_bf16 v[116:119], a[12:15], v[160:163], v[116:119]
  v_mfma_f32_16x16x32_bf16 v[116:119], a[28:31], v[164:167], v[116:119]
  v_mfma_f32_16x16x32_bf16 v[116:119], a[44:47], v[168:171], v[116:119]
  buffer_load_dwordx4 v[156:159], v2, s[20:23], s77 offen offset:3072 sc1
  v_mfma_f32_16x16x32_bf16 v[116:119], a[60:63], v[172:175], v[116:119]
  s_waitcnt vmcnt(24)
  v_add_u32 v2, 4096, v2
  v_and_b32 v2, 0x3fff, v2
  v_mfma_f32_16x16x32_bf16 v[72:75], a[0:3], v[176:179], v[72:75]
  v_mfma_f32_16x16x32_bf16 v[72:75], a[16:19], v[180:183], v[72:75]
  v_mfma_f32_16x16x32_bf16 v[72:75], a[32:35], v[184:187], v[72:75]
  buffer_load_dwordx4 v[160:163], v2, s[20:23], s74 offen offset:0 sc1
  v_mfma_f32_16x16x32_bf16 v[72:75], a[48:51], v[188:191], v[72:75]
  v_mfma_f32_16x16x32_bf16 v[88:91], a[4:7], v[176:179], v[88:91]
  v_mfma_f32_16x16x32_bf16 v[88:91], a[20:23], v[180:183], v[88:91]
  v_mfma_f32_16x16x32_bf16 v[88:91], a[36:39], v[184:187], v[88:91]
  buffer_load_dwordx4 v[164:167], v2, s[20:23], s74 offen offset:1024 sc1
  v_mfma_f32_16x16x32_bf16 v[88:91], a[52:55], v[188:191], v[88:91]
  s_waitcnt vmcnt(11)
  v_mfma_f32_16x16x32_bf16 v[104:107], a[8:11], v[176:179], v[104:107]
  buffer_store_dword v1, v29, s[20:23], s88 offen sc1
  v_mfma_f32_16x16x32_bf16 v[104:107], a[24:27], v[180:183], v[104:107]
  v_mfma_f32_16x16x32_bf16 v[104:107], a[40:43], v[184:187], v[104:107]
  buffer_load_dwordx4 v[168:171], v2, s[20:23], s74 offen offset:2048 sc1
  v_mfma_f32_16x16x32_bf16 v[104:107], a[56:59], v[188:191], v[104:107]
  v_mfma_f32_16x16x32_bf16 v[120:123], a[12:15], v[176:179], v[120:123]
  v_mfma_f32_16x16x32_bf16 v[120:123], a[28:31], v[180:183], v[120:123]
  v_mfma_f32_16x16x32_bf16 v[120:123], a[44:47], v[184:187], v[120:123]
  buffer_load_dwordx4 v[172:175], v2, s[20:23], s74 offen offset:3072 sc1
  v_mfma_f32_16x16x32_bf16 v[120:123], a[60:63], v[188:191], v[120:123]
  v_mfma_f32_16x16x32_bf16 v[32:35], a[0:3], v[192:195], v[32:35]
  v_mfma_f32_16x16x32_bf16 v[32:35], a[16:19], v[196:199], v[32:35]
  v_mfma_f32_16x16x32_bf16 v[32:35], a[32:35], v[200:203], v[32:35]
  buffer_load_dwordx4 v[176:179], v2, s[20:23], s75 offen offset:0 sc1
  v_mfma_f32_16x16x32_bf16 v[32:35], a[48:51], v[204:207], v[32:35]
  v_mfma_f32_16x16x32_bf16 v[36:39], a[4:7], v[192:195], v[36:39]
  v_mfma_f32_16x16x32_bf16 v[36:39], a[20:23], v[196:199], v[36:39]
  s_waitcnt vmcnt(63)
  s_barrier
  v_mfma_f32_16x16x32_bf16 v[36:39], a[36:39], v[200:203], v[36:39]
  buffer_load_dwordx4 v[180:183], v2, s[20:23], s75 offen offset:1024 sc1
  v_mfma_f32_16x16x32_bf16 v[36:39], a[52:55], v[204:207], v[36:39]
  ds_read_b128 v[48:51], v25 offset:0
  ds_read_b128 v[52:55], v25 offset:16
  v_mfma_f32_16x16x32_bf16 v[40:43], a[8:11], v[192:195], v[40:43]
  v_mfma_f32_16x16x32_bf16 v[40:43], a[24:27], v[196:199], v[40:43]
  v_mfma_f32_16x16x32_bf16 v[40:43], a[40:43], v[200:203], v[40:43]
  buffer_load_dwordx4 v[184:187], v2, s[20:23], s75 offen offset:2048 sc1
  v_mfma_f32_16x16x32_bf16 v[40:43], a[56:59], v[204:207], v[40:43]
  v_mfma_f32_16x16x32_bf16 v[44:47], a[12:15], v[192:195], v[44:47]
  v_mfma_f32_16x16x32_bf16 v[44:47], a[28:31], v[196:199], v[44:47]
  v_mfma_f32_16x16x32_bf16 v[44:47], a[44:47], v[200:203], v[44:47]
  buffer_load_dwordx4 v[188:191], v2, s[20:23], s75 offen offset:3072 sc1
  v_mfma_f32_16x16x32_bf16 v[44:47], a[60:63], v[204:207], v[44:47]
  v_mfma_f32_16x16x32_bf16 v[64:67], a[64:67], v[208:211], v[64:67]
  v_mfma_f32_16x16x32_bf16 v[64:67], a[80:83], v[212:215], v[64:67]
  s_waitcnt lgkmcnt(0)
  v_lshlrev_b32 v26, 16, v48
  v_lshlrev_b32 v27, 16, v56
  v_mfma_f32_16x16x32_bf16 v[64:67], a[96:99], v[216:219], v[64:67]
  buffer_load_dwordx4 v[192:195], v2, s[20:23], s76 offen offset:0 sc1
  v_mfma_f32_16x16x32_bf16 v[64:67], a[112:115], v[220:223], v[64:67]
  v_and_b32 v48, 0xffff0000, v48
  v_and_b32 v56, 0xffff0000, v56
  v_mfma_f32_16x16x32_bf16 v[80:83], a[68:71], v[208:211], v[80:83]
  v_mul_f32 v26, v26, v27
  v_mul_f32 v48, v48, v56
  v_mfma_f32_16x16x32_bf16 v[80:83], a[84:87], v[212:215], v[80:83]
  v_cvt_pk_bf16_f32 v56, v26, v48
  v_mfma_f32_16x16x32_bf16 v[80:83], a[100:103], v[216:219], v[80:83]
  buffer_load_dwordx4 v[196:199], v2, s[20:23], s76 offen offset:1024 sc1
  v_mfma_f32_16x16x32_bf16 v[80:83], a[116:119], v[220:223], v[80:83]
  s_mov_b32 s27, 0
  v_mfma_f32_16x16x32_bf16 v[96:99], a[72:75], v[208:211], v[96:99]
  buffer_store_dword v56, v24, s[8:11], s27 offen offset:0
  v_mfma_f32_16x16x32_bf16 v[96:99], a[88:91], v[212:215], v[96:99]
  v_lshlrev_b32 v26, 16, v52
  v_lshlrev_b32 v27, 16, v57
  v_mfma_f32_16x16x32_bf16 v[96:99], a[104:107], v[216:219], v[96:99]
  buffer_load_dwordx4 v[200:203], v2, s[20:23], s76 offen offset:2048 sc1
  v_mfma_f32_16x16x32_bf16 v[96:99], a[120:123], v[220:223], v[96:99]
  v_and_b32 v52, 0xffff0000, v52
  v_and_b32 v57, 0xffff0000, v57
  v_mfma_f32_16x16x32_bf16 v[112:115], a[76:79], v[208:211], v[112:115]
  s_xor_b32 s26, s88, 16384
  v_mul_f32 v26, v26, v27
  v_mul_f32 v52, v52, v57
  v_mfma_f32_16x16x32_bf16 v[112:115], a[92:95], v[212:215], v[112:115]
  buffer_load_dword v6, off, s[20:23], s26 sc1
  v_mfma_f32_16x16x32_bf16 v[112:115], a[108:111], v[216:219], v[112:115]
  buffer_load_dwordx4 v[204:207], v2, s[20:23], s76 offen offset:3072 sc1
  v_mfma_f32_16x16x32_bf16 v[112:115], a[124:127], v[220:223], v[112:115]
  s_waitcnt vmcnt(23)
  v_cvt_pk_bf16_f32 v57, v26, v52
  v_mfma_f32_16x16x32_bf16 v[68:71], a[64:67], v[224:227], v[68:71]
  s_mov_b32 s27, 0
  v_mfma_f32_16x16x32_bf16 v[68:71], a[80:83], v[228:231], v[68:71]
  buffer_store_dword v57, v24, s[8:11], s27 offen offset:2048
  v_mfma_f32_16x16x32_bf16 v[68:71], a[96:99], v[232:235], v[68:71]
  buffer_load_dwordx4 v[208:211], v2, s[20:23], s77 offen offset:0 sc1
  v_mfma_f32_16x16x32_bf16 v[68:71], a[112:115], v[236:239], v[68:71]
  v_lshlrev_b32 v26, 16, v49
  v_lshlrev_b32 v27, 16, v58
  v_mfma_f32_16x16x32_bf16 v[84:87], a[68:71], v[224:227], v[84:87]
  v_and_b32 v49, 0xffff0000, v49
  v_and_b32 v58, 0xffff0000, v58
  v_mfma_f32_16x16x32_bf16 v[84:87], a[84:87], v[228:231], v[84:87]
  v_mul_f32 v26, v26, v27
  v_mul_f32 v49, v49, v58
  v_mfma_f32_16x16x32_bf16 v[84:87], a[100:103], v[232:235], v[84:87]
  buffer_load_dwordx4 v[212:215], v2, s[20:23], s77 offen offset:1024 sc1
  v_mfma_f32_16x16x32_bf16 v[84:87], a[116:119], v[236:239], v[84:87]
  v_cvt_pk_bf16_f32 v58, v26, v49
  v_mfma_f32_16x16x32_bf16 v[100:103], a[72:75], v[224:227], v[100:103]
  s_mov_b32 s27, 4096
  v_mfma_f32_16x16x32_bf16 v[100:103], a[88:91], v[228:231], v[100:103]
  buffer_store_dword v58, v24, s[8:11], s27 offen offset:0
  v_mfma_f32_16x16x32_bf16 v[100:103], a[104:107], v[232:235], v[100:103]
  buffer_load_dwordx4 v[216:219], v2, s[20:23], s77 offen offset:2048 sc1
  v_mfma_f32_16x16x32_bf16 v[100:103], a[120:123], v[236:239], v[100:103]
  v_lshlrev_b32 v26, 16, v53
  v_lshlrev_b32 v27, 16, v59
  v_mfma_f32_16x16x32_bf16 v[116:119], a[76:79], v[224:227], v[116:119]
  v_and_b32 v53, 0xffff0000, v53
  v_and_b32 v59, 0xffff0000, v59
  v_mfma_f32_16x16x32_bf16 v[116:119], a[92:95], v[228:231], v[116:119]
  v_mul_f32 v26, v26, v27
  v_mul_f32 v53, v53, v59
  v_mfma_f32_16x16x32_bf16 v[116:119], a[108:111], v[232:235], v[116:119]
  buffer_load_dwordx4 v[220:223], v2, s[20:23], s77 offen offset:3072 sc1
  v_mfma_f32_16x16x32_bf16 v[116:119], a[124:127], v[236:239], v[116:119]
  s_waitcnt vmcnt(25)
  v_add_u32 v2, 4096, v2
  v_and_b32 v2, 0x3fff, v2
  v_mfma_f32_16x16x32_bf16 v[72:75], a[64:67], v[128:131], v[72:75]
  v_cvt_pk_bf16_f32 v59, v26, v53
  v_mfma_f32_16x16x32_bf16 v[72:75], a[80:83], v[132:135], v[72:75]
  s_mov_b32 s27, 4096
  v_mfma_f32_16x16x32_bf16 v[72:75], a[96:99], v[136:139], v[72:75]
  buffer_store_dword v59, v24, s[8:11], s27 offen offset:2048
  v_mfma_f32_16x16x32_bf16 v[72:75], a[112:115], v[140:143], v[72:75]
  v_lshlrev_b32 v26, 16, v50
  v_lshlrev_b32 v27, 16, v60
  v_mfma_f32_16x16x32_bf16 v[88:91], a[68:71], v[128:131], v[88:91]
  v_and_b32 v50, 0xffff0000, v50
  v_and_b32 v60, 0xffff0000, v60
  v_mfma_f32_16x16x32_bf16 v[88:91], a[84:87], v[132:135], v[88:91]
  v_mul_f32 v26, v26, v27
  v_mul_f32 v50, v50, v60
  v_mfma_f32_16x16x32_bf16 v[88:91], a[100:103], v[136:139], v[88:91]
  v_cvt_pk_bf16_f32 v60, v26, v50
  v_mfma_f32_16x16x32_bf16 v[88:91], a[116:119], v[140:143], v[88:91]
  s_mov_b32 s27, 8192
  v_mfma_f32_16x16x32_bf16 v[104:107], a[72:75], v[128:131], v[104:107]
  buffer_store_dword v60, v24, s[8:11], s27 offen offset:0
  v_mfma_f32_16x16x32_bf16 v[104:107], a[88:91], v[132:135], v[104:107]
  v_lshlrev_b32 v26, 16, v54
  v_lshlrev_b32 v27, 16, v61
  v_mfma_f32_16x16x32_bf16 v[104:107], a[104:107], v[136:139], v[104:107]
  v_and_b32 v54, 0xffff0000, v54
  v_and_b32 v61, 0xffff0000, v61
  v_mfma_f32_16x16x32_bf16 v[104:107], a[120:123], v[140:143], v[104:107]
  v_mul_f32 v26, v26, v27
  v_mul_f32 v54, v54, v61
  v_mfma_f32_16x16x32_bf16 v[120:123], a[76:79], v[128:131], v[120:123]
  v_cvt_pk_bf16_f32 v61, v26, v54
  v_mfma_f32_16x16x32_bf16 v[120:123], a[92:95], v[132:135], v[120:123]
  s_mov_b32 s27, 8192
  v_mfma_f32_16x16x32_bf16 v[120:123], a[108:111], v[136:139], v[120:123]
  buffer_store_dword v61, v24, s[8:11], s27 offen offset:2048
  v_mfma_f32_16x16x32_bf16 v[120:123], a[124:127], v[140:143], v[120:123]
  s_waitcnt vmcnt(24)
  v_lshlrev_b32 v26, 16, v51
  v_lshlrev_b32 v27, 16, v62
  v_mfma_f32_16x16x32_bf16 v[32:35], a[64:67], v[144:147], v[32:35]
  v_and_b32 v51, 0xffff0000, v51
  v_and_b32 v62, 0xffff0000, v62
  v_mfma_f32_16x16x32_bf16 v[32:35], a[80:83], v[148:151], v[32:35]
  v_mul_f32 v26, v26, v27
  v_mul_f32 v51, v51, v62
  v_mfma_f32_16x16x32_bf16 v[32:35], a[96:99], v[152:155], v[32:35]
  v_cvt_pk_bf16_f32 v62, v26, v51
  v_mfma_f32_16x16x32_bf16 v[32:35], a[112:115], v[156:159], v[32:35]
  s_mov_b32 s27, 12288
  v_mfma_f32_16x16x32_bf16 v[36:39], a[68:71], v[144:147], v[36:39]
  buffer_store_dword v62, v24, s[8:11], s27 offen offset:0
  v_mfma_f32_16x16x32_bf16 v[36:39], a[84:87], v[148:151], v[36:39]
  v_lshlrev_b32 v26, 16, v55
  v_lshlrev_b32 v27, 16, v63
  v_mfma_f32_16x16x32_bf16 v[36:39], a[100:103], v[152:155], v[36:39]
  v_and_b32 v55, 0xffff0000, v55
  v_and_b32 v63, 0xffff0000, v63
  v_mfma_f32_16x16x32_bf16 v[36:39], a[116:119], v[156:159], v[36:39]
  v_mul_f32 v26, v26, v27
  v_mul_f32 v55, v55, v63
  v_mfma_f32_16x16x32_bf16 v[40:43], a[72:75], v[144:147], v[40:43]
  v_cvt_pk_bf16_f32 v63, v26, v55
  v_mfma_f32_16x16x32_bf16 v[40:43], a[88:91], v[148:151], v[40:43]
  s_waitcnt vmcnt(11)
  v_xor_b32 v6, s92, v6
  v_cmp_lt_u32 vcc, 15, v6
  v_mfma_f32_16x16x32_bf16 v[40:43], a[104:107], v[152:155], v[40:43]
  s_mov_b32 s27, 12288
  v_mfma_f32_16x16x32_bf16 v[40:43], a[120:123], v[156:159], v[40:43]
  s_cbranch_vccnz pspin
pspin_ok:
  v_mfma_f32_16x16x32_bf16 v[44:47], a[76:79], v[144:147], v[44:47]
  buffer_load_dwordx4 v[76:79], v12, s[20:23], s82 offen offset:0 sc1
  v_mfma_f32_16x16x32_bf16 v[44:47], a[92:95], v[148:151], v[44:47]
  buffer_load_dwordx4 v[92:95], v12, s[20:23], s82 offen offset:1024 sc1
  v_mfma_f32_16x16x32_bf16 v[44:47], a[108:111], v[152:155], v[44:47]
  buffer_load_dwordx4 v[108:111], v12, s[20:23], s82 offen offset:2048 sc1
  v_mfma_f32_16x16x32_bf16 v[44:47], a[124:127], v[156:159], v[44:47]
  v_mfma_f32_16x16x32_bf16 v[64:67], a[128:131], v[160:163], v[64:67]
  buffer_load_dwordx4 v[124:127], v12, s[20:23], s82 offen offset:3072 sc1
  v_mfma_f32_16x16x32_bf16 v[64:67], a[144:147], v[164:167], v[64:67]
  buffer_store_dword v63, v24, s[8:11], s27 offen offset:2048
  v_mfma_f32_16x16x32_bf16 v[64:67], a[160:163], v[168:171], v[64:67]
  v_mfma_f32_16x16x32_bf16 v[64:67], a[224:227], v[172:175], v[64:67]
  v_mfma_f32_16x16x32_bf16 v[80:83], a[132:135], v[160:163], v[80:83]
  v_mfma_f32_16x16x32_bf16 v[80:83], a[148:151], v[164:167], v[80:83]
  v_mfma_f32_16x16x32_bf16 v[80:83], a[164:167], v[168:171], v[80:83]
  v_mfma_f32_16x16x32_bf16 v[80:83], a[228:231], v[172:175], v[80:83]
  v_mfma_f32_16x16x32_bf16 v[96:99], a[136:139], v[160:163], v[96:99]
  v_mfma_f32_16x16x32_bf16 v[96:99], a[152:155], v[164:167], v[96:99]
  v_mfma_f32_16x16x32_bf16 v[96:99], a[168:171], v[168:171], v[96:99]
  v_mfma_f32_16x16x32_bf16 v[96:99], a[232:235], v[172:175], v[96:99]
  v_mfma_f32_16x16x32_bf16 v[112:115], a[140:143], v[160:163], v[112:115]
  ds_write_b128 v17, v[64:67] offset:0
  v_mfma_f32_16x16x32_bf16 v[112:115], a[156:159], v[164:167], v[112:115]
  v_mfma_f32_16x16x32_bf16 v[112:115], a[172:175], v[168:171], v[112:115]
  v_mfma_f32_16x16x32_bf16 v[112:115], a[236:239], v[172:175], v[112:115]
  v_mfma_f32_16x16x32_bf16 v[68:71], a[128:131], v[176:179], v[68:71]
  ds_write_b128 v17, v[80:83] offset:1024
  v_mfma_f32_16x16x32_bf16 v[68:71], a[144:147], v[180:183], v[68:71]
  v_mfma_f32_16x16x32_bf16 v[68:71], a[160:163], v[184:187], v[68:71]
  v_mfma_f32_16x16x32_bf16 v[68:71], a[224:227], v[188:191], v[68:71]
  v_mfma_f32_16x16x32_bf16 v[84:87], a[132:135], v[176:179], v[84:87]
  ds_write_b128 v17, v[96:99] offset:2048
  v_mfma_f32_16x16x32_bf16 v[84:87], a[148:151], v[180:183], v[84:87]
  v_mfma_f32_16x16x32_bf16 v[84:87], a[164:167], v[184:187], v[84:87]
  v_mfma_f32_16x16x32_bf16 v[84:87], a[228:231], v[188:191], v[84:87]
  v_mfma_f32_16x16x32_bf16 v[100:103], a[136:139], v[176:179], v[100:103]
  ds_write_b128 v17, v[112:115] offset:3072
  v_mfma_f32_16x16x32_bf16 v[100:103], a[152:155], v[180:183], v[100:103]
  v_mfma_f32_16x16x32_bf16 v[100:103], a[168:171], v[184:187], v[100:103]
  v_mfma_f32_16x16x32_bf16 v[100:103], a[232:235], v[188:191], v[100:103]
  v_mfma_f32_16x16x32_bf16 v[116:119], a[140:143], v[176:179], v[116:119]
  ds_write_b128 v17, v[68:71] offset:16384
  v_mfma_f32_16x16x32_bf16 v[116:119], a[156:159], v[180:183], v[116:119]
  v_mfma_f32_16x16x32_bf16 v[116:119], a[172:175], v[184:187], v[116:119]
  v_mfma_f32_16x16x32_bf16 v[116:119], a[236:239], v[188:191], v[116:119]
  s_waitcnt vmcnt(15)
  v_mfma_f32_16x16x32_bf16 v[72:75], a[128:131], v[192:195], v[72:75]
  ds_write_b128 v17, v[84:87] offset:17408
  v_mfma_f32_16x16x32_bf16 v[72:75], a[144:147], v[196:199], v[72:75]
  v_mfma_f32_16x16x32_bf16 v[72:75], a[160:163], v[200:203], v[72:75]
  v_mfma_f32_16x16x32_bf16 v[72:75], a[224:227], v[204:207], v[72:75]
  v_mfma_f32_16x16x32_bf16 v[88:91], a[132:135], v[192:195], v[88:91]
  ds_write_b128 v17, v[100:103] offset:18432
  v_mfma_f32_16x16x32_bf16 v[88:91], a[148:151], v[196:199], v[88:91]
  v_mfma_f32_16x16x32_bf16 v[88:91], a[164:167], v[200:203], v[88:91]
  v_mfma_f32_16x16x32_bf16 v[88:91], a[228:231], v[204:207], v[88:91]
  v_mfma_f32_16x16x32_bf16 v[104:107], a[136:139], v[192:195], v[104:107]
  ds_write_b128 v17, v[116:119] offset:19456
  v_mfma_f32_16x16x32_bf16 v[104:107], a[152:155], v[196:199], v[104:107]
  v_mfma_f32_16x16x32_bf16 v[104:107], a[168:171], v[200:203], v[104:107]
  v_mfma_f32_16x16x32_bf16 v[104:107], a[232:235], v[204:207], v[104:107]
  v_mfma_f32_16x16x32_bf16 v[120:123], a[140:143], v[192:195], v[120:123]
  ds_write_b128 v18, v[72:75] offset:0
  v_mfma_f32_16x16x32_bf16 v[120:123], a[156:159], v[196:199], v[120:123]
  v_mfma_f32_16x16x32_bf16 v[120:123], a[172:175], v[200:203], v[120:123]
  v_mfma_f32_16x16x32_bf16 v[120:123], a[236:239], v[204:207], v[120:123]
  s_waitcnt vmcnt(9)
  v_mfma_f32_16x16x32_bf16 v[32:35], a[128:131], v[208:211], v[32:35]
  ds_write_b128 v18, v[88:91] offset:1024
  v_mfma_f32_16x16x32_bf16 v[32:35], a[144:147], v[212:215], v[32:35]
  v_mfma_f32_16x16x32_bf16 v[32:35], a[160:163], v[216:219], v[32:35]
  v_mfma_f32_16x16x32_bf16 v[32:35], a[224:227], v[220:223], v[32:35]
  v_mfma_f32_16x16x32_bf16 v[36:39], a[132:135], v[208:211], v[36:39]
  ds_write_b128 v18, v[104:107] offset:2048
  v_mfma_f32_16x16x32_bf16 v[36:39], a[148:151], v[212:215], v[36:39]
  v_mfma_f32_16x16x32_bf16 v[36:39], a[164:167], v[216:219], v[36:39]
  v_mfma_f32_16x16x32_bf16 v[36:39], a[228:231], v[220:223], v[36:39]
  v_mfma_f32_16x16x32_bf16 v[40:43], a[136:139], v[208:211], v[40:43]
  ds_write_b128 v18, v[120:123] offset:3072
  v_mfma_f32_16x16x32_bf16 v[40:43], a[152:155], v[212:215], v[40:43]
  v_mfma_f32_16x16x32_bf16 v[40:43], a[168:171], v[216:219], v[40:43]
  v_mfma_f32_16x16x32_bf16 v[40:43], a[232:235], v[220:223], v[40:43]
  v_mfma_f32_16x16x32_bf16 v[44:47], a[140:143], v[208:211], v[44:47]
  v_mfma_f32_16x16x32_bf16 v[44:47], a[156:159], v[212:215], v[44:47]
  v_mfma_f32_16x16x32_bf16 v[44:47], a[172:175], v[216:219], v[44:47]
  v_mfma_f32_16x16x32_bf16 v[44:47], a[236:239], v[220:223], v[44:47]
  s_waitcnt lgkmcnt(0)
  s_barrier
  ds_read_b128 v[128:131], v7 offset:0
  ds_read_b128 v[144:147], v8 offset:16384
  ds_read_b128 v[160:163], v9 offset:0
  ds_read_b128 v[132:135], v7 offset:1024
  ds_read_b128 v[148:151], v8 offset:17408
  ds_read_b128 v[164:167], v9 offset:1024
  ds_read_b128 v[136:139], v7 offset:2048
  ds_read_b128 v[152:155], v8 offset:18432
  ds_read_b128 v[168:171], v9 offset:2048
  ds_read_b128 v[140:143], v7 offset:3072
  ds_read_b128 v[156:159], v8 offset:19456
  ds_read_b128 v[172:175], v9 offset:3072
  s_waitcnt lgkmcnt(11)
  v_pk_add_f32 v[32:33], v[32:33], v[128:129]
  s_waitcnt lgkmcnt(9)
  v_pk_add_f32 v[144:145], v[144:145], v[160:161]
  v_pk_add_f32 v[34:35], v[34:35], v[130:131]
  v_pk_add_f32 v[146:147], v[146:147], v[162:163]
  v_pk_add_f32 v[32:33], v[32:33], v[144:145]
  v_pk_add_f32 v[34:35], v[34:35], v[146:147]
  s_waitcnt vmcnt(4)
  v_pk_add_f32 v[32:33], v[32:33], v[76:77]
  v_pk_add_f32 v[34:35], v[34:35], v[78:79]
  v_cvt_pk_bf16_f32 v48, v32, v33
  v_cvt_pk_bf16_f32 v49, v34, v35
  s_waitcnt lgkmcnt(8)
  v_pk_add_f32 v[36:37], v[36:37], v[132:133]
  s_waitcnt lgkmcnt(6)
  v_pk_add_f32 v[148:149], v[148:149], v[164:165]
  v_pk_add_f32 v[38:39], v[38:39], v[134:135]
  v_pk_add_f32 v[150:151], v[150:151], v[166:167]
  v_pk_add_f32 v[36:37], v[36:37], v[148:149]
  v_pk_add_f32 v[38:39], v[38:39], v[150:151]
  s_waitcnt vmcnt(3)
  v_pk_add_f32 v[36:37], v[36:37], v[92:93]
  v_pk_add_f32 v[38:39], v[38:39], v[94:95]
  v_cvt_pk_bf16_f32 v50, v36, v37
  v_cvt_pk_bf16_f32 v51, v38, v39
  s_nop 0
  v_permlane16_swap_b32 v48, v50
  v_permlane16_swap_b32 v49, v51
  buffer_store_dwordx4 v[48:51], v10, s[8:11], s89 offen offset:0
  s_waitcnt lgkmcnt(5)
  v_pk_add_f32 v[40:41], v[40:41], v[136:137]
  s_waitcnt lgkmcnt(3)
  v_pk_add_f32 v[152:153], v[152:153], v[168:169]
  v_pk_add_f32 v[42:43], v[42:43], v[138:139]
  v_pk_add_f32 v[154:155], v[154:155], v[170:171]
  v_pk_add_f32 v[40:41], v[40:41], v[152:153]
  v_pk_add_f32 v[42:43], v[42:43], v[154:155]
  s_waitcnt vmcnt(3)
  v_pk_add_f32 v[40:41], v[40:41], v[108:109]
  v_pk_add_f32 v[42:43], v[42:43], v[110:111]
  v_cvt_pk_bf16_f32 v52, v40, v41
  v_cvt_pk_bf16_f32 v53, v42, v43
  s_waitcnt lgkmcnt(2)
  v_pk_add_f32 v[44:45], v[44:45], v[140:141]
  s_waitcnt lgkmcnt(0)
  v_pk_add_f32 v[156:157], v[156:157], v[172:173]
  v_pk_add_f32 v[46:47], v[46:47], v[142:143]
  v_pk_add_f32 v[158:159], v[158:159], v[174:175]
  v_pk_add_f32 v[44:45], v[44:45], v[156:157]
  v_pk_add_f32 v[46:47], v[46:47], v[158:159]
  s_waitcnt vmcnt(2)
  v_pk_add_f32 v[44:45], v[44:45], v[124:125]
  v_pk_add_f32 v[46:47], v[46:47], v[126:127]
  v_cvt_pk_bf16_f32 v54, v44, v45
  v_cvt_pk_bf16_f32 v55, v46, v47
  s_nop 0
  v_permlane16_swap_b32 v52, v54
  v_permlane16_swap_b32 v53, v55
  buffer_store_dwordx4 v[52:55], v10, s[8:11], s89 offen offset:64
L_exit:
  s_endpgm
low_i:
  s_cmp_lg_u32 s6, 0
  s_cbranch_scc1 m64_first
  v_mfma_f32_16x16x32_bf16 v[32:35], a[64:67], v[192:195], 0
  s_add_u32 s78, s78, 16384
  ds_read_b128 a[96:99], v3 offset:8192
  ds_read_b128 a[100:103], v3 offset:9216
  v_mfma_f32_16x16x32_bf16 v[32:35], a[68:71], v[200:203], v[32:35]
  s_cmp_eq_u32 s78, s62
  buffer_load_dwordx4 a[176:179], v28, s[20:23], s67 offen offset:0 sc1
  v_exp_f32 v61, v61
  v_mfma_f32_16x16x32_bf16 v[32:35], a[72:75], v[208:211], v[32:35]
  s_cmov_b32 s78, s79
  ds_read_b128 a[104:107], v3 offset:10240
  v_cvt_pk_bf16_f32 v58, v60, v61
  v_mfma_f32_16x16x32_bf16 v[32:35], a[76:79], v[216:219], v[32:35]
  s_cmp_eq_u32 s78, s63
  v_exp_f32 v62, v62
  v_mfma_f32_16x16x32_bf16 v[36:39], a[80:83], v[192:195], 0
  s_cmov_b32 s78, s94
  ds_read_b128 a[108:111], v3 offset:11264
  ds_read_b128 a[112:115], v3 offset:12288
  v_mfma_f32_16x16x32_bf16 v[36:39], a[84:87], v[200:203], v[36:39]
  s_mov_b32 m0, s65
  v_exp_f32 v63, v63
  v_mfma_f32_16x16x32_bf16 v[36:39], a[88:91], v[208:211], v[36:39]
  s_add_u32 s65, s65, 16384
  ds_read_b128 a[116:119], v3 offset:13312
  v_cvt_pk_bf16_f32 v59, v62, v63
  v_mfma_f32_16x16x32_bf16 v[36:39], a[92:95], v[216:219], v[36:39]
  buffer_load_dwordx4 v28, s[16:19], s78 offen offset:0 sc1 lds
  v_mfma_f32_16x16x32_bf16 v[40:43], a[64:67], v[224:227], 0
  s_add_u32 s64, s64, 16384
  ds_read_b128 a[120:123], v3 offset:14336
  ds_read_b128 a[124:127], v3 offset:15360
  v_mfma_f32_16x16x32_bf16 v[40:43], a[68:71], v[232:235], v[40:43]
  s_sub_u32 s24, s64, 163840
  buffer_load_dwordx4 a[180:183], v28, s[20:23], s67 offen offset:1024 sc1
  v_exp_f32 v32, v32
  v_mfma_f32_16x16x32_bf16 v[40:43], a[72:75], v[240:243], v[40:43]
  buffer_load_dwordx4 v28, s[16:19], s78 offen offset:1024 sc1 lds
  v_mfma_f32_16x16x32_bf16 v[40:43], a[76:79], v[248:251], v[40:43]
  s_min_u32 s64, s64, s24
  v_exp_f32 v33, v33
  v_mfma_f32_16x16x32_bf16 v[44:47], a[80:83], v[224:227], 0
  v_add_u32 v3, s64, v12
  v_cvt_pk_bf16_f32 v32, v32, v33
  v_mfma_f32_16x16x32_bf16 v[44:47], a[84:87], v[232:235], v[44:47]
  s_sub_u32 s25, s65, 163840
  v_exp_f32 v34, v34
  v_mfma_f32_16x16x32_bf16 v[44:47], a[88:91], v[240:243], v[44:47]
  buffer_load_dwordx4 v28, s[16:19], s78 offen offset:2048 sc1 lds
  v_mfma_f32_16x16x32_bf16 v[44:47], a[92:95], v[248:251], v[44:47]
  s_min_u32 s65, s65, s25
  v_exp_f32 v35, v35
  v_mfma_f32_16x16x32_bf16 v[96:99], a[128:131], v[48:51], v[96:99]
  buffer_load_dwordx4 a[184:187], v28, s[20:23], s67 offen offset:2048 sc1
  v_cvt_pk_bf16_f32 v33, v34, v35
  v_mfma_f32_16x16x32_bf16 v[196:199], a[132:135], v[48:51], v[196:199]
  v_exp_f32 v36, v36
  v_mfma_f32_16x16x32_bf16 v[100:103], a[136:139], v[48:51], v[100:103]
  ds_read_b128 a[64:67], v3 offset:0
  ds_read_b128 a[68:71], v3 offset:1024
  v_mfma_f32_16x16x32_bf16 v[204:207], a[140:143], v[48:51], v[204:207]
  v_exp_f32 v37, v37
  v_mfma_f32_16x16x32_bf16 v[104:107], a[144:147], v[48:51], v[104:107]
  ds_read_b128 a[72:75], v3 offset:2048
  v_cvt_pk_bf16_f32 v34, v36, v37
  v_mfma_f32_16x16x32_bf16 v[212:215], a[148:151], v[48:51], v[212:215]
  v_exp_f32 v38, v38
  v_mfma_f32_16x16x32_bf16 v[108:111], a[152:155], v[48:51], v[108:111]
  ds_read_b128 a[76:79], v3 offset:3072
  ds_read_b128 a[80:83], v3 offset:4096
  v_mfma_f32_16x16x32_bf16 v[220:223], a[156:159], v[48:51], v[220:223]
  v_exp_f32 v39, v39
  v_mfma_f32_16x16x32_bf16 a[168:171], a[224:227], v[48:51], a[168:171]
  ds_read_b128 a[84:87], v3 offset:5120
  v_cvt_pk_bf16_f32 v35, v38, v39
  v_mfma_f32_16x16x32_bf16 v[112:115], a[128:131], v[56:59], v[112:115]
  buffer_load_dwordx4 a[188:191], v28, s[20:23], s67 offen offset:3072 sc1
  v_exp_f32 v40, v40
  v_mfma_f32_16x16x32_bf16 v[228:231], a[132:135], v[56:59], v[228:231]
  s_add_u32 s67, s67, 16384
  ds_read_b128 a[88:91], v3 offset:6144
  ds_read_b128 a[92:95], v3 offset:7168
  v_mfma_f32_16x16x32_bf16 v[116:119], a[136:139], v[56:59], v[116:119]
  v_exp_f32 v41, v41
  v_mfma_f32_16x16x32_bf16 v[236:239], a[140:143], v[56:59], v[236:239]
  v_cvt_pk_bf16_f32 v40, v40, v41
  v_mfma_f32_16x16x32_bf16 v[120:123], a[144:147], v[56:59], v[120:123]
  v_exp_f32 v42, v42
  v_mfma_f32_16x16x32_bf16 v[244:247], a[148:151], v[56:59], v[244:247]
  buffer_load_dwordx4 v28, s[16:19], s78 offen offset:3072 sc1 lds
  v_mfma_f32_16x16x32_bf16 v[124:127], a[152:155], v[56:59], v[124:127]
  v_exp_f32 v43, v43
  v_mfma_f32_16x16x32_bf16 v[252:255], a[156:159], v[56:59], v[252:255]
  buffer_load_dwordx4 a[192:195], v28, s[20:23], s67 offen offset:0 sc1
  v_cvt_pk_bf16_f32 v41, v42, v43
  v_mfma_f32_16x16x32_bf16 a[172:175], a[224:227], v[56:59], a[172:175]
  s_waitcnt lgkmcnt(0)
  v_exp_f32 v44, v44
  v_mfma_f32_16x16x32_bf16 v[48:51], a[64:67], v[192:195], 0
  s_add_u32 s78, s78, 16384
  ds_read_b128 a[128:131], v3 offset:8192
  ds_read_b128 a[132:135], v3 offset:9216
  v_mfma_f32_16x16x32_bf16 v[48:51], a[68:71], v[200:203], v[48:51]
  s_cmp_eq_u32 s78, s62
  v_exp_f32 v45, v45
  v_mfma_f32_16x16x32_bf16 v[48:51], a[72:75], v[208:211], v[48:51]
  s_cmov_b32 s78, s79
  ds_read_b128 a[136:139], v3 offset:10240
  v_cvt_pk_bf16_f32 v42, v44, v45
  v_mfma_f32_16x16x32_bf16 v[48:51], a[76:79], v[216:219], v[48:51]
  s_cmp_eq_u32 s78, s63
  v_exp_f32 v46, v46
  v_mfma_f32_16x16x32_bf16 v[52:55], a[80:83], v[192:195], 0
  s_cmov_b32 s78, s94
  ds_read_b128 a[140:143], v3 offset:11264
  ds_read_b128 a[144:147], v3 offset:12288
  v_mfma_f32_16x16x32_bf16 v[52:55], a[84:87], v[200:203], v[52:55]
  s_mov_b32 m0, s65
  buffer_load_dwordx4 a[196:199], v28, s[20:23], s67 offen offset:1024 sc1
  v_exp_f32 v47, v47
  v_mfma_f32_16x16x32_bf16 v[52:55], a[88:91], v[208:211], v[52:55]
  s_add_u32 s65, s65, 16384
  ds_read_b128 a[148:151], v3 offset:13312
  v_cvt_pk_bf16_f32 v43, v46, v47
  v_mfma_f32_16x16x32_bf16 v[52:55], a[92:95], v[216:219], v[52:55]
  buffer_load_dwordx4 v28, s[16:19], s78 offen offset:0 sc1 lds
  v_mfma_f32_16x16x32_bf16 v[56:59], a[64:67], v[224:227], 0
  s_add_u32 s64, s64, 16384
  ds_read_b128 a[152:155], v3 offset:14336
  ds_read_b128 a[156:159], v3 offset:15360
  v_mfma_f32_16x16x32_bf16 v[56:59], a[68:71], v[232:235], v[56:59]
  s_sub_u32 s24, s64, 163840
  v_exp_f32 v48, v48
  v_mfma_f32_16x16x32_bf16 v[56:59], a[72:75], v[240:243], v[56:59]
  buffer_load_dwordx4 v28, s[16:19], s78 offen offset:1024 sc1 lds
  v_mfma_f32_16x16x32_bf16 v[56:59], a[76:79], v[248:251], v[56:59]
  s_min_u32 s64, s64, s24
  v_exp_f32 v49, v49
  v_mfma_f32_16x16x32_bf16 v[60:63], a[80:83], v[224:227], 0
  v_add_u32 v3, s64, v12
  v_cvt_pk_bf16_f32 v48, v48, v49
  v_mfma_f32_16x16x32_bf16 v[60:63], a[84:87], v[232:235], v[60:63]
  s_sub_u32 s25, s65, 163840
  buffer_load_dwordx4 a[200:203], v28, s[20:23], s67 offen offset:2048 sc1
  v_exp_f32 v50, v50
  v_mfma_f32_16x16x32_bf16 v[60:63], a[88:91], v[240:243], v[60:63]
  buffer_load_dwordx4 v28, s[16:19], s78 offen offset:2048 sc1 lds
  v_mfma_f32_16x16x32_bf16 v[60:63], a[92:95], v[248:251], v[60:63]
  s_min_u32 s65, s65, s25
  v_exp_f32 v51, v51
  v_mfma_f32_16x16x32_bf16 v[96:99], a[96:99], v[32:35], v[96:99]
  v_cvt_pk_bf16_f32 v49, v50, v51
  v_mfma_f32_16x16x32_bf16 v[196:199], a[100:103], v[32:35], v[196:199]
  v_exp_f32 v52, v52
  v_mfma_f32_16x16x32_bf16 v[100:103], a[104:107], v[32:35], v[100:103]
  ds_read_b128 a[64:67], v3 offset:0
  ds_read_b128 a[68:71], v3 offset:1024
  v_mfma_f32_16x16x32_bf16 v[204:207], a[108:111], v[32:35], v[204:207]
  v_exp_f32 v53, v53
  v_mfma_f32_16x16x32_bf16 v[104:107], a[112:115], v[32:35], v[104:107]
  ds_read_b128 a[72:75], v3 offset:2048
  v_cvt_pk_bf16_f32 v50, v52, v53
  v_mfma_f32_16x16x32_bf16 v[212:215], a[116:119], v[32:35], v[212:215]
  buffer_load_dwordx4 a[204:207], v28, s[20:23], s67 offen offset:3072 sc1
  v_exp_f32 v54, v54
  v_mfma_f32_16x16x32_bf16 v[108:111], a[120:123], v[32:35], v[108:111]
  s_add_u32 s67, s67, 16384
  ds_read_b128 a[76:79], v3 offset:3072
  ds_read_b128 a[80:83], v3 offset:4096
  v_mfma_f32_16x16x32_bf16 v[220:223], a[124:127], v[32:35], v[220:223]
  v_exp_f32 v55, v55
  v_mfma_f32_16x16x32_bf16 a[168:171], a[224:227], v[32:35], a[168:171]
  ds_read_b128 a[84:87], v3 offset:5120
  v_cvt_pk_bf16_f32 v51, v54, v55
  v_mfma_f32_16x16x32_bf16 v[112:115], a[96:99], v[40:43], v[112:115]
  v_exp_f32 v56, v56
  v_mfma_f32_16x16x32_bf16 v[228:231], a[100:103], v[40:43], v[228:231]
  ds_read_b128 a[88:91], v3 offset:6144
  ds_read_b128 a[92:95], v3 offset:7168
  v_mfma_f32_16x16x32_bf16 v[116:119], a[104:107], v[40:43], v[116:119]
  v_exp_f32 v57, v57
  v_mfma_f32_16x16x32_bf16 v[236:239], a[108:111], v[40:43], v[236:239]
  v_cvt_pk_bf16_f32 v56, v56, v57
  v_mfma_f32_16x16x32_bf16 v[120:123], a[112:115], v[40:43], v[120:123]
  buffer_load_dwordx4 a[208:211], v28, s[20:23], s67 offen offset:0 sc1
  v_exp_f32 v58, v58
  v_mfma_f32_16x16x32_bf16 v[244:247], a[116:119], v[40:43], v[244:247]
  buffer_load_dwordx4 v28, s[16:19], s78 offen offset:3072 sc1 lds
  v_mfma_f32_16x16x32_bf16 v[124:127], a[120:123], v[40:43], v[124:127]
  v_exp_f32 v59, v59
  v_mfma_f32_16x16x32_bf16 v[252:255], a[124:127], v[40:43], v[252:255]
  v_cvt_pk_bf16_f32 v57, v58, v59
  v_mfma_f32_16x16x32_bf16 a[172:175], a[224:227], v[40:43], a[172:175]
  s_waitcnt lgkmcnt(0)
  v_exp_f32 v60, v60
  v_mfma_f32_16x16x32_bf16 v[32:35], a[64:67], v[192:195], 0
  s_add_u32 s78, s78, 16384
  ds_read_b128 a[96:99], v3 offset:8192
  ds_read_b128 a[100:103], v3 offset:9216
  v_mfma_f32_16x16x32_bf16 v[32:35], a[68:71], v[200:203], v[32:35]
  s_cmp_eq_u32 s78, s62
  v_exp_f32 v61, v61
  v_mfma_f32_16x16x32_bf16 v[32:35], a[72:75], v[208:211], v[32:35]
  s_cmov_b32 s78, s79
  ds_read_b128 a[104:107], v3 offset:10240
  v_cvt_pk_bf16_f32 v58, v60, v61
  v_mfma_f32_16x16x32_bf16 v[32:35], a[76:79], v[216:219], v[32:35]
  s_cmp_eq_u32 s78, s63
  buffer_load_dwordx4 a[212:215], v28, s[20:23], s67 offen offset:1024 sc1
  v_exp_f32 v62, v62
  v_mfma_f32_16x16x32_bf16 v[36:39], a[80:83], v[192:195], 0
  s_cmov_b32 s78, s94
  ds_read_b128 a[108:111], v3 offset:11264
  ds_read_b128 a[112:115], v3 offset:12288
  v_mfma_f32_16x16x32_bf16 v[36:39], a[84:87], v[200:203], v[36:39]
  s_mov_b32 m0, s65
  v_exp_f32 v63, v63
  v_mfma_f32_16x16x32_bf16 v[36:39], a[88:91], v[208:211], v[36:39]
  s_add_u32 s65, s65, 16384
  ds_read_b128 a[116:119], v3 offset:13312
  v_cvt_pk_bf16_f32 v59, v62, v63
  v_mfma_f32_16x16x32_bf16 v[36:39], a[92:95], v[216:219], v[36:39]
  buffer_load_dwordx4 v28, s[16:19], s78 offen offset:0 sc1 lds
  v_mfma_f32_16x16x32_bf16 v[40:43], a[64:67], v[224:227], 0
  s_add_u32 s64, s64, 16384
  ds_read_b128 a[120:123], v3 offset:14336
  ds_read_b128 a[124:127], v3 offset:15360
  v_mfma_f32_16x16x32_bf16 v[40:43], a[68:71], v[232:235], v[40:43]
  s_sub_u32 s24, s64, 163840
  v_exp_f32 v32, v32
  v_mfma_f32_16x16x32_bf16 v[40:43], a[72:75], v[240:243], v[40:43]
  buffer_load_dwordx4 v28, s[16:19], s78 offen offset:1024 sc1 lds
  v_mfma_f32_16x16x32_bf16 v[40:43], a[76:79], v[248:251], v[40:43]
  s_min_u32 s64, s64, s24
  buffer_load_dwordx4 a[216:219], v28, s[20:23], s67 offen offset:2048 sc1
  v_exp_f32 v33, v33
  v_mfma_f32_16x16x32_bf16 v[44:47], a[80:83], v[224:227], 0
  v_add_u32 v3, s64, v12
  v_cvt_pk_bf16_f32 v32, v32, v33
  v_mfma_f32_16x16x32_bf16 v[44:47], a[84:87], v[232:235], v[44:47]
  s_sub_u32 s25, s65, 163840
  v_exp_f32 v34, v34
  v_mfma_f32_16x16x32_bf16 v[44:47], a[88:91], v[240:243], v[44:47]
  buffer_load_dwordx4 v28, s[16:19], s78 offen offset:2048 sc1 lds
  v_mfma_f32_16x16x32_bf16 v[44:47], a[92:95], v[248:251], v[44:47]
  s_min_u32 s65, s65, s25
  v_exp_f32 v35, v35
  v_mfma_f32_16x16x32_bf16 v[96:99], a[128:131], v[48:51], v[96:99]
  v_cvt_pk_bf16_f32 v33, v34, v35
  v_mfma_f32_16x16x32_bf16 v[196:199], a[132:135], v[48:51], v[196:199]
  v_exp_f32 v36, v36
  v_mfma_f32_16x16x32_bf16 v[100:103], a[136:139], v[48:51], v[100:103]
  ds_read_b128 a[64:67], v3 offset:0
  ds_read_b128 a[68:71], v3 offset:1024
  v_mfma_f32_16x16x32_bf16 v[204:207], a[140:143], v[48:51], v[204:207]
  buffer_load_dwordx4 a[220:223], v28, s[20:23], s67 offen offset:3072 sc1
  v_exp_f32 v37, v37
  v_mfma_f32_16x16x32_bf16 v[104:107], a[144:147], v[48:51], v[104:107]
  s_add_u32 s67, s67, 16384
  ds_read_b128 a[72:75], v3 offset:2048
  v_cvt_pk_bf16_f32 v34, v36, v37
  v_mfma_f32_16x16x32_bf16 v[212:215], a[148:151], v[48:51], v[212:215]
  v_exp_f32 v38, v38
  v_mfma_f32_16x16x32_bf16 v[108:111], a[152:155], v[48:51], v[108:111]
  ds_read_b128 a[76:79], v3 offset:3072
  ds_read_b128 a[80:83], v3 offset:4096
  v_mfma_f32_16x16x32_bf16 v[220:223], a[156:159], v[48:51], v[220:223]
  v_exp_f32 v39, v39
  v_mfma_f32_16x16x32_bf16 a[168:171], a[224:227], v[48:51], a[168:171]
  ds_read_b128 a[84:87], v3 offset:5120
  v_cvt_pk_bf16_f32 v35, v38, v39
  v_mfma_f32_16x16x32_bf16 v[112:115], a[128:131], v[56:59], v[112:115]
  v_exp_f32 v40, v40
  v_mfma_f32_16x16x32_bf16 v[228:231], a[132:135], v[56:59], v[228:231]
  ds_read_b128 a[88:91], v3 offset:6144
  ds_read_b128 a[92:95], v3 offset:7168
  v_mfma_f32_16x16x32_bf16 v[116:119], a[136:139], v[56:59], v[116:119]
  buffer_load_dwordx4 a[240:243], v28, s[20:23], s67 offen offset:0 sc1
  v_exp_f32 v41, v41
  v_mfma_f32_16x16x32_bf16 v[236:239], a[140:143], v[56:59], v[236:239]
  v_cvt_pk_bf16_f32 v40, v40, v41
  v_mfma_f32_16x16x32_bf16 v[120:123], a[144:147], v[56:59], v[120:123]
  v_exp_f32 v42, v42
  v_mfma_f32_16x16x32_bf16 v[244:247], a[148:151], v[56:59], v[244:247]
  buffer_load_dwordx4 v28, s[16:19], s78 offen offset:3072 sc1 lds
  v_mfma_f32_16x16x32_bf16 v[124:127], a[152:155], v[56:59], v[124:127]
  v_exp_f32 v43, v43
  v_mfma_f32_16x16x32_bf16 v[252:255], a[156:159], v[56:59], v[252:255]
  v_cvt_pk_bf16_f32 v41, v42, v43
  v_mfma_f32_16x16x32_bf16 a[172:175], a[224:227], v[56:59], a[172:175]
  s_waitcnt lgkmcnt(0)
  buffer_load_dwordx4 a[244:247], v28, s[20:23], s67 offen offset:1024 sc1
  v_exp_f32 v44, v44
  v_mfma_f32_16x16x32_bf16 v[48:51], a[64:67], v[192:195], 0
  s_add_u32 s78, s78, 16384
  ds_read_b128 a[128:131], v3 offset:8192
  ds_read_b128 a[132:135], v3 offset:9216
  v_mfma_f32_16x16x32_bf16 v[48:51], a[68:71], v[200:203], v[48:51]
  s_cmp_eq_u32 s78, s62
  v_exp_f32 v45, v45
  v_mfma_f32_16x16x32_bf16 v[48:51], a[72:75], v[208:211], v[48:51]
  s_cmov_b32 s78, s79
  ds_read_b128 a[136:139], v3 offset:10240
  v_cvt_pk_bf16_f32 v42, v44, v45
  v_mfma_f32_16x16x32_bf16 v[48:51], a[76:79], v[216:219], v[48:51]
  s_cmp_eq_u32 s78, s63
  v_exp_f32 v46, v46
  v_mfma_f32_16x16x32_bf16 v[52:55], a[80:83], v[192:195], 0
  s_cmov_b32 s78, s94
  ds_read_b128 a[140:143], v3 offset:11264
  ds_read_b128 a[144:147], v3 offset:12288
  v_mfma_f32_16x16x32_bf16 v[52:55], a[84:87], v[200:203], v[52:55]
  s_mov_b32 m0, s65
  v_exp_f32 v47, v47
  v_mfma_f32_16x16x32_bf16 v[52:55], a[88:91], v[208:211], v[52:55]
  s_add_u32 s65, s65, 16384
  ds_read_b128 a[148:151], v3 offset:13312
  v_cvt_pk_bf16_f32 v43, v46, v47
  v_mfma_f32_16x16x32_bf16 v[52:55], a[92:95], v[216:219], v[52:55]
  buffer_load_dwordx4 v28, s[16:19], s78 offen offset:0 sc1 lds
  v_mfma_f32_16x16x32_bf16 v[56:59], a[64:67], v[224:227], 0
  s_add_u32 s64, s64, 16384
  ds_read_b128 a[152:155], v3 offset:14336
  ds_read_b128 a[156:159], v3 offset:15360
  v_mfma_f32_16x16x32_bf16 v[56:59], a[68:71], v[232:235], v[56:59]
  s_sub_u32 s24, s64, 163840
  buffer_load_dwordx4 a[248:251], v28, s[20:23], s67 offen offset:2048 sc1
  v_exp_f32 v48, v48
  v_mfma_f32_16x16x32_bf16 v[56:59], a[72:75], v[240:243], v[56:59]
  buffer_load_dwordx4 v28, s[16:19], s78 offen offset:1024 sc1 lds
  v_mfma_f32_16x16x32_bf16 v[56:59], a[76:79], v[248:251], v[56:59]
  s_min_u32 s64, s64, s24
  v_exp_f32 v49, v49
  v_mfma_f32_16x16x32_bf16 v[60:63], a[80:83], v[224:227], 0
  v_add_u32 v3, s64, v12
  v_cvt_pk_bf16_f32 v48, v48, v49
  v_mfma_f32_16x16x32_bf16 v[60:63], a[84:87], v[232:235], v[60:63]
  s_sub_u32 s25, s65, 163840
  v_exp_f32 v50, v50
  v_mfma_f32_16x16x32_bf16 v[60:63], a[88:91], v[240:243], v[60:63]
  buffer_load_dwordx4 v28, s[16:19], s78 offen offset:2048 sc1 lds
  v_mfma_f32_16x16x32_bf16 v[60:63], a[92:95], v[248:251], v[60:63]
  s_min_u32 s65, s65, s25
  buffer_load_dwordx4 a[252:255], v28, s[20:23], s67 offen offset:3072 sc1
  v_exp_f32 v51, v51
  v_mfma_f32_16x16x32_bf16 v[96:99], a[96:99], v[32:35], v[96:99]
  s_waitcnt vmcnt(14) lgkmcnt(0)
  s_barrier
  v_cvt_pk_bf16_f32 v49, v50, v51
  v_mfma_f32_16x16x32_bf16 v[196:199], a[100:103], v[32:35], v[196:199]
  s_add_u32 s67, s67, 16384
  v_exp_f32 v52, v52
  v_mfma_f32_16x16x32_bf16 v[100:103], a[104:107], v[32:35], v[100:103]
  ds_read_b128 a[64:67], v3 offset:0
  ds_read_b128 a[68:71], v3 offset:1024
  v_mfma_f32_16x16x32_bf16 v[204:207], a[108:111], v[32:35], v[204:207]
  v_exp_f32 v53, v53
  v_mfma_f32_16x16x32_bf16 v[104:107], a[112:115], v[32:35], v[104:107]
  ds_read_b128 a[72:75], v3 offset:2048
  v_cvt_pk_bf16_f32 v50, v52, v53
  v_mfma_f32_16x16x32_bf16 v[212:215], a[116:119], v[32:35], v[212:215]
  v_exp_f32 v54, v54
  v_mfma_f32_16x16x32_bf16 v[108:111], a[120:123], v[32:35], v[108:111]
  ds_read_b128 a[76:79], v3 offset:3072
  ds_read_b128 a[80:83], v3 offset:4096
  v_mfma_f32_16x16x32_bf16 v[220:223], a[124:127], v[32:35], v[220:223]
  v_exp_f32 v55, v55
  v_mfma_f32_16x16x32_bf16 a[168:171], a[224:227], v[32:35], a[168:171]
  ds_read_b128 a[84:87], v3 offset:5120
  v_cvt_pk_bf16_f32 v51, v54, v55
  v_mfma_f32_16x16x32_bf16 v[112:115], a[96:99], v[40:43], v[112:115]
  v_exp_f32 v56, v56
  v_mfma_f32_16x16x32_bf16 v[228:231], a[100:103], v[40:43], v[228:231]
  ds_read_b128 a[88:91], v3 offset:6144
  ds_read_b128 a[92:95], v3 offset:7168
  v_mfma_f32_16x16x32_bf16 v[116:119], a[104:107], v[40:43], v[116:119]
  v_exp_f32 v57, v57
  v_mfma_f32_16x16x32_bf16 v[236:239], a[108:111], v[40:43], v[236:239]
  v_cvt_pk_bf16_f32 v56, v56, v57
  v_mfma_f32_16x16x32_bf16 v[120:123], a[112:115], v[40:43], v[120:123]
  v_exp_f32 v58, v58
  v_mfma_f32_16x16x32_bf16 v[244:247], a[116:119], v[40:43], v[244:247]
  buffer_load_dwordx4 v28, s[16:19], s78 offen offset:3072 sc1 lds
  v_mfma_f32_16x16x32_bf16 v[124:127], a[120:123], v[40:43], v[124:127]
  v_exp_f32 v59, v59
  v_mfma_f32_16x16x32_bf16 v[252:255], a[124:127], v[40:43], v[252:255]
  v_cvt_pk_bf16_f32 v57, v58, v59
  v_mfma_f32_16x16x32_bf16 a[172:175], a[224:227], v[40:43], a[172:175]
  s_waitcnt lgkmcnt(0)
  v_exp_f32 v60, v60
  v_mfma_f32_16x16x32_bf16 v[32:35], a[64:67], v[192:195], 0
  s_add_u32 s78, s78, 16384
  ds_read_b128 a[96:99], v3 offset:8192
  ds_read_b128 a[100:103], v3 offset:9216
  v_mfma_f32_16x16x32_bf16 v[32:35], a[68:71], v[200:203], v[32:35]
  s_cmp_eq_u32 s78, s62
  buffer_load_dwordx4 a[0:3], v28, s[20:23], s67 offen offset:0 sc1
  v_exp_f32 v61, v61
  v_mfma_f32_16x16x32_bf16 v[32:35], a[72:75], v[208:211], v[32:35]
  s_cmov_b32 s78, s79
  ds_read_b128 a[104:107], v3 offset:10240
  v_cvt_pk_bf16_f32 v58, v60, v61
  v_mfma_f32_16x16x32_bf16 v[32:35], a[76:79], v[216:219], v[32:35]
  s_cmp_eq_u32 s78, s63
  v_exp_f32 v62, v62
  v_mfma_f32_16x16x32_bf16 v[36:39], a[80:83], v[192:195], 0
  s_cmov_b32 s78, s94
  ds_read_b128 a[108:111], v3 offset:11264
  ds_read_b128 a[112:115], v3 offset:12288
  v_mfma_f32_16x16x32_bf16 v[36:39], a[84:87], v[200:203], v[36:39]
  s_mov_b32 m0, s65
  v_exp_f32 v63, v63
  v_mfma_f32_16x16x32_bf16 v[36:39], a[88:91], v[208:211], v[36:39]
  s_add_u32 s65, s65, 16384
  ds_read_b128 a[116:119], v3 offset:13312
  v_cvt_pk_bf16_f32 v59, v62, v63
  v_mfma_f32_16x16x32_bf16 v[36:39], a[92:95], v[216:219], v[36:39]
  buffer_load_dwordx4 v28, s[16:19], s78 offen offset:0 sc1 lds
  v_mfma_f32_16x16x32_bf16 v[40:43], a[64:67], v[224:227], 0
  s_add_u32 s64, s64, 16384
  ds_read_b128 a[120:123], v3 offset:14336
  ds_read_b128 a[124:127], v3 offset:15360
  v_mfma_f32_16x16x32_bf16 v[40:43], a[68:71], v[232:235], v[40:43]
  s_sub_u32 s24, s64, 163840
  buffer_load_dwordx4 a[4:7], v28, s[20:23], s67 offen offset:1024 sc1
  v_exp_f32 v32, v32
  v_mfma_f32_16x16x32_bf16 v[40:43], a[72:75], v[240:243], v[40:43]
  buffer_load_dwordx4 v28, s[16:19], s78 offen offset:1024 sc1 lds
  v_mfma_f32_16x16x32_bf16 v[40:43], a[76:79], v[248:251], v[40:43]
  s_min_u32 s64, s64, s24
  v_exp_f32 v33, v33
  v_mfma_f32_16x16x32_bf16 v[44:47], a[80:83], v[224:227], 0
  v_add_u32 v3, s64, v12
  v_cvt_pk_bf16_f32 v32, v32, v33
  v_mfma_f32_16x16x32_bf16 v[44:47], a[84:87], v[232:235], v[44:47]
  s_sub_u32 s25, s65, 163840
  v_exp_f32 v34, v34
  v_mfma_f32_16x16x32_bf16 v[44:47], a[88:91], v[240:243], v[44:47]
  buffer_load_dwordx4 v28, s[16:19], s78 offen offset:2048 sc1 lds
  v_mfma_f32_16x16x32_bf16 v[44:47], a[92:95], v[248:251], v[44:47]
  s_min_u32 s65, s65, s25
  v_exp_f32 v35, v35
  v_mfma_f32_16x16x32_bf16 v[96:99], a[128:131], v[48:51], v[96:99]
  buffer_load_dwordx4 a[8:11], v28, s[20:23], s67 offen offset:2048 sc1
  v_cvt_pk_bf16_f32 v33, v34, v35
  v_mfma_f32_16x16x32_bf16 v[196:199], a[132:135], v[48:51], v[196:199]
  v_exp_f32 v36, v36
  v_mfma_f32_16x16x32_bf16 v[100:103], a[136:139], v[48:51], v[100:103]
  ds_read_b128 a[64:67], v3 offset:0
  ds_read_b128 a[68:71], v3 offset:1024
  v_mfma_f32_16x16x32_bf16 v[204:207], a[140:143], v[48:51], v[204:207]
  v_exp_f32 v37, v37
  v_mfma_f32_16x16x32_bf16 v[104:107], a[144:147], v[48:51], v[104:107]
  ds_read_b128 a[72:75], v3 offset:2048
  v_cvt_pk_bf16_f32 v34, v36, v37
  v_mfma_f32_16x16x32_bf16 v[212:215], a[148:151], v[48:51], v[212:215]
  v_exp_f32 v38, v38
  v_mfma_f32_16x16x32_bf16 v[108:111], a[152:155], v[48:51], v[108:111]
  ds_read_b128 a[76:79], v3 offset:3072
  ds_read_b128 a[80:83], v3 offset:4096
  v_mfma_f32_16x16x32_bf16 v[220:223], a[156:159], v[48:51], v[220:223]
  v_exp_f32 v39, v39
  v_mfma_f32_16x16x32_bf16 a[168:171], a[224:227], v[48:51], a[168:171]
  ds_read_b128 a[84:87], v3 offset:5120
  v_cvt_pk_bf16_f32 v35, v38, v39
  v_mfma_f32_16x16x32_bf16 v[112:115], a[128:131], v[56:59], v[112:115]
  buffer_load_dwordx4 a[12:15], v28, s[20:23], s67 offen offset:3072 sc1
  v_exp_f32 v40, v40
  v_mfma_f32_16x16x32_bf16 v[228:231], a[132:135], v[56:59], v[228:231]
  s_add_u32 s67, s67, 16384
  ds_read_b128 a[88:91], v3 offset:6144
  ds_read_b128 a[92:95], v3 offset:7168
  v_mfma_f32_16x16x32_bf16 v[116:119], a[136:139], v[56:59], v[116:119]
  v_exp_f32 v41, v41
  v_mfma_f32_16x16x32_bf16 v[236:239], a[140:143], v[56:59], v[236:239]
  v_cvt_pk_bf16_f32 v40, v40, v41
  v_mfma_f32_16x16x32_bf16 v[120:123], a[144:147], v[56:59], v[120:123]
  v_exp_f32 v42, v42
  v_mfma_f32_16x16x32_bf16 v[244:247], a[148:151], v[56:59], v[244:247]
  buffer_load_dwordx4 v28, s[16:19], s78 offen offset:3072 sc1 lds
  v_mfma_f32_16x16x32_bf16 v[124:127], a[152:155], v[56:59], v[124:127]
  v_exp_f32 v43, v43
  v_mfma_f32_16x16x32_bf16 v[252:255], a[156:159], v[56:59], v[252:255]
  buffer_load_dwordx4 a[16:19], v28, s[20:23], s67 offen offset:0 sc1
  v_cvt_pk_bf16_f32 v41, v42, v43
  v_mfma_f32_16x16x32_bf16 a[172:175], a[224:227], v[56:59], a[172:175]
  s_waitcnt lgkmcnt(0)
  v_exp_f32 v44, v44
  v_mfma_f32_16x16x32_bf16 v[48:51], a[64:67], v[192:195], 0
  s_add_u32 s78, s78, 16384
  ds_read_b128 a[128:131], v3 offset:8192
  ds_read_b128 a[132:135], v3 offset:9216
  v_mfma_f32_16x16x32_bf16 v[48:51], a[68:71], v[200:203], v[48:51]
  s_cmp_eq_u32 s78, s62
  v_exp_f32 v45, v45
  v_mfma_f32_16x16x32_bf16 v[48:51], a[72:75], v[208:211], v[48:51]
  s_cmov_b32 s78, s79
  ds_read_b128 a[136:139], v3 offset:10240
  v_cvt_pk_bf16_f32 v42, v44, v45
  v_mfma_f32_16x16x32_bf16 v[48:51], a[76:79], v[216:219], v[48:51]
  s_cmp_eq_u32 s78, s63
  v_exp_f32 v46, v46
  v_mfma_f32_16x16x32_bf16 v[52:55], a[80:83], v[192:195], 0
  s_cmov_b32 s78, s94
  ds_read_b128 a[140:143], v3 offset:11264
  ds_read_b128 a[144:147], v3 offset:12288
  v_mfma_f32_16x16x32_bf16 v[52:55], a[84:87], v[200:203], v[52:55]
  s_mov_b32 m0, s65
  buffer_load_dwordx4 a[20:23], v28, s[20:23], s67 offen offset:1024 sc1
  v_exp_f32 v47, v47
  v_mfma_f32_16x16x32_bf16 v[52:55], a[88:91], v[208:211], v[52:55]
  s_add_u32 s65, s65, 16384
  ds_read_b128 a[148:151], v3 offset:13312
  v_cvt_pk_bf16_f32 v43, v46, v47
  v_mfma_f32_16x16x32_bf16 v[52:55], a[92:95], v[216:219], v[52:55]
  buffer_load_dwordx4 v28, s[16:19], s78 offen offset:0 sc1 lds
  v_mfma_f32_16x16x32_bf16 v[56:59], a[64:67], v[224:227], 0
  s_add_u32 s64, s64, 16384
  ds_read_b128 a[152:155], v3 offset:14336
  ds_read_b128 a[156:159], v3 offset:15360
  v_mfma_f32_16x16x32_bf16 v[56:59], a[68:71], v[232:235], v[56:59]
  s_sub_u32 s24, s64, 163840
  v_exp_f32 v48, v48
  v_mfma_f32_16x16x32_bf16 v[56:59], a[72:75], v[240:243], v[56:59]
  buffer_load_dwordx4 v28, s[16:19], s78 offen offset:1024 sc1 lds
  v_mfma_f32_16x16x32_bf16 v[56:59], a[76:79], v[248:251], v[56:59]
  s_min_u32 s64, s64, s24
  v_exp_f32 v49, v49
  v_mfma_f32_16x16x32_bf16 v[60:63], a[80:83], v[224:227], 0
  v_add_u32 v3, s64, v12
  v_cvt_pk_bf16_f32 v48, v48, v49
  v_mfma_f32_16x16x32_bf16 v[60:63], a[84:87], v[232:235], v[60:63]
  s_sub_u32 s25, s65, 163840
  buffer_load_dwordx4 a[24:27], v28, s[20:23], s67 offen offset:2048 sc1
  v_exp_f32 v50, v50
  v_mfma_f32_16x16x32_bf16 v[60:63], a[88:91], v[240:243], v[60:63]
  buffer_load_dwordx4 v28, s[16:19], s78 offen offset:2048 sc1 lds
  v_mfma_f32_16x16x32_bf16 v[60:63], a[92:95], v[248:251], v[60:63]
  s_min_u32 s65, s65, s25
  v_exp_f32 v51, v51
  v_mfma_f32_16x16x32_bf16 v[96:99], a[96:99], v[32:35], v[96:99]
  v_cvt_pk_bf16_f32 v49, v50, v51
  v_mfma_f32_16x16x32_bf16 v[196:199], a[100:103], v[32:35], v[196:199]
  v_exp_f32 v52, v52
  v_mfma_f32_16x16x32_bf16 v[100:103], a[104:107], v[32:35], v[100:103]
  ds_read_b128 a[64:67], v3 offset:0
  ds_read_b128 a[68:71], v3 offset:1024
  v_mfma_f32_16x16x32_bf16 v[204:207], a[108:111], v[32:35], v[204:207]
  v_exp_f32 v53, v53
  v_mfma_f32_16x16x32_bf16 v[104:107], a[112:115], v[32:35], v[104:107]
  ds_read_b128 a[72:75], v3 offset:2048
  v_cvt_pk_bf16_f32 v50, v52, v53
  v_mfma_f32_16x16x32_bf16 v[212:215], a[116:119], v[32:35], v[212:215]
  buffer_load_dwordx4 a[28:31], v28, s[20:23], s67 offen offset:3072 sc1
  v_exp_f32 v54, v54
  v_mfma_f32_16x16x32_bf16 v[108:111], a[120:123], v[32:35], v[108:111]
  s_add_u32 s67, s67, 16384
  ds_read_b128 a[76:79], v3 offset:3072
  ds_read_b128 a[80:83], v3 offset:4096
  v_mfma_f32_16x16x32_bf16 v[220:223], a[124:127], v[32:35], v[220:223]
  v_exp_f32 v55, v55
  v_mfma_f32_16x16x32_bf16 a[168:171], a[224:227], v[32:35], a[168:171]
  ds_read_b128 a[84:87], v3 offset:5120
  v_cvt_pk_bf16_f32 v51, v54, v55
  v_mfma_f32_16x16x32_bf16 v[112:115], a[96:99], v[40:43], v[112:115]
  v_exp_f32 v56, v56
  v_mfma_f32_16x16x32_bf16 v[228:231], a[100:103], v[40:43], v[228:231]
  ds_read_b128 a[88:91], v3 offset:6144
  ds_read_b128 a[92:95], v3 offset:7168
  v_mfma_f32_16x16x32_bf16 v[116:119], a[104:107], v[40:43], v[116:119]
  v_exp_f32 v57, v57
  v_mfma_f32_16x16x32_bf16 v[236:239], a[108:111], v[40:43], v[236:239]
  v_cvt_pk_bf16_f32 v56, v56, v57
  v_mfma_f32_16x16x32_bf16 v[120:123], a[112:115], v[40:43], v[120:123]
  buffer_load_dwordx4 a[32:35], v28, s[20:23], s67 offen offset:0 sc1
  v_exp_f32 v58, v58
  v_mfma_f32_16x16x32_bf16 v[244:247], a[116:119], v[40:43], v[244:247]
  buffer_load_dwordx4 v28, s[16:19], s78 offen offset:3072 sc1 lds
  v_mfma_f32_16x16x32_bf16 v[124:127], a[120:123], v[40:43], v[124:127]
  v_exp_f32 v59, v59
  v_mfma_f32_16x16x32_bf16 v[252:255], a[124:127], v[40:43], v[252:255]
  v_cvt_pk_bf16_f32 v57, v58, v59
  v_mfma_f32_16x16x32_bf16 a[172:175], a[224:227], v[40:43], a[172:175]
  s_waitcnt lgkmcnt(0)
  v_exp_f32 v60, v60
  v_mfma_f32_16x16x32_bf16 v[32:35], a[64:67], v[192:195], 0
  s_add_u32 s78, s78, 16384
  ds_read_b128 a[96:99], v3 offset:8192
  ds_read_b128 a[100:103], v3 offset:9216
  v_mfma_f32_16x16x32_bf16 v[32:35], a[68:71], v[200:203], v[32:35]
  s_cmp_eq_u32 s78, s62
  v_exp_f32 v61, v61
  v_mfma_f32_16x16x32_bf16 v[32:35], a[72:75], v[208:211], v[32:35]
  s_cmov_b32 s78, s79
  ds_read_b128 a[104:107], v3 offset:10240
  v_cvt_pk_bf16_f32 v58, v60, v61
  v_mfma_f32_16x16x32_bf16 v[32:35], a[76:79], v[216:219], v[32:35]
  s_cmp_eq_u32 s78, s63
  buffer_load_dwordx4 a[36:39], v28, s[20:23], s67 offen offset:1024 sc1
  v_exp_f32 v62, v62
  v_mfma_f32_16x16x32_bf16 v[36:39], a[80:83], v[192:195], 0
  s_cmov_b32 s78, s94
  ds_read_b128 a[108:111], v3 offset:11264
  ds_read_b128 a[112:115], v3 offset:12288
  v_mfma_f32_16x16x32_bf16 v[36:39], a[84:87], v[200:203], v[36:39]
  s_mov_b32 m0, s65
  v_exp_f32 v63, v63
  v_mfma_f32_16x16x32_bf16 v[36:39], a[88:91], v[208:211], v[36:39]
  s_add_u32 s65, s65, 16384
  ds_read_b128 a[116:119], v3 offset:13312
  v_cvt_pk_bf16_f32 v59, v62, v63
  v_mfma_f32_16x16x32_bf16 v[36:39], a[92:95], v[216:219], v[36:39]
  buffer_load_dwordx4 v28, s[16:19], s78 offen offset:0 sc1 lds
  v_mfma_f32_16x16x32_bf16 v[40:43], a[64:67], v[224:227], 0
  s_add_u32 s64, s64, 16384
  ds_read_b128 a[120:123], v3 offset:14336
  ds_read_b128 a[124:127], v3 offset:15360
  v_mfma_f32_16x16x32_bf16 v[40:43], a[68:71], v[232:235], v[40:43]
  s_sub_u32 s24, s64, 163840
  v_exp_f32 v32, v32
  v_mfma_f32_16x16x32_bf16 v[40:43], a[72:75], v[240:243], v[40:43]
  buffer_load_dwordx4 v28, s[16:19], s78 offen offset:1024 sc1 lds
  v_mfma_f32_16x16x32_bf16 v[40:43], a[76:79], v[248:251], v[40:43]
  s_min_u32 s64, s64, s24
  buffer_load_dwordx4 a[40:43], v28, s[20:23], s67 offen offset:2048 sc1
  v_exp_f32 v33, v33
  v_mfma_f32_16x16x32_bf16 v[44:47], a[80:83], v[224:227], 0
  v_add_u32 v3, s64, v12
  v_cvt_pk_bf16_f32 v32, v32, v33
  v_mfma_f32_16x16x32_bf16 v[44:47], a[84:87], v[232:235], v[44:47]
  s_sub_u32 s25, s65, 163840
  v_exp_f32 v34, v34
  v_mfma_f32_16x16x32_bf16 v[44:47], a[88:91], v[240:243], v[44:47]
  buffer_load_dwordx4 v28, s[16:19], s78 offen offset:2048 sc1 lds
  v_mfma_f32_16x16x32_bf16 v[44:47], a[92:95], v[248:251], v[44:47]
  s_min_u32 s65, s65, s25
  v_exp_f32 v35, v35
  v_mfma_f32_16x16x32_bf16 v[96:99], a[128:131], v[48:51], v[96:99]
  v_cvt_pk_bf16_f32 v33, v34, v35
  v_mfma_f32_16x16x32_bf16 v[196:199], a[132:135], v[48:51], v[196:199]
  v_exp_f32 v36, v36
  v_mfma_f32_16x16x32_bf16 v[100:103], a[136:139], v[48:51], v[100:103]
  ds_read_b128 a[64:67], v3 offset:0
  ds_read_b128 a[68:71], v3 offset:1024
  v_mfma_f32_16x16x32_bf16 v[204:207], a[140:143], v[48:51], v[204:207]
  buffer_load_dwordx4 a[44:47], v28, s[20:23], s67 offen offset:3072 sc1
  v_exp_f32 v37, v37
  v_mfma_f32_16x16x32_bf16 v[104:107], a[144:147], v[48:51], v[104:107]
  s_add_u32 s67, s67, 16384
  ds_read_b128 a[72:75], v3 offset:2048
  v_cvt_pk_bf16_f32 v34, v36, v37
  v_mfma_f32_16x16x32_bf16 v[212:215], a[148:151], v[48:51], v[212:215]
  v_exp_f32 v38, v38
  v_mfma_f32_16x16x32_bf16 v[108:111], a[152:155], v[48:51], v[108:111]
  ds_read_b128 a[76:79], v3 offset:3072
  ds_read_b128 a[80:83], v3 offset:4096
  v_mfma_f32_16x16x32_bf16 v[220:223], a[156:159], v[48:51], v[220:223]
  v_exp_f32 v39, v39
  v_mfma_f32_16x16x32_bf16 a[168:171], a[224:227], v[48:51], a[168:171]
  ds_read_b128 a[84:87], v3 offset:5120
  v_cvt_pk_bf16_f32 v35, v38, v39
  v_mfma_f32_16x16x32_bf16 v[112:115], a[128:131], v[56:59], v[112:115]
  v_exp_f32 v40, v40
  v_mfma_f32_16x16x32_bf16 v[228:231], a[132:135], v[56:59], v[228:231]
  ds_read_b128 a[88:91], v3 offset:6144
  ds_read_b128 a[92:95], v3 offset:7168
  v_mfma_f32_16x16x32_bf16 v[116:119], a[136:139], v[56:59], v[116:119]
  buffer_load_dwordx4 a[48:51], v28, s[20:23], s67 offen offset:0 sc1
  v_exp_f32 v41, v41
  v_mfma_f32_16x16x32_bf16 v[236:239], a[140:143], v[56:59], v[236:239]
  v_cvt_pk_bf16_f32 v40, v40, v41
  v_mfma_f32_16x16x32_bf16 v[120:123], a[144:147], v[56:59], v[120:123]
  v_exp_f32 v42, v42
  v_mfma_f32_16x16x32_bf16 v[244:247], a[148:151], v[56:59], v[244:247]
  buffer_load_dwordx4 v28, s[16:19], s78 offen offset:3072 sc1 lds
  v_mfma_f32_16x16x32_bf16 v[124:127], a[152:155], v[56:59], v[124:127]
  v_exp_f32 v43, v43
  v_mfma_f32_16x16x32_bf16 v[252:255], a[156:159], v[56:59], v[252:255]
  v_cvt_pk_bf16_f32 v41, v42, v43
  v_mfma_f32_16x16x32_bf16 a[172:175], a[224:227], v[56:59], a[172:175]
  s_waitcnt lgkmcnt(0)
  buffer_load_dwordx4 a[52:55], v28, s[20:23], s67 offen offset:1024 sc1
  v_exp_f32 v44, v44
  v_mfma_f32_16x16x32_bf16 v[48:51], a[64:67], v[192:195], 0
  s_add_u32 s78, s78, 16384
  ds_read_b128 a[128:131], v3 offset:8192
  ds_read_b128 a[132:135], v3 offset:9216
  v_mfma_f32_16x16x32_bf16 v[48:51], a[68:71], v[200:203], v[48:51]
  s_cmp_eq_u32 s78, s62
  v_exp_f32 v45, v45
  v_mfma_f32_16x16x32_bf16 v[48:51], a[72:75], v[208:211], v[48:51]
  s_cmov_b32 s78, s79
  ds_read_b128 a[136:139], v3 offset:10240
  v_cvt_pk_bf16_f32 v42, v44, v45
  v_mfma_f32_16x16x32_bf16 v[48:51], a[76:79], v[216:219], v[48:51]
  s_cmp_eq_u32 s78, s63
  v_exp_f32 v46, v46
  v_mfma_f32_16x16x32_bf16 v[52:55], a[80:83], v[192:195], 0
  s_cmov_b32 s78, s94
  ds_read_b128 a[140:143], v3 offset:11264
  ds_read_b128 a[144:147], v3 offset:12288
  v_mfma_f32_16x16x32_bf16 v[52:55], a[84:87], v[200:203], v[52:55]
  s_mov_b32 m0, s65
  v_exp_f32 v47, v47
  v_mfma_f32_16x16x32_bf16 v[52:55], a[88:91], v[208:211], v[52:55]
  s_add_u32 s65, s65, 16384
  ds_read_b128 a[148:151], v3 offset:13312
  v_cvt_pk_bf16_f32 v43, v46, v47
  v_mfma_f32_16x16x32_bf16 v[52:55], a[92:95], v[216:219], v[52:55]
  buffer_load_dwordx4 v28, s[16:19], s78 offen offset:0 sc1 lds
  v_mfma_f32_16x16x32_bf16 v[56:59], a[64:67], v[224:227], 0
  s_add_u32 s64, s64, 16384
  ds_read_b128 a[152:155], v3 offset:14336
  ds_read_b128 a[156:159], v3 offset:15360
  v_mfma_f32_16x16x32_bf16 v[56:59], a[68:71], v[232:235], v[56:59]
  s_sub_u32 s24, s64, 163840
  buffer_load_dwordx4 a[56:59], v28, s[20:23], s67 offen offset:2048 sc1
  v_exp_f32 v48, v48
  v_mfma_f32_16x16x32_bf16 v[56:59], a[72:75], v[240:243], v[56:59]
  buffer_load_dwordx4 v28, s[16:19], s78 offen offset:1024 sc1 lds
  v_mfma_f32_16x16x32_bf16 v[56:59], a[76:79], v[248:251], v[56:59]
  s_min_u32 s64, s64, s24
  v_exp_f32 v49, v49
  v_mfma_f32_16x16x32_bf16 v[60:63], a[80:83], v[224:227], 0
  v_add_u32 v3, s64, v12
  v_cvt_pk_bf16_f32 v48, v48, v49
  v_mfma_f32_16x16x32_bf16 v[60:63], a[84:87], v[232:235], v[60:63]
  s_sub_u32 s25, s65, 163840
  v_exp_f32 v50, v50
  v_mfma_f32_16x16x32_bf16 v[60:63], a[88:91], v[240:243], v[60:63]
  buffer_load_dwordx4 v28, s[16:19], s78 offen offset:2048 sc1 lds
  v_mfma_f32_16x16x32_bf16 v[60:63], a[92:95], v[248:251], v[60:63]
  s_min_u32 s65, s65, s25
  buffer_load_dwordx4 a[60:63], v28, s[20:23], s67 offen offset:3072 sc1
  v_exp_f32 v51, v51
  v_mfma_f32_16x16x32_bf16 v[96:99], a[96:99], v[32:35], v[96:99]
  s_waitcnt vmcnt(14) lgkmcnt(0)
  s_barrier
  v_cvt_pk_bf16_f32 v49, v50, v51
  v_mfma_f32_16x16x32_bf16 v[196:199], a[100:103], v[32:35], v[196:199]
  s_add_u32 s67, s67, 16384
  v_exp_f32 v52, v52
  v_mfma_f32_16x16x32_bf16 v[100:103], a[104:107], v[32:35], v[100:103]
  ds_read_b128 a[64:67], v3 offset:0
  ds_read_b128 a[68:71], v3 offset:1024
  v_mfma_f32_16x16x32_bf16 v[204:207], a[108:111], v[32:35], v[204:207]
  v_exp_f32 v53, v53
  v_mfma_f32_16x16x32_bf16 v[104:107], a[112:115], v[32:35], v[104:107]
  ds_read_b128 a[72:75], v3 offset:2048
  v_cvt_pk_bf16_f32 v50, v52, v53
  v_mfma_f32_16x16x32_bf16 v[212:215], a[116:119], v[32:35], v[212:215]
  v_exp_f32 v54, v54
  v_mfma_f32_16x16x32_bf16 v[108:111], a[120:123], v[32:35], v[108:111]
  ds_read_b128 a[76:79], v3 offset:3072
  ds_read_b128 a[80:83], v3 offset:4096
  v_mfma_f32_16x16x32_bf16 v[220:223], a[124:127], v[32:35], v[220:223]
  v_exp_f32 v55, v55
  v_mfma_f32_16x16x32_bf16 a[168:171], a[224:227], v[32:35], a[168:171]
  ds_read_b128 a[84:87], v3 offset:5120
  v_cvt_pk_bf16_f32 v51, v54, v55
  v_mfma_f32_16x16x32_bf16 v[112:115], a[96:99], v[40:43], v[112:115]
  v_exp_f32 v56, v56
  v_mfma_f32_16x16x32_bf16 v[228:231], a[100:103], v[40:43], v[228:231]
  ds_read_b128 a[88:91], v3 offset:6144
  ds_read_b128 a[92:95], v3 offset:7168
  v_mfma_f32_16x16x32_bf16 v[116:119], a[104:107], v[40:43], v[116:119]
  v_exp_f32 v57, v57
  v_mfma_f32_16x16x32_bf16 v[236:239], a[108:111], v[40:43], v[236:239]
  v_cvt_pk_bf16_f32 v56, v56, v57
  v_mfma_f32_16x16x32_bf16 v[120:123], a[112:115], v[40:43], v[120:123]
  v_exp_f32 v58, v58
  v_mfma_f32_16x16x32_bf16 v[244:247], a[116:119], v[40:43], v[244:247]
  buffer_load_dwordx4 v28, s[16:19], s78 offen offset:3072 sc1 lds
  v_mfma_f32_16x16x32_bf16 v[124:127], a[120:123], v[40:43], v[124:127]
  v_exp_f32 v59, v59
  v_mfma_f32_16x16x32_bf16 v[252:255], a[124:127], v[40:43], v[252:255]
  v_cvt_pk_bf16_f32 v57, v58, v59
  v_mfma_f32_16x16x32_bf16 a[172:175], a[224:227], v[40:43], a[172:175]
  s_waitcnt lgkmcnt(0)
  v_exp_f32 v60, v60
  s_mov_b32 s81, 2
  s_branch m64_done
low_i2:
  s_cmp_lg_u32 s66, 0
  s_cbranch_scc1 m64
  s_branch m64_done
slow:
  s_lshl_b32 s24, s6, 2
  s_add_u32 s24, s24, s4
  s_lshl_b32 s27, s24, 14
  s_mov_b32 s28, 0
  v_mov_b32 v24, v20
  v_mov_b32 v25, v20
  v_mov_b32 v64, 0
  v_mov_b32 v65, 0
  v_mov_b32 v66, 0
  v_mov_b32 v67, 0
  v_mov_b32 v132, 0
  v_mov_b32 v133, 0
  v_mov_b32 v134, 0
  v_mov_b32 v135, 0
  v_mov_b32 v68, 0
  v_mov_b32 v69, 0
  v_mov_b32 v70, 0
  v_mov_b32 v71, 0
  v_mov_b32 v140, 0
  v_mov_b32 v141, 0
  v_mov_b32 v142, 0
  v_mov_b32 v143, 0
  v_mov_b32 v72, 0
  v_mov_b32 v73, 0
  v_mov_b32 v74, 0
  v_mov_b32 v75, 0
  v_mov_b32 v148, 0
  v_mov_b32 v149, 0
  v_mov_b32 v150, 0
  v_mov_b32 v151, 0
  v_mov_b32 v76, 0
  v_mov_b32 v77, 0
  v_mov_b32 v78, 0
  v_mov_b32 v79, 0
  v_mov_b32 v156, 0
  v_mov_b32 v157, 0
  v_mov_b32 v158, 0
  v_mov_b32 v159, 0
  v_accvgpr_write_b32 a160, 0
  v_accvgpr_write_b32 a161, 0
  v_accvgpr_write_b32 a162, 0
  v_accvgpr_write_b32 a163, 0
  v_mov_b32 v80, 0
  v_mov_b32 v81, 0
  v_mov_b32 v82, 0
  v_mov_b32 v83, 0
  v_mov_b32 v164, 0
  v_mov_b32 v165, 0
  v_mov_b32 v166, 0
  v_mov_b32 v167, 0
  v_mov_b32 v84, 0
  v_mov_b32 v85, 0
  v_mov_b32 v86, 0
  v_mov_b32 v87, 0
  v_mov_b32 v172, 0
  v_mov_b32 v173, 0
  v_mov_b32 v174, 0
  v_mov_b32 v175, 0
  v_mov_b32 v88, 0
  v_mov_b32 v89, 0
  v_mov_b32 v90, 0
  v_mov_b32 v91, 0
  v_mov_b32 v180, 0
  v_mov_b32 v181, 0
  v_mov_b32 v182, 0
  v_mov_b32 v183, 0
  v_mov_b32 v92, 0
  v_mov_b32 v93, 0
  v_mov_b32 v94, 0
  v_mov_b32 v95, 0
  v_mov_b32 v188, 0
  v_mov_b32 v189, 0
  v_mov_b32 v190, 0
  v_mov_b32 v191, 0
  v_accvgpr_write_b32 a164, 0
  v_accvgpr_write_b32 a165, 0
  v_accvgpr_write_b32 a166, 0
  v_accvgpr_write_b32 a167, 0
slow0_pass:
  s_mov_b32 s26, 0
  v_mov_b32 v48, 0
  v_mov_b32 v49, 0
  v_mov_b32 v50, 0
  v_mov_b32 v51, 0
  v_mov_b32 v52, 0
  v_mov_b32 v53, 0
  v_mov_b32 v54, 0
  v_mov_b32 v55, 0
  v_mov_b32 v56, 0
  v_mov_b32 v57, 0
  v_mov_b32 v58, 0
  v_mov_b32 v59, 0
  v_mov_b32 v60, 0
  v_mov_b32 v61, 0
  v_mov_b32 v62, 0
  v_mov_b32 v63, 0
slow0_loop:
  s_add_u32 s25, s26, 0
  buffer_load_dwordx4 a[64:67], v12, s[16:19], s25 offen offset:0 sc1
  s_add_u32 s25, s26, 0
  buffer_load_dwordx4 a[68:71], v12, s[16:19], s25 offen offset:1024 sc1
  s_add_u32 s25, s26, 0
  buffer_load_dwordx4 a[72:75], v12, s[16:19], s25 offen offset:2048 sc1
  s_add_u32 s25, s26, 0
  buffer_load_dwordx4 a[76:79], v12, s[16:19], s25 offen offset:3072 sc1
  s_add_u32 s25, s26, 4096
  buffer_load_dwordx4 a[80:83], v12, s[16:19], s25 offen offset:0 sc1
  s_add_u32 s25, s26, 4096
  buffer_load_dwordx4 a[84:87], v12, s[16:19], s25 offen offset:1024 sc1
  s_add_u32 s25, s26, 4096
  buffer_load_dwordx4 a[88:91], v12, s[16:19], s25 offen offset:2048 sc1
  s_add_u32 s25, s26, 4096
  buffer_load_dwordx4 a[92:95], v12, s[16:19], s25 offen offset:3072 sc1
  s_add_u32 s25, s26, 8192
  buffer_load_dwordx4 a[96:99], v12, s[16:19], s25 offen offset:0 sc1
  s_add_u32 s25, s26, 8192
  buffer_load_dwordx4 a[100:103], v12, s[16:19], s25 offen offset:1024 sc1
  s_add_u32 s25, s26, 8192
  buffer_load_dwordx4 a[104:107], v12, s[16:19], s25 offen offset:2048 sc1
  s_add_u32 s25, s26, 8192
  buffer_load_dwordx4 a[108:111], v12, s[16:19], s25 offen offset:3072 sc1
  s_add_u32 s25, s26, 12288
  buffer_load_dwordx4 a[112:115], v12, s[16:19], s25 offen offset:0 sc1
  s_add_u32 s25, s26, 12288
  buffer_load_dwordx4 a[116:119], v12, s[16:19], s25 offen offset:1024 sc1
  s_add_u32 s25, s26, 12288
  buffer_load_dwordx4 a[120:123], v12, s[16:19], s25 offen offset:2048 sc1
  s_add_u32 s25, s26, 12288
  buffer_load_dwordx4 a[124:127], v12, s[16:19], s25 offen offset:3072 sc1
  s_cmp_lg_u32 s26, s27
  s_cbranch_scc1 slow0_nomask
  v_mov_b32 v48, v16
  v_mov_b32 v52, v20
  v_mov_b32 v60, v16
  v_mov_b32 v49, v17
  v_mov_b32 v53, v20
  v_mov_b32 v61, v17
  v_mov_b32 v50, v18
  v_mov_b32 v54, v20
  v_mov_b32 v62, v18
  v_mov_b32 v51, v19
  v_mov_b32 v55, v20
  v_mov_b32 v63, v19
slow0_nomask:
  s_waitcnt vmcnt(0)
  s_nop 1
  v_mfma_f32_16x16x32_bf16 v[32:35], a[64:67], v[128:131], v[48:51]
  v_mfma_f32_16x16x32_bf16 v[32:35], a[68:71], v[136:139], v[32:35]
  v_mfma_f32_16x16x32_bf16 v[32:35], a[72:75], v[144:147], v[32:35]
  v_mfma_f32_16x16x32_bf16 v[32:35], a[76:79], v[152:155], v[32:35]
  v_mfma_f32_16x16x32_bf16 v[36:39], a[80:83], v[128:131], v[52:55]
  v_mfma_f32_16x16x32_bf16 v[36:39], a[84:87], v[136:139], v[36:39]
  v_mfma_f32_16x16x32_bf16 v[36:39], a[88:91], v[144:147], v[36:39]
  v_mfma_f32_16x16x32_bf16 v[36:39], a[92:95], v[152:155], v[36:39]
  v_mfma_f32_16x16x32_bf16 v[40:43], a[64:67], v[160:163], v[56:59]
  v_mfma_f32_16x16x32_bf16 v[40:43], a[68:71], v[168:171], v[40:43]
  v_mfma_f32_16x16x32_bf16 v[40:43], a[72:75], v[176:179], v[40:43]
  v_mfma_f32_16x16x32_bf16 v[40:43], a[76:79], v[184:187], v[40:43]
  v_mfma_f32_16x16x32_bf16 v[44:47], a[80:83], v[160:163], v[60:63]
  v_mfma_f32_16x16x32_bf16 v[44:47], a[84:87], v[168:171], v[44:47]
  v_mfma_f32_16x16x32_bf16 v[44:47], a[88:91], v[176:179], v[44:47]
  v_mfma_f32_16x16x32_bf16 v[44:47], a[92:95], v[184:187], v[44:47]
  s_nop 7
  s_cmp_lg_u32 s28, 0
  s_cbranch_scc1 slow0_p2
  v_max_f32 v24, v24, v32
  v_max_f32 v24, v24, v33
  v_max_f32 v24, v24, v34
  v_max_f32 v24, v24, v35
  v_max_f32 v24, v24, v36
  v_max_f32 v24, v24, v37
  v_max_f32 v24, v24, v38
  v_max_f32 v24, v24, v39
  v_max_f32 v25, v25, v40
  v_max_f32 v25, v25, v41
  v_max_f32 v25, v25, v42
  v_max_f32 v25, v25, v43
  v_max_f32 v25, v25, v44
  v_max_f32 v25, v25, v45
  v_max_f32 v25, v25, v46
  v_max_f32 v25, v25, v47
  s_branch slow0_next
slow0_p2:
  v_sub_f32 v32, v32, v24
  v_sub_f32 v33, v33, v24
  v_sub_f32 v34, v34, v24
  v_sub_f32 v35, v35, v24
  v_sub_f32 v36, v36, v24
  v_sub_f32 v37, v37, v24
  v_sub_f32 v38, v38, v24
  v_sub_f32 v39, v39, v24
  v_sub_f32 v40, v40, v25
  v_sub_f32 v41, v41, v25
  v_sub_f32 v42, v42, v25
  v_sub_f32 v43, v43, v25
  v_sub_f32 v44, v44, v25
  v_sub_f32 v45, v45, v25
  v_sub_f32 v46, v46, v25
  v_sub_f32 v47, v47, v25
  v_exp_f32 v32, v32
  v_exp_f32 v33, v33
  v_exp_f32 v34, v34
  v_exp_f32 v35, v35
  v_exp_f32 v36, v36
  v_exp_f32 v37, v37
  v_exp_f32 v38, v38
  v_exp_f32 v39, v39
  v_exp_f32 v40, v40
  v_exp_f32 v41, v41
  v_exp_f32 v42, v42
  v_exp_f32 v43, v43
  v_exp_f32 v44, v44
  v_exp_f32 v45, v45
  v_exp_f32 v46, v46
  v_exp_f32 v47, v47
  v_cvt_pk_bf16_f32 v32, v32, v33
  v_cvt_pk_bf16_f32 v33, v34, v35
  v_cvt_pk_bf16_f32 v34, v36, v37
  v_cvt_pk_bf16_f32 v35, v38, v39
  v_cvt_pk_bf16_f32 v40, v40, v41
  v_cvt_pk_bf16_f32 v41, v42, v43
  v_cvt_pk_bf16_f32 v42, v44, v45
  v_cvt_pk_bf16_f32 v43, v46, v47
  v_mfma_f32_16x16x32_bf16 v[64:67], a[96:99], v[32:35], v[64:67]
  v_mfma_f32_16x16x32_bf16 v[132:135], a[100:103], v[32:35], v[132:135]
  v_mfma_f32_16x16x32_bf16 v[68:71], a[104:107], v[32:35], v[68:71]
  v_mfma_f32_16x16x32_bf16 v[140:143], a[108:111], v[32:35], v[140:143]
  v_mfma_f32_16x16x32_bf16 v[72:75], a[112:115], v[32:35], v[72:75]
  v_mfma_f32_16x16x32_bf16 v[148:151], a[116:119], v[32:35], v[148:151]
  v_mfma_f32_16x16x32_bf16 v[76:79], a[120:123], v[32:35], v[76:79]
  v_mfma_f32_16x16x32_bf16 v[156:159], a[124:127], v[32:35], v[156:159]
  v_mfma_f32_16x16x32_bf16 a[160:163], a[224:227], v[32:35], a[160:163]
  v_mfma_f32_16x16x32_bf16 v[80:83], a[96:99], v[40:43], v[80:83]
  v_mfma_f32_16x16x32_bf16 v[164:167], a[100:103], v[40:43], v[164:167]
  v_mfma_f32_16x16x32_bf16 v[84:87], a[104:107], v[40:43], v[84:87]
  v_mfma_f32_16x16x32_bf16 v[172:175], a[108:111], v[40:43], v[172:175]
  v_mfma_f32_16x16x32_bf16 v[88:91], a[112:115], v[40:43], v[88:91]
  v_mfma_f32_16x16x32_bf16 v[180:183], a[116:119], v[40:43], v[180:183]
  v_mfma_f32_16x16x32_bf16 v[92:95], a[120:123], v[40:43], v[92:95]
  v_mfma_f32_16x16x32_bf16 v[188:191], a[124:127], v[40:43], v[188:191]
  v_mfma_f32_16x16x32_bf16 a[164:167], a[224:227], v[40:43], a[164:167]
  s_nop 7
slow0_next:
  s_add_u32 s26, s26, 16384
  s_cmp_le_u32 s26, s27
  s_cbranch_scc1 slow0_loop
  s_cmp_lg_u32 s28, 0
  s_cbranch_scc1 slow0_done
  v_xor_b32 v26, 16, v0
  v_lshlrev_b32 v26, 2, v26
  v_xor_b32 v27, 32, v0
  v_lshlrev_b32 v27, 2, v27
  ds_bpermute_b32 v30, v26, v24
  s_waitcnt lgkmcnt(0)
  v_max_f32 v24, v24, v30
  ds_bpermute_b32 v30, v27, v24
  s_waitcnt lgkmcnt(0)
  v_max_f32 v24, v24, v30
  ds_bpermute_b32 v30, v26, v25
  s_waitcnt lgkmcnt(0)
  v_max_f32 v25, v25, v30
  ds_bpermute_b32 v30, v27, v25
  s_waitcnt lgkmcnt(0)
  v_max_f32 v25, v25, v30
  s_mov_b32 s28, 1
  s_branch slow0_pass
slow0_done:
  v_accvgpr_read_b32 v24, a160
  v_accvgpr_read_b32 v25, a164
  v_rcp_f32 v26, v25
  v_rcp_f32 v24, v24
  s_add_u32 s24, s52, 131072
  v_mov_b32 v25, v24
  v_mov_b32 v27, v26
  v_pk_mul_f32 v[64:65], v[64:65], v[24:25]
  v_pk_mul_f32 v[66:67], v[66:67], v[24:25]
  v_pk_mul_f32 v[132:133], v[132:133], v[24:25]
  v_pk_mul_f32 v[134:135], v[134:135], v[24:25]
  v_cvt_pk_bf16_f32 v64, v64, v65
  v_cvt_pk_bf16_f32 v65, v66, v67
  v_cvt_pk_bf16_f32 v66, v132, v133
  v_cvt_pk_bf16_f32 v67, v134, v135
  buffer_store_dwordx4 v[64:67], v12, s[20:23], s52 offen offset:0 sc1
  v_pk_mul_f32 v[68:69], v[68:69], v[24:25]
  v_pk_mul_f32 v[70:71], v[70:71], v[24:25]
  v_pk_mul_f32 v[140:141], v[140:141], v[24:25]
  v_pk_mul_f32 v[142:143], v[142:143], v[24:25]
  v_cvt_pk_bf16_f32 v68, v68, v69
  v_cvt_pk_bf16_f32 v69, v70, v71
  v_cvt_pk_bf16_f32 v70, v140, v141
  v_cvt_pk_bf16_f32 v71, v142, v143
  buffer_store_dwordx4 v[68:71], v12, s[20:23], s52 offen offset:1024 sc1
  v_pk_mul_f32 v[72:73], v[72:73], v[24:25]
  v_pk_mul_f32 v[74:75], v[74:75], v[24:25]
  v_pk_mul_f32 v[148:149], v[148:149], v[24:25]
  v_pk_mul_f32 v[150:151], v[150:151], v[24:25]
  v_cvt_pk_bf16_f32 v72, v72, v73
  v_cvt_pk_bf16_f32 v73, v74, v75
  v_cvt_pk_bf16_f32 v74, v148, v149
  v_cvt_pk_bf16_f32 v75, v150, v151
  buffer_store_dwordx4 v[72:75], v12, s[20:23], s52 offen offset:2048 sc1
  v_pk_mul_f32 v[76:77], v[76:77], v[24:25]
  v_pk_mul_f32 v[78:79], v[78:79], v[24:25]
  v_pk_mul_f32 v[156:157], v[156:157], v[24:25]
  v_pk_mul_f32 v[158:159], v[158:159], v[24:25]
  v_cvt_pk_bf16_f32 v76, v76, v77
  v_cvt_pk_bf16_f32 v77, v78, v79
  v_cvt_pk_bf16_f32 v78, v156, v157
  v_cvt_pk_bf16_f32 v79, v158, v159
  buffer_store_dwordx4 v[76:79], v12, s[20:23], s52 offen offset:3072 sc1
  v_pk_mul_f32 v[80:81], v[80:81], v[26:27]
  v_pk_mul_f32 v[82:83], v[82:83], v[26:27]
  v_pk_mul_f32 v[164:165], v[164:165], v[26:27]
  v_pk_mul_f32 v[166:167], v[166:167], v[26:27]
  v_cvt_pk_bf16_f32 v80, v80, v81
  v_cvt_pk_bf16_f32 v81, v82, v83
  v_cvt_pk_bf16_f32 v82, v164, v165
  v_cvt_pk_bf16_f32 v83, v166, v167
  buffer_store_dwordx4 v[80:83], v12, s[20:23], s24 offen offset:0 sc1
  v_pk_mul_f32 v[84:85], v[84:85], v[26:27]
  v_pk_mul_f32 v[86:87], v[86:87], v[26:27]
  v_pk_mul_f32 v[172:173], v[172:173], v[26:27]
  v_pk_mul_f32 v[174:175], v[174:175], v[26:27]
  v_cvt_pk_bf16_f32 v84, v84, v85
  v_cvt_pk_bf16_f32 v85, v86, v87
  v_cvt_pk_bf16_f32 v86, v172, v173
  v_cvt_pk_bf16_f32 v87, v174, v175
  buffer_store_dwordx4 v[84:87], v12, s[20:23], s24 offen offset:1024 sc1
  v_pk_mul_f32 v[88:89], v[88:89], v[26:27]
  v_pk_mul_f32 v[90:91], v[90:91], v[26:27]
  v_pk_mul_f32 v[180:181], v[180:181], v[26:27]
  v_pk_mul_f32 v[182:183], v[182:183], v[26:27]
  v_cvt_pk_bf16_f32 v88, v88, v89
  v_cvt_pk_bf16_f32 v89, v90, v91
  v_cvt_pk_bf16_f32 v90, v180, v181
  v_cvt_pk_bf16_f32 v91, v182, v183
  buffer_store_dwordx4 v[88:91], v12, s[20:23], s24 offen offset:2048 sc1
  v_pk_mul_f32 v[92:93], v[92:93], v[26:27]
  v_pk_mul_f32 v[94:95], v[94:95], v[26:27]
  v_pk_mul_f32 v[188:189], v[188:189], v[26:27]
  v_pk_mul_f32 v[190:191], v[190:191], v[26:27]
  v_cvt_pk_bf16_f32 v92, v92, v93
  v_cvt_pk_bf16_f32 v93, v94, v95
  v_cvt_pk_bf16_f32 v94, v188, v189
  v_cvt_pk_bf16_f32 v95, v190, v191
  buffer_store_dwordx4 v[92:95], v12, s[20:23], s24 offen offset:3072 sc1
  s_lshl_b32 s24, s6, 2
  s_add_u32 s24, s24, s4
  s_sub_u32 s24, 63, s24
  s_lshl_b32 s27, s24, 14
  s_mov_b32 s28, 0
  v_mov_b32 v24, v20
  v_mov_b32 v25, v20
  v_mov_b32 v96, 0
  v_mov_b32 v97, 0
  v_mov_b32 v98, 0
  v_mov_b32 v99, 0
  v_mov_b32 v196, 0
  v_mov_b32 v197, 0
  v_mov_b32 v198, 0
  v_mov_b32 v199, 0
  v_mov_b32 v100, 0
  v_mov_b32 v101, 0
  v_mov_b32 v102, 0
  v_mov_b32 v103, 0
  v_mov_b32 v204, 0
  v_mov_b32 v205, 0
  v_mov_b32 v206, 0
  v_mov_b32 v207, 0
  v_mov_b32 v104, 0
  v_mov_b32 v105, 0
  v_mov_b32 v106, 0
  v_mov_b32 v107, 0
  v_mov_b32 v212, 0
  v_mov_b32 v213, 0
  v_mov_b32 v214, 0
  v_mov_b32 v215, 0
  v_mov_b32 v108, 0
  v_mov_b32 v109, 0
  v_mov_b32 v110, 0
  v_mov_b32 v111, 0
  v_mov_b32 v220, 0
  v_mov_b32 v221, 0
  v_mov_b32 v222, 0
  v_mov_b32 v223, 0
  v_accvgpr_write_b32 a168, 0
  v_accvgpr_write_b32 a169, 0
  v_accvgpr_write_b32 a170, 0
  v_accvgpr_write_b32 a171, 0
  v_mov_b32 v112, 0
  v_mov_b32 v113, 0
  v_mov_b32 v114, 0
  v_mov_b32 v115, 0
  v_mov_b32 v228, 0
  v_mov_b32 v229, 0
  v_mov_b32 v230, 0
  v_mov_b32 v231, 0
  v_mov_b32 v116, 0
  v_mov_b32 v117, 0
  v_mov_b32 v118, 0
  v_mov_b32 v119, 0
  v_mov_b32 v236, 0
  v_mov_b32 v237, 0
  v_mov_b32 v238, 0
  v_mov_b32 v239, 0
  v_mov_b32 v120, 0
  v_mov_b32 v121, 0
  v_mov_b32 v122, 0
  v_mov_b32 v123, 0
  v_mov_b32 v244, 0
  v_mov_b32 v245, 0
  v_mov_b32 v246, 0
  v_mov_b32 v247, 0
  v_mov_b32 v124, 0
  v_mov_b32 v125, 0
  v_mov_b32 v126, 0
  v_mov_b32 v127, 0
  v_mov_b32 v252, 0
  v_mov_b32 v253, 0
  v_mov_b32 v254, 0
  v_mov_b32 v255, 0
  v_accvgpr_write_b32 a172, 0
  v_accvgpr_write_b32 a173, 0
  v_accvgpr_write_b32 a174, 0
  v_accvgpr_write_b32 a175, 0
slow1_pass:
  s_mov_b32 s26, 0
  v_mov_b32 v48, 0
  v_mov_b32 v49, 0
  v_mov_b32 v50, 0
  v_mov_b32 v51, 0
  v_mov_b32 v52, 0
  v_mov_b32 v53, 0
  v_mov_b32 v54, 0
  v_mov_b32 v55, 0
  v_mov_b32 v56, 0
  v_mov_b32 v57, 0
  v_mov_b32 v58, 0
  v_mov_b32 v59, 0
  v_mov_b32 v60, 0
  v_mov_b32 v61, 0
  v_mov_b32 v62, 0
  v_mov_b32 v63, 0
slow1_loop:
  s_add_u32 s25, s26, 0
  buffer_load_dwordx4 a[64:67], v12, s[16:19], s25 offen offset:0 sc1
  s_add_u32 s25, s26, 0
  buffer_load_dwordx4 a[68:71], v12, s[16:19], s25 offen offset:1024 sc1
  s_add_u32 s25, s26, 0
  buffer_load_dwordx4 a[72:75], v12, s[16:19], s25 offen offset:2048 sc1
  s_add_u32 s25, s26, 0
  buffer_load_dwordx4 a[76:79], v12, s[16:19], s25 offen offset:3072 sc1
  s_add_u32 s25, s26, 4096
  buffer_load_dwordx4 a[80:83], v12, s[16:19], s25 offen offset:0 sc1
  s_add_u32 s25, s26, 4096
  buffer_load_dwordx4 a[84:87], v12, s[16:19], s25 offen offset:1024 sc1
  s_add_u32 s25, s26, 4096
  buffer_load_dwordx4 a[88:91], v12, s[16:19], s25 offen offset:2048 sc1
  s_add_u32 s25, s26, 4096
  buffer_load_dwordx4 a[92:95], v12, s[16:19], s25 offen offset:3072 sc1
  s_add_u32 s25, s26, 8192
  buffer_load_dwordx4 a[96:99], v12, s[16:19], s25 offen offset:0 sc1
  s_add_u32 s25, s26, 8192
  buffer_load_dwordx4 a[100:103], v12, s[16:19], s25 offen offset:1024 sc1
  s_add_u32 s25, s26, 8192
  buffer_load_dwordx4 a[104:107], v12, s[16:19], s25 offen offset:2048 sc1
  s_add_u32 s25, s26, 8192
  buffer_load_dwordx4 a[108:111], v12, s[16:19], s25 offen offset:3072 sc1
  s_add_u32 s25, s26, 12288
  buffer_load_dwordx4 a[112:115], v12, s[16:19], s25 offen offset:0 sc1
  s_add_u32 s25, s26, 12288
  buffer_load_dwordx4 a[116:119], v12, s[16:19], s25 offen offset:1024 sc1
  s_add_u32 s25, s26, 12288
  buffer_load_dwordx4 a[120:123], v12, s[16:19], s25 offen offset:2048 sc1
  s_add_u32 s25, s26, 12288
  buffer_load_dwordx4 a[124:127], v12, s[16:19], s25 offen offset:3072 sc1
  s_cmp_lg_u32 s26, s27
  s_cbranch_scc1 slow1_nomask
  v_mov_b32 v48, v16
  v_mov_b32 v52, v20
  v_mov_b32 v60, v16
  v_mov_b32 v49, v17
  v_mov_b32 v53, v20
  v_mov_b32 v61, v17
  v_mov_b32 v50, v18
  v_mov_b32 v54, v20
  v_mov_b32 v62, v18
  v_mov_b32 v51, v19
  v_mov_b32 v55, v20
  v_mov_b32 v63, v19
slow1_nomask:
  s_waitcnt vmcnt(0)
  s_nop 1
  v_mfma_f32_16x16x32_bf16 v[32:35], a[64:67], v[192:195], v[48:51]
  v_mfma_f32_16x16x32_bf16 v[32:35], a[68:71], v[200:203], v[32:35]
  v_mfma_f32_16x16x32_bf16 v[32:35], a[72:75], v[208:211], v[32:35]
  v_mfma_f32_16x16x32_bf16 v[32:35], a[76:79], v[216:219], v[32:35]
  v_mfma_f32_16x16x32_bf16 v[36:39], a[80:83], v[192:195], v[52:55]
  v_mfma_f32_16x16x32_bf16 v[36:39], a[84:87], v[200:203], v[36:39]
  v_mfma_f32_16x16x32_bf16 v[36:39], a[88:91], v[208:211], v[36:39]
  v_mfma_f32_16x16x32_bf16 v[36:39], a[92:95], v[216:219], v[36:39]
  v_mfma_f32_16x16x32_bf16 v[40:43], a[64:67], v[224:227], v[56:59]
  v_mfma_f32_16x16x32_bf16 v[40:43], a[68:71], v[232:235], v[40:43]
  v_mfma_f32_16x16x32_bf16 v[40:43], a[72:75], v[240:243], v[40:43]
  v_mfma_f32_16x16x32_bf16 v[40:43], a[76:79], v[248:251], v[40:43]
  v_mfma_f32_16x16x32_bf16 v[44:47], a[80:83], v[224:227], v[60:63]
  v_mfma_f32_16x16x32_bf16 v[44:47], a[84:87], v[232:235], v[44:47]
  v_mfma_f32_16x16x32_bf16 v[44:47], a[88:91], v[240:243], v[44:47]
  v_mfma_f32_16x16x32_bf16 v[44:47], a[92:95], v[248:251], v[44:47]
  s_nop 7
  s_cmp_lg_u32 s28, 0
  s_cbranch_scc1 slow1_p2
  v_max_f32 v24, v24, v32
  v_max_f32 v24, v24, v33
  v_max_f32 v24, v24, v34
  v_max_f32 v24, v24, v35
  v_max_f32 v24, v24, v36
  v_max_f32 v24, v24, v37
  v_max_f32 v24, v24, v38
  v_max_f32 v24, v24, v39
  v_max_f32 v25, v25, v40
  v_max_f32 v25, v25, v41
  v_max_f32 v25, v25, v42
  v_max_f32 v25, v25, v43
  v_max_f32 v25, v25, v44
  v_max_f32 v25, v25, v45
  v_max_f32 v25, v25, v46
  v_max_f32 v25, v25, v47
  s_branch slow1_next
slow1_p2:
  v_sub_f32 v32, v32, v24
  v_sub_f32 v33, v33, v24
  v_sub_f32 v34, v34, v24
  v_sub_f32 v35, v35, v24
  v_sub_f32 v36, v36, v24
  v_sub_f32 v37, v37, v24
  v_sub_f32 v38, v38, v24
  v_sub_f32 v39, v39, v24
  v_sub_f32 v40, v40, v25
  v_sub_f32 v41, v41, v25
  v_sub_f32 v42, v42, v25
  v_sub_f32 v43, v43, v25
  v_sub_f32 v44, v44, v25
  v_sub_f32 v45, v45, v25
  v_sub_f32 v46, v46, v25
  v_sub_f32 v47, v47, v25
  v_exp_f32 v32, v32
  v_exp_f32 v33, v33
  v_exp_f32 v34, v34
  v_exp_f32 v35, v35
  v_exp_f32 v36, v36
  v_exp_f32 v37, v37
  v_exp_f32 v38, v38
  v_exp_f32 v39, v39
  v_exp_f32 v40, v40
  v_exp_f32 v41, v41
  v_exp_f32 v42, v42
  v_exp_f32 v43, v43
  v_exp_f32 v44, v44
  v_exp_f32 v45, v45
  v_exp_f32 v46, v46
  v_exp_f32 v47, v47
  v_cvt_pk_bf16_f32 v32, v32, v33
  v_cvt_pk_bf16_f32 v33, v34, v35
  v_cvt_pk_bf16_f32 v34, v36, v37
  v_cvt_pk_bf16_f32 v35, v38, v39
  v_cvt_pk_bf16_f32 v40, v40, v41
  v_cvt_pk_bf16_f32 v41, v42, v43
  v_cvt_pk_bf16_f32 v42, v44, v45
  v_cvt_pk_bf16_f32 v43, v46, v47
  v_mfma_f32_16x16x32_bf16 v[96:99], a[96:99], v[32:35], v[96:99]
  v_mfma_f32_16x16x32_bf16 v[196:199], a[100:103], v[32:35], v[196:199]
  v_mfma_f32_16x16x32_bf16 v[100:103], a[104:107], v[32:35], v[100:103]
  v_mfma_f32_16x16x32_bf16 v[204:207], a[108:111], v[32:35], v[204:207]
  v_mfma_f32_16x16x32_bf16 v[104:107], a[112:115], v[32:35], v[104:107]
  v_mfma_f32_16x16x32_bf16 v[212:215], a[116:119], v[32:35], v[212:215]
  v_mfma_f32_16x16x32_bf16 v[108:111], a[120:123], v[32:35], v[108:111]
  v_mfma_f32_16x16x32_bf16 v[220:223], a[124:127], v[32:35], v[220:223]
  v_mfma_f32_16x16x32_bf16 a[168:171], a[224:227], v[32:35], a[168:171]
  v_mfma_f32_16x16x32_bf16 v[112:115], a[96:99], v[40:43], v[112:115]
  v_mfma_f32_16x16x32_bf16 v[228:231], a[100:103], v[40:43], v[228:231]
  v_mfma_f32_16x16x32_bf16 v[116:119], a[104:107], v[40:43], v[116:119]
  v_mfma_f32_16x16x32_bf16 v[236:239], a[108:111], v[40:43], v[236:239]
  v_mfma_f32_16x16x32_bf16 v[120:123], a[112:115], v[40:43], v[120:123]
  v_mfma_f32_16x16x32_bf16 v[244:247], a[116:119], v[40:43], v[244:247]
  v_mfma_f32_16x16x32_bf16 v[124:127], a[120:123], v[40:43], v[124:127]
  v_mfma_f32_16x16x32_bf16 v[252:255], a[124:127], v[40:43], v[252:255]
  v_mfma_f32_16x16x32_bf16 a[172:175], a[224:227], v[40:43], a[172:175]
  s_nop 7
slow1_next:
  s_add_u32 s26, s26, 16384
  s_cmp_le_u32 s26, s27
  s_cbranch_scc1 slow1_loop
  s_cmp_lg_u32 s28, 0
  s_cbranch_scc1 slow1_done
  v_xor_b32 v26, 16, v0
  v_lshlrev_b32 v26, 2, v26
  v_xor_b32 v27, 32, v0
  v_lshlrev_b32 v27, 2, v27
  ds_bpermute_b32 v30, v26, v24
  s_waitcnt lgkmcnt(0)
  v_max_f32 v24, v24, v30
  ds_bpermute_b32 v30, v27, v24
  s_waitcnt lgkmcnt(0)
  v_max_f32 v24, v24, v30
  ds_bpermute_b32 v30, v26, v25
  s_waitcnt lgkmcnt(0)
  v_max_f32 v25, v25, v30
  ds_bpermute_b32 v30, v27, v25
  s_waitcnt lgkmcnt(0)
  v_max_f32 v25, v25, v30
  s_mov_b32 s28, 1
  s_branch slow1_pass
slow1_done:
  v_accvgpr_read_b32 v24, a168
  v_accvgpr_read_b32 v25, a172
  s_branch epi
spin0:
  s_mov_b32 s31, 0
spin0_a:
  s_sleep 2
  v_and_b32 v6, 7, v0
  v_lshlrev_b32 v6, 9, v6
  s_andn2_b32 s26, s93, 0xe00
  s_add_u32 s26, s26, 32768
  buffer_load_dword v6, v6, s[20:23], s26 offen sc1
  s_waitcnt vmcnt(0)
  v_xor_b32 v6, s92, v6
  v_cmp_lt_u32 vcc, 15, v6
  s_add_u32 s31, s31, 1
  s_cmp_gt_u32 s31, 2000000
  s_cbranch_scc1 spun0
  s_cbranch_vccnz spin0_a
  s_branch spun0
spin1:
  s_mov_b32 s31, 0
spin1_a:
  s_sleep 2
  v_and_b32 v6, 7, v0
  v_lshlrev_b32 v6, 9, v6
  s_andn2_b32 s26, s93, 0xe00
  s_add_u32 s26, s26, 32768
  buffer_load_dword v6, v6, s[20:23], s26 offen sc1
  s_waitcnt vmcnt(0)
  v_xor_b32 v6, s92, v6
  v_cmp_lt_u32 vcc, 15, v6
  s_add_u32 s31, s31, 1
  s_cmp_gt_u32 s31, 2000000
  s_cbranch_scc1 spun1
  s_cbranch_vccnz spin1_a
  s_branch spun1
spin2:
  s_mov_b32 s31, 0
spin2_a:
  s_sleep 2
  v_and_b32 v6, 7, v0
  v_lshlrev_b32 v6, 9, v6
  s_andn2_b32 s26, s93, 0xe00
  s_add_u32 s26, s26, 32768
  buffer_load_dword v6, v6, s[20:23], s26 offen sc1
  s_waitcnt vmcnt(0)
  v_xor_b32 v6, s92, v6
  v_cmp_lt_u32 vcc, 15, v6
  s_add_u32 s31, s31, 1
  s_cmp_gt_u32 s31, 2000000
  s_cbranch_scc1 spun2
  s_cbranch_vccnz spin2_a
  s_branch spun2
spin3:
  s_mov_b32 s31, 0
spin3_a:
  s_sleep 2
  v_and_b32 v6, 7, v0
  v_lshlrev_b32 v6, 9, v6
  s_andn2_b32 s26, s93, 0xe00
  s_add_u32 s26, s26, 32768
  buffer_load_dword v6, v6, s[20:23], s26 offen sc1
  s_waitcnt vmcnt(0)
  v_xor_b32 v6, s92, v6
  v_cmp_lt_u32 vcc, 15, v6
  s_add_u32 s31, s31, 1
  s_cmp_gt_u32 s31, 2000000
  s_cbranch_scc1 spun3
  s_cbranch_vccnz spin3_a
  s_branch spun3
m64_hook:
  s_mov_b32 s31, 0
  s_cmp_eq_u32 s81, 5
  s_cbranch_scc1 m64_chk
  s_cmp_eq_u32 s81, 4
  s_cbranch_scc1 m64_four
  buffer_load_dword v8, v13, s[8:11], 0 offen
  s_mov_b32 s8, s40
  s_mov_b32 s9, s41
  buffer_load_dword v9, v13, s[8:11], 0 offen
  s_branch m64_back
m64_four:
  s_mov_b32 s26, 59834368
  buffer_load_dword v6, v15, s[20:23], s26 offen sc1
  s_branch m64_back
m64_again:
  s_sleep 2
  s_mov_b32 s26, 59834368
  s_waitcnt vmcnt(0)
  buffer_load_dword v6, v15, s[20:23], s26 offen sc1
  s_waitcnt vmcnt(0)
m64_chk:
  v_xor_b32 v6, s92, v6
  v_cmp_lt_u32 vcc, 15, v6
  s_add_u32 s31, s31, 1
  s_cmp_gt_u32 s31, 2000000
  s_cbranch_scc1 m64_back
  s_cbranch_vccnz m64_again
  s_branch m64_back
m32_hook:
  s_mov_b32 s31, 0
  s_cmp_eq_u32 s81, 5
  s_cbranch_scc1 m32_chk
  s_mov_b32 s26, 59834368
  buffer_load_dword v6, v15, s[20:23], s26 offen sc1
  s_branch m32_back
m32_again:
  s_sleep 2
  s_mov_b32 s26, 59834368
  s_waitcnt vmcnt(0)
  buffer_load_dword v6, v15, s[20:23], s26 offen sc1
  s_waitcnt vmcnt(0)
m32_chk:
  v_xor_b32 v6, s92, v6
  v_cmp_lt_u32 vcc, 15, v6
  s_add_u32 s31, s31, 1
  s_cmp_gt_u32 s31, 2000000
  s_cbranch_scc1 m32_back
  s_cbranch_vccnz m32_again
  s_branch m32_back
cspin:
  s_mov_b32 s29, 0
cspin_a:
  s_lshl_b32 s26, s82, 13
  s_add_u32 s26, s26, s91
  buffer_load_dword v6, v5, s[20:23], s26 offen sc1
  s_waitcnt vmcnt(0)
  v_xor_b32 v6, s92, v6
  v_cmp_lt_u32 vcc, 15, v6
  s_add_u32 s29, s29, 1
  s_cmp_gt_u32 s29, 2000000
  s_cbranch_scc1 cspin_ok
  s_cbranch_vccnz cspin_a
  s_branch cspin_ok
cspin2:
  s_mov_b32 s29, 0
cspin2_a:
  s_lshl_b32 s26, s73, 13
  s_add_u32 s26, s26, s91
  buffer_load_dword v6, v5, s[20:23], s26 offen sc1
  s_waitcnt vmcnt(0)
  v_xor_b32 v6, s92, v6
  v_cmp_lt_u32 vcc, 15, v6
  s_add_u32 s29, s29, 1
  s_cmp_gt_u32 s29, 2000000
  s_cbranch_scc1 cspin2_ok
  s_cbranch_vccnz cspin2_a
  s_branch cspin2_ok
pspin:
  s_mov_b32 s29, 0
pspin_a:
  s_xor_b32 s26, s88, 16384
  buffer_load_dword v6, off, s[20:23], s26 sc1
  s_waitcnt vmcnt(0)
  v_xor_b32 v6, s92, v6
  v_cmp_lt_u32 vcc, 15, v6
  s_add_u32 s29, s29, 1
  s_cmp_gt_u32 s29, 2000000
  s_cbranch_scc1 pspin_ok
  s_cbranch_vccnz pspin_a
  s_branch pspin_ok
wspin:
  s_mov_b32 s29, 0
wspin_a:
  s_mov_b32 s26, 60293120
  buffer_load_dword v6, v14, s[20:23], s26 offen sc1
  s_waitcnt vmcnt(0)
  v_xor_b32 v6, s92, v6
  v_cmp_lt_u32 vcc, 15, v6
  s_add_u32 s29, s29, 1
  s_cmp_gt_u32 s29, 2000000
  s_cbranch_scc1 wspin_ok
  s_cbranch_vccnz wspin_a
  s_cmp_lt_u32 s6, 4
  s_branch wspin_ok
nspin:
  s_mov_b32 s29, 0
nspin_a:
  s_sleep 2
  buffer_load_dword v30, off, s[16:19], 0 sc1
  s_waitcnt vmcnt(0)
  v_readfirstlane_b32 s92, v30
  s_add_u32 s29, s29, 1
  s_cmp_gt_u32 s29, 2000000
  s_cbranch_scc1 nspun
  s_cmp_eq_u32 s92, 0
  s_cbranch_scc1 nspin_a
  s_branch nspun
xspin:
  s_mov_b32 s25, 0
xspin_a:
  s_sleep 2
  v_lshlrev_b32 v27, 5, v29
  s_andn2_b32 s26, s93, 0xf80
  buffer_load_dword v27, v27, s[20:23], s26 offen sc1
  s_waitcnt vmcnt(0)
  v_xor_b32 v27, s92, v27
  v_cmp_lt_u32 vcc, 15, v27
  s_add_u32 s25, s25, 1
  s_cmp_gt_u32 s25, 2000000
  s_cbranch_scc1 xspin_b
  s_cbranch_vccnz xspin_a
xspin_b:
  v_cmp_ne_u32 vcc, 0, v27
  s_nop 1
  s_cbranch_vccz xspun
  s_mov_b32 s80, 1
  s_branch xspun
xwb:
  buffer_wbl2 sc1
  s_waitcnt vmcnt(0)
  s_branch xwb_ok
zspin:
  s_mov_b32 s29, 0
zspin_a:
  s_sleep 2
  v_and_b32 v26, 7, v0
  v_lshlrev_b32 v26, 7, v26
  s_lshl_b32 s28, s7, 2
  s_add_u32 s28, s28, s4
  s_lshl_b32 s28, s28, 10
  s_add_u32 s28, s28, 59867136
  buffer_load_dword v26, v26, s[20:23], s28 offen sc1
  s_waitcnt vmcnt(0)
  v_xor_b32 v26, s92, v26
  v_cmp_lt_u32 vcc, 15, v26
  s_add_u32 s29, s29, 1
  s_cmp_gt_u32 s29, 2000000
  s_cbranch_scc1 zspun
  s_cbranch_vccnz zspin_a
  s_branch zspun
L_end:
.section .rodata,"a"
.p2align 6
.amdhsa_kernel concat_heads__ssm_conv_h3__compressed_kv_cla__prompt_kernel
  .amdhsa_next_free_vgpr 512
  .amdhsa_next_free_sgpr 102
  .amdhsa_accum_offset 256
  .amdhsa_group_segment_fixed_size 0
  .amdhsa_kernarg_size 120
  .amdhsa_user_sgpr_count 2
  .amdhsa_user_sgpr_kernarg_segment_ptr 1
  .amdhsa_system_sgpr_workgroup_id_x 1
  .amdhsa_float_denorm_mode_32 3
.end_amdhsa_kernel
```
